```python
import torch

def _softmax(x, axis=-1):
    return torch.softmax(x, dim=axis)

def _gelu(x):
    return torch.nn.functional.gelu(x, approximate='tanh')

def _silu(x):
    return torch.nn.functional.silu(x)

def _sigmoid(x):
    return torch.sigmoid(x)

def _layernorm(x, axis=-1, eps=1e-05):
    m = x.mean(dim=axis, keepdim=True)
    v = x.var(dim=axis, keepdim=True, unbiased=False)
    return (x - m) / torch.sqrt(v + eps)

def _scatter_add(tgt, idx, src, axis=0):
    return tgt.clone().index_add_(axis, idx, src)

def _segment_sum(src, seg, n):
    out = torch.zeros((n,) + src.shape[1:], dtype=src.dtype)
    return out.index_add_(0, seg, src)

def _pad(x, pw):
    flat = tuple((v for pair in reversed(pw) for v in pair))
    return torch.nn.functional.pad(x, flat)
kernel_name = 'sequential_preLN__memory_aug_recurrent_mem_tr__glu_gated_bilinear__prompt'

def setup_inputs():

    _w = lambda a: (lambda t: t.to(torch.bfloat16) if t.is_floating_point() else t)(torch.as_tensor(a))

    def _A_setup():
        B, S, Dm = (1, 2048, 512)
        H, Dh = (32, 128)
        M, seg = (8, 32)
        seg = min(seg, S)
        S = S // seg * seg
        return {'x': _w((lambda *s: torch.randn(*s, dtype=torch.bfloat16) * 0.05)(B, S, Dm)), 'mem0': _w((lambda *s: torch.randn(*s, dtype=torch.bfloat16) * 0.2)(B, M, Dm)), 'Wq': _w((lambda *s: torch.randn(*s, dtype=torch.bfloat16) * 1.6)(Dm, H, Dh) * Dm ** (-0.5)), 'Wk': _w((lambda *s: torch.randn(*s, dtype=torch.bfloat16) * 1.6)(Dm, H, Dh) * Dm ** (-0.5)), 'Wv': _w((lambda *s: torch.randn(*s, dtype=torch.bfloat16) * 0.2)(Dm, H, Dh) * Dm ** (-0.5)), 'Wo': _w((lambda *s: torch.randn(*s, dtype=torch.bfloat16) * 0.2)(H, Dh, Dm) * (H * Dh) ** (-0.5)), 'seg_len': seg}
    _A_in = _A_setup()

    def _B_setup():
        B, S, D, F = (1, 2048, 512, 1376)
        return {'x': _w((lambda *s: torch.randn(*s, dtype=torch.bfloat16) * 0.05)(B, S, D)), 'w_gate': _w((lambda *s: torch.randn(*s, dtype=torch.bfloat16) * 0.2)(D, F) * D ** (-0.5)), 'w_up': _w((lambda *s: torch.randn(*s, dtype=torch.bfloat16) * 0.2)(D, F) * D ** (-0.5)), 'w_down': _w((lambda *s: torch.randn(*s, dtype=torch.bfloat16) * 0.2)(F, D) * F ** (-0.5))}
    _B_in = _B_setup()
    return {'A_x': _A_in['x'], 'A_mem0': _A_in['mem0'], 'A_Wq': _A_in['Wq'], 'A_Wk': _A_in['Wk'], 'A_Wv': _A_in['Wv'], 'A_Wo': _A_in['Wo'], 'A_seg_len': _A_in['seg_len'], 'B_x': _B_in['x'], 'B_w_gate': _B_in['w_gate'], 'B_w_up': _B_in['w_up'], 'B_w_down': _B_in['w_down']}

def reference(A_x, A_mem0, A_Wq, A_Wk, A_Wv, A_Wo, A_seg_len, B_x, B_w_gate, B_w_up, B_w_down):

    def _A_ref(x, mem0, Wq, Wk, Wv, Wo, seg_len):
        B, S, Dm = x.shape
        H, Dh = (Wq.shape[1], Wq.shape[2])
        M = mem0.shape[1]
        scale = Dh ** (-0.5)
        n_seg = S // seg_len
        L = M + seg_len
        idx = torch.arange(L)
        mask = (idx[:, None] < M) | (idx[:, None] >= idx[None, :])
        mem = mem0
        outs = []
        for s in range(n_seg):
            xs = x[:, s * seg_len:(s + 1) * seg_len, :].clone()
            h = torch.concatenate([mem, xs], axis=1)
            q = torch.einsum('btd,dhe->bhte', h, Wq)
            k = torch.einsum('btd,dhe->bhte', h, Wk)
            v = torch.einsum('btd,dhe->bhte', h, Wv)
            scores = torch.einsum('bhqe,bhke->bhqk', q, k) * scale
            scores = torch.where(mask[None, None], scores, -1000000000.0)
            p = _softmax(scores, axis=-1)
            o = torch.einsum('bhqk,bhke->bhqe', p, v)
            o = torch.einsum('bhte,hed->btd', o, Wo)
            mem = o[:, :M, :].clone()
            outs.append(o[:, M:, :])
        return torch.concatenate(outs, axis=1)

    def _B_ref(x, w_gate, w_up, w_down):
        g = torch.einsum('bsd,df->bsf', x, w_gate)
        u = torch.einsum('bsd,df->bsf', x, w_up)
        h = g * u
        return torch.einsum('bsf,fd->bsd', h, w_down)
    x = A_x
    h = x + _A_ref(_layernorm(x, axis=-1), A_mem0, A_Wq, A_Wk, A_Wv, A_Wo, A_seg_len)
    h2 = h + _B_ref(_layernorm(h, axis=-1), B_w_gate, B_w_up, B_w_down)
    return h2
```

```asm
; @launch kernel=sequential_preLN__memory_aug_recurrent_mem_tr__glu_gated_bilinear__prompt_kernel grid=(256,1,1) block=(256,1,1) lds=163840
.amdgcn_target "amdgcn-amd-amdhsa--gfx950"
.text
.globl sequential_preLN__memory_aug_recurrent_mem_tr__glu_gated_bilinear__prompt_kernel
.p2align 8
.type sequential_preLN__memory_aug_recurrent_mem_tr__glu_gated_bilinear__prompt_kernel,@function
sequential_preLN__memory_aug_recurrent_mem_tr__glu_gated_bilinear__prompt_kernel:
    s_cmp_ge_u32 s2, 256
    s_cbranch_scc1 L_exit0
    v_lshrrev_b32 v1, 6, v0
    v_and_b32 v0, 63, v0
    s_nop 0
    v_readfirstlane_b32 s19, v1
    s_load_dwordx2 s[16:17], s[0:1], 96
    s_load_dwordx2 s[14:15], s[0:1], 104
    s_load_dwordx8 s[4:11], s[0:1], 16
    s_load_dwordx2 s[12:13], s[0:1], 8
    s_getreg_b32 s80, hwreg(HW_REG_XCC_ID, 0, 4)
    s_waitcnt lgkmcnt(0)
    s_and_b32 s80, s80, 7
    s_cmp_eq_u32 s19, 0
    s_cbranch_scc0 L_T_tick
    s_lshl_b32 s56, s80, 2
    v_mov_b32 v1, s56
    v_mov_b32 v2, 1
    s_mov_b64 exec, 1
    global_atomic_add v3, v1, v2, s[16:17] sc0
    s_waitcnt vmcnt(0)
    v_mov_b32 v4, 163832
    ds_write_b32 v4, v3
    s_waitcnt lgkmcnt(0)
    s_mov_b64 exec, -1
L_T_tick:
    s_barrier
    v_mov_b32 v4, 163832
    ds_read_b32 v3, v4
    s_waitcnt lgkmcnt(0)
    v_readfirstlane_b32 s81, v3
    s_nop 3
    s_barrier
    s_mov_b32 s82, 0
    s_mov_b32 s84, 0
    s_mov_b32 s83, s80
    s_mov_b32 s18, s81
    s_cmp_lt_u32 s81, 32
    s_cbranch_scc0 L_fallback
L_dispatch:
    s_cmp_eq_u32 s83, 0
    s_cbranch_scc1 L_role_chain
    s_cmp_le_u32 s83, 1
    s_cbranch_scc1 L_role_kv
    s_branch L_role_x
L_exit0:
    s_endpgm
L_role_chain:
    v_mov_b32 v100, v0
    v_and_b32 v104, 15, v0
    v_lshrrev_b32 v105, 4, v0
    v_lshrrev_b32 v101, 5, v100
    v_lshlrev_b32 v101, 1, v101
    s_lshl_b32 s52, s19, 2
    v_or_b32 v101, s52, v101
    v_xor_b32 v101, v101, v104
    v_lshlrev_b32 v101, 4, v101
    s_lshl_b32 s52, s19, 4
    v_add_u32 v102, s52, v105
    v_lshlrev_b32 v102, 13, v102
    s_lshl_b32 s52, s18, 8
    v_add3_u32 v106, v101, v102, s52
    s_lshl_b32 s53, s19, 12
    s_add_u32 s54, s4, 0x0
    s_addc_u32 s55, s5, 0
    s_add_u32 m0, s53, 0
    s_nop 0
    global_load_lds_dwordx4 v106, s[54:55]
    s_add_u32 s54, s4, 0x8000
    s_addc_u32 s55, s5, 0
    s_add_u32 m0, s53, 1024
    s_nop 0
    global_load_lds_dwordx4 v106, s[54:55]
    s_add_u32 s54, s4, 0x10000
    s_addc_u32 s55, s5, 0
    s_add_u32 m0, s53, 2048
    s_nop 0
    global_load_lds_dwordx4 v106, s[54:55]
    s_add_u32 s54, s4, 0x18000
    s_addc_u32 s55, s5, 0
    s_add_u32 m0, s53, 3072
    s_nop 0
    global_load_lds_dwordx4 v106, s[54:55]
    s_add_u32 s54, s4, 0x80000
    s_addc_u32 s55, s5, 0
    s_add_u32 m0, s53, 16384
    s_nop 0
    global_load_lds_dwordx4 v106, s[54:55]
    s_add_u32 s54, s4, 0x88000
    s_addc_u32 s55, s5, 0
    s_add_u32 m0, s53, 17408
    s_nop 0
    global_load_lds_dwordx4 v106, s[54:55]
    s_add_u32 s54, s4, 0x90000
    s_addc_u32 s55, s5, 0
    s_add_u32 m0, s53, 18432
    s_nop 0
    global_load_lds_dwordx4 v106, s[54:55]
    s_add_u32 s54, s4, 0x98000
    s_addc_u32 s55, s5, 0
    s_add_u32 m0, s53, 19456
    s_nop 0
    global_load_lds_dwordx4 v106, s[54:55]
    s_add_u32 s54, s4, 0x100000
    s_addc_u32 s55, s5, 0
    s_add_u32 m0, s53, 32768
    s_nop 0
    global_load_lds_dwordx4 v106, s[54:55]
    s_add_u32 s54, s4, 0x108000
    s_addc_u32 s55, s5, 0
    s_add_u32 m0, s53, 33792
    s_nop 0
    global_load_lds_dwordx4 v106, s[54:55]
    s_add_u32 s54, s4, 0x110000
    s_addc_u32 s55, s5, 0
    s_add_u32 m0, s53, 34816
    s_nop 0
    global_load_lds_dwordx4 v106, s[54:55]
    s_add_u32 s54, s4, 0x118000
    s_addc_u32 s55, s5, 0
    s_add_u32 m0, s53, 35840
    s_nop 0
    global_load_lds_dwordx4 v106, s[54:55]
    s_add_u32 s54, s4, 0x180000
    s_addc_u32 s55, s5, 0
    s_add_u32 m0, s53, 49152
    s_nop 0
    global_load_lds_dwordx4 v106, s[54:55]
    s_add_u32 s54, s4, 0x188000
    s_addc_u32 s55, s5, 0
    s_add_u32 m0, s53, 50176
    s_nop 0
    global_load_lds_dwordx4 v106, s[54:55]
    s_add_u32 s54, s4, 0x190000
    s_addc_u32 s55, s5, 0
    s_add_u32 m0, s53, 51200
    s_nop 0
    global_load_lds_dwordx4 v106, s[54:55]
    s_add_u32 s54, s4, 0x198000
    s_addc_u32 s55, s5, 0
    s_add_u32 m0, s53, 52224
    s_nop 0
    global_load_lds_dwordx4 v106, s[54:55]
    s_add_u32 s54, s4, 0x200000
    s_addc_u32 s55, s5, 0
    s_add_u32 m0, s53, 65536
    s_nop 0
    global_load_lds_dwordx4 v106, s[54:55]
    s_add_u32 s54, s4, 0x208000
    s_addc_u32 s55, s5, 0
    s_add_u32 m0, s53, 66560
    s_nop 0
    global_load_lds_dwordx4 v106, s[54:55]
    s_add_u32 s54, s4, 0x210000
    s_addc_u32 s55, s5, 0
    s_add_u32 m0, s53, 67584
    s_nop 0
    global_load_lds_dwordx4 v106, s[54:55]
    s_add_u32 s54, s4, 0x218000
    s_addc_u32 s55, s5, 0
    s_add_u32 m0, s53, 68608
    s_nop 0
    global_load_lds_dwordx4 v106, s[54:55]
    s_add_u32 s54, s4, 0x280000
    s_addc_u32 s55, s5, 0
    s_add_u32 m0, s53, 81920
    s_nop 0
    global_load_lds_dwordx4 v106, s[54:55]
    s_add_u32 s54, s4, 0x288000
    s_addc_u32 s55, s5, 0
    s_add_u32 m0, s53, 82944
    s_nop 0
    global_load_lds_dwordx4 v106, s[54:55]
    s_add_u32 s54, s4, 0x290000
    s_addc_u32 s55, s5, 0
    s_add_u32 m0, s53, 83968
    s_nop 0
    global_load_lds_dwordx4 v106, s[54:55]
    s_add_u32 s54, s4, 0x298000
    s_addc_u32 s55, s5, 0
    s_add_u32 m0, s53, 84992
    s_nop 0
    global_load_lds_dwordx4 v106, s[54:55]
    s_add_u32 s54, s4, 0x300000
    s_addc_u32 s55, s5, 0
    s_add_u32 m0, s53, 98304
    s_nop 0
    global_load_lds_dwordx4 v106, s[54:55]
    s_add_u32 s54, s4, 0x308000
    s_addc_u32 s55, s5, 0
    s_add_u32 m0, s53, 99328
    s_nop 0
    global_load_lds_dwordx4 v106, s[54:55]
    s_add_u32 s54, s4, 0x310000
    s_addc_u32 s55, s5, 0
    s_add_u32 m0, s53, 100352
    s_nop 0
    global_load_lds_dwordx4 v106, s[54:55]
    s_add_u32 s54, s4, 0x318000
    s_addc_u32 s55, s5, 0
    s_add_u32 m0, s53, 101376
    s_nop 0
    global_load_lds_dwordx4 v106, s[54:55]
    v_mov_b32 v100, v0
    v_and_b32 v104, 15, v100
    v_lshrrev_b32 v105, 4, v100
    v_lshlrev_b32 v101, 4, v100
    v_add_u32 v2, 131072, v101
    s_lshl_b32 s52, s19, 15
    v_add_u32 v14, s52, v101
    v_lshlrev_b32 v1, 5, v100
    v_mov_b32 v0, v101
    v_bfe_u32 v102, v100, 1, 1
    v_mov_b32 v15, 0x44444444
    v_mov_b32 v103, 0xeeeeeeee
    v_cmp_eq_u32 vcc, 1, v102
    s_nop 1
    v_cndmask_b32 v15, v15, v103, vcc
    v_lshrrev_b32 v102, 2, v104
    v_lshlrev_b32 v103, 1, v105
    v_xor_b32 v3, v103, v102
    v_xor_b32 v4, 1, v3
    v_lshl_add_u32 v3, v102, 4, v3
    v_lshlrev_b32 v3, 4, v3
    v_and_b32 v103, 3, v104
    v_lshl_add_u32 v3, v103, 2, v3
    s_lshl_b32 s52, s19, 10
    s_add_u32 s52, s52, 139264
    v_add_u32 v3, s52, v3
    v_lshl_add_u32 v4, v102, 4, v4
    v_lshlrev_b32 v4, 4, v4
    v_and_b32 v103, 3, v104
    v_lshl_add_u32 v4, v103, 2, v4
    s_lshl_b32 s52, s19, 10
    s_add_u32 s52, s52, 139264
    v_add_u32 v4, s52, v4
    v_xor_b32 v102, v104, v105
    v_lshl_add_u32 v102, v105, 4, v102
    v_lshlrev_b32 v102, 4, v102
    v_add_u32 v5, 139264, v102
    v_lshrrev_b32 v102, 2, v104
    v_lshlrev_b32 v102, 1, v102
    v_and_b32 v103, 1, v104
    v_add3_u32 v102, v102, v103, 8
    v_xor_b32 v102, v102, v105
    v_lshl_add_u32 v102, v105, 4, v102
    v_lshlrev_b32 v102, 4, v102
    v_add_u32 v6, 139264, v102
    v_lshrrev_b32 v102, 1, v104
    v_lshlrev_b32 v102, 2, v102
    v_and_b32 v103, 1, v104
    v_add_u32 v102, v102, v103
    s_and_b32 s52, s19, 1
    s_lshl_b32 s52, s52, 1
    v_add_u32 v102, s52, v102
    v_and_b32 v102, 15, v102
    v_lshl_add_u32 v102, v105, 4, v102
    v_lshlrev_b32 v102, 4, v102
    s_lshr_b32 s52, s19, 1
    s_lshl_b32 s52, s52, 10
    s_add_u32 s52, s52, 143360
    v_add_u32 v7, s52, v102
    v_lshlrev_b32 v103, 3, v100
    v_and_b32 v103, 0x1f0, v103
    v_add_u32 v103, 162304, v103
    v_and_b32 v102, 8, v100
    v_cmp_ne_u32 vcc, 0, v102
    s_nop 1
    v_cndmask_b32 v7, v7, v103, vcc
    v_lshrrev_b32 v102, 2, v104
    s_lshl_b32 s52, s19, 3
    v_add_u32 v102, s52, v102
    v_lshlrev_b32 v102, 13, v102
    v_and_b32 v103, 3, v104
    v_lshlrev_b32 v103, 4, v103
    v_lshl_add_u32 v103, v105, 11, v103
    s_lshl_b32 s52, s18, 6
    v_add3_u32 v8, v102, v103, s52
    v_bfe_u32 v102, v100, 4, 1
    v_lshlrev_b32 v102, 1, v102
    v_bfe_u32 v103, v100, 2, 1
    v_add_u32 v102, v102, v103
    v_lshlrev_b32 v102, 4, v102
    v_and_b32 v103, 3, v100
    v_lshl_add_u32 v102, v103, 2, v102
    s_lshr_b32 s52, s18, 2
    s_lshl_b32 s52, s52, 10
    s_and_b32 s53, s18, 3
    s_lshl_b32 s53, s53, 8
    s_add_u32 s52, s52, s53
    s_lshl_b32 s53, s19, 6
    s_add_u32 s52, s52, s53
    v_add_u32 v10, s52, v102
    s_lshl_b32 s52, s18, 8
    s_add_u32 s52, s52, 0x10000
    v_lshlrev_b32 v103, 2, v100
    v_add_u32 v103, s52, v103
    v_and_b32 v102, 0x28, v100
    v_cmp_ne_u32 vcc, 0, v102
    s_nop 1
    v_cndmask_b32 v10, v10, v103, vcc
    v_lshrrev_b32 v102, 2, v104
    v_lshlrev_b32 v102, 1, v102
    v_and_b32 v103, 1, v104
    v_add_u32 v102, v102, v103
    v_lshlrev_b32 v102, 4, v102
    v_lshl_add_u32 v102, v105, 7, v102
    s_lshl_b32 s52, s19, 9
    v_add_u32 v11, s52, v102
    v_lshlrev_b32 v102, 2, v100
    s_lshl_b32 s52, s19, 9
    v_add_u32 v12, s52, v102
    v_and_b32 v102, 7, v104
    v_mov_b32 v16, 0
    v_mov_b32 v103, 0x3f80
    v_cmp_eq_u32 vcc, 0, v102
    s_nop 1
    v_cndmask_b32 v16, v16, v103, vcc
    v_mov_b32 v103, 0x3f800000
    v_cmp_eq_u32 vcc, 1, v102
    s_nop 1
    v_cndmask_b32 v16, v16, v103, vcc
    v_mov_b32 v20, 0x3f803f80
    v_mov_b32 v17, 0
    v_mov_b32 v103, 0x3f80
    v_cmp_eq_u32 vcc, 2, v102
    s_nop 1
    v_cndmask_b32 v17, v17, v103, vcc
    v_mov_b32 v103, 0x3f800000
    v_cmp_eq_u32 vcc, 3, v102
    s_nop 1
    v_cndmask_b32 v17, v17, v103, vcc
    v_mov_b32 v21, 0x3f803f80
    v_mov_b32 v18, 0
    v_mov_b32 v103, 0x3f80
    v_cmp_eq_u32 vcc, 4, v102
    s_nop 1
    v_cndmask_b32 v18, v18, v103, vcc
    v_mov_b32 v103, 0x3f800000
    v_cmp_eq_u32 vcc, 5, v102
    s_nop 1
    v_cndmask_b32 v18, v18, v103, vcc
    v_mov_b32 v22, 0x3f803f80
    v_mov_b32 v19, 0
    v_mov_b32 v103, 0x3f80
    v_cmp_eq_u32 vcc, 6, v102
    s_nop 1
    v_cndmask_b32 v19, v19, v103, vcc
    v_mov_b32 v103, 0x3f800000
    v_cmp_eq_u32 vcc, 7, v102
    s_nop 1
    v_cndmask_b32 v19, v19, v103, vcc
    v_mov_b32 v23, 0x3f803f80
    s_mov_b32 s46, 0x33333333
    s_mov_b32 s47, 0x33333333
    s_mov_b32 s48, 0x00ff00ff
    s_mov_b32 s49, 0x00ff00ff
    s_mov_b32 s50, 0x00ff00ff
    s_mov_b32 s51, 0
    s_and_b32 s52, s19, 1
    s_lshl_b32 s52, s52, 1
    s_lshr_b32 s53, s19, 1
    s_lshl_b32 s53, s53, 3
    s_or_b32 s52, s52, s53
    v_and_b32 v101, 1, v105
    v_lshlrev_b32 v101, 2, v101
    v_or_b32 v101, s52, v101
    v_xor_b32 v101, v101, v104
    v_lshrrev_b32 v102, 2, v101
    v_lshlrev_b32 v102, 8, v102
    v_and_b32 v101, 3, v101
    v_lshl_add_u32 v101, v101, 4, v102
    s_lshl_b32 s52, s19, 4
    v_add_u32 v102, s52, v105
    v_lshlrev_b32 v102, 10, v102
    s_lshl_b32 s52, s18, 17
    v_add3_u32 v107, v101, v102, s52
    v_lshrrev_b32 v101, 5, v100
    v_bfe_u32 v102, v100, 4, 1
    v_lshlrev_b32 v101, 2, v101
    v_lshl_add_u32 v101, v102, 1, v101
    v_bfe_u32 v103, v100, 2, 2
    v_lshl_add_u32 v101, v103, 4, v101
    v_lshlrev_b32 v101, 8, v101
    v_lshlrev_b32 v102, 1, v102
    v_lshl_add_u32 v102, v103, 2, v102
    v_bfe_u32 v103, v100, 1, 1
    s_lshl_b32 s52, s19, 2
    v_or_b32 v103, s52, v103
    v_xor_b32 v102, v102, v103
    v_lshl_add_u32 v101, v102, 4, v101
    v_and_b32 v103, 1, v100
    v_lshl_add_u32 v108, v103, 3, v101
    v_xor_b32 v109, 32, v108
    v_lshrrev_b32 v101, 5, v100
    v_bfe_u32 v102, v100, 4, 1
    v_lshlrev_b32 v101, 2, v101
    v_lshl_add_u32 v101, v102, 4, v101
    v_bfe_u32 v103, v100, 2, 1
    v_add_u32 v101, v101, v103
    v_lshlrev_b32 v102, 1, v102
    v_lshl_add_u32 v102, v103, 2, v102
    v_bfe_u32 v103, v100, 3, 1
    v_lshl_add_u32 v101, v103, 5, v101
    v_lshl_add_u32 v102, v103, 3, v102
    v_lshlrev_b32 v101, 8, v101
    v_bfe_u32 v103, v100, 1, 1
    s_lshl_b32 s52, s19, 2
    v_or_b32 v103, s52, v103
    v_xor_b32 v102, v102, v103
    v_lshl_add_u32 v101, v102, 4, v101
    v_and_b32 v103, 1, v100
    v_lshl_add_u32 v110, v103, 3, v101
    v_xor_b32 v111, 32, v110
    v_add_u32 v112, 0x10000, v108
    v_add_u32 v113, 0x10000, v109
    v_add_u32 v114, 0x10000, v110
    v_add_u32 v115, 0x10000, v111
    s_mov_b32 s20, 0
    s_mov_b32 s43, 0
    s_mov_b32 s42, 0
    s_mov_b32 s44, 0x3e0293ee
    s_mov_b32 s45, 0x3e0293ee
    s_add_u32 s30, s14, 0x82000
    s_addc_u32 s31, s15, 0
    s_add_u32 s32, s14, 0x86000
    s_addc_u32 s33, s15, 0
    s_lshl_b32 s52, s19, 11
    s_add_u32 s52, s52, 0x80000
    s_add_u32 s28, s14, s52
    s_addc_u32 s29, s15, 0
    s_lshl_b32 s52, s18, 13
    s_lshl_b32 s53, s19, 11
    s_add_u32 s52, s52, s53
    s_add_u32 s53, s52, 0x1000000
    s_add_u32 s34, s14, s53
    s_addc_u32 s35, s15, 0
    s_add_u32 s53, s52, 0x2000000
    s_add_u32 s36, s14, s53
    s_addc_u32 s37, s15, 0
    s_lshl_b32 s52, s18, 11
    s_add_u32 s53, s52, 0x3000000
    s_add_u32 s38, s14, s53
    s_addc_u32 s39, s15, 0
    s_add_u32 s53, s52, 0x3400000
    s_add_u32 s40, s14, s53
    s_addc_u32 s41, s15, 0
    s_mov_b32 s96, s14
    s_and_b32 s97, s15, 0xffff
    s_mov_b32 s98, 0x10000000
    s_mov_b32 s99, 0x00020000
    s_lshl_b32 s52, s18, 2
    s_add_u32 s76, s52, 0xa0000
    s_add_u32 s77, s52, 0xa2080
    s_cmp_eq_u32 s82, 0
    s_cbranch_scc0 L_c_initS
    v_mov_b32 v124, -1
    v_mov_b32 v125, -1
    v_mov_b32 v126, -1
    v_mov_b32 v127, -1
    s_lshl_b32 s52, s18, 13
    s_lshl_b32 s53, s19, 11
    s_add_u32 s52, s52, s53
    v_add_u32 v99, s52, v0
    s_add_u32 s54, s14, 0x0
    s_addc_u32 s55, s15, 0
    global_store_dwordx4 v99, v[124:127], s[54:55]
    global_store_dwordx4 v99, v[124:127], s[54:55] offset:1024
    s_add_u32 s54, s14, 0x40000
    s_addc_u32 s55, s15, 0
    global_store_dwordx4 v99, v[124:127], s[54:55]
    global_store_dwordx4 v99, v[124:127], s[54:55] offset:1024
    s_add_u32 s54, s14, 0x80000
    s_addc_u32 s55, s15, 0
    global_store_dword v10, v124, s[54:55]
    s_add_u32 s54, s14, 0x82000
    s_addc_u32 s55, s15, 0
    global_store_dword v10, v124, s[54:55]
    s_add_u32 s54, s14, 0x84000
    s_addc_u32 s55, s15, 0
    global_store_dword v10, v124, s[54:55]
    s_add_u32 s54, s14, 0x86000
    s_addc_u32 s55, s15, 0
    global_store_dword v10, v124, s[54:55]
    s_branch L_c_initD
L_c_initS:
    v_mov_b32 v124, -1
    v_mov_b32 v125, -1
    v_mov_b32 v126, -1
    v_mov_b32 v127, -1
    s_lshl_b32 s52, s18, 13
    s_lshl_b32 s53, s19, 11
    s_add_u32 s52, s52, s53
    v_add_u32 v99, s52, v0
    s_add_u32 s54, s14, 0x0
    s_addc_u32 s55, s15, 0
    global_store_dwordx4 v99, v[124:127], s[54:55] sc1
    global_store_dwordx4 v99, v[124:127], s[54:55] offset:1024 sc1
    s_add_u32 s54, s14, 0x40000
    s_addc_u32 s55, s15, 0
    global_store_dwordx4 v99, v[124:127], s[54:55] sc1
    global_store_dwordx4 v99, v[124:127], s[54:55] offset:1024 sc1
    s_add_u32 s54, s14, 0x80000
    s_addc_u32 s55, s15, 0
    global_store_dword v10, v124, s[54:55] sc1
    s_add_u32 s54, s14, 0x82000
    s_addc_u32 s55, s15, 0
    global_store_dword v10, v124, s[54:55] sc1
    s_add_u32 s54, s14, 0x84000
    s_addc_u32 s55, s15, 0
    global_store_dword v10, v124, s[54:55] sc1
    s_add_u32 s54, s14, 0x86000
    s_addc_u32 s55, s15, 0
    global_store_dword v10, v124, s[54:55] sc1
L_c_initD:
    s_cmp_eq_u32 s19, 0
    s_cbranch_scc1 L_c_load0
    s_cmp_eq_u32 s19, 1
    s_cbranch_scc1 L_c_load1
    s_cmp_eq_u32 s19, 2
    s_cbranch_scc1 L_c_load2
    s_cmp_eq_u32 s19, 3
    s_cbranch_scc1 L_c_load3
    s_endpgm
L_c_load0:
    s_waitcnt vmcnt(32)
    s_barrier
    s_add_u32 s54, s4, 0x380000
    s_addc_u32 s55, s5, 0
    s_mov_b32 m0, 114688
    s_nop 0
    global_load_lds_dwordx4 v106, s[54:55]
    s_add_u32 s54, s4, 0x388000
    s_addc_u32 s55, s5, 0
    s_mov_b32 m0, 115712
    s_nop 0
    global_load_lds_dwordx4 v106, s[54:55]
    s_add_u32 s54, s4, 0x390000
    s_addc_u32 s55, s5, 0
    s_mov_b32 m0, 116736
    s_nop 0
    global_load_lds_dwordx4 v106, s[54:55]
    s_add_u32 s54, s4, 0x398000
    s_addc_u32 s55, s5, 0
    s_mov_b32 m0, 117760
    s_nop 0
    global_load_lds_dwordx4 v106, s[54:55]
    ds_read_b64_tr_b16 v[24:25], v108 offset:0
    ds_read_b64_tr_b16 v[26:27], v108 offset:256
    ds_read_b64_tr_b16 v[28:29], v108 offset:2048
    ds_read_b64_tr_b16 v[30:31], v108 offset:2304
    ds_read_b64_tr_b16 v[32:33], v109 offset:0
    ds_read_b64_tr_b16 v[34:35], v109 offset:256
    ds_read_b64_tr_b16 v[36:37], v109 offset:2048
    ds_read_b64_tr_b16 v[38:39], v109 offset:2304
    s_waitcnt lgkmcnt(0)
    s_waitcnt vmcnt(32)
    s_barrier
    s_add_u32 s54, s6, 0x0
    s_addc_u32 s55, s7, 0
    s_mov_b32 m0, 0
    s_nop 0
    global_load_lds_dwordx4 v106, s[54:55]
    s_add_u32 s54, s6, 0x8000
    s_addc_u32 s55, s7, 0
    s_mov_b32 m0, 1024
    s_nop 0
    global_load_lds_dwordx4 v106, s[54:55]
    s_add_u32 s54, s6, 0x10000
    s_addc_u32 s55, s7, 0
    s_mov_b32 m0, 2048
    s_nop 0
    global_load_lds_dwordx4 v106, s[54:55]
    s_add_u32 s54, s6, 0x18000
    s_addc_u32 s55, s7, 0
    s_mov_b32 m0, 3072
    s_nop 0
    global_load_lds_dwordx4 v106, s[54:55]
    ds_read_b64_tr_b16 v[40:41], v108 offset:16384
    ds_read_b64_tr_b16 v[42:43], v108 offset:16640
    ds_read_b64_tr_b16 v[44:45], v108 offset:18432
    ds_read_b64_tr_b16 v[46:47], v108 offset:18688
    ds_read_b64_tr_b16 v[48:49], v109 offset:16384
    ds_read_b64_tr_b16 v[50:51], v109 offset:16640
    ds_read_b64_tr_b16 v[52:53], v109 offset:18432
    ds_read_b64_tr_b16 v[54:55], v109 offset:18688
    s_waitcnt lgkmcnt(0)
    s_waitcnt vmcnt(32)
    s_barrier
    s_add_u32 s54, s6, 0x80000
    s_addc_u32 s55, s7, 0
    s_mov_b32 m0, 16384
    s_nop 0
    global_load_lds_dwordx4 v106, s[54:55]
    s_add_u32 s54, s6, 0x88000
    s_addc_u32 s55, s7, 0
    s_mov_b32 m0, 17408
    s_nop 0
    global_load_lds_dwordx4 v106, s[54:55]
    s_add_u32 s54, s6, 0x90000
    s_addc_u32 s55, s7, 0
    s_mov_b32 m0, 18432
    s_nop 0
    global_load_lds_dwordx4 v106, s[54:55]
    s_add_u32 s54, s6, 0x98000
    s_addc_u32 s55, s7, 0
    s_mov_b32 m0, 19456
    s_nop 0
    global_load_lds_dwordx4 v106, s[54:55]
    ds_read_b64_tr_b16 a[0:1], v108 offset:32768
    ds_read_b64_tr_b16 a[2:3], v108 offset:33024
    ds_read_b64_tr_b16 a[4:5], v108 offset:34816
    ds_read_b64_tr_b16 a[6:7], v108 offset:35072
    ds_read_b64_tr_b16 a[48:49], v109 offset:32768
    ds_read_b64_tr_b16 a[50:51], v109 offset:33024
    ds_read_b64_tr_b16 a[52:53], v109 offset:34816
    ds_read_b64_tr_b16 a[54:55], v109 offset:35072
    s_waitcnt lgkmcnt(0)
    s_waitcnt vmcnt(32)
    s_barrier
    s_add_u32 s54, s6, 0x100000
    s_addc_u32 s55, s7, 0
    s_mov_b32 m0, 32768
    s_nop 0
    global_load_lds_dwordx4 v106, s[54:55]
    s_add_u32 s54, s6, 0x108000
    s_addc_u32 s55, s7, 0
    s_mov_b32 m0, 33792
    s_nop 0
    global_load_lds_dwordx4 v106, s[54:55]
    s_add_u32 s54, s6, 0x110000
    s_addc_u32 s55, s7, 0
    s_mov_b32 m0, 34816
    s_nop 0
    global_load_lds_dwordx4 v106, s[54:55]
    s_add_u32 s54, s6, 0x118000
    s_addc_u32 s55, s7, 0
    s_mov_b32 m0, 35840
    s_nop 0
    global_load_lds_dwordx4 v106, s[54:55]
    ds_read_b64_tr_b16 a[8:9], v108 offset:49152
    ds_read_b64_tr_b16 a[10:11], v108 offset:49408
    ds_read_b64_tr_b16 a[12:13], v108 offset:51200
    ds_read_b64_tr_b16 a[14:15], v108 offset:51456
    ds_read_b64_tr_b16 a[56:57], v109 offset:49152
    ds_read_b64_tr_b16 a[58:59], v109 offset:49408
    ds_read_b64_tr_b16 a[60:61], v109 offset:51200
    ds_read_b64_tr_b16 a[62:63], v109 offset:51456
    s_waitcnt lgkmcnt(0)
    s_waitcnt vmcnt(32)
    s_barrier
    s_add_u32 s54, s6, 0x180000
    s_addc_u32 s55, s7, 0
    s_mov_b32 m0, 49152
    s_nop 0
    global_load_lds_dwordx4 v106, s[54:55]
    s_add_u32 s54, s6, 0x188000
    s_addc_u32 s55, s7, 0
    s_mov_b32 m0, 50176
    s_nop 0
    global_load_lds_dwordx4 v106, s[54:55]
    s_add_u32 s54, s6, 0x190000
    s_addc_u32 s55, s7, 0
    s_mov_b32 m0, 51200
    s_nop 0
    global_load_lds_dwordx4 v106, s[54:55]
    s_add_u32 s54, s6, 0x198000
    s_addc_u32 s55, s7, 0
    s_mov_b32 m0, 52224
    s_nop 0
    global_load_lds_dwordx4 v106, s[54:55]
    ds_read_b64_tr_b16 a[16:17], v112 offset:0
    ds_read_b64_tr_b16 a[18:19], v112 offset:256
    ds_read_b64_tr_b16 a[20:21], v112 offset:2048
    ds_read_b64_tr_b16 a[22:23], v112 offset:2304
    ds_read_b64_tr_b16 a[64:65], v113 offset:0
    ds_read_b64_tr_b16 a[66:67], v113 offset:256
    ds_read_b64_tr_b16 a[68:69], v113 offset:2048
    ds_read_b64_tr_b16 a[70:71], v113 offset:2304
    s_waitcnt lgkmcnt(0)
    s_waitcnt vmcnt(32)
    s_barrier
    s_add_u32 s54, s6, 0x200000
    s_addc_u32 s55, s7, 0
    s_mov_b32 m0, 65536
    s_nop 0
    global_load_lds_dwordx4 v106, s[54:55]
    s_add_u32 s54, s6, 0x208000
    s_addc_u32 s55, s7, 0
    s_mov_b32 m0, 66560
    s_nop 0
    global_load_lds_dwordx4 v106, s[54:55]
    s_add_u32 s54, s6, 0x210000
    s_addc_u32 s55, s7, 0
    s_mov_b32 m0, 67584
    s_nop 0
    global_load_lds_dwordx4 v106, s[54:55]
    s_add_u32 s54, s6, 0x218000
    s_addc_u32 s55, s7, 0
    s_mov_b32 m0, 68608
    s_nop 0
    global_load_lds_dwordx4 v106, s[54:55]
    ds_read_b64_tr_b16 a[24:25], v112 offset:16384
    ds_read_b64_tr_b16 a[26:27], v112 offset:16640
    ds_read_b64_tr_b16 a[28:29], v112 offset:18432
    ds_read_b64_tr_b16 a[30:31], v112 offset:18688
    ds_read_b64_tr_b16 a[72:73], v113 offset:16384
    ds_read_b64_tr_b16 a[74:75], v113 offset:16640
    ds_read_b64_tr_b16 a[76:77], v113 offset:18432
    ds_read_b64_tr_b16 a[78:79], v113 offset:18688
    s_waitcnt lgkmcnt(0)
    s_waitcnt vmcnt(32)
    s_barrier
    s_add_u32 s54, s6, 0x280000
    s_addc_u32 s55, s7, 0
    s_mov_b32 m0, 81920
    s_nop 0
    global_load_lds_dwordx4 v106, s[54:55]
    s_add_u32 s54, s6, 0x288000
    s_addc_u32 s55, s7, 0
    s_mov_b32 m0, 82944
    s_nop 0
    global_load_lds_dwordx4 v106, s[54:55]
    s_add_u32 s54, s6, 0x290000
    s_addc_u32 s55, s7, 0
    s_mov_b32 m0, 83968
    s_nop 0
    global_load_lds_dwordx4 v106, s[54:55]
    s_add_u32 s54, s6, 0x298000
    s_addc_u32 s55, s7, 0
    s_mov_b32 m0, 84992
    s_nop 0
    global_load_lds_dwordx4 v106, s[54:55]
    ds_read_b64_tr_b16 a[32:33], v112 offset:32768
    ds_read_b64_tr_b16 a[34:35], v112 offset:33024
    ds_read_b64_tr_b16 a[36:37], v112 offset:34816
    ds_read_b64_tr_b16 a[38:39], v112 offset:35072
    ds_read_b64_tr_b16 a[80:81], v113 offset:32768
    ds_read_b64_tr_b16 a[82:83], v113 offset:33024
    ds_read_b64_tr_b16 a[84:85], v113 offset:34816
    ds_read_b64_tr_b16 a[86:87], v113 offset:35072
    s_waitcnt lgkmcnt(0)
    s_waitcnt vmcnt(24)
    s_barrier
    s_add_u32 s54, s6, 0x300000
    s_addc_u32 s55, s7, 0
    s_mov_b32 m0, 98304
    s_nop 0
    global_load_lds_dwordx4 v106, s[54:55]
    s_add_u32 s54, s6, 0x308000
    s_addc_u32 s55, s7, 0
    s_mov_b32 m0, 99328
    s_nop 0
    global_load_lds_dwordx4 v106, s[54:55]
    s_add_u32 s54, s6, 0x310000
    s_addc_u32 s55, s7, 0
    s_mov_b32 m0, 100352
    s_nop 0
    global_load_lds_dwordx4 v106, s[54:55]
    s_add_u32 s54, s6, 0x318000
    s_addc_u32 s55, s7, 0
    s_mov_b32 m0, 101376
    s_nop 0
    global_load_lds_dwordx4 v106, s[54:55]
    ds_read_b64_tr_b16 a[40:41], v112 offset:49152
    ds_read_b64_tr_b16 a[42:43], v112 offset:49408
    ds_read_b64_tr_b16 a[44:45], v112 offset:51200
    ds_read_b64_tr_b16 a[46:47], v112 offset:51456
    ds_read_b64_tr_b16 a[88:89], v113 offset:49152
    ds_read_b64_tr_b16 a[90:91], v113 offset:49408
    ds_read_b64_tr_b16 a[92:93], v113 offset:51200
    ds_read_b64_tr_b16 a[94:95], v113 offset:51456
    s_waitcnt lgkmcnt(0)
    s_waitcnt vmcnt(24)
    s_barrier
    s_add_u32 s54, s6, 0x380000
    s_addc_u32 s55, s7, 0
    s_mov_b32 m0, 114688
    s_nop 0
    global_load_lds_dwordx4 v106, s[54:55]
    s_add_u32 s54, s6, 0x388000
    s_addc_u32 s55, s7, 0
    s_mov_b32 m0, 115712
    s_nop 0
    global_load_lds_dwordx4 v106, s[54:55]
    s_add_u32 s54, s6, 0x390000
    s_addc_u32 s55, s7, 0
    s_mov_b32 m0, 116736
    s_nop 0
    global_load_lds_dwordx4 v106, s[54:55]
    s_add_u32 s54, s6, 0x398000
    s_addc_u32 s55, s7, 0
    s_mov_b32 m0, 117760
    s_nop 0
    global_load_lds_dwordx4 v106, s[54:55]
    s_add_u32 s56, s84, 36
    v_mov_b32 v124, s56
    v_mov_b32 v125, 1
    s_mov_b64 exec, 1
    global_atomic_add v124, v125, s[16:17]
    s_mov_b64 exec, -1
    ds_read_b64_tr_b16 v[56:57], v108 offset:0
    ds_read_b64_tr_b16 v[58:59], v108 offset:256
    ds_read_b64_tr_b16 v[60:61], v108 offset:2048
    ds_read_b64_tr_b16 v[62:63], v108 offset:2304
    ds_read_b64_tr_b16 v[64:65], v109 offset:0
    ds_read_b64_tr_b16 v[66:67], v109 offset:256
    ds_read_b64_tr_b16 v[68:69], v109 offset:2048
    ds_read_b64_tr_b16 v[70:71], v109 offset:2304
    s_waitcnt lgkmcnt(0)
    s_waitcnt vmcnt(25)
    s_barrier
    s_add_u32 s54, s8, 0x0
    s_addc_u32 s55, s9, 0
    s_mov_b32 m0, 0
    s_nop 0
    global_load_lds_dwordx4 v106, s[54:55]
    s_add_u32 s54, s8, 0x8000
    s_addc_u32 s55, s9, 0
    s_mov_b32 m0, 1024
    s_nop 0
    global_load_lds_dwordx4 v106, s[54:55]
    s_add_u32 s54, s8, 0x10000
    s_addc_u32 s55, s9, 0
    s_mov_b32 m0, 2048
    s_nop 0
    global_load_lds_dwordx4 v106, s[54:55]
    s_add_u32 s54, s8, 0x18000
    s_addc_u32 s55, s9, 0
    s_mov_b32 m0, 3072
    s_nop 0
    global_load_lds_dwordx4 v106, s[54:55]
    ds_read_b64_tr_b16 v[72:73], v108 offset:16384
    ds_read_b64_tr_b16 v[74:75], v108 offset:16640
    ds_read_b64_tr_b16 v[76:77], v108 offset:18432
    ds_read_b64_tr_b16 v[78:79], v108 offset:18688
    ds_read_b64_tr_b16 v[80:81], v109 offset:16384
    ds_read_b64_tr_b16 v[82:83], v109 offset:16640
    ds_read_b64_tr_b16 v[84:85], v109 offset:18432
    ds_read_b64_tr_b16 v[86:87], v109 offset:18688
    s_waitcnt lgkmcnt(0)
    s_waitcnt vmcnt(25)
    s_barrier
    s_add_u32 s54, s8, 0x80000
    s_addc_u32 s55, s9, 0
    s_mov_b32 m0, 16384
    s_nop 0
    global_load_lds_dwordx4 v106, s[54:55]
    s_add_u32 s54, s8, 0x88000
    s_addc_u32 s55, s9, 0
    s_mov_b32 m0, 17408
    s_nop 0
    global_load_lds_dwordx4 v106, s[54:55]
    s_add_u32 s54, s8, 0x90000
    s_addc_u32 s55, s9, 0
    s_mov_b32 m0, 18432
    s_nop 0
    global_load_lds_dwordx4 v106, s[54:55]
    s_add_u32 s54, s8, 0x98000
    s_addc_u32 s55, s9, 0
    s_mov_b32 m0, 19456
    s_nop 0
    global_load_lds_dwordx4 v106, s[54:55]
    v_and_b32 v104, 15, v100
    v_lshrrev_b32 v105, 4, v100
    v_lshrrev_b32 v101, 2, v104
    v_lshlrev_b32 v101, 1, v101
    v_and_b32 v102, 1, v104
    v_add_u32 v101, v101, v102
    v_lshlrev_b32 v101, 10, v101
    v_bfe_u32 v102, v104, 1, 1
    v_lshlrev_b32 v102, 6, v102
    v_lshl_add_u32 v102, v105, 3, v102
    v_add_u32 v101, v101, v102
    s_lshl_b32 s52, s19, 8
    v_add_u32 v101, s52, v101
    global_load_dwordx2 v[96:97], v101, s[12:13]
    global_load_dwordx2 v[98:99], v101, s[12:13] offset:32
    global_load_dwordx2 v[124:125], v101, s[12:13] offset:128
    global_load_dwordx2 v[126:127], v101, s[12:13] offset:160
    ds_read_b64_tr_b16 a[96:97], v108 offset:32768
    ds_read_b64_tr_b16 a[98:99], v108 offset:33024
    ds_read_b64_tr_b16 a[100:101], v108 offset:34816
    ds_read_b64_tr_b16 a[102:103], v108 offset:35072
    ds_read_b64_tr_b16 a[144:145], v109 offset:32768
    ds_read_b64_tr_b16 a[146:147], v109 offset:33024
    ds_read_b64_tr_b16 a[148:149], v109 offset:34816
    ds_read_b64_tr_b16 a[150:151], v109 offset:35072
    s_waitcnt lgkmcnt(0)
    s_waitcnt vmcnt(29)
    s_barrier
    s_add_u32 s54, s8, 0x100000
    s_addc_u32 s55, s9, 0
    s_mov_b32 m0, 32768
    s_nop 0
    global_load_lds_dwordx4 v106, s[54:55]
    s_add_u32 s54, s8, 0x108000
    s_addc_u32 s55, s9, 0
    s_mov_b32 m0, 33792
    s_nop 0
    global_load_lds_dwordx4 v106, s[54:55]
    s_add_u32 s54, s8, 0x110000
    s_addc_u32 s55, s9, 0
    s_mov_b32 m0, 34816
    s_nop 0
    global_load_lds_dwordx4 v106, s[54:55]
    s_add_u32 s54, s8, 0x118000
    s_addc_u32 s55, s9, 0
    s_mov_b32 m0, 35840
    s_nop 0
    global_load_lds_dwordx4 v106, s[54:55]
    ds_read_b64_tr_b16 a[104:105], v108 offset:49152
    ds_read_b64_tr_b16 a[106:107], v108 offset:49408
    ds_read_b64_tr_b16 a[108:109], v108 offset:51200
    ds_read_b64_tr_b16 a[110:111], v108 offset:51456
    ds_read_b64_tr_b16 a[152:153], v109 offset:49152
    ds_read_b64_tr_b16 a[154:155], v109 offset:49408
    ds_read_b64_tr_b16 a[156:157], v109 offset:51200
    ds_read_b64_tr_b16 a[158:159], v109 offset:51456
    s_waitcnt lgkmcnt(0)
    s_waitcnt vmcnt(29)
    s_barrier
    s_add_u32 s54, s8, 0x180000
    s_addc_u32 s55, s9, 0
    s_mov_b32 m0, 49152
    s_nop 0
    global_load_lds_dwordx4 v106, s[54:55]
    s_add_u32 s54, s8, 0x188000
    s_addc_u32 s55, s9, 0
    s_mov_b32 m0, 50176
    s_nop 0
    global_load_lds_dwordx4 v106, s[54:55]
    s_add_u32 s54, s8, 0x190000
    s_addc_u32 s55, s9, 0
    s_mov_b32 m0, 51200
    s_nop 0
    global_load_lds_dwordx4 v106, s[54:55]
    s_add_u32 s54, s8, 0x198000
    s_addc_u32 s55, s9, 0
    s_mov_b32 m0, 52224
    s_nop 0
    global_load_lds_dwordx4 v106, s[54:55]
    ds_read_b64_tr_b16 a[112:113], v112 offset:0
    ds_read_b64_tr_b16 a[114:115], v112 offset:256
    ds_read_b64_tr_b16 a[116:117], v112 offset:2048
    ds_read_b64_tr_b16 a[118:119], v112 offset:2304
    ds_read_b64_tr_b16 a[160:161], v113 offset:0
    ds_read_b64_tr_b16 a[162:163], v113 offset:256
    ds_read_b64_tr_b16 a[164:165], v113 offset:2048
    ds_read_b64_tr_b16 a[166:167], v113 offset:2304
    s_waitcnt lgkmcnt(0)
    s_waitcnt vmcnt(29)
    s_barrier
    s_add_u32 s54, s8, 0x200000
    s_addc_u32 s55, s9, 0
    s_mov_b32 m0, 65536
    s_nop 0
    global_load_lds_dwordx4 v106, s[54:55]
    s_add_u32 s54, s8, 0x208000
    s_addc_u32 s55, s9, 0
    s_mov_b32 m0, 66560
    s_nop 0
    global_load_lds_dwordx4 v106, s[54:55]
    s_add_u32 s54, s8, 0x210000
    s_addc_u32 s55, s9, 0
    s_mov_b32 m0, 67584
    s_nop 0
    global_load_lds_dwordx4 v106, s[54:55]
    s_add_u32 s54, s8, 0x218000
    s_addc_u32 s55, s9, 0
    s_mov_b32 m0, 68608
    s_nop 0
    global_load_lds_dwordx4 v106, s[54:55]
    ds_read_b64_tr_b16 a[120:121], v112 offset:16384
    ds_read_b64_tr_b16 a[122:123], v112 offset:16640
    ds_read_b64_tr_b16 a[124:125], v112 offset:18432
    ds_read_b64_tr_b16 a[126:127], v112 offset:18688
    ds_read_b64_tr_b16 a[168:169], v113 offset:16384
    ds_read_b64_tr_b16 a[170:171], v113 offset:16640
    ds_read_b64_tr_b16 a[172:173], v113 offset:18432
    ds_read_b64_tr_b16 a[174:175], v113 offset:18688
    s_waitcnt lgkmcnt(0)
    s_waitcnt vmcnt(29)
    s_barrier
    s_add_u32 s54, s8, 0x280000
    s_addc_u32 s55, s9, 0
    s_mov_b32 m0, 81920
    s_nop 0
    global_load_lds_dwordx4 v106, s[54:55]
    s_add_u32 s54, s8, 0x288000
    s_addc_u32 s55, s9, 0
    s_mov_b32 m0, 82944
    s_nop 0
    global_load_lds_dwordx4 v106, s[54:55]
    s_add_u32 s54, s8, 0x290000
    s_addc_u32 s55, s9, 0
    s_mov_b32 m0, 83968
    s_nop 0
    global_load_lds_dwordx4 v106, s[54:55]
    s_add_u32 s54, s8, 0x298000
    s_addc_u32 s55, s9, 0
    s_mov_b32 m0, 84992
    s_nop 0
    global_load_lds_dwordx4 v106, s[54:55]
    ds_read_b64_tr_b16 a[128:129], v112 offset:32768
    ds_read_b64_tr_b16 a[130:131], v112 offset:33024
    ds_read_b64_tr_b16 a[132:133], v112 offset:34816
    ds_read_b64_tr_b16 a[134:135], v112 offset:35072
    ds_read_b64_tr_b16 a[176:177], v113 offset:32768
    ds_read_b64_tr_b16 a[178:179], v113 offset:33024
    ds_read_b64_tr_b16 a[180:181], v113 offset:34816
    ds_read_b64_tr_b16 a[182:183], v113 offset:35072
    s_waitcnt lgkmcnt(0)
    s_waitcnt vmcnt(29)
    s_barrier
    s_add_u32 s54, s8, 0x300000
    s_addc_u32 s55, s9, 0
    s_mov_b32 m0, 98304
    s_nop 0
    global_load_lds_dwordx4 v106, s[54:55]
    s_add_u32 s54, s8, 0x308000
    s_addc_u32 s55, s9, 0
    s_mov_b32 m0, 99328
    s_nop 0
    global_load_lds_dwordx4 v106, s[54:55]
    s_add_u32 s54, s8, 0x310000
    s_addc_u32 s55, s9, 0
    s_mov_b32 m0, 100352
    s_nop 0
    global_load_lds_dwordx4 v106, s[54:55]
    s_add_u32 s54, s8, 0x318000
    s_addc_u32 s55, s9, 0
    s_mov_b32 m0, 101376
    s_nop 0
    global_load_lds_dwordx4 v106, s[54:55]
    ds_read_b64_tr_b16 a[136:137], v112 offset:49152
    ds_read_b64_tr_b16 a[138:139], v112 offset:49408
    ds_read_b64_tr_b16 a[140:141], v112 offset:51200
    ds_read_b64_tr_b16 a[142:143], v112 offset:51456
    ds_read_b64_tr_b16 a[184:185], v113 offset:49152
    ds_read_b64_tr_b16 a[186:187], v113 offset:49408
    ds_read_b64_tr_b16 a[188:189], v113 offset:51200
    ds_read_b64_tr_b16 a[190:191], v113 offset:51456
    s_waitcnt lgkmcnt(0)
    s_waitcnt vmcnt(28)
    s_barrier
    s_add_u32 s54, s8, 0x380000
    s_addc_u32 s55, s9, 0
    s_mov_b32 m0, 114688
    s_nop 0
    global_load_lds_dwordx4 v106, s[54:55]
    s_add_u32 s54, s8, 0x388000
    s_addc_u32 s55, s9, 0
    s_mov_b32 m0, 115712
    s_nop 0
    global_load_lds_dwordx4 v106, s[54:55]
    s_add_u32 s54, s8, 0x390000
    s_addc_u32 s55, s9, 0
    s_mov_b32 m0, 116736
    s_nop 0
    global_load_lds_dwordx4 v106, s[54:55]
    s_add_u32 s54, s8, 0x398000
    s_addc_u32 s55, s9, 0
    s_mov_b32 m0, 117760
    s_nop 0
    global_load_lds_dwordx4 v106, s[54:55]
    ds_read_b64_tr_b16 a[192:193], v108 offset:0
    ds_read_b64_tr_b16 a[194:195], v108 offset:256
    ds_read_b64_tr_b16 a[196:197], v108 offset:2048
    ds_read_b64_tr_b16 a[198:199], v108 offset:2304
    ds_read_b64_tr_b16 v[128:129], v109 offset:0
    ds_read_b64_tr_b16 v[130:131], v109 offset:256
    ds_read_b64_tr_b16 v[132:133], v109 offset:2048
    ds_read_b64_tr_b16 v[134:135], v109 offset:2304
    s_waitcnt lgkmcnt(0)
    s_waitcnt vmcnt(28)
    s_barrier
    s_add_u32 s54, s10, 0x0
    s_addc_u32 s55, s11, 0
    s_mov_b32 m0, 0
    s_nop 0
    global_load_lds_dwordx4 v107, s[54:55]
    s_add_u32 s54, s10, 0x1000
    s_addc_u32 s55, s11, 0
    s_mov_b32 m0, 1024
    s_nop 0
    global_load_lds_dwordx4 v107, s[54:55]
    s_add_u32 s54, s10, 0x2000
    s_addc_u32 s55, s11, 0
    s_mov_b32 m0, 2048
    s_nop 0
    global_load_lds_dwordx4 v107, s[54:55]
    s_add_u32 s54, s10, 0x3000
    s_addc_u32 s55, s11, 0
    s_mov_b32 m0, 3072
    s_nop 0
    global_load_lds_dwordx4 v107, s[54:55]
    ds_read_b64_tr_b16 a[200:201], v108 offset:16384
    ds_read_b64_tr_b16 a[202:203], v108 offset:16640
    ds_read_b64_tr_b16 a[204:205], v108 offset:18432
    ds_read_b64_tr_b16 a[206:207], v108 offset:18688
    ds_read_b64_tr_b16 v[136:137], v109 offset:16384
    ds_read_b64_tr_b16 v[138:139], v109 offset:16640
    ds_read_b64_tr_b16 v[140:141], v109 offset:18432
    ds_read_b64_tr_b16 v[142:143], v109 offset:18688
    s_waitcnt lgkmcnt(0)
    s_waitcnt vmcnt(24)
    s_barrier
    s_add_u32 s54, s10, 0x40
    s_addc_u32 s55, s11, 0
    s_mov_b32 m0, 16384
    s_nop 0
    global_load_lds_dwordx4 v107, s[54:55]
    s_add_u32 s54, s10, 0x1040
    s_addc_u32 s55, s11, 0
    s_mov_b32 m0, 17408
    s_nop 0
    global_load_lds_dwordx4 v107, s[54:55]
    s_add_u32 s54, s10, 0x2040
    s_addc_u32 s55, s11, 0
    s_mov_b32 m0, 18432
    s_nop 0
    global_load_lds_dwordx4 v107, s[54:55]
    s_add_u32 s54, s10, 0x3040
    s_addc_u32 s55, s11, 0
    s_mov_b32 m0, 19456
    s_nop 0
    global_load_lds_dwordx4 v107, s[54:55]
    ds_read_b64_tr_b16 a[208:209], v108 offset:32768
    ds_read_b64_tr_b16 a[210:211], v108 offset:33024
    ds_read_b64_tr_b16 a[212:213], v108 offset:34816
    ds_read_b64_tr_b16 a[214:215], v108 offset:35072
    ds_read_b64_tr_b16 v[144:145], v109 offset:32768
    ds_read_b64_tr_b16 v[146:147], v109 offset:33024
    ds_read_b64_tr_b16 v[148:149], v109 offset:34816
    ds_read_b64_tr_b16 v[150:151], v109 offset:35072
    s_waitcnt lgkmcnt(0)
    s_waitcnt vmcnt(24)
    s_barrier
    s_add_u32 s54, s10, 0x80
    s_addc_u32 s55, s11, 0
    s_mov_b32 m0, 32768
    s_nop 0
    global_load_lds_dwordx4 v107, s[54:55]
    s_add_u32 s54, s10, 0x1080
    s_addc_u32 s55, s11, 0
    s_mov_b32 m0, 33792
    s_nop 0
    global_load_lds_dwordx4 v107, s[54:55]
    s_add_u32 s54, s10, 0x2080
    s_addc_u32 s55, s11, 0
    s_mov_b32 m0, 34816
    s_nop 0
    global_load_lds_dwordx4 v107, s[54:55]
    s_add_u32 s54, s10, 0x3080
    s_addc_u32 s55, s11, 0
    s_mov_b32 m0, 35840
    s_nop 0
    global_load_lds_dwordx4 v107, s[54:55]
    ds_read_b64_tr_b16 a[216:217], v108 offset:49152
    ds_read_b64_tr_b16 a[218:219], v108 offset:49408
    ds_read_b64_tr_b16 a[220:221], v108 offset:51200
    ds_read_b64_tr_b16 a[222:223], v108 offset:51456
    ds_read_b64_tr_b16 v[152:153], v109 offset:49152
    ds_read_b64_tr_b16 v[154:155], v109 offset:49408
    ds_read_b64_tr_b16 v[156:157], v109 offset:51200
    ds_read_b64_tr_b16 v[158:159], v109 offset:51456
    s_waitcnt lgkmcnt(0)
    s_waitcnt vmcnt(24)
    s_barrier
    s_add_u32 s54, s10, 0xc0
    s_addc_u32 s55, s11, 0
    s_mov_b32 m0, 49152
    s_nop 0
    global_load_lds_dwordx4 v107, s[54:55]
    s_add_u32 s54, s10, 0x10c0
    s_addc_u32 s55, s11, 0
    s_mov_b32 m0, 50176
    s_nop 0
    global_load_lds_dwordx4 v107, s[54:55]
    s_add_u32 s54, s10, 0x20c0
    s_addc_u32 s55, s11, 0
    s_mov_b32 m0, 51200
    s_nop 0
    global_load_lds_dwordx4 v107, s[54:55]
    s_add_u32 s54, s10, 0x30c0
    s_addc_u32 s55, s11, 0
    s_mov_b32 m0, 52224
    s_nop 0
    global_load_lds_dwordx4 v107, s[54:55]
    ds_read_b64_tr_b16 a[224:225], v112 offset:0
    ds_read_b64_tr_b16 a[226:227], v112 offset:256
    ds_read_b64_tr_b16 a[228:229], v112 offset:2048
    ds_read_b64_tr_b16 a[230:231], v112 offset:2304
    ds_read_b64_tr_b16 v[160:161], v113 offset:0
    ds_read_b64_tr_b16 v[162:163], v113 offset:256
    ds_read_b64_tr_b16 v[164:165], v113 offset:2048
    ds_read_b64_tr_b16 v[166:167], v113 offset:2304
    s_waitcnt lgkmcnt(0)
    s_waitcnt vmcnt(24)
    s_barrier
    s_add_u32 s54, s10, 0x10000
    s_addc_u32 s55, s11, 0
    s_mov_b32 m0, 65536
    s_nop 0
    global_load_lds_dwordx4 v107, s[54:55]
    s_add_u32 s54, s10, 0x11000
    s_addc_u32 s55, s11, 0
    s_mov_b32 m0, 66560
    s_nop 0
    global_load_lds_dwordx4 v107, s[54:55]
    s_add_u32 s54, s10, 0x12000
    s_addc_u32 s55, s11, 0
    s_mov_b32 m0, 67584
    s_nop 0
    global_load_lds_dwordx4 v107, s[54:55]
    s_add_u32 s54, s10, 0x13000
    s_addc_u32 s55, s11, 0
    s_mov_b32 m0, 68608
    s_nop 0
    global_load_lds_dwordx4 v107, s[54:55]
    ds_read_b64_tr_b16 a[232:233], v112 offset:16384
    ds_read_b64_tr_b16 a[234:235], v112 offset:16640
    ds_read_b64_tr_b16 a[236:237], v112 offset:18432
    ds_read_b64_tr_b16 a[238:239], v112 offset:18688
    ds_read_b64_tr_b16 v[168:169], v113 offset:16384
    ds_read_b64_tr_b16 v[170:171], v113 offset:16640
    ds_read_b64_tr_b16 v[172:173], v113 offset:18432
    ds_read_b64_tr_b16 v[174:175], v113 offset:18688
    s_waitcnt lgkmcnt(0)
    s_waitcnt vmcnt(24)
    s_barrier
    ds_read_b64_tr_b16 a[240:241], v112 offset:32768
    ds_read_b64_tr_b16 a[242:243], v112 offset:33024
    ds_read_b64_tr_b16 a[244:245], v112 offset:34816
    ds_read_b64_tr_b16 a[246:247], v112 offset:35072
    ds_read_b64_tr_b16 v[176:177], v113 offset:32768
    ds_read_b64_tr_b16 v[178:179], v113 offset:33024
    ds_read_b64_tr_b16 v[180:181], v113 offset:34816
    ds_read_b64_tr_b16 v[182:183], v113 offset:35072
    s_waitcnt lgkmcnt(0)
    s_waitcnt vmcnt(20)
    s_barrier
    s_add_u32 s54, s10, 0x10040
    s_addc_u32 s55, s11, 0
    s_mov_b32 m0, 98304
    s_nop 0
    global_load_lds_dwordx4 v107, s[54:55]
    s_add_u32 s54, s10, 0x11040
    s_addc_u32 s55, s11, 0
    s_mov_b32 m0, 99328
    s_nop 0
    global_load_lds_dwordx4 v107, s[54:55]
    s_add_u32 s54, s10, 0x12040
    s_addc_u32 s55, s11, 0
    s_mov_b32 m0, 100352
    s_nop 0
    global_load_lds_dwordx4 v107, s[54:55]
    s_add_u32 s54, s10, 0x13040
    s_addc_u32 s55, s11, 0
    s_mov_b32 m0, 101376
    s_nop 0
    global_load_lds_dwordx4 v107, s[54:55]
    ds_read_b64_tr_b16 a[248:249], v112 offset:49152
    ds_read_b64_tr_b16 a[250:251], v112 offset:49408
    ds_read_b64_tr_b16 a[252:253], v112 offset:51200
    ds_read_b64_tr_b16 a[254:255], v112 offset:51456
    ds_read_b64_tr_b16 v[184:185], v113 offset:49152
    ds_read_b64_tr_b16 v[186:187], v113 offset:49408
    ds_read_b64_tr_b16 v[188:189], v113 offset:51200
    ds_read_b64_tr_b16 v[190:191], v113 offset:51456
    s_waitcnt lgkmcnt(0)
    s_waitcnt vmcnt(20)
    s_barrier
    ds_read_b64_tr_b16 v[192:193], v110 offset:0
    ds_read_b64_tr_b16 v[194:195], v110 offset:512
    ds_read_b64_tr_b16 v[196:197], v110 offset:2048
    ds_read_b64_tr_b16 v[198:199], v110 offset:2560
    ds_read_b64_tr_b16 v[200:201], v111 offset:0
    ds_read_b64_tr_b16 v[202:203], v111 offset:512
    ds_read_b64_tr_b16 v[204:205], v111 offset:2048
    ds_read_b64_tr_b16 v[206:207], v111 offset:2560
    s_waitcnt lgkmcnt(0)
    s_waitcnt vmcnt(16)
    s_barrier
    s_add_u32 s54, s10, 0x10080
    s_addc_u32 s55, s11, 0
    s_mov_b32 m0, 0
    s_nop 0
    global_load_lds_dwordx4 v107, s[54:55]
    s_add_u32 s54, s10, 0x11080
    s_addc_u32 s55, s11, 0
    s_mov_b32 m0, 1024
    s_nop 0
    global_load_lds_dwordx4 v107, s[54:55]
    s_add_u32 s54, s10, 0x12080
    s_addc_u32 s55, s11, 0
    s_mov_b32 m0, 2048
    s_nop 0
    global_load_lds_dwordx4 v107, s[54:55]
    s_add_u32 s54, s10, 0x13080
    s_addc_u32 s55, s11, 0
    s_mov_b32 m0, 3072
    s_nop 0
    global_load_lds_dwordx4 v107, s[54:55]
    ds_read_b64_tr_b16 v[208:209], v110 offset:16384
    ds_read_b64_tr_b16 v[210:211], v110 offset:16896
    ds_read_b64_tr_b16 v[212:213], v110 offset:18432
    ds_read_b64_tr_b16 v[214:215], v110 offset:18944
    ds_read_b64_tr_b16 v[216:217], v111 offset:16384
    ds_read_b64_tr_b16 v[218:219], v111 offset:16896
    ds_read_b64_tr_b16 v[220:221], v111 offset:18432
    ds_read_b64_tr_b16 v[222:223], v111 offset:18944
    s_waitcnt lgkmcnt(0)
    s_waitcnt vmcnt(16)
    s_barrier
    ds_read_b64_tr_b16 v[224:225], v110 offset:32768
    ds_read_b64_tr_b16 v[226:227], v110 offset:33280
    ds_read_b64_tr_b16 v[228:229], v110 offset:34816
    ds_read_b64_tr_b16 v[230:231], v110 offset:35328
    ds_read_b64_tr_b16 v[232:233], v111 offset:32768
    ds_read_b64_tr_b16 v[234:235], v111 offset:33280
    ds_read_b64_tr_b16 v[236:237], v111 offset:34816
    ds_read_b64_tr_b16 v[238:239], v111 offset:35328
    s_waitcnt lgkmcnt(0)
    s_waitcnt vmcnt(12)
    s_barrier
    s_add_u32 s54, s10, 0x100c0
    s_addc_u32 s55, s11, 0
    s_mov_b32 m0, 32768
    s_nop 0
    global_load_lds_dwordx4 v107, s[54:55]
    s_add_u32 s54, s10, 0x110c0
    s_addc_u32 s55, s11, 0
    s_mov_b32 m0, 33792
    s_nop 0
    global_load_lds_dwordx4 v107, s[54:55]
    s_add_u32 s54, s10, 0x120c0
    s_addc_u32 s55, s11, 0
    s_mov_b32 m0, 34816
    s_nop 0
    global_load_lds_dwordx4 v107, s[54:55]
    s_add_u32 s54, s10, 0x130c0
    s_addc_u32 s55, s11, 0
    s_mov_b32 m0, 35840
    s_nop 0
    global_load_lds_dwordx4 v107, s[54:55]
    ds_read_b64_tr_b16 v[240:241], v110 offset:49152
    ds_read_b64_tr_b16 v[242:243], v110 offset:49664
    ds_read_b64_tr_b16 v[244:245], v110 offset:51200
    ds_read_b64_tr_b16 v[246:247], v110 offset:51712
    ds_read_b64_tr_b16 v[248:249], v111 offset:49152
    ds_read_b64_tr_b16 v[250:251], v111 offset:49664
    ds_read_b64_tr_b16 v[252:253], v111 offset:51200
    ds_read_b64_tr_b16 v[254:255], v111 offset:51712
    s_waitcnt lgkmcnt(0)
    s_waitcnt vmcnt(12)
    s_barrier
    ds_read_b64_tr_b16 v[88:89], v114 offset:0
    ds_read_b64_tr_b16 v[90:91], v114 offset:512
    ds_read_b64_tr_b16 v[92:93], v114 offset:2048
    ds_read_b64_tr_b16 v[94:95], v114 offset:2560
    ds_read_b64_tr_b16 v[116:117], v115 offset:0
    ds_read_b64_tr_b16 v[118:119], v115 offset:512
    ds_read_b64_tr_b16 v[120:121], v115 offset:2048
    ds_read_b64_tr_b16 v[122:123], v115 offset:2560
    s_waitcnt lgkmcnt(0)
    ds_write_b128 v14, v[88:91] offset:16384
    ds_write_b128 v14, v[92:95] offset:17408
    ds_write_b128 v14, v[116:119] offset:18432
    ds_write_b128 v14, v[120:123] offset:19456
    s_waitcnt lgkmcnt(0)
    s_waitcnt vmcnt(8)
    s_barrier
    ds_read_b64_tr_b16 v[88:89], v114 offset:32768
    ds_read_b64_tr_b16 v[90:91], v114 offset:33280
    ds_read_b64_tr_b16 v[92:93], v114 offset:34816
    ds_read_b64_tr_b16 v[94:95], v114 offset:35328
    ds_read_b64_tr_b16 v[116:117], v115 offset:32768
    ds_read_b64_tr_b16 v[118:119], v115 offset:33280
    ds_read_b64_tr_b16 v[120:121], v115 offset:34816
    ds_read_b64_tr_b16 v[122:123], v115 offset:35328
    s_waitcnt lgkmcnt(0)
    ds_write_b128 v14, v[88:91] offset:20480
    ds_write_b128 v14, v[92:95] offset:21504
    ds_write_b128 v14, v[116:119] offset:22528
    ds_write_b128 v14, v[120:123] offset:23552
    s_waitcnt lgkmcnt(0)
    s_waitcnt vmcnt(4)
    s_barrier
    ds_read_b64_tr_b16 v[88:89], v110 offset:0
    ds_read_b64_tr_b16 v[90:91], v110 offset:512
    ds_read_b64_tr_b16 v[92:93], v110 offset:2048
    ds_read_b64_tr_b16 v[94:95], v110 offset:2560
    ds_read_b64_tr_b16 v[116:117], v111 offset:0
    ds_read_b64_tr_b16 v[118:119], v111 offset:512
    ds_read_b64_tr_b16 v[120:121], v111 offset:2048
    ds_read_b64_tr_b16 v[122:123], v111 offset:2560
    s_waitcnt lgkmcnt(0)
    ds_write_b128 v14, v[88:91] offset:24576
    ds_write_b128 v14, v[92:95] offset:25600
    ds_write_b128 v14, v[116:119] offset:26624
    ds_write_b128 v14, v[120:123] offset:27648
    s_waitcnt lgkmcnt(0)
    s_waitcnt vmcnt(0)
    s_barrier
    ds_read_b64_tr_b16 v[88:89], v110 offset:32768
    ds_read_b64_tr_b16 v[90:91], v110 offset:33280
    ds_read_b64_tr_b16 v[92:93], v110 offset:34816
    ds_read_b64_tr_b16 v[94:95], v110 offset:35328
    ds_read_b64_tr_b16 v[116:117], v111 offset:32768
    ds_read_b64_tr_b16 v[118:119], v111 offset:33280
    ds_read_b64_tr_b16 v[120:121], v111 offset:34816
    ds_read_b64_tr_b16 v[122:123], v111 offset:35328
    s_waitcnt lgkmcnt(0)
    ds_write_b128 v14, v[88:91] offset:28672
    ds_write_b128 v14, v[92:95] offset:29696
    ds_write_b128 v14, v[116:119] offset:30720
    ds_write_b128 v14, v[120:123] offset:31744
    s_waitcnt lgkmcnt(0)
    s_barrier
    ds_write_b128 v14, v[24:27] offset:0
    ds_write_b128 v14, v[28:31] offset:1024
    ds_write_b128 v14, v[32:35] offset:2048
    ds_write_b128 v14, v[36:39] offset:3072
    ds_write_b128 v14, v[40:43] offset:4096
    ds_write_b128 v14, v[44:47] offset:5120
    ds_write_b128 v14, v[48:51] offset:6144
    ds_write_b128 v14, v[52:55] offset:7168
    ds_write_b128 v14, v[56:59] offset:8192
    ds_write_b128 v14, v[60:63] offset:9216
    ds_write_b128 v14, v[64:67] offset:10240
    ds_write_b128 v14, v[68:71] offset:11264
    ds_write_b128 v14, v[72:75] offset:12288
    ds_write_b128 v14, v[76:79] offset:13312
    ds_write_b128 v14, v[80:83] offset:14336
    ds_write_b128 v14, v[84:87] offset:15360
    s_waitcnt lgkmcnt(0)
    s_branch L_c_loaded
L_c_load1:
    s_waitcnt vmcnt(32)
    s_barrier
    s_add_u32 s54, s4, 0x380000
    s_addc_u32 s55, s5, 0
    s_mov_b32 m0, 118784
    s_nop 0
    global_load_lds_dwordx4 v106, s[54:55]
    s_add_u32 s54, s4, 0x388000
    s_addc_u32 s55, s5, 0
    s_mov_b32 m0, 119808
    s_nop 0
    global_load_lds_dwordx4 v106, s[54:55]
    s_add_u32 s54, s4, 0x390000
    s_addc_u32 s55, s5, 0
    s_mov_b32 m0, 120832
    s_nop 0
    global_load_lds_dwordx4 v106, s[54:55]
    s_add_u32 s54, s4, 0x398000
    s_addc_u32 s55, s5, 0
    s_mov_b32 m0, 121856
    s_nop 0
    global_load_lds_dwordx4 v106, s[54:55]
    ds_read_b64_tr_b16 a[32:33], v108 offset:0
    ds_read_b64_tr_b16 a[34:35], v108 offset:256
    ds_read_b64_tr_b16 a[36:37], v108 offset:2048
    ds_read_b64_tr_b16 a[38:39], v108 offset:2304
    ds_read_b64_tr_b16 a[80:81], v109 offset:0
    ds_read_b64_tr_b16 a[82:83], v109 offset:256
    ds_read_b64_tr_b16 a[84:85], v109 offset:2048
    ds_read_b64_tr_b16 a[86:87], v109 offset:2304
    s_waitcnt lgkmcnt(0)
    s_waitcnt vmcnt(32)
    s_barrier
    s_add_u32 s54, s6, 0x0
    s_addc_u32 s55, s7, 0
    s_mov_b32 m0, 4096
    s_nop 0
    global_load_lds_dwordx4 v106, s[54:55]
    s_add_u32 s54, s6, 0x8000
    s_addc_u32 s55, s7, 0
    s_mov_b32 m0, 5120
    s_nop 0
    global_load_lds_dwordx4 v106, s[54:55]
    s_add_u32 s54, s6, 0x10000
    s_addc_u32 s55, s7, 0
    s_mov_b32 m0, 6144
    s_nop 0
    global_load_lds_dwordx4 v106, s[54:55]
    s_add_u32 s54, s6, 0x18000
    s_addc_u32 s55, s7, 0
    s_mov_b32 m0, 7168
    s_nop 0
    global_load_lds_dwordx4 v106, s[54:55]
    ds_read_b64_tr_b16 a[40:41], v108 offset:16384
    ds_read_b64_tr_b16 a[42:43], v108 offset:16640
    ds_read_b64_tr_b16 a[44:45], v108 offset:18432
    ds_read_b64_tr_b16 a[46:47], v108 offset:18688
    ds_read_b64_tr_b16 a[88:89], v109 offset:16384
    ds_read_b64_tr_b16 a[90:91], v109 offset:16640
    ds_read_b64_tr_b16 a[92:93], v109 offset:18432
    ds_read_b64_tr_b16 a[94:95], v109 offset:18688
    s_waitcnt lgkmcnt(0)
    s_waitcnt vmcnt(32)
    s_barrier
    s_add_u32 s54, s6, 0x80000
    s_addc_u32 s55, s7, 0
    s_mov_b32 m0, 20480
    s_nop 0
    global_load_lds_dwordx4 v106, s[54:55]
    s_add_u32 s54, s6, 0x88000
    s_addc_u32 s55, s7, 0
    s_mov_b32 m0, 21504
    s_nop 0
    global_load_lds_dwordx4 v106, s[54:55]
    s_add_u32 s54, s6, 0x90000
    s_addc_u32 s55, s7, 0
    s_mov_b32 m0, 22528
    s_nop 0
    global_load_lds_dwordx4 v106, s[54:55]
    s_add_u32 s54, s6, 0x98000
    s_addc_u32 s55, s7, 0
    s_mov_b32 m0, 23552
    s_nop 0
    global_load_lds_dwordx4 v106, s[54:55]
    ds_read_b64_tr_b16 v[24:25], v108 offset:32768
    ds_read_b64_tr_b16 v[26:27], v108 offset:33024
    ds_read_b64_tr_b16 v[28:29], v108 offset:34816
    ds_read_b64_tr_b16 v[30:31], v108 offset:35072
    ds_read_b64_tr_b16 v[32:33], v109 offset:32768
    ds_read_b64_tr_b16 v[34:35], v109 offset:33024
    ds_read_b64_tr_b16 v[36:37], v109 offset:34816
    ds_read_b64_tr_b16 v[38:39], v109 offset:35072
    s_waitcnt lgkmcnt(0)
    s_waitcnt vmcnt(32)
    s_barrier
    s_add_u32 s54, s6, 0x100000
    s_addc_u32 s55, s7, 0
    s_mov_b32 m0, 36864
    s_nop 0
    global_load_lds_dwordx4 v106, s[54:55]
    s_add_u32 s54, s6, 0x108000
    s_addc_u32 s55, s7, 0
    s_mov_b32 m0, 37888
    s_nop 0
    global_load_lds_dwordx4 v106, s[54:55]
    s_add_u32 s54, s6, 0x110000
    s_addc_u32 s55, s7, 0
    s_mov_b32 m0, 38912
    s_nop 0
    global_load_lds_dwordx4 v106, s[54:55]
    s_add_u32 s54, s6, 0x118000
    s_addc_u32 s55, s7, 0
    s_mov_b32 m0, 39936
    s_nop 0
    global_load_lds_dwordx4 v106, s[54:55]
    ds_read_b64_tr_b16 v[40:41], v108 offset:49152
    ds_read_b64_tr_b16 v[42:43], v108 offset:49408
    ds_read_b64_tr_b16 v[44:45], v108 offset:51200
    ds_read_b64_tr_b16 v[46:47], v108 offset:51456
    ds_read_b64_tr_b16 v[48:49], v109 offset:49152
    ds_read_b64_tr_b16 v[50:51], v109 offset:49408
    ds_read_b64_tr_b16 v[52:53], v109 offset:51200
    ds_read_b64_tr_b16 v[54:55], v109 offset:51456
    s_waitcnt lgkmcnt(0)
    s_waitcnt vmcnt(32)
    s_barrier
    s_add_u32 s54, s6, 0x180000
    s_addc_u32 s55, s7, 0
    s_mov_b32 m0, 53248
    s_nop 0
    global_load_lds_dwordx4 v106, s[54:55]
    s_add_u32 s54, s6, 0x188000
    s_addc_u32 s55, s7, 0
    s_mov_b32 m0, 54272
    s_nop 0
    global_load_lds_dwordx4 v106, s[54:55]
    s_add_u32 s54, s6, 0x190000
    s_addc_u32 s55, s7, 0
    s_mov_b32 m0, 55296
    s_nop 0
    global_load_lds_dwordx4 v106, s[54:55]
    s_add_u32 s54, s6, 0x198000
    s_addc_u32 s55, s7, 0
    s_mov_b32 m0, 56320
    s_nop 0
    global_load_lds_dwordx4 v106, s[54:55]
    ds_read_b64_tr_b16 a[0:1], v112 offset:0
    ds_read_b64_tr_b16 a[2:3], v112 offset:256
    ds_read_b64_tr_b16 a[4:5], v112 offset:2048
    ds_read_b64_tr_b16 a[6:7], v112 offset:2304
    ds_read_b64_tr_b16 a[48:49], v113 offset:0
    ds_read_b64_tr_b16 a[50:51], v113 offset:256
    ds_read_b64_tr_b16 a[52:53], v113 offset:2048
    ds_read_b64_tr_b16 a[54:55], v113 offset:2304
    s_waitcnt lgkmcnt(0)
    s_waitcnt vmcnt(32)
    s_barrier
    s_add_u32 s54, s6, 0x200000
    s_addc_u32 s55, s7, 0
    s_mov_b32 m0, 69632
    s_nop 0
    global_load_lds_dwordx4 v106, s[54:55]
    s_add_u32 s54, s6, 0x208000
    s_addc_u32 s55, s7, 0
    s_mov_b32 m0, 70656
    s_nop 0
    global_load_lds_dwordx4 v106, s[54:55]
    s_add_u32 s54, s6, 0x210000
    s_addc_u32 s55, s7, 0
    s_mov_b32 m0, 71680
    s_nop 0
    global_load_lds_dwordx4 v106, s[54:55]
    s_add_u32 s54, s6, 0x218000
    s_addc_u32 s55, s7, 0
    s_mov_b32 m0, 72704
    s_nop 0
    global_load_lds_dwordx4 v106, s[54:55]
    ds_read_b64_tr_b16 a[8:9], v112 offset:16384
    ds_read_b64_tr_b16 a[10:11], v112 offset:16640
    ds_read_b64_tr_b16 a[12:13], v112 offset:18432
    ds_read_b64_tr_b16 a[14:15], v112 offset:18688
    ds_read_b64_tr_b16 a[56:57], v113 offset:16384
    ds_read_b64_tr_b16 a[58:59], v113 offset:16640
    ds_read_b64_tr_b16 a[60:61], v113 offset:18432
    ds_read_b64_tr_b16 a[62:63], v113 offset:18688
    s_waitcnt lgkmcnt(0)
    s_waitcnt vmcnt(32)
    s_barrier
    s_add_u32 s54, s6, 0x280000
    s_addc_u32 s55, s7, 0
    s_mov_b32 m0, 86016
    s_nop 0
    global_load_lds_dwordx4 v106, s[54:55]
    s_add_u32 s54, s6, 0x288000
    s_addc_u32 s55, s7, 0
    s_mov_b32 m0, 87040
    s_nop 0
    global_load_lds_dwordx4 v106, s[54:55]
    s_add_u32 s54, s6, 0x290000
    s_addc_u32 s55, s7, 0
    s_mov_b32 m0, 88064
    s_nop 0
    global_load_lds_dwordx4 v106, s[54:55]
    s_add_u32 s54, s6, 0x298000
    s_addc_u32 s55, s7, 0
    s_mov_b32 m0, 89088
    s_nop 0
    global_load_lds_dwordx4 v106, s[54:55]
    ds_read_b64_tr_b16 a[16:17], v112 offset:32768
    ds_read_b64_tr_b16 a[18:19], v112 offset:33024
    ds_read_b64_tr_b16 a[20:21], v112 offset:34816
    ds_read_b64_tr_b16 a[22:23], v112 offset:35072
    ds_read_b64_tr_b16 a[64:65], v113 offset:32768
    ds_read_b64_tr_b16 a[66:67], v113 offset:33024
    ds_read_b64_tr_b16 a[68:69], v113 offset:34816
    ds_read_b64_tr_b16 a[70:71], v113 offset:35072
    s_waitcnt lgkmcnt(0)
    s_waitcnt vmcnt(24)
    s_barrier
    s_add_u32 s54, s6, 0x300000
    s_addc_u32 s55, s7, 0
    s_mov_b32 m0, 102400
    s_nop 0
    global_load_lds_dwordx4 v106, s[54:55]
    s_add_u32 s54, s6, 0x308000
    s_addc_u32 s55, s7, 0
    s_mov_b32 m0, 103424
    s_nop 0
    global_load_lds_dwordx4 v106, s[54:55]
    s_add_u32 s54, s6, 0x310000
    s_addc_u32 s55, s7, 0
    s_mov_b32 m0, 104448
    s_nop 0
    global_load_lds_dwordx4 v106, s[54:55]
    s_add_u32 s54, s6, 0x318000
    s_addc_u32 s55, s7, 0
    s_mov_b32 m0, 105472
    s_nop 0
    global_load_lds_dwordx4 v106, s[54:55]
    ds_read_b64_tr_b16 a[24:25], v112 offset:49152
    ds_read_b64_tr_b16 a[26:27], v112 offset:49408
    ds_read_b64_tr_b16 a[28:29], v112 offset:51200
    ds_read_b64_tr_b16 a[30:31], v112 offset:51456
    ds_read_b64_tr_b16 a[72:73], v113 offset:49152
    ds_read_b64_tr_b16 a[74:75], v113 offset:49408
    ds_read_b64_tr_b16 a[76:77], v113 offset:51200
    ds_read_b64_tr_b16 a[78:79], v113 offset:51456
    s_waitcnt lgkmcnt(0)
    s_waitcnt vmcnt(24)
    s_barrier
    s_add_u32 s54, s6, 0x380000
    s_addc_u32 s55, s7, 0
    s_mov_b32 m0, 118784
    s_nop 0
    global_load_lds_dwordx4 v106, s[54:55]
    s_add_u32 s54, s6, 0x388000
    s_addc_u32 s55, s7, 0
    s_mov_b32 m0, 119808
    s_nop 0
    global_load_lds_dwordx4 v106, s[54:55]
    s_add_u32 s54, s6, 0x390000
    s_addc_u32 s55, s7, 0
    s_mov_b32 m0, 120832
    s_nop 0
    global_load_lds_dwordx4 v106, s[54:55]
    s_add_u32 s54, s6, 0x398000
    s_addc_u32 s55, s7, 0
    s_mov_b32 m0, 121856
    s_nop 0
    global_load_lds_dwordx4 v106, s[54:55]
    ds_read_b64_tr_b16 a[128:129], v108 offset:0
    ds_read_b64_tr_b16 a[130:131], v108 offset:256
    ds_read_b64_tr_b16 a[132:133], v108 offset:2048
    ds_read_b64_tr_b16 a[134:135], v108 offset:2304
    ds_read_b64_tr_b16 a[176:177], v109 offset:0
    ds_read_b64_tr_b16 a[178:179], v109 offset:256
    ds_read_b64_tr_b16 a[180:181], v109 offset:2048
    ds_read_b64_tr_b16 a[182:183], v109 offset:2304
    s_waitcnt lgkmcnt(0)
    s_waitcnt vmcnt(24)
    s_barrier
    s_add_u32 s54, s8, 0x0
    s_addc_u32 s55, s9, 0
    s_mov_b32 m0, 4096
    s_nop 0
    global_load_lds_dwordx4 v106, s[54:55]
    s_add_u32 s54, s8, 0x8000
    s_addc_u32 s55, s9, 0
    s_mov_b32 m0, 5120
    s_nop 0
    global_load_lds_dwordx4 v106, s[54:55]
    s_add_u32 s54, s8, 0x10000
    s_addc_u32 s55, s9, 0
    s_mov_b32 m0, 6144
    s_nop 0
    global_load_lds_dwordx4 v106, s[54:55]
    s_add_u32 s54, s8, 0x18000
    s_addc_u32 s55, s9, 0
    s_mov_b32 m0, 7168
    s_nop 0
    global_load_lds_dwordx4 v106, s[54:55]
    ds_read_b64_tr_b16 a[136:137], v108 offset:16384
    ds_read_b64_tr_b16 a[138:139], v108 offset:16640
    ds_read_b64_tr_b16 a[140:141], v108 offset:18432
    ds_read_b64_tr_b16 a[142:143], v108 offset:18688
    ds_read_b64_tr_b16 a[184:185], v109 offset:16384
    ds_read_b64_tr_b16 a[186:187], v109 offset:16640
    ds_read_b64_tr_b16 a[188:189], v109 offset:18432
    ds_read_b64_tr_b16 a[190:191], v109 offset:18688
    s_waitcnt lgkmcnt(0)
    s_waitcnt vmcnt(24)
    s_barrier
    s_add_u32 s54, s8, 0x80000
    s_addc_u32 s55, s9, 0
    s_mov_b32 m0, 20480
    s_nop 0
    global_load_lds_dwordx4 v106, s[54:55]
    s_add_u32 s54, s8, 0x88000
    s_addc_u32 s55, s9, 0
    s_mov_b32 m0, 21504
    s_nop 0
    global_load_lds_dwordx4 v106, s[54:55]
    s_add_u32 s54, s8, 0x90000
    s_addc_u32 s55, s9, 0
    s_mov_b32 m0, 22528
    s_nop 0
    global_load_lds_dwordx4 v106, s[54:55]
    s_add_u32 s54, s8, 0x98000
    s_addc_u32 s55, s9, 0
    s_mov_b32 m0, 23552
    s_nop 0
    global_load_lds_dwordx4 v106, s[54:55]
    v_and_b32 v104, 15, v100
    v_lshrrev_b32 v105, 4, v100
    v_lshrrev_b32 v101, 2, v104
    v_lshlrev_b32 v101, 1, v101
    v_and_b32 v102, 1, v104
    v_add_u32 v101, v101, v102
    v_lshlrev_b32 v101, 10, v101
    v_bfe_u32 v102, v104, 1, 1
    v_lshlrev_b32 v102, 6, v102
    v_lshl_add_u32 v102, v105, 3, v102
    v_add_u32 v101, v101, v102
    s_lshl_b32 s52, s19, 8
    v_add_u32 v101, s52, v101
    global_load_dwordx2 v[96:97], v101, s[12:13]
    global_load_dwordx2 v[98:99], v101, s[12:13] offset:32
    global_load_dwordx2 v[124:125], v101, s[12:13] offset:128
    global_load_dwordx2 v[126:127], v101, s[12:13] offset:160
    ds_read_b64_tr_b16 v[56:57], v108 offset:32768
    ds_read_b64_tr_b16 v[58:59], v108 offset:33024
    ds_read_b64_tr_b16 v[60:61], v108 offset:34816
    ds_read_b64_tr_b16 v[62:63], v108 offset:35072
    ds_read_b64_tr_b16 v[64:65], v109 offset:32768
    ds_read_b64_tr_b16 v[66:67], v109 offset:33024
    ds_read_b64_tr_b16 v[68:69], v109 offset:34816
    ds_read_b64_tr_b16 v[70:71], v109 offset:35072
    s_waitcnt lgkmcnt(0)
    s_waitcnt vmcnt(28)
    s_barrier
    s_add_u32 s54, s8, 0x100000
    s_addc_u32 s55, s9, 0
    s_mov_b32 m0, 36864
    s_nop 0
    global_load_lds_dwordx4 v106, s[54:55]
    s_add_u32 s54, s8, 0x108000
    s_addc_u32 s55, s9, 0
    s_mov_b32 m0, 37888
    s_nop 0
    global_load_lds_dwordx4 v106, s[54:55]
    s_add_u32 s54, s8, 0x110000
    s_addc_u32 s55, s9, 0
    s_mov_b32 m0, 38912
    s_nop 0
    global_load_lds_dwordx4 v106, s[54:55]
    s_add_u32 s54, s8, 0x118000
    s_addc_u32 s55, s9, 0
    s_mov_b32 m0, 39936
    s_nop 0
    global_load_lds_dwordx4 v106, s[54:55]
    ds_read_b64_tr_b16 v[72:73], v108 offset:49152
    ds_read_b64_tr_b16 v[74:75], v108 offset:49408
    ds_read_b64_tr_b16 v[76:77], v108 offset:51200
    ds_read_b64_tr_b16 v[78:79], v108 offset:51456
    ds_read_b64_tr_b16 v[80:81], v109 offset:49152
    ds_read_b64_tr_b16 v[82:83], v109 offset:49408
    ds_read_b64_tr_b16 v[84:85], v109 offset:51200
    ds_read_b64_tr_b16 v[86:87], v109 offset:51456
    s_waitcnt lgkmcnt(0)
    s_waitcnt vmcnt(28)
    s_barrier
    s_add_u32 s54, s8, 0x180000
    s_addc_u32 s55, s9, 0
    s_mov_b32 m0, 53248
    s_nop 0
    global_load_lds_dwordx4 v106, s[54:55]
    s_add_u32 s54, s8, 0x188000
    s_addc_u32 s55, s9, 0
    s_mov_b32 m0, 54272
    s_nop 0
    global_load_lds_dwordx4 v106, s[54:55]
    s_add_u32 s54, s8, 0x190000
    s_addc_u32 s55, s9, 0
    s_mov_b32 m0, 55296
    s_nop 0
    global_load_lds_dwordx4 v106, s[54:55]
    s_add_u32 s54, s8, 0x198000
    s_addc_u32 s55, s9, 0
    s_mov_b32 m0, 56320
    s_nop 0
    global_load_lds_dwordx4 v106, s[54:55]
    ds_read_b64_tr_b16 a[96:97], v112 offset:0
    ds_read_b64_tr_b16 a[98:99], v112 offset:256
    ds_read_b64_tr_b16 a[100:101], v112 offset:2048
    ds_read_b64_tr_b16 a[102:103], v112 offset:2304
    ds_read_b64_tr_b16 a[144:145], v113 offset:0
    ds_read_b64_tr_b16 a[146:147], v113 offset:256
    ds_read_b64_tr_b16 a[148:149], v113 offset:2048
    ds_read_b64_tr_b16 a[150:151], v113 offset:2304
    s_waitcnt lgkmcnt(0)
    s_waitcnt vmcnt(28)
    s_barrier
    s_add_u32 s54, s8, 0x200000
    s_addc_u32 s55, s9, 0
    s_mov_b32 m0, 69632
    s_nop 0
    global_load_lds_dwordx4 v106, s[54:55]
    s_add_u32 s54, s8, 0x208000
    s_addc_u32 s55, s9, 0
    s_mov_b32 m0, 70656
    s_nop 0
    global_load_lds_dwordx4 v106, s[54:55]
    s_add_u32 s54, s8, 0x210000
    s_addc_u32 s55, s9, 0
    s_mov_b32 m0, 71680
    s_nop 0
    global_load_lds_dwordx4 v106, s[54:55]
    s_add_u32 s54, s8, 0x218000
    s_addc_u32 s55, s9, 0
    s_mov_b32 m0, 72704
    s_nop 0
    global_load_lds_dwordx4 v106, s[54:55]
    ds_read_b64_tr_b16 a[104:105], v112 offset:16384
    ds_read_b64_tr_b16 a[106:107], v112 offset:16640
    ds_read_b64_tr_b16 a[108:109], v112 offset:18432
    ds_read_b64_tr_b16 a[110:111], v112 offset:18688
    ds_read_b64_tr_b16 a[152:153], v113 offset:16384
    ds_read_b64_tr_b16 a[154:155], v113 offset:16640
    ds_read_b64_tr_b16 a[156:157], v113 offset:18432
    ds_read_b64_tr_b16 a[158:159], v113 offset:18688
    s_waitcnt lgkmcnt(0)
    s_waitcnt vmcnt(28)
    s_barrier
    s_add_u32 s54, s8, 0x280000
    s_addc_u32 s55, s9, 0
    s_mov_b32 m0, 86016
    s_nop 0
    global_load_lds_dwordx4 v106, s[54:55]
    s_add_u32 s54, s8, 0x288000
    s_addc_u32 s55, s9, 0
    s_mov_b32 m0, 87040
    s_nop 0
    global_load_lds_dwordx4 v106, s[54:55]
    s_add_u32 s54, s8, 0x290000
    s_addc_u32 s55, s9, 0
    s_mov_b32 m0, 88064
    s_nop 0
    global_load_lds_dwordx4 v106, s[54:55]
    s_add_u32 s54, s8, 0x298000
    s_addc_u32 s55, s9, 0
    s_mov_b32 m0, 89088
    s_nop 0
    global_load_lds_dwordx4 v106, s[54:55]
    ds_read_b64_tr_b16 a[112:113], v112 offset:32768
    ds_read_b64_tr_b16 a[114:115], v112 offset:33024
    ds_read_b64_tr_b16 a[116:117], v112 offset:34816
    ds_read_b64_tr_b16 a[118:119], v112 offset:35072
    ds_read_b64_tr_b16 a[160:161], v113 offset:32768
    ds_read_b64_tr_b16 a[162:163], v113 offset:33024
    ds_read_b64_tr_b16 a[164:165], v113 offset:34816
    ds_read_b64_tr_b16 a[166:167], v113 offset:35072
    s_waitcnt lgkmcnt(0)
    s_waitcnt vmcnt(28)
    s_barrier
    s_add_u32 s54, s8, 0x300000
    s_addc_u32 s55, s9, 0
    s_mov_b32 m0, 102400
    s_nop 0
    global_load_lds_dwordx4 v106, s[54:55]
    s_add_u32 s54, s8, 0x308000
    s_addc_u32 s55, s9, 0
    s_mov_b32 m0, 103424
    s_nop 0
    global_load_lds_dwordx4 v106, s[54:55]
    s_add_u32 s54, s8, 0x310000
    s_addc_u32 s55, s9, 0
    s_mov_b32 m0, 104448
    s_nop 0
    global_load_lds_dwordx4 v106, s[54:55]
    s_add_u32 s54, s8, 0x318000
    s_addc_u32 s55, s9, 0
    s_mov_b32 m0, 105472
    s_nop 0
    global_load_lds_dwordx4 v106, s[54:55]
    ds_read_b64_tr_b16 a[120:121], v112 offset:49152
    ds_read_b64_tr_b16 a[122:123], v112 offset:49408
    ds_read_b64_tr_b16 a[124:125], v112 offset:51200
    ds_read_b64_tr_b16 a[126:127], v112 offset:51456
    ds_read_b64_tr_b16 a[168:169], v113 offset:49152
    ds_read_b64_tr_b16 a[170:171], v113 offset:49408
    ds_read_b64_tr_b16 a[172:173], v113 offset:51200
    ds_read_b64_tr_b16 a[174:175], v113 offset:51456
    s_waitcnt lgkmcnt(0)
    s_waitcnt vmcnt(28)
    s_barrier
    s_add_u32 s54, s8, 0x380000
    s_addc_u32 s55, s9, 0
    s_mov_b32 m0, 118784
    s_nop 0
    global_load_lds_dwordx4 v106, s[54:55]
    s_add_u32 s54, s8, 0x388000
    s_addc_u32 s55, s9, 0
    s_mov_b32 m0, 119808
    s_nop 0
    global_load_lds_dwordx4 v106, s[54:55]
    s_add_u32 s54, s8, 0x390000
    s_addc_u32 s55, s9, 0
    s_mov_b32 m0, 120832
    s_nop 0
    global_load_lds_dwordx4 v106, s[54:55]
    s_add_u32 s54, s8, 0x398000
    s_addc_u32 s55, s9, 0
    s_mov_b32 m0, 121856
    s_nop 0
    global_load_lds_dwordx4 v106, s[54:55]
    ds_read_b64_tr_b16 a[192:193], v108 offset:0
    ds_read_b64_tr_b16 a[194:195], v108 offset:256
    ds_read_b64_tr_b16 a[196:197], v108 offset:2048
    ds_read_b64_tr_b16 a[198:199], v108 offset:2304
    ds_read_b64_tr_b16 v[128:129], v109 offset:0
    ds_read_b64_tr_b16 v[130:131], v109 offset:256
    ds_read_b64_tr_b16 v[132:133], v109 offset:2048
    ds_read_b64_tr_b16 v[134:135], v109 offset:2304
    s_waitcnt lgkmcnt(0)
    s_waitcnt vmcnt(28)
    s_barrier
    s_add_u32 s54, s10, 0x0
    s_addc_u32 s55, s11, 0
    s_mov_b32 m0, 4096
    s_nop 0
    global_load_lds_dwordx4 v107, s[54:55]
    s_add_u32 s54, s10, 0x1000
    s_addc_u32 s55, s11, 0
    s_mov_b32 m0, 5120
    s_nop 0
    global_load_lds_dwordx4 v107, s[54:55]
    s_add_u32 s54, s10, 0x2000
    s_addc_u32 s55, s11, 0
    s_mov_b32 m0, 6144
    s_nop 0
    global_load_lds_dwordx4 v107, s[54:55]
    s_add_u32 s54, s10, 0x3000
    s_addc_u32 s55, s11, 0
    s_mov_b32 m0, 7168
    s_nop 0
    global_load_lds_dwordx4 v107, s[54:55]
    ds_read_b64_tr_b16 a[200:201], v108 offset:16384
    ds_read_b64_tr_b16 a[202:203], v108 offset:16640
    ds_read_b64_tr_b16 a[204:205], v108 offset:18432
    ds_read_b64_tr_b16 a[206:207], v108 offset:18688
    ds_read_b64_tr_b16 v[136:137], v109 offset:16384
    ds_read_b64_tr_b16 v[138:139], v109 offset:16640
    ds_read_b64_tr_b16 v[140:141], v109 offset:18432
    ds_read_b64_tr_b16 v[142:143], v109 offset:18688
    s_waitcnt lgkmcnt(0)
    s_waitcnt vmcnt(24)
    s_barrier
    s_add_u32 s54, s10, 0x40
    s_addc_u32 s55, s11, 0
    s_mov_b32 m0, 20480
    s_nop 0
    global_load_lds_dwordx4 v107, s[54:55]
    s_add_u32 s54, s10, 0x1040
    s_addc_u32 s55, s11, 0
    s_mov_b32 m0, 21504
    s_nop 0
    global_load_lds_dwordx4 v107, s[54:55]
    s_add_u32 s54, s10, 0x2040
    s_addc_u32 s55, s11, 0
    s_mov_b32 m0, 22528
    s_nop 0
    global_load_lds_dwordx4 v107, s[54:55]
    s_add_u32 s54, s10, 0x3040
    s_addc_u32 s55, s11, 0
    s_mov_b32 m0, 23552
    s_nop 0
    global_load_lds_dwordx4 v107, s[54:55]
    ds_read_b64_tr_b16 a[208:209], v108 offset:32768
    ds_read_b64_tr_b16 a[210:211], v108 offset:33024
    ds_read_b64_tr_b16 a[212:213], v108 offset:34816
    ds_read_b64_tr_b16 a[214:215], v108 offset:35072
    ds_read_b64_tr_b16 v[144:145], v109 offset:32768
    ds_read_b64_tr_b16 v[146:147], v109 offset:33024
    ds_read_b64_tr_b16 v[148:149], v109 offset:34816
    ds_read_b64_tr_b16 v[150:151], v109 offset:35072
    s_waitcnt lgkmcnt(0)
    s_waitcnt vmcnt(24)
    s_barrier
    s_add_u32 s54, s10, 0x80
    s_addc_u32 s55, s11, 0
    s_mov_b32 m0, 36864
    s_nop 0
    global_load_lds_dwordx4 v107, s[54:55]
    s_add_u32 s54, s10, 0x1080
    s_addc_u32 s55, s11, 0
    s_mov_b32 m0, 37888
    s_nop 0
    global_load_lds_dwordx4 v107, s[54:55]
    s_add_u32 s54, s10, 0x2080
    s_addc_u32 s55, s11, 0
    s_mov_b32 m0, 38912
    s_nop 0
    global_load_lds_dwordx4 v107, s[54:55]
    s_add_u32 s54, s10, 0x3080
    s_addc_u32 s55, s11, 0
    s_mov_b32 m0, 39936
    s_nop 0
    global_load_lds_dwordx4 v107, s[54:55]
    ds_read_b64_tr_b16 a[216:217], v108 offset:49152
    ds_read_b64_tr_b16 a[218:219], v108 offset:49408
    ds_read_b64_tr_b16 a[220:221], v108 offset:51200
    ds_read_b64_tr_b16 a[222:223], v108 offset:51456
    ds_read_b64_tr_b16 v[152:153], v109 offset:49152
    ds_read_b64_tr_b16 v[154:155], v109 offset:49408
    ds_read_b64_tr_b16 v[156:157], v109 offset:51200
    ds_read_b64_tr_b16 v[158:159], v109 offset:51456
    s_waitcnt lgkmcnt(0)
    s_waitcnt vmcnt(24)
    s_barrier
    s_add_u32 s54, s10, 0xc0
    s_addc_u32 s55, s11, 0
    s_mov_b32 m0, 53248
    s_nop 0
    global_load_lds_dwordx4 v107, s[54:55]
    s_add_u32 s54, s10, 0x10c0
    s_addc_u32 s55, s11, 0
    s_mov_b32 m0, 54272
    s_nop 0
    global_load_lds_dwordx4 v107, s[54:55]
    s_add_u32 s54, s10, 0x20c0
    s_addc_u32 s55, s11, 0
    s_mov_b32 m0, 55296
    s_nop 0
    global_load_lds_dwordx4 v107, s[54:55]
    s_add_u32 s54, s10, 0x30c0
    s_addc_u32 s55, s11, 0
    s_mov_b32 m0, 56320
    s_nop 0
    global_load_lds_dwordx4 v107, s[54:55]
    ds_read_b64_tr_b16 a[224:225], v112 offset:0
    ds_read_b64_tr_b16 a[226:227], v112 offset:256
    ds_read_b64_tr_b16 a[228:229], v112 offset:2048
    ds_read_b64_tr_b16 a[230:231], v112 offset:2304
    ds_read_b64_tr_b16 v[160:161], v113 offset:0
    ds_read_b64_tr_b16 v[162:163], v113 offset:256
    ds_read_b64_tr_b16 v[164:165], v113 offset:2048
    ds_read_b64_tr_b16 v[166:167], v113 offset:2304
    s_waitcnt lgkmcnt(0)
    s_waitcnt vmcnt(24)
    s_barrier
    s_add_u32 s54, s10, 0x10000
    s_addc_u32 s55, s11, 0
    s_mov_b32 m0, 69632
    s_nop 0
    global_load_lds_dwordx4 v107, s[54:55]
    s_add_u32 s54, s10, 0x11000
    s_addc_u32 s55, s11, 0
    s_mov_b32 m0, 70656
    s_nop 0
    global_load_lds_dwordx4 v107, s[54:55]
    s_add_u32 s54, s10, 0x12000
    s_addc_u32 s55, s11, 0
    s_mov_b32 m0, 71680
    s_nop 0
    global_load_lds_dwordx4 v107, s[54:55]
    s_add_u32 s54, s10, 0x13000
    s_addc_u32 s55, s11, 0
    s_mov_b32 m0, 72704
    s_nop 0
    global_load_lds_dwordx4 v107, s[54:55]
    ds_read_b64_tr_b16 a[232:233], v112 offset:16384
    ds_read_b64_tr_b16 a[234:235], v112 offset:16640
    ds_read_b64_tr_b16 a[236:237], v112 offset:18432
    ds_read_b64_tr_b16 a[238:239], v112 offset:18688
    ds_read_b64_tr_b16 v[168:169], v113 offset:16384
    ds_read_b64_tr_b16 v[170:171], v113 offset:16640
    ds_read_b64_tr_b16 v[172:173], v113 offset:18432
    ds_read_b64_tr_b16 v[174:175], v113 offset:18688
    s_waitcnt lgkmcnt(0)
    s_waitcnt vmcnt(24)
    s_barrier
    ds_read_b64_tr_b16 a[240:241], v112 offset:32768
    ds_read_b64_tr_b16 a[242:243], v112 offset:33024
    ds_read_b64_tr_b16 a[244:245], v112 offset:34816
    ds_read_b64_tr_b16 a[246:247], v112 offset:35072
    ds_read_b64_tr_b16 v[176:177], v113 offset:32768
    ds_read_b64_tr_b16 v[178:179], v113 offset:33024
    ds_read_b64_tr_b16 v[180:181], v113 offset:34816
    ds_read_b64_tr_b16 v[182:183], v113 offset:35072
    s_waitcnt lgkmcnt(0)
    s_waitcnt vmcnt(20)
    s_barrier
    s_add_u32 s54, s10, 0x10040
    s_addc_u32 s55, s11, 0
    s_mov_b32 m0, 102400
    s_nop 0
    global_load_lds_dwordx4 v107, s[54:55]
    s_add_u32 s54, s10, 0x11040
    s_addc_u32 s55, s11, 0
    s_mov_b32 m0, 103424
    s_nop 0
    global_load_lds_dwordx4 v107, s[54:55]
    s_add_u32 s54, s10, 0x12040
    s_addc_u32 s55, s11, 0
    s_mov_b32 m0, 104448
    s_nop 0
    global_load_lds_dwordx4 v107, s[54:55]
    s_add_u32 s54, s10, 0x13040
    s_addc_u32 s55, s11, 0
    s_mov_b32 m0, 105472
    s_nop 0
    global_load_lds_dwordx4 v107, s[54:55]
    ds_read_b64_tr_b16 a[248:249], v112 offset:49152
    ds_read_b64_tr_b16 a[250:251], v112 offset:49408
    ds_read_b64_tr_b16 a[252:253], v112 offset:51200
    ds_read_b64_tr_b16 a[254:255], v112 offset:51456
    ds_read_b64_tr_b16 v[184:185], v113 offset:49152
    ds_read_b64_tr_b16 v[186:187], v113 offset:49408
    ds_read_b64_tr_b16 v[188:189], v113 offset:51200
    ds_read_b64_tr_b16 v[190:191], v113 offset:51456
    s_waitcnt lgkmcnt(0)
    s_waitcnt vmcnt(20)
    s_barrier
    ds_read_b64_tr_b16 v[192:193], v110 offset:0
    ds_read_b64_tr_b16 v[194:195], v110 offset:512
    ds_read_b64_tr_b16 v[196:197], v110 offset:2048
    ds_read_b64_tr_b16 v[198:199], v110 offset:2560
    ds_read_b64_tr_b16 v[200:201], v111 offset:0
    ds_read_b64_tr_b16 v[202:203], v111 offset:512
    ds_read_b64_tr_b16 v[204:205], v111 offset:2048
    ds_read_b64_tr_b16 v[206:207], v111 offset:2560
    s_waitcnt lgkmcnt(0)
    s_waitcnt vmcnt(16)
    s_barrier
    s_add_u32 s54, s10, 0x10080
    s_addc_u32 s55, s11, 0
    s_mov_b32 m0, 4096
    s_nop 0
    global_load_lds_dwordx4 v107, s[54:55]
    s_add_u32 s54, s10, 0x11080
    s_addc_u32 s55, s11, 0
    s_mov_b32 m0, 5120
    s_nop 0
    global_load_lds_dwordx4 v107, s[54:55]
    s_add_u32 s54, s10, 0x12080
    s_addc_u32 s55, s11, 0
    s_mov_b32 m0, 6144
    s_nop 0
    global_load_lds_dwordx4 v107, s[54:55]
    s_add_u32 s54, s10, 0x13080
    s_addc_u32 s55, s11, 0
    s_mov_b32 m0, 7168
    s_nop 0
    global_load_lds_dwordx4 v107, s[54:55]
    ds_read_b64_tr_b16 v[208:209], v110 offset:16384
    ds_read_b64_tr_b16 v[210:211], v110 offset:16896
    ds_read_b64_tr_b16 v[212:213], v110 offset:18432
    ds_read_b64_tr_b16 v[214:215], v110 offset:18944
    ds_read_b64_tr_b16 v[216:217], v111 offset:16384
    ds_read_b64_tr_b16 v[218:219], v111 offset:16896
    ds_read_b64_tr_b16 v[220:221], v111 offset:18432
    ds_read_b64_tr_b16 v[222:223], v111 offset:18944
    s_waitcnt lgkmcnt(0)
    s_waitcnt vmcnt(16)
    s_barrier
    ds_read_b64_tr_b16 v[224:225], v110 offset:32768
    ds_read_b64_tr_b16 v[226:227], v110 offset:33280
    ds_read_b64_tr_b16 v[228:229], v110 offset:34816
    ds_read_b64_tr_b16 v[230:231], v110 offset:35328
    ds_read_b64_tr_b16 v[232:233], v111 offset:32768
    ds_read_b64_tr_b16 v[234:235], v111 offset:33280
    ds_read_b64_tr_b16 v[236:237], v111 offset:34816
    ds_read_b64_tr_b16 v[238:239], v111 offset:35328
    s_waitcnt lgkmcnt(0)
    s_waitcnt vmcnt(12)
    s_barrier
    s_add_u32 s54, s10, 0x100c0
    s_addc_u32 s55, s11, 0
    s_mov_b32 m0, 36864
    s_nop 0
    global_load_lds_dwordx4 v107, s[54:55]
    s_add_u32 s54, s10, 0x110c0
    s_addc_u32 s55, s11, 0
    s_mov_b32 m0, 37888
    s_nop 0
    global_load_lds_dwordx4 v107, s[54:55]
    s_add_u32 s54, s10, 0x120c0
    s_addc_u32 s55, s11, 0
    s_mov_b32 m0, 38912
    s_nop 0
    global_load_lds_dwordx4 v107, s[54:55]
    s_add_u32 s54, s10, 0x130c0
    s_addc_u32 s55, s11, 0
    s_mov_b32 m0, 39936
    s_nop 0
    global_load_lds_dwordx4 v107, s[54:55]
    ds_read_b64_tr_b16 v[240:241], v110 offset:49152
    ds_read_b64_tr_b16 v[242:243], v110 offset:49664
    ds_read_b64_tr_b16 v[244:245], v110 offset:51200
    ds_read_b64_tr_b16 v[246:247], v110 offset:51712
    ds_read_b64_tr_b16 v[248:249], v111 offset:49152
    ds_read_b64_tr_b16 v[250:251], v111 offset:49664
    ds_read_b64_tr_b16 v[252:253], v111 offset:51200
    ds_read_b64_tr_b16 v[254:255], v111 offset:51712
    s_waitcnt lgkmcnt(0)
    s_waitcnt vmcnt(12)
    s_barrier
    ds_read_b64_tr_b16 v[88:89], v114 offset:0
    ds_read_b64_tr_b16 v[90:91], v114 offset:512
    ds_read_b64_tr_b16 v[92:93], v114 offset:2048
    ds_read_b64_tr_b16 v[94:95], v114 offset:2560
    ds_read_b64_tr_b16 v[116:117], v115 offset:0
    ds_read_b64_tr_b16 v[118:119], v115 offset:512
    ds_read_b64_tr_b16 v[120:121], v115 offset:2048
    ds_read_b64_tr_b16 v[122:123], v115 offset:2560
    s_waitcnt lgkmcnt(0)
    ds_write_b128 v14, v[88:91] offset:16384
    ds_write_b128 v14, v[92:95] offset:17408
    ds_write_b128 v14, v[116:119] offset:18432
    ds_write_b128 v14, v[120:123] offset:19456
    s_waitcnt lgkmcnt(0)
    s_waitcnt vmcnt(8)
    s_barrier
    ds_read_b64_tr_b16 v[88:89], v114 offset:32768
    ds_read_b64_tr_b16 v[90:91], v114 offset:33280
    ds_read_b64_tr_b16 v[92:93], v114 offset:34816
    ds_read_b64_tr_b16 v[94:95], v114 offset:35328
    ds_read_b64_tr_b16 v[116:117], v115 offset:32768
    ds_read_b64_tr_b16 v[118:119], v115 offset:33280
    ds_read_b64_tr_b16 v[120:121], v115 offset:34816
    ds_read_b64_tr_b16 v[122:123], v115 offset:35328
    s_waitcnt lgkmcnt(0)
    ds_write_b128 v14, v[88:91] offset:20480
    ds_write_b128 v14, v[92:95] offset:21504
    ds_write_b128 v14, v[116:119] offset:22528
    ds_write_b128 v14, v[120:123] offset:23552
    s_waitcnt lgkmcnt(0)
    s_waitcnt vmcnt(4)
    s_barrier
    ds_read_b64_tr_b16 v[88:89], v110 offset:0
    ds_read_b64_tr_b16 v[90:91], v110 offset:512
    ds_read_b64_tr_b16 v[92:93], v110 offset:2048
    ds_read_b64_tr_b16 v[94:95], v110 offset:2560
    ds_read_b64_tr_b16 v[116:117], v111 offset:0
    ds_read_b64_tr_b16 v[118:119], v111 offset:512
    ds_read_b64_tr_b16 v[120:121], v111 offset:2048
    ds_read_b64_tr_b16 v[122:123], v111 offset:2560
    s_waitcnt lgkmcnt(0)
    ds_write_b128 v14, v[88:91] offset:24576
    ds_write_b128 v14, v[92:95] offset:25600
    ds_write_b128 v14, v[116:119] offset:26624
    ds_write_b128 v14, v[120:123] offset:27648
    s_waitcnt lgkmcnt(0)
    s_waitcnt vmcnt(0)
    s_barrier
    ds_read_b64_tr_b16 v[88:89], v110 offset:32768
    ds_read_b64_tr_b16 v[90:91], v110 offset:33280
    ds_read_b64_tr_b16 v[92:93], v110 offset:34816
    ds_read_b64_tr_b16 v[94:95], v110 offset:35328
    ds_read_b64_tr_b16 v[116:117], v111 offset:32768
    ds_read_b64_tr_b16 v[118:119], v111 offset:33280
    ds_read_b64_tr_b16 v[120:121], v111 offset:34816
    ds_read_b64_tr_b16 v[122:123], v111 offset:35328
    s_waitcnt lgkmcnt(0)
    ds_write_b128 v14, v[88:91] offset:28672
    ds_write_b128 v14, v[92:95] offset:29696
    ds_write_b128 v14, v[116:119] offset:30720
    ds_write_b128 v14, v[120:123] offset:31744
    s_waitcnt lgkmcnt(0)
    s_barrier
    ds_write_b128 v14, v[24:27] offset:0
    ds_write_b128 v14, v[28:31] offset:1024
    ds_write_b128 v14, v[32:35] offset:2048
    ds_write_b128 v14, v[36:39] offset:3072
    ds_write_b128 v14, v[40:43] offset:4096
    ds_write_b128 v14, v[44:47] offset:5120
    ds_write_b128 v14, v[48:51] offset:6144
    ds_write_b128 v14, v[52:55] offset:7168
    ds_write_b128 v14, v[56:59] offset:8192
    ds_write_b128 v14, v[60:63] offset:9216
    ds_write_b128 v14, v[64:67] offset:10240
    ds_write_b128 v14, v[68:71] offset:11264
    ds_write_b128 v14, v[72:75] offset:12288
    ds_write_b128 v14, v[76:79] offset:13312
    ds_write_b128 v14, v[80:83] offset:14336
    ds_write_b128 v14, v[84:87] offset:15360
    s_waitcnt lgkmcnt(0)
    s_branch L_c_loaded
L_c_load2:
    s_waitcnt vmcnt(32)
    s_barrier
    s_add_u32 s54, s4, 0x380000
    s_addc_u32 s55, s5, 0
    s_mov_b32 m0, 122880
    s_nop 0
    global_load_lds_dwordx4 v106, s[54:55]
    s_add_u32 s54, s4, 0x388000
    s_addc_u32 s55, s5, 0
    s_mov_b32 m0, 123904
    s_nop 0
    global_load_lds_dwordx4 v106, s[54:55]
    s_add_u32 s54, s4, 0x390000
    s_addc_u32 s55, s5, 0
    s_mov_b32 m0, 124928
    s_nop 0
    global_load_lds_dwordx4 v106, s[54:55]
    s_add_u32 s54, s4, 0x398000
    s_addc_u32 s55, s5, 0
    s_mov_b32 m0, 125952
    s_nop 0
    global_load_lds_dwordx4 v106, s[54:55]
    ds_read_b64_tr_b16 a[16:17], v108 offset:0
    ds_read_b64_tr_b16 a[18:19], v108 offset:256
    ds_read_b64_tr_b16 a[20:21], v108 offset:2048
    ds_read_b64_tr_b16 a[22:23], v108 offset:2304
    ds_read_b64_tr_b16 a[64:65], v109 offset:0
    ds_read_b64_tr_b16 a[66:67], v109 offset:256
    ds_read_b64_tr_b16 a[68:69], v109 offset:2048
    ds_read_b64_tr_b16 a[70:71], v109 offset:2304
    s_waitcnt lgkmcnt(0)
    s_waitcnt vmcnt(32)
    s_barrier
    s_add_u32 s54, s6, 0x0
    s_addc_u32 s55, s7, 0
    s_mov_b32 m0, 8192
    s_nop 0
    global_load_lds_dwordx4 v106, s[54:55]
    s_add_u32 s54, s6, 0x8000
    s_addc_u32 s55, s7, 0
    s_mov_b32 m0, 9216
    s_nop 0
    global_load_lds_dwordx4 v106, s[54:55]
    s_add_u32 s54, s6, 0x10000
    s_addc_u32 s55, s7, 0
    s_mov_b32 m0, 10240
    s_nop 0
    global_load_lds_dwordx4 v106, s[54:55]
    s_add_u32 s54, s6, 0x18000
    s_addc_u32 s55, s7, 0
    s_mov_b32 m0, 11264
    s_nop 0
    global_load_lds_dwordx4 v106, s[54:55]
    ds_read_b64_tr_b16 a[24:25], v108 offset:16384
    ds_read_b64_tr_b16 a[26:27], v108 offset:16640
    ds_read_b64_tr_b16 a[28:29], v108 offset:18432
    ds_read_b64_tr_b16 a[30:31], v108 offset:18688
    ds_read_b64_tr_b16 a[72:73], v109 offset:16384
    ds_read_b64_tr_b16 a[74:75], v109 offset:16640
    ds_read_b64_tr_b16 a[76:77], v109 offset:18432
    ds_read_b64_tr_b16 a[78:79], v109 offset:18688
    s_waitcnt lgkmcnt(0)
    s_waitcnt vmcnt(32)
    s_barrier
    s_add_u32 s54, s6, 0x80000
    s_addc_u32 s55, s7, 0
    s_mov_b32 m0, 24576
    s_nop 0
    global_load_lds_dwordx4 v106, s[54:55]
    s_add_u32 s54, s6, 0x88000
    s_addc_u32 s55, s7, 0
    s_mov_b32 m0, 25600
    s_nop 0
    global_load_lds_dwordx4 v106, s[54:55]
    s_add_u32 s54, s6, 0x90000
    s_addc_u32 s55, s7, 0
    s_mov_b32 m0, 26624
    s_nop 0
    global_load_lds_dwordx4 v106, s[54:55]
    s_add_u32 s54, s6, 0x98000
    s_addc_u32 s55, s7, 0
    s_mov_b32 m0, 27648
    s_nop 0
    global_load_lds_dwordx4 v106, s[54:55]
    ds_read_b64_tr_b16 a[32:33], v108 offset:32768
    ds_read_b64_tr_b16 a[34:35], v108 offset:33024
    ds_read_b64_tr_b16 a[36:37], v108 offset:34816
    ds_read_b64_tr_b16 a[38:39], v108 offset:35072
    ds_read_b64_tr_b16 a[80:81], v109 offset:32768
    ds_read_b64_tr_b16 a[82:83], v109 offset:33024
    ds_read_b64_tr_b16 a[84:85], v109 offset:34816
    ds_read_b64_tr_b16 a[86:87], v109 offset:35072
    s_waitcnt lgkmcnt(0)
    s_waitcnt vmcnt(32)
    s_barrier
    s_add_u32 s54, s6, 0x100000
    s_addc_u32 s55, s7, 0
    s_mov_b32 m0, 40960
    s_nop 0
    global_load_lds_dwordx4 v106, s[54:55]
    s_add_u32 s54, s6, 0x108000
    s_addc_u32 s55, s7, 0
    s_mov_b32 m0, 41984
    s_nop 0
    global_load_lds_dwordx4 v106, s[54:55]
    s_add_u32 s54, s6, 0x110000
    s_addc_u32 s55, s7, 0
    s_mov_b32 m0, 43008
    s_nop 0
    global_load_lds_dwordx4 v106, s[54:55]
    s_add_u32 s54, s6, 0x118000
    s_addc_u32 s55, s7, 0
    s_mov_b32 m0, 44032
    s_nop 0
    global_load_lds_dwordx4 v106, s[54:55]
    ds_read_b64_tr_b16 a[40:41], v108 offset:49152
    ds_read_b64_tr_b16 a[42:43], v108 offset:49408
    ds_read_b64_tr_b16 a[44:45], v108 offset:51200
    ds_read_b64_tr_b16 a[46:47], v108 offset:51456
    ds_read_b64_tr_b16 a[88:89], v109 offset:49152
    ds_read_b64_tr_b16 a[90:91], v109 offset:49408
    ds_read_b64_tr_b16 a[92:93], v109 offset:51200
    ds_read_b64_tr_b16 a[94:95], v109 offset:51456
    s_waitcnt lgkmcnt(0)
    s_waitcnt vmcnt(32)
    s_barrier
    s_add_u32 s54, s6, 0x180000
    s_addc_u32 s55, s7, 0
    s_mov_b32 m0, 57344
    s_nop 0
    global_load_lds_dwordx4 v106, s[54:55]
    s_add_u32 s54, s6, 0x188000
    s_addc_u32 s55, s7, 0
    s_mov_b32 m0, 58368
    s_nop 0
    global_load_lds_dwordx4 v106, s[54:55]
    s_add_u32 s54, s6, 0x190000
    s_addc_u32 s55, s7, 0
    s_mov_b32 m0, 59392
    s_nop 0
    global_load_lds_dwordx4 v106, s[54:55]
    s_add_u32 s54, s6, 0x198000
    s_addc_u32 s55, s7, 0
    s_mov_b32 m0, 60416
    s_nop 0
    global_load_lds_dwordx4 v106, s[54:55]
    ds_read_b64_tr_b16 v[24:25], v112 offset:0
    ds_read_b64_tr_b16 v[26:27], v112 offset:256
    ds_read_b64_tr_b16 v[28:29], v112 offset:2048
    ds_read_b64_tr_b16 v[30:31], v112 offset:2304
    ds_read_b64_tr_b16 v[32:33], v113 offset:0
    ds_read_b64_tr_b16 v[34:35], v113 offset:256
    ds_read_b64_tr_b16 v[36:37], v113 offset:2048
    ds_read_b64_tr_b16 v[38:39], v113 offset:2304
    s_waitcnt lgkmcnt(0)
    s_waitcnt vmcnt(32)
    s_barrier
    s_add_u32 s54, s6, 0x200000
    s_addc_u32 s55, s7, 0
    s_mov_b32 m0, 73728
    s_nop 0
    global_load_lds_dwordx4 v106, s[54:55]
    s_add_u32 s54, s6, 0x208000
    s_addc_u32 s55, s7, 0
    s_mov_b32 m0, 74752
    s_nop 0
    global_load_lds_dwordx4 v106, s[54:55]
    s_add_u32 s54, s6, 0x210000
    s_addc_u32 s55, s7, 0
    s_mov_b32 m0, 75776
    s_nop 0
    global_load_lds_dwordx4 v106, s[54:55]
    s_add_u32 s54, s6, 0x218000
    s_addc_u32 s55, s7, 0
    s_mov_b32 m0, 76800
    s_nop 0
    global_load_lds_dwordx4 v106, s[54:55]
    ds_read_b64_tr_b16 v[40:41], v112 offset:16384
    ds_read_b64_tr_b16 v[42:43], v112 offset:16640
    ds_read_b64_tr_b16 v[44:45], v112 offset:18432
    ds_read_b64_tr_b16 v[46:47], v112 offset:18688
    ds_read_b64_tr_b16 v[48:49], v113 offset:16384
    ds_read_b64_tr_b16 v[50:51], v113 offset:16640
    ds_read_b64_tr_b16 v[52:53], v113 offset:18432
    ds_read_b64_tr_b16 v[54:55], v113 offset:18688
    s_waitcnt lgkmcnt(0)
    s_waitcnt vmcnt(32)
    s_barrier
    s_add_u32 s54, s6, 0x280000
    s_addc_u32 s55, s7, 0
    s_mov_b32 m0, 90112
    s_nop 0
    global_load_lds_dwordx4 v106, s[54:55]
    s_add_u32 s54, s6, 0x288000
    s_addc_u32 s55, s7, 0
    s_mov_b32 m0, 91136
    s_nop 0
    global_load_lds_dwordx4 v106, s[54:55]
    s_add_u32 s54, s6, 0x290000
    s_addc_u32 s55, s7, 0
    s_mov_b32 m0, 92160
    s_nop 0
    global_load_lds_dwordx4 v106, s[54:55]
    s_add_u32 s54, s6, 0x298000
    s_addc_u32 s55, s7, 0
    s_mov_b32 m0, 93184
    s_nop 0
    global_load_lds_dwordx4 v106, s[54:55]
    ds_read_b64_tr_b16 a[0:1], v112 offset:32768
    ds_read_b64_tr_b16 a[2:3], v112 offset:33024
    ds_read_b64_tr_b16 a[4:5], v112 offset:34816
    ds_read_b64_tr_b16 a[6:7], v112 offset:35072
    ds_read_b64_tr_b16 a[48:49], v113 offset:32768
    ds_read_b64_tr_b16 a[50:51], v113 offset:33024
    ds_read_b64_tr_b16 a[52:53], v113 offset:34816
    ds_read_b64_tr_b16 a[54:55], v113 offset:35072
    s_waitcnt lgkmcnt(0)
    s_waitcnt vmcnt(24)
    s_barrier
    s_add_u32 s54, s6, 0x300000
    s_addc_u32 s55, s7, 0
    s_mov_b32 m0, 106496
    s_nop 0
    global_load_lds_dwordx4 v106, s[54:55]
    s_add_u32 s54, s6, 0x308000
    s_addc_u32 s55, s7, 0
    s_mov_b32 m0, 107520
    s_nop 0
    global_load_lds_dwordx4 v106, s[54:55]
    s_add_u32 s54, s6, 0x310000
    s_addc_u32 s55, s7, 0
    s_mov_b32 m0, 108544
    s_nop 0
    global_load_lds_dwordx4 v106, s[54:55]
    s_add_u32 s54, s6, 0x318000
    s_addc_u32 s55, s7, 0
    s_mov_b32 m0, 109568
    s_nop 0
    global_load_lds_dwordx4 v106, s[54:55]
    ds_read_b64_tr_b16 a[8:9], v112 offset:49152
    ds_read_b64_tr_b16 a[10:11], v112 offset:49408
    ds_read_b64_tr_b16 a[12:13], v112 offset:51200
    ds_read_b64_tr_b16 a[14:15], v112 offset:51456
    ds_read_b64_tr_b16 a[56:57], v113 offset:49152
    ds_read_b64_tr_b16 a[58:59], v113 offset:49408
    ds_read_b64_tr_b16 a[60:61], v113 offset:51200
    ds_read_b64_tr_b16 a[62:63], v113 offset:51456
    s_waitcnt lgkmcnt(0)
    s_waitcnt vmcnt(24)
    s_barrier
    s_add_u32 s54, s6, 0x380000
    s_addc_u32 s55, s7, 0
    s_mov_b32 m0, 122880
    s_nop 0
    global_load_lds_dwordx4 v106, s[54:55]
    s_add_u32 s54, s6, 0x388000
    s_addc_u32 s55, s7, 0
    s_mov_b32 m0, 123904
    s_nop 0
    global_load_lds_dwordx4 v106, s[54:55]
    s_add_u32 s54, s6, 0x390000
    s_addc_u32 s55, s7, 0
    s_mov_b32 m0, 124928
    s_nop 0
    global_load_lds_dwordx4 v106, s[54:55]
    s_add_u32 s54, s6, 0x398000
    s_addc_u32 s55, s7, 0
    s_mov_b32 m0, 125952
    s_nop 0
    global_load_lds_dwordx4 v106, s[54:55]
    ds_read_b64_tr_b16 a[112:113], v108 offset:0
    ds_read_b64_tr_b16 a[114:115], v108 offset:256
    ds_read_b64_tr_b16 a[116:117], v108 offset:2048
    ds_read_b64_tr_b16 a[118:119], v108 offset:2304
    ds_read_b64_tr_b16 a[160:161], v109 offset:0
    ds_read_b64_tr_b16 a[162:163], v109 offset:256
    ds_read_b64_tr_b16 a[164:165], v109 offset:2048
    ds_read_b64_tr_b16 a[166:167], v109 offset:2304
    s_waitcnt lgkmcnt(0)
    s_waitcnt vmcnt(24)
    s_barrier
    s_add_u32 s54, s8, 0x0
    s_addc_u32 s55, s9, 0
    s_mov_b32 m0, 8192
    s_nop 0
    global_load_lds_dwordx4 v106, s[54:55]
    s_add_u32 s54, s8, 0x8000
    s_addc_u32 s55, s9, 0
    s_mov_b32 m0, 9216
    s_nop 0
    global_load_lds_dwordx4 v106, s[54:55]
    s_add_u32 s54, s8, 0x10000
    s_addc_u32 s55, s9, 0
    s_mov_b32 m0, 10240
    s_nop 0
    global_load_lds_dwordx4 v106, s[54:55]
    s_add_u32 s54, s8, 0x18000
    s_addc_u32 s55, s9, 0
    s_mov_b32 m0, 11264
    s_nop 0
    global_load_lds_dwordx4 v106, s[54:55]
    ds_read_b64_tr_b16 a[120:121], v108 offset:16384
    ds_read_b64_tr_b16 a[122:123], v108 offset:16640
    ds_read_b64_tr_b16 a[124:125], v108 offset:18432
    ds_read_b64_tr_b16 a[126:127], v108 offset:18688
    ds_read_b64_tr_b16 a[168:169], v109 offset:16384
    ds_read_b64_tr_b16 a[170:171], v109 offset:16640
    ds_read_b64_tr_b16 a[172:173], v109 offset:18432
    ds_read_b64_tr_b16 a[174:175], v109 offset:18688
    s_waitcnt lgkmcnt(0)
    s_waitcnt vmcnt(24)
    s_barrier
    s_add_u32 s54, s8, 0x80000
    s_addc_u32 s55, s9, 0
    s_mov_b32 m0, 24576
    s_nop 0
    global_load_lds_dwordx4 v106, s[54:55]
    s_add_u32 s54, s8, 0x88000
    s_addc_u32 s55, s9, 0
    s_mov_b32 m0, 25600
    s_nop 0
    global_load_lds_dwordx4 v106, s[54:55]
    s_add_u32 s54, s8, 0x90000
    s_addc_u32 s55, s9, 0
    s_mov_b32 m0, 26624
    s_nop 0
    global_load_lds_dwordx4 v106, s[54:55]
    s_add_u32 s54, s8, 0x98000
    s_addc_u32 s55, s9, 0
    s_mov_b32 m0, 27648
    s_nop 0
    global_load_lds_dwordx4 v106, s[54:55]
    v_and_b32 v104, 15, v100
    v_lshrrev_b32 v105, 4, v100
    v_lshrrev_b32 v101, 2, v104
    v_lshlrev_b32 v101, 1, v101
    v_and_b32 v102, 1, v104
    v_add_u32 v101, v101, v102
    v_lshlrev_b32 v101, 10, v101
    v_bfe_u32 v102, v104, 1, 1
    v_lshlrev_b32 v102, 6, v102
    v_lshl_add_u32 v102, v105, 3, v102
    v_add_u32 v101, v101, v102
    s_lshl_b32 s52, s19, 8
    v_add_u32 v101, s52, v101
    global_load_dwordx2 v[96:97], v101, s[12:13]
    global_load_dwordx2 v[98:99], v101, s[12:13] offset:32
    global_load_dwordx2 v[124:125], v101, s[12:13] offset:128
    global_load_dwordx2 v[126:127], v101, s[12:13] offset:160
    ds_read_b64_tr_b16 a[128:129], v108 offset:32768
    ds_read_b64_tr_b16 a[130:131], v108 offset:33024
    ds_read_b64_tr_b16 a[132:133], v108 offset:34816
    ds_read_b64_tr_b16 a[134:135], v108 offset:35072
    ds_read_b64_tr_b16 a[176:177], v109 offset:32768
    ds_read_b64_tr_b16 a[178:179], v109 offset:33024
    ds_read_b64_tr_b16 a[180:181], v109 offset:34816
    ds_read_b64_tr_b16 a[182:183], v109 offset:35072
    s_waitcnt lgkmcnt(0)
    s_waitcnt vmcnt(28)
    s_barrier
    s_add_u32 s54, s8, 0x100000
    s_addc_u32 s55, s9, 0
    s_mov_b32 m0, 40960
    s_nop 0
    global_load_lds_dwordx4 v106, s[54:55]
    s_add_u32 s54, s8, 0x108000
    s_addc_u32 s55, s9, 0
    s_mov_b32 m0, 41984
    s_nop 0
    global_load_lds_dwordx4 v106, s[54:55]
    s_add_u32 s54, s8, 0x110000
    s_addc_u32 s55, s9, 0
    s_mov_b32 m0, 43008
    s_nop 0
    global_load_lds_dwordx4 v106, s[54:55]
    s_add_u32 s54, s8, 0x118000
    s_addc_u32 s55, s9, 0
    s_mov_b32 m0, 44032
    s_nop 0
    global_load_lds_dwordx4 v106, s[54:55]
    ds_read_b64_tr_b16 a[136:137], v108 offset:49152
    ds_read_b64_tr_b16 a[138:139], v108 offset:49408
    ds_read_b64_tr_b16 a[140:141], v108 offset:51200
    ds_read_b64_tr_b16 a[142:143], v108 offset:51456
    ds_read_b64_tr_b16 a[184:185], v109 offset:49152
    ds_read_b64_tr_b16 a[186:187], v109 offset:49408
    ds_read_b64_tr_b16 a[188:189], v109 offset:51200
    ds_read_b64_tr_b16 a[190:191], v109 offset:51456
    s_waitcnt lgkmcnt(0)
    s_waitcnt vmcnt(28)
    s_barrier
    s_add_u32 s54, s8, 0x180000
    s_addc_u32 s55, s9, 0
    s_mov_b32 m0, 57344
    s_nop 0
    global_load_lds_dwordx4 v106, s[54:55]
    s_add_u32 s54, s8, 0x188000
    s_addc_u32 s55, s9, 0
    s_mov_b32 m0, 58368
    s_nop 0
    global_load_lds_dwordx4 v106, s[54:55]
    s_add_u32 s54, s8, 0x190000
    s_addc_u32 s55, s9, 0
    s_mov_b32 m0, 59392
    s_nop 0
    global_load_lds_dwordx4 v106, s[54:55]
    s_add_u32 s54, s8, 0x198000
    s_addc_u32 s55, s9, 0
    s_mov_b32 m0, 60416
    s_nop 0
    global_load_lds_dwordx4 v106, s[54:55]
    ds_read_b64_tr_b16 v[56:57], v112 offset:0
    ds_read_b64_tr_b16 v[58:59], v112 offset:256
    ds_read_b64_tr_b16 v[60:61], v112 offset:2048
    ds_read_b64_tr_b16 v[62:63], v112 offset:2304
    ds_read_b64_tr_b16 v[64:65], v113 offset:0
    ds_read_b64_tr_b16 v[66:67], v113 offset:256
    ds_read_b64_tr_b16 v[68:69], v113 offset:2048
    ds_read_b64_tr_b16 v[70:71], v113 offset:2304
    s_waitcnt lgkmcnt(0)
    s_waitcnt vmcnt(28)
    s_barrier
    s_add_u32 s54, s8, 0x200000
    s_addc_u32 s55, s9, 0
    s_mov_b32 m0, 73728
    s_nop 0
    global_load_lds_dwordx4 v106, s[54:55]
    s_add_u32 s54, s8, 0x208000
    s_addc_u32 s55, s9, 0
    s_mov_b32 m0, 74752
    s_nop 0
    global_load_lds_dwordx4 v106, s[54:55]
    s_add_u32 s54, s8, 0x210000
    s_addc_u32 s55, s9, 0
    s_mov_b32 m0, 75776
    s_nop 0
    global_load_lds_dwordx4 v106, s[54:55]
    s_add_u32 s54, s8, 0x218000
    s_addc_u32 s55, s9, 0
    s_mov_b32 m0, 76800
    s_nop 0
    global_load_lds_dwordx4 v106, s[54:55]
    ds_read_b64_tr_b16 v[72:73], v112 offset:16384
    ds_read_b64_tr_b16 v[74:75], v112 offset:16640
    ds_read_b64_tr_b16 v[76:77], v112 offset:18432
    ds_read_b64_tr_b16 v[78:79], v112 offset:18688
    ds_read_b64_tr_b16 v[80:81], v113 offset:16384
    ds_read_b64_tr_b16 v[82:83], v113 offset:16640
    ds_read_b64_tr_b16 v[84:85], v113 offset:18432
    ds_read_b64_tr_b16 v[86:87], v113 offset:18688
    s_waitcnt lgkmcnt(0)
    s_waitcnt vmcnt(28)
    s_barrier
    s_add_u32 s54, s8, 0x280000
    s_addc_u32 s55, s9, 0
    s_mov_b32 m0, 90112
    s_nop 0
    global_load_lds_dwordx4 v106, s[54:55]
    s_add_u32 s54, s8, 0x288000
    s_addc_u32 s55, s9, 0
    s_mov_b32 m0, 91136
    s_nop 0
    global_load_lds_dwordx4 v106, s[54:55]
    s_add_u32 s54, s8, 0x290000
    s_addc_u32 s55, s9, 0
    s_mov_b32 m0, 92160
    s_nop 0
    global_load_lds_dwordx4 v106, s[54:55]
    s_add_u32 s54, s8, 0x298000
    s_addc_u32 s55, s9, 0
    s_mov_b32 m0, 93184
    s_nop 0
    global_load_lds_dwordx4 v106, s[54:55]
    ds_read_b64_tr_b16 a[96:97], v112 offset:32768
    ds_read_b64_tr_b16 a[98:99], v112 offset:33024
    ds_read_b64_tr_b16 a[100:101], v112 offset:34816
    ds_read_b64_tr_b16 a[102:103], v112 offset:35072
    ds_read_b64_tr_b16 a[144:145], v113 offset:32768
    ds_read_b64_tr_b16 a[146:147], v113 offset:33024
    ds_read_b64_tr_b16 a[148:149], v113 offset:34816
    ds_read_b64_tr_b16 a[150:151], v113 offset:35072
    s_waitcnt lgkmcnt(0)
    s_waitcnt vmcnt(28)
    s_barrier
    s_add_u32 s54, s8, 0x300000
    s_addc_u32 s55, s9, 0
    s_mov_b32 m0, 106496
    s_nop 0
    global_load_lds_dwordx4 v106, s[54:55]
    s_add_u32 s54, s8, 0x308000
    s_addc_u32 s55, s9, 0
    s_mov_b32 m0, 107520
    s_nop 0
    global_load_lds_dwordx4 v106, s[54:55]
    s_add_u32 s54, s8, 0x310000
    s_addc_u32 s55, s9, 0
    s_mov_b32 m0, 108544
    s_nop 0
    global_load_lds_dwordx4 v106, s[54:55]
    s_add_u32 s54, s8, 0x318000
    s_addc_u32 s55, s9, 0
    s_mov_b32 m0, 109568
    s_nop 0
    global_load_lds_dwordx4 v106, s[54:55]
    ds_read_b64_tr_b16 a[104:105], v112 offset:49152
    ds_read_b64_tr_b16 a[106:107], v112 offset:49408
    ds_read_b64_tr_b16 a[108:109], v112 offset:51200
    ds_read_b64_tr_b16 a[110:111], v112 offset:51456
    ds_read_b64_tr_b16 a[152:153], v113 offset:49152
    ds_read_b64_tr_b16 a[154:155], v113 offset:49408
    ds_read_b64_tr_b16 a[156:157], v113 offset:51200
    ds_read_b64_tr_b16 a[158:159], v113 offset:51456
    s_waitcnt lgkmcnt(0)
    s_waitcnt vmcnt(28)
    s_barrier
    s_add_u32 s54, s8, 0x380000
    s_addc_u32 s55, s9, 0
    s_mov_b32 m0, 122880
    s_nop 0
    global_load_lds_dwordx4 v106, s[54:55]
    s_add_u32 s54, s8, 0x388000
    s_addc_u32 s55, s9, 0
    s_mov_b32 m0, 123904
    s_nop 0
    global_load_lds_dwordx4 v106, s[54:55]
    s_add_u32 s54, s8, 0x390000
    s_addc_u32 s55, s9, 0
    s_mov_b32 m0, 124928
    s_nop 0
    global_load_lds_dwordx4 v106, s[54:55]
    s_add_u32 s54, s8, 0x398000
    s_addc_u32 s55, s9, 0
    s_mov_b32 m0, 125952
    s_nop 0
    global_load_lds_dwordx4 v106, s[54:55]
    ds_read_b64_tr_b16 a[192:193], v108 offset:0
    ds_read_b64_tr_b16 a[194:195], v108 offset:256
    ds_read_b64_tr_b16 a[196:197], v108 offset:2048
    ds_read_b64_tr_b16 a[198:199], v108 offset:2304
    ds_read_b64_tr_b16 v[128:129], v109 offset:0
    ds_read_b64_tr_b16 v[130:131], v109 offset:256
    ds_read_b64_tr_b16 v[132:133], v109 offset:2048
    ds_read_b64_tr_b16 v[134:135], v109 offset:2304
    s_waitcnt lgkmcnt(0)
    s_waitcnt vmcnt(28)
    s_barrier
    s_add_u32 s54, s10, 0x0
    s_addc_u32 s55, s11, 0
    s_mov_b32 m0, 8192
    s_nop 0
    global_load_lds_dwordx4 v107, s[54:55]
    s_add_u32 s54, s10, 0x1000
    s_addc_u32 s55, s11, 0
    s_mov_b32 m0, 9216
    s_nop 0
    global_load_lds_dwordx4 v107, s[54:55]
    s_add_u32 s54, s10, 0x2000
    s_addc_u32 s55, s11, 0
    s_mov_b32 m0, 10240
    s_nop 0
    global_load_lds_dwordx4 v107, s[54:55]
    s_add_u32 s54, s10, 0x3000
    s_addc_u32 s55, s11, 0
    s_mov_b32 m0, 11264
    s_nop 0
    global_load_lds_dwordx4 v107, s[54:55]
    ds_read_b64_tr_b16 a[200:201], v108 offset:16384
    ds_read_b64_tr_b16 a[202:203], v108 offset:16640
    ds_read_b64_tr_b16 a[204:205], v108 offset:18432
    ds_read_b64_tr_b16 a[206:207], v108 offset:18688
    ds_read_b64_tr_b16 v[136:137], v109 offset:16384
    ds_read_b64_tr_b16 v[138:139], v109 offset:16640
    ds_read_b64_tr_b16 v[140:141], v109 offset:18432
    ds_read_b64_tr_b16 v[142:143], v109 offset:18688
    s_waitcnt lgkmcnt(0)
    s_waitcnt vmcnt(24)
    s_barrier
    s_add_u32 s54, s10, 0x40
    s_addc_u32 s55, s11, 0
    s_mov_b32 m0, 24576
    s_nop 0
    global_load_lds_dwordx4 v107, s[54:55]
    s_add_u32 s54, s10, 0x1040
    s_addc_u32 s55, s11, 0
    s_mov_b32 m0, 25600
    s_nop 0
    global_load_lds_dwordx4 v107, s[54:55]
    s_add_u32 s54, s10, 0x2040
    s_addc_u32 s55, s11, 0
    s_mov_b32 m0, 26624
    s_nop 0
    global_load_lds_dwordx4 v107, s[54:55]
    s_add_u32 s54, s10, 0x3040
    s_addc_u32 s55, s11, 0
    s_mov_b32 m0, 27648
    s_nop 0
    global_load_lds_dwordx4 v107, s[54:55]
    ds_read_b64_tr_b16 a[208:209], v108 offset:32768
    ds_read_b64_tr_b16 a[210:211], v108 offset:33024
    ds_read_b64_tr_b16 a[212:213], v108 offset:34816
    ds_read_b64_tr_b16 a[214:215], v108 offset:35072
    ds_read_b64_tr_b16 v[144:145], v109 offset:32768
    ds_read_b64_tr_b16 v[146:147], v109 offset:33024
    ds_read_b64_tr_b16 v[148:149], v109 offset:34816
    ds_read_b64_tr_b16 v[150:151], v109 offset:35072
    s_waitcnt lgkmcnt(0)
    s_waitcnt vmcnt(24)
    s_barrier
    s_add_u32 s54, s10, 0x80
    s_addc_u32 s55, s11, 0
    s_mov_b32 m0, 40960
    s_nop 0
    global_load_lds_dwordx4 v107, s[54:55]
    s_add_u32 s54, s10, 0x1080
    s_addc_u32 s55, s11, 0
    s_mov_b32 m0, 41984
    s_nop 0
    global_load_lds_dwordx4 v107, s[54:55]
    s_add_u32 s54, s10, 0x2080
    s_addc_u32 s55, s11, 0
    s_mov_b32 m0, 43008
    s_nop 0
    global_load_lds_dwordx4 v107, s[54:55]
    s_add_u32 s54, s10, 0x3080
    s_addc_u32 s55, s11, 0
    s_mov_b32 m0, 44032
    s_nop 0
    global_load_lds_dwordx4 v107, s[54:55]
    ds_read_b64_tr_b16 a[216:217], v108 offset:49152
    ds_read_b64_tr_b16 a[218:219], v108 offset:49408
    ds_read_b64_tr_b16 a[220:221], v108 offset:51200
    ds_read_b64_tr_b16 a[222:223], v108 offset:51456
    ds_read_b64_tr_b16 v[152:153], v109 offset:49152
    ds_read_b64_tr_b16 v[154:155], v109 offset:49408
    ds_read_b64_tr_b16 v[156:157], v109 offset:51200
    ds_read_b64_tr_b16 v[158:159], v109 offset:51456
    s_waitcnt lgkmcnt(0)
    s_waitcnt vmcnt(24)
    s_barrier
    s_add_u32 s54, s10, 0xc0
    s_addc_u32 s55, s11, 0
    s_mov_b32 m0, 57344
    s_nop 0
    global_load_lds_dwordx4 v107, s[54:55]
    s_add_u32 s54, s10, 0x10c0
    s_addc_u32 s55, s11, 0
    s_mov_b32 m0, 58368
    s_nop 0
    global_load_lds_dwordx4 v107, s[54:55]
    s_add_u32 s54, s10, 0x20c0
    s_addc_u32 s55, s11, 0
    s_mov_b32 m0, 59392
    s_nop 0
    global_load_lds_dwordx4 v107, s[54:55]
    s_add_u32 s54, s10, 0x30c0
    s_addc_u32 s55, s11, 0
    s_mov_b32 m0, 60416
    s_nop 0
    global_load_lds_dwordx4 v107, s[54:55]
    ds_read_b64_tr_b16 a[224:225], v112 offset:0
    ds_read_b64_tr_b16 a[226:227], v112 offset:256
    ds_read_b64_tr_b16 a[228:229], v112 offset:2048
    ds_read_b64_tr_b16 a[230:231], v112 offset:2304
    ds_read_b64_tr_b16 v[160:161], v113 offset:0
    ds_read_b64_tr_b16 v[162:163], v113 offset:256
    ds_read_b64_tr_b16 v[164:165], v113 offset:2048
    ds_read_b64_tr_b16 v[166:167], v113 offset:2304
    s_waitcnt lgkmcnt(0)
    s_waitcnt vmcnt(24)
    s_barrier
    s_add_u32 s54, s10, 0x10000
    s_addc_u32 s55, s11, 0
    s_mov_b32 m0, 73728
    s_nop 0
    global_load_lds_dwordx4 v107, s[54:55]
    s_add_u32 s54, s10, 0x11000
    s_addc_u32 s55, s11, 0
    s_mov_b32 m0, 74752
    s_nop 0
    global_load_lds_dwordx4 v107, s[54:55]
    s_add_u32 s54, s10, 0x12000
    s_addc_u32 s55, s11, 0
    s_mov_b32 m0, 75776
    s_nop 0
    global_load_lds_dwordx4 v107, s[54:55]
    s_add_u32 s54, s10, 0x13000
    s_addc_u32 s55, s11, 0
    s_mov_b32 m0, 76800
    s_nop 0
    global_load_lds_dwordx4 v107, s[54:55]
    ds_read_b64_tr_b16 a[232:233], v112 offset:16384
    ds_read_b64_tr_b16 a[234:235], v112 offset:16640
    ds_read_b64_tr_b16 a[236:237], v112 offset:18432
    ds_read_b64_tr_b16 a[238:239], v112 offset:18688
    ds_read_b64_tr_b16 v[168:169], v113 offset:16384
    ds_read_b64_tr_b16 v[170:171], v113 offset:16640
    ds_read_b64_tr_b16 v[172:173], v113 offset:18432
    ds_read_b64_tr_b16 v[174:175], v113 offset:18688
    s_waitcnt lgkmcnt(0)
    s_waitcnt vmcnt(24)
    s_barrier
    ds_read_b64_tr_b16 a[240:241], v112 offset:32768
    ds_read_b64_tr_b16 a[242:243], v112 offset:33024
    ds_read_b64_tr_b16 a[244:245], v112 offset:34816
    ds_read_b64_tr_b16 a[246:247], v112 offset:35072
    ds_read_b64_tr_b16 v[176:177], v113 offset:32768
    ds_read_b64_tr_b16 v[178:179], v113 offset:33024
    ds_read_b64_tr_b16 v[180:181], v113 offset:34816
    ds_read_b64_tr_b16 v[182:183], v113 offset:35072
    s_waitcnt lgkmcnt(0)
    s_waitcnt vmcnt(20)
    s_barrier
    s_add_u32 s54, s10, 0x10040
    s_addc_u32 s55, s11, 0
    s_mov_b32 m0, 106496
    s_nop 0
    global_load_lds_dwordx4 v107, s[54:55]
    s_add_u32 s54, s10, 0x11040
    s_addc_u32 s55, s11, 0
    s_mov_b32 m0, 107520
    s_nop 0
    global_load_lds_dwordx4 v107, s[54:55]
    s_add_u32 s54, s10, 0x12040
    s_addc_u32 s55, s11, 0
    s_mov_b32 m0, 108544
    s_nop 0
    global_load_lds_dwordx4 v107, s[54:55]
    s_add_u32 s54, s10, 0x13040
    s_addc_u32 s55, s11, 0
    s_mov_b32 m0, 109568
    s_nop 0
    global_load_lds_dwordx4 v107, s[54:55]
    ds_read_b64_tr_b16 a[248:249], v112 offset:49152
    ds_read_b64_tr_b16 a[250:251], v112 offset:49408
    ds_read_b64_tr_b16 a[252:253], v112 offset:51200
    ds_read_b64_tr_b16 a[254:255], v112 offset:51456
    ds_read_b64_tr_b16 v[184:185], v113 offset:49152
    ds_read_b64_tr_b16 v[186:187], v113 offset:49408
    ds_read_b64_tr_b16 v[188:189], v113 offset:51200
    ds_read_b64_tr_b16 v[190:191], v113 offset:51456
    s_waitcnt lgkmcnt(0)
    s_waitcnt vmcnt(20)
    s_barrier
    ds_read_b64_tr_b16 v[192:193], v110 offset:0
    ds_read_b64_tr_b16 v[194:195], v110 offset:512
    ds_read_b64_tr_b16 v[196:197], v110 offset:2048
    ds_read_b64_tr_b16 v[198:199], v110 offset:2560
    ds_read_b64_tr_b16 v[200:201], v111 offset:0
    ds_read_b64_tr_b16 v[202:203], v111 offset:512
    ds_read_b64_tr_b16 v[204:205], v111 offset:2048
    ds_read_b64_tr_b16 v[206:207], v111 offset:2560
    s_waitcnt lgkmcnt(0)
    s_waitcnt vmcnt(16)
    s_barrier
    s_add_u32 s54, s10, 0x10080
    s_addc_u32 s55, s11, 0
    s_mov_b32 m0, 8192
    s_nop 0
    global_load_lds_dwordx4 v107, s[54:55]
    s_add_u32 s54, s10, 0x11080
    s_addc_u32 s55, s11, 0
    s_mov_b32 m0, 9216
    s_nop 0
    global_load_lds_dwordx4 v107, s[54:55]
    s_add_u32 s54, s10, 0x12080
    s_addc_u32 s55, s11, 0
    s_mov_b32 m0, 10240
    s_nop 0
    global_load_lds_dwordx4 v107, s[54:55]
    s_add_u32 s54, s10, 0x13080
    s_addc_u32 s55, s11, 0
    s_mov_b32 m0, 11264
    s_nop 0
    global_load_lds_dwordx4 v107, s[54:55]
    ds_read_b64_tr_b16 v[208:209], v110 offset:16384
    ds_read_b64_tr_b16 v[210:211], v110 offset:16896
    ds_read_b64_tr_b16 v[212:213], v110 offset:18432
    ds_read_b64_tr_b16 v[214:215], v110 offset:18944
    ds_read_b64_tr_b16 v[216:217], v111 offset:16384
    ds_read_b64_tr_b16 v[218:219], v111 offset:16896
    ds_read_b64_tr_b16 v[220:221], v111 offset:18432
    ds_read_b64_tr_b16 v[222:223], v111 offset:18944
    s_waitcnt lgkmcnt(0)
    s_waitcnt vmcnt(16)
    s_barrier
    ds_read_b64_tr_b16 v[224:225], v110 offset:32768
    ds_read_b64_tr_b16 v[226:227], v110 offset:33280
    ds_read_b64_tr_b16 v[228:229], v110 offset:34816
    ds_read_b64_tr_b16 v[230:231], v110 offset:35328
    ds_read_b64_tr_b16 v[232:233], v111 offset:32768
    ds_read_b64_tr_b16 v[234:235], v111 offset:33280
    ds_read_b64_tr_b16 v[236:237], v111 offset:34816
    ds_read_b64_tr_b16 v[238:239], v111 offset:35328
    s_waitcnt lgkmcnt(0)
    s_waitcnt vmcnt(12)
    s_barrier
    s_add_u32 s54, s10, 0x100c0
    s_addc_u32 s55, s11, 0
    s_mov_b32 m0, 40960
    s_nop 0
    global_load_lds_dwordx4 v107, s[54:55]
    s_add_u32 s54, s10, 0x110c0
    s_addc_u32 s55, s11, 0
    s_mov_b32 m0, 41984
    s_nop 0
    global_load_lds_dwordx4 v107, s[54:55]
    s_add_u32 s54, s10, 0x120c0
    s_addc_u32 s55, s11, 0
    s_mov_b32 m0, 43008
    s_nop 0
    global_load_lds_dwordx4 v107, s[54:55]
    s_add_u32 s54, s10, 0x130c0
    s_addc_u32 s55, s11, 0
    s_mov_b32 m0, 44032
    s_nop 0
    global_load_lds_dwordx4 v107, s[54:55]
    ds_read_b64_tr_b16 v[240:241], v110 offset:49152
    ds_read_b64_tr_b16 v[242:243], v110 offset:49664
    ds_read_b64_tr_b16 v[244:245], v110 offset:51200
    ds_read_b64_tr_b16 v[246:247], v110 offset:51712
    ds_read_b64_tr_b16 v[248:249], v111 offset:49152
    ds_read_b64_tr_b16 v[250:251], v111 offset:49664
    ds_read_b64_tr_b16 v[252:253], v111 offset:51200
    ds_read_b64_tr_b16 v[254:255], v111 offset:51712
    s_waitcnt lgkmcnt(0)
    s_waitcnt vmcnt(12)
    s_barrier
    ds_read_b64_tr_b16 v[88:89], v114 offset:0
    ds_read_b64_tr_b16 v[90:91], v114 offset:512
    ds_read_b64_tr_b16 v[92:93], v114 offset:2048
    ds_read_b64_tr_b16 v[94:95], v114 offset:2560
    ds_read_b64_tr_b16 v[116:117], v115 offset:0
    ds_read_b64_tr_b16 v[118:119], v115 offset:512
    ds_read_b64_tr_b16 v[120:121], v115 offset:2048
    ds_read_b64_tr_b16 v[122:123], v115 offset:2560
    s_waitcnt lgkmcnt(0)
    ds_write_b128 v14, v[88:91] offset:16384
    ds_write_b128 v14, v[92:95] offset:17408
    ds_write_b128 v14, v[116:119] offset:18432
    ds_write_b128 v14, v[120:123] offset:19456
    s_waitcnt lgkmcnt(0)
    s_waitcnt vmcnt(8)
    s_barrier
    ds_read_b64_tr_b16 v[88:89], v114 offset:32768
    ds_read_b64_tr_b16 v[90:91], v114 offset:33280
    ds_read_b64_tr_b16 v[92:93], v114 offset:34816
    ds_read_b64_tr_b16 v[94:95], v114 offset:35328
    ds_read_b64_tr_b16 v[116:117], v115 offset:32768
    ds_read_b64_tr_b16 v[118:119], v115 offset:33280
    ds_read_b64_tr_b16 v[120:121], v115 offset:34816
    ds_read_b64_tr_b16 v[122:123], v115 offset:35328
    s_waitcnt lgkmcnt(0)
    ds_write_b128 v14, v[88:91] offset:20480
    ds_write_b128 v14, v[92:95] offset:21504
    ds_write_b128 v14, v[116:119] offset:22528
    ds_write_b128 v14, v[120:123] offset:23552
    s_waitcnt lgkmcnt(0)
    s_waitcnt vmcnt(4)
    s_barrier
    ds_read_b64_tr_b16 v[88:89], v110 offset:0
    ds_read_b64_tr_b16 v[90:91], v110 offset:512
    ds_read_b64_tr_b16 v[92:93], v110 offset:2048
    ds_read_b64_tr_b16 v[94:95], v110 offset:2560
    ds_read_b64_tr_b16 v[116:117], v111 offset:0
    ds_read_b64_tr_b16 v[118:119], v111 offset:512
    ds_read_b64_tr_b16 v[120:121], v111 offset:2048
    ds_read_b64_tr_b16 v[122:123], v111 offset:2560
    s_waitcnt lgkmcnt(0)
    ds_write_b128 v14, v[88:91] offset:24576
    ds_write_b128 v14, v[92:95] offset:25600
    ds_write_b128 v14, v[116:119] offset:26624
    ds_write_b128 v14, v[120:123] offset:27648
    s_waitcnt lgkmcnt(0)
    s_waitcnt vmcnt(0)
    s_barrier
    ds_read_b64_tr_b16 v[88:89], v110 offset:32768
    ds_read_b64_tr_b16 v[90:91], v110 offset:33280
    ds_read_b64_tr_b16 v[92:93], v110 offset:34816
    ds_read_b64_tr_b16 v[94:95], v110 offset:35328
    ds_read_b64_tr_b16 v[116:117], v111 offset:32768
    ds_read_b64_tr_b16 v[118:119], v111 offset:33280
    ds_read_b64_tr_b16 v[120:121], v111 offset:34816
    ds_read_b64_tr_b16 v[122:123], v111 offset:35328
    s_waitcnt lgkmcnt(0)
    ds_write_b128 v14, v[88:91] offset:28672
    ds_write_b128 v14, v[92:95] offset:29696
    ds_write_b128 v14, v[116:119] offset:30720
    ds_write_b128 v14, v[120:123] offset:31744
    s_waitcnt lgkmcnt(0)
    s_barrier
    ds_write_b128 v14, v[24:27] offset:0
    ds_write_b128 v14, v[28:31] offset:1024
    ds_write_b128 v14, v[32:35] offset:2048
    ds_write_b128 v14, v[36:39] offset:3072
    ds_write_b128 v14, v[40:43] offset:4096
    ds_write_b128 v14, v[44:47] offset:5120
    ds_write_b128 v14, v[48:51] offset:6144
    ds_write_b128 v14, v[52:55] offset:7168
    ds_write_b128 v14, v[56:59] offset:8192
    ds_write_b128 v14, v[60:63] offset:9216
    ds_write_b128 v14, v[64:67] offset:10240
    ds_write_b128 v14, v[68:71] offset:11264
    ds_write_b128 v14, v[72:75] offset:12288
    ds_write_b128 v14, v[76:79] offset:13312
    ds_write_b128 v14, v[80:83] offset:14336
    ds_write_b128 v14, v[84:87] offset:15360
    s_waitcnt lgkmcnt(0)
    s_branch L_c_loaded
L_c_load3:
    s_waitcnt vmcnt(32)
    s_barrier
    s_add_u32 s54, s4, 0x380000
    s_addc_u32 s55, s5, 0
    s_mov_b32 m0, 126976
    s_nop 0
    global_load_lds_dwordx4 v106, s[54:55]
    s_add_u32 s54, s4, 0x388000
    s_addc_u32 s55, s5, 0
    s_mov_b32 m0, 128000
    s_nop 0
    global_load_lds_dwordx4 v106, s[54:55]
    s_add_u32 s54, s4, 0x390000
    s_addc_u32 s55, s5, 0
    s_mov_b32 m0, 129024
    s_nop 0
    global_load_lds_dwordx4 v106, s[54:55]
    s_add_u32 s54, s4, 0x398000
    s_addc_u32 s55, s5, 0
    s_mov_b32 m0, 130048
    s_nop 0
    global_load_lds_dwordx4 v106, s[54:55]
    ds_read_b64_tr_b16 a[0:1], v108 offset:0
    ds_read_b64_tr_b16 a[2:3], v108 offset:256
    ds_read_b64_tr_b16 a[4:5], v108 offset:2048
    ds_read_b64_tr_b16 a[6:7], v108 offset:2304
    ds_read_b64_tr_b16 a[48:49], v109 offset:0
    ds_read_b64_tr_b16 a[50:51], v109 offset:256
    ds_read_b64_tr_b16 a[52:53], v109 offset:2048
    ds_read_b64_tr_b16 a[54:55], v109 offset:2304
    s_waitcnt lgkmcnt(0)
    s_waitcnt vmcnt(32)
    s_barrier
    s_add_u32 s54, s6, 0x0
    s_addc_u32 s55, s7, 0
    s_mov_b32 m0, 12288
    s_nop 0
    global_load_lds_dwordx4 v106, s[54:55]
    s_add_u32 s54, s6, 0x8000
    s_addc_u32 s55, s7, 0
    s_mov_b32 m0, 13312
    s_nop 0
    global_load_lds_dwordx4 v106, s[54:55]
    s_add_u32 s54, s6, 0x10000
    s_addc_u32 s55, s7, 0
    s_mov_b32 m0, 14336
    s_nop 0
    global_load_lds_dwordx4 v106, s[54:55]
    s_add_u32 s54, s6, 0x18000
    s_addc_u32 s55, s7, 0
    s_mov_b32 m0, 15360
    s_nop 0
    global_load_lds_dwordx4 v106, s[54:55]
    ds_read_b64_tr_b16 a[8:9], v108 offset:16384
    ds_read_b64_tr_b16 a[10:11], v108 offset:16640
    ds_read_b64_tr_b16 a[12:13], v108 offset:18432
    ds_read_b64_tr_b16 a[14:15], v108 offset:18688
    ds_read_b64_tr_b16 a[56:57], v109 offset:16384
    ds_read_b64_tr_b16 a[58:59], v109 offset:16640
    ds_read_b64_tr_b16 a[60:61], v109 offset:18432
    ds_read_b64_tr_b16 a[62:63], v109 offset:18688
    s_waitcnt lgkmcnt(0)
    s_waitcnt vmcnt(32)
    s_barrier
    s_add_u32 s54, s6, 0x80000
    s_addc_u32 s55, s7, 0
    s_mov_b32 m0, 28672
    s_nop 0
    global_load_lds_dwordx4 v106, s[54:55]
    s_add_u32 s54, s6, 0x88000
    s_addc_u32 s55, s7, 0
    s_mov_b32 m0, 29696
    s_nop 0
    global_load_lds_dwordx4 v106, s[54:55]
    s_add_u32 s54, s6, 0x90000
    s_addc_u32 s55, s7, 0
    s_mov_b32 m0, 30720
    s_nop 0
    global_load_lds_dwordx4 v106, s[54:55]
    s_add_u32 s54, s6, 0x98000
    s_addc_u32 s55, s7, 0
    s_mov_b32 m0, 31744
    s_nop 0
    global_load_lds_dwordx4 v106, s[54:55]
    ds_read_b64_tr_b16 a[16:17], v108 offset:32768
    ds_read_b64_tr_b16 a[18:19], v108 offset:33024
    ds_read_b64_tr_b16 a[20:21], v108 offset:34816
    ds_read_b64_tr_b16 a[22:23], v108 offset:35072
    ds_read_b64_tr_b16 a[64:65], v109 offset:32768
    ds_read_b64_tr_b16 a[66:67], v109 offset:33024
    ds_read_b64_tr_b16 a[68:69], v109 offset:34816
    ds_read_b64_tr_b16 a[70:71], v109 offset:35072
    s_waitcnt lgkmcnt(0)
    s_waitcnt vmcnt(32)
    s_barrier
    s_add_u32 s54, s6, 0x100000
    s_addc_u32 s55, s7, 0
    s_mov_b32 m0, 45056
    s_nop 0
    global_load_lds_dwordx4 v106, s[54:55]
    s_add_u32 s54, s6, 0x108000
    s_addc_u32 s55, s7, 0
    s_mov_b32 m0, 46080
    s_nop 0
    global_load_lds_dwordx4 v106, s[54:55]
    s_add_u32 s54, s6, 0x110000
    s_addc_u32 s55, s7, 0
    s_mov_b32 m0, 47104
    s_nop 0
    global_load_lds_dwordx4 v106, s[54:55]
    s_add_u32 s54, s6, 0x118000
    s_addc_u32 s55, s7, 0
    s_mov_b32 m0, 48128
    s_nop 0
    global_load_lds_dwordx4 v106, s[54:55]
    ds_read_b64_tr_b16 a[24:25], v108 offset:49152
    ds_read_b64_tr_b16 a[26:27], v108 offset:49408
    ds_read_b64_tr_b16 a[28:29], v108 offset:51200
    ds_read_b64_tr_b16 a[30:31], v108 offset:51456
    ds_read_b64_tr_b16 a[72:73], v109 offset:49152
    ds_read_b64_tr_b16 a[74:75], v109 offset:49408
    ds_read_b64_tr_b16 a[76:77], v109 offset:51200
    ds_read_b64_tr_b16 a[78:79], v109 offset:51456
    s_waitcnt lgkmcnt(0)
    s_waitcnt vmcnt(32)
    s_barrier
    s_add_u32 s54, s6, 0x180000
    s_addc_u32 s55, s7, 0
    s_mov_b32 m0, 61440
    s_nop 0
    global_load_lds_dwordx4 v106, s[54:55]
    s_add_u32 s54, s6, 0x188000
    s_addc_u32 s55, s7, 0
    s_mov_b32 m0, 62464
    s_nop 0
    global_load_lds_dwordx4 v106, s[54:55]
    s_add_u32 s54, s6, 0x190000
    s_addc_u32 s55, s7, 0
    s_mov_b32 m0, 63488
    s_nop 0
    global_load_lds_dwordx4 v106, s[54:55]
    s_add_u32 s54, s6, 0x198000
    s_addc_u32 s55, s7, 0
    s_mov_b32 m0, 64512
    s_nop 0
    global_load_lds_dwordx4 v106, s[54:55]
    ds_read_b64_tr_b16 a[32:33], v112 offset:0
    ds_read_b64_tr_b16 a[34:35], v112 offset:256
    ds_read_b64_tr_b16 a[36:37], v112 offset:2048
    ds_read_b64_tr_b16 a[38:39], v112 offset:2304
    ds_read_b64_tr_b16 a[80:81], v113 offset:0
    ds_read_b64_tr_b16 a[82:83], v113 offset:256
    ds_read_b64_tr_b16 a[84:85], v113 offset:2048
    ds_read_b64_tr_b16 a[86:87], v113 offset:2304
    s_waitcnt lgkmcnt(0)
    s_waitcnt vmcnt(32)
    s_barrier
    s_add_u32 s54, s6, 0x200000
    s_addc_u32 s55, s7, 0
    s_mov_b32 m0, 77824
    s_nop 0
    global_load_lds_dwordx4 v106, s[54:55]
    s_add_u32 s54, s6, 0x208000
    s_addc_u32 s55, s7, 0
    s_mov_b32 m0, 78848
    s_nop 0
    global_load_lds_dwordx4 v106, s[54:55]
    s_add_u32 s54, s6, 0x210000
    s_addc_u32 s55, s7, 0
    s_mov_b32 m0, 79872
    s_nop 0
    global_load_lds_dwordx4 v106, s[54:55]
    s_add_u32 s54, s6, 0x218000
    s_addc_u32 s55, s7, 0
    s_mov_b32 m0, 80896
    s_nop 0
    global_load_lds_dwordx4 v106, s[54:55]
    ds_read_b64_tr_b16 a[40:41], v112 offset:16384
    ds_read_b64_tr_b16 a[42:43], v112 offset:16640
    ds_read_b64_tr_b16 a[44:45], v112 offset:18432
    ds_read_b64_tr_b16 a[46:47], v112 offset:18688
    ds_read_b64_tr_b16 a[88:89], v113 offset:16384
    ds_read_b64_tr_b16 a[90:91], v113 offset:16640
    ds_read_b64_tr_b16 a[92:93], v113 offset:18432
    ds_read_b64_tr_b16 a[94:95], v113 offset:18688
    s_waitcnt lgkmcnt(0)
    s_waitcnt vmcnt(32)
    s_barrier
    s_add_u32 s54, s6, 0x280000
    s_addc_u32 s55, s7, 0
    s_mov_b32 m0, 94208
    s_nop 0
    global_load_lds_dwordx4 v106, s[54:55]
    s_add_u32 s54, s6, 0x288000
    s_addc_u32 s55, s7, 0
    s_mov_b32 m0, 95232
    s_nop 0
    global_load_lds_dwordx4 v106, s[54:55]
    s_add_u32 s54, s6, 0x290000
    s_addc_u32 s55, s7, 0
    s_mov_b32 m0, 96256
    s_nop 0
    global_load_lds_dwordx4 v106, s[54:55]
    s_add_u32 s54, s6, 0x298000
    s_addc_u32 s55, s7, 0
    s_mov_b32 m0, 97280
    s_nop 0
    global_load_lds_dwordx4 v106, s[54:55]
    ds_read_b64_tr_b16 v[24:25], v112 offset:32768
    ds_read_b64_tr_b16 v[26:27], v112 offset:33024
    ds_read_b64_tr_b16 v[28:29], v112 offset:34816
    ds_read_b64_tr_b16 v[30:31], v112 offset:35072
    ds_read_b64_tr_b16 v[32:33], v113 offset:32768
    ds_read_b64_tr_b16 v[34:35], v113 offset:33024
    ds_read_b64_tr_b16 v[36:37], v113 offset:34816
    ds_read_b64_tr_b16 v[38:39], v113 offset:35072
    s_waitcnt lgkmcnt(0)
    s_waitcnt vmcnt(24)
    s_barrier
    s_add_u32 s54, s6, 0x300000
    s_addc_u32 s55, s7, 0
    s_mov_b32 m0, 110592
    s_nop 0
    global_load_lds_dwordx4 v106, s[54:55]
    s_add_u32 s54, s6, 0x308000
    s_addc_u32 s55, s7, 0
    s_mov_b32 m0, 111616
    s_nop 0
    global_load_lds_dwordx4 v106, s[54:55]
    s_add_u32 s54, s6, 0x310000
    s_addc_u32 s55, s7, 0
    s_mov_b32 m0, 112640
    s_nop 0
    global_load_lds_dwordx4 v106, s[54:55]
    s_add_u32 s54, s6, 0x318000
    s_addc_u32 s55, s7, 0
    s_mov_b32 m0, 113664
    s_nop 0
    global_load_lds_dwordx4 v106, s[54:55]
    ds_read_b64_tr_b16 v[40:41], v112 offset:49152
    ds_read_b64_tr_b16 v[42:43], v112 offset:49408
    ds_read_b64_tr_b16 v[44:45], v112 offset:51200
    ds_read_b64_tr_b16 v[46:47], v112 offset:51456
    ds_read_b64_tr_b16 v[48:49], v113 offset:49152
    ds_read_b64_tr_b16 v[50:51], v113 offset:49408
    ds_read_b64_tr_b16 v[52:53], v113 offset:51200
    ds_read_b64_tr_b16 v[54:55], v113 offset:51456
    s_waitcnt lgkmcnt(0)
    s_waitcnt vmcnt(24)
    s_barrier
    s_add_u32 s54, s6, 0x380000
    s_addc_u32 s55, s7, 0
    s_mov_b32 m0, 126976
    s_nop 0
    global_load_lds_dwordx4 v106, s[54:55]
    s_add_u32 s54, s6, 0x388000
    s_addc_u32 s55, s7, 0
    s_mov_b32 m0, 128000
    s_nop 0
    global_load_lds_dwordx4 v106, s[54:55]
    s_add_u32 s54, s6, 0x390000
    s_addc_u32 s55, s7, 0
    s_mov_b32 m0, 129024
    s_nop 0
    global_load_lds_dwordx4 v106, s[54:55]
    s_add_u32 s54, s6, 0x398000
    s_addc_u32 s55, s7, 0
    s_mov_b32 m0, 130048
    s_nop 0
    global_load_lds_dwordx4 v106, s[54:55]
    ds_read_b64_tr_b16 a[96:97], v108 offset:0
    ds_read_b64_tr_b16 a[98:99], v108 offset:256
    ds_read_b64_tr_b16 a[100:101], v108 offset:2048
    ds_read_b64_tr_b16 a[102:103], v108 offset:2304
    ds_read_b64_tr_b16 a[144:145], v109 offset:0
    ds_read_b64_tr_b16 a[146:147], v109 offset:256
    ds_read_b64_tr_b16 a[148:149], v109 offset:2048
    ds_read_b64_tr_b16 a[150:151], v109 offset:2304
    s_waitcnt lgkmcnt(0)
    s_waitcnt vmcnt(24)
    s_barrier
    s_add_u32 s54, s8, 0x0
    s_addc_u32 s55, s9, 0
    s_mov_b32 m0, 12288
    s_nop 0
    global_load_lds_dwordx4 v106, s[54:55]
    s_add_u32 s54, s8, 0x8000
    s_addc_u32 s55, s9, 0
    s_mov_b32 m0, 13312
    s_nop 0
    global_load_lds_dwordx4 v106, s[54:55]
    s_add_u32 s54, s8, 0x10000
    s_addc_u32 s55, s9, 0
    s_mov_b32 m0, 14336
    s_nop 0
    global_load_lds_dwordx4 v106, s[54:55]
    s_add_u32 s54, s8, 0x18000
    s_addc_u32 s55, s9, 0
    s_mov_b32 m0, 15360
    s_nop 0
    global_load_lds_dwordx4 v106, s[54:55]
    ds_read_b64_tr_b16 a[104:105], v108 offset:16384
    ds_read_b64_tr_b16 a[106:107], v108 offset:16640
    ds_read_b64_tr_b16 a[108:109], v108 offset:18432
    ds_read_b64_tr_b16 a[110:111], v108 offset:18688
    ds_read_b64_tr_b16 a[152:153], v109 offset:16384
    ds_read_b64_tr_b16 a[154:155], v109 offset:16640
    ds_read_b64_tr_b16 a[156:157], v109 offset:18432
    ds_read_b64_tr_b16 a[158:159], v109 offset:18688
    s_waitcnt lgkmcnt(0)
    s_waitcnt vmcnt(24)
    s_barrier
    s_add_u32 s54, s8, 0x80000
    s_addc_u32 s55, s9, 0
    s_mov_b32 m0, 28672
    s_nop 0
    global_load_lds_dwordx4 v106, s[54:55]
    s_add_u32 s54, s8, 0x88000
    s_addc_u32 s55, s9, 0
    s_mov_b32 m0, 29696
    s_nop 0
    global_load_lds_dwordx4 v106, s[54:55]
    s_add_u32 s54, s8, 0x90000
    s_addc_u32 s55, s9, 0
    s_mov_b32 m0, 30720
    s_nop 0
    global_load_lds_dwordx4 v106, s[54:55]
    s_add_u32 s54, s8, 0x98000
    s_addc_u32 s55, s9, 0
    s_mov_b32 m0, 31744
    s_nop 0
    global_load_lds_dwordx4 v106, s[54:55]
    v_and_b32 v104, 15, v100
    v_lshrrev_b32 v105, 4, v100
    v_lshrrev_b32 v101, 2, v104
    v_lshlrev_b32 v101, 1, v101
    v_and_b32 v102, 1, v104
    v_add_u32 v101, v101, v102
    v_lshlrev_b32 v101, 10, v101
    v_bfe_u32 v102, v104, 1, 1
    v_lshlrev_b32 v102, 6, v102
    v_lshl_add_u32 v102, v105, 3, v102
    v_add_u32 v101, v101, v102
    s_lshl_b32 s52, s19, 8
    v_add_u32 v101, s52, v101
    global_load_dwordx2 v[96:97], v101, s[12:13]
    global_load_dwordx2 v[98:99], v101, s[12:13] offset:32
    global_load_dwordx2 v[124:125], v101, s[12:13] offset:128
    global_load_dwordx2 v[126:127], v101, s[12:13] offset:160
    ds_read_b64_tr_b16 a[112:113], v108 offset:32768
    ds_read_b64_tr_b16 a[114:115], v108 offset:33024
    ds_read_b64_tr_b16 a[116:117], v108 offset:34816
    ds_read_b64_tr_b16 a[118:119], v108 offset:35072
    ds_read_b64_tr_b16 a[160:161], v109 offset:32768
    ds_read_b64_tr_b16 a[162:163], v109 offset:33024
    ds_read_b64_tr_b16 a[164:165], v109 offset:34816
    ds_read_b64_tr_b16 a[166:167], v109 offset:35072
    s_waitcnt lgkmcnt(0)
    s_waitcnt vmcnt(28)
    s_barrier
    s_add_u32 s54, s8, 0x100000
    s_addc_u32 s55, s9, 0
    s_mov_b32 m0, 45056
    s_nop 0
    global_load_lds_dwordx4 v106, s[54:55]
    s_add_u32 s54, s8, 0x108000
    s_addc_u32 s55, s9, 0
    s_mov_b32 m0, 46080
    s_nop 0
    global_load_lds_dwordx4 v106, s[54:55]
    s_add_u32 s54, s8, 0x110000
    s_addc_u32 s55, s9, 0
    s_mov_b32 m0, 47104
    s_nop 0
    global_load_lds_dwordx4 v106, s[54:55]
    s_add_u32 s54, s8, 0x118000
    s_addc_u32 s55, s9, 0
    s_mov_b32 m0, 48128
    s_nop 0
    global_load_lds_dwordx4 v106, s[54:55]
    ds_read_b64_tr_b16 a[120:121], v108 offset:49152
    ds_read_b64_tr_b16 a[122:123], v108 offset:49408
    ds_read_b64_tr_b16 a[124:125], v108 offset:51200
    ds_read_b64_tr_b16 a[126:127], v108 offset:51456
    ds_read_b64_tr_b16 a[168:169], v109 offset:49152
    ds_read_b64_tr_b16 a[170:171], v109 offset:49408
    ds_read_b64_tr_b16 a[172:173], v109 offset:51200
    ds_read_b64_tr_b16 a[174:175], v109 offset:51456
    s_waitcnt lgkmcnt(0)
    s_waitcnt vmcnt(28)
    s_barrier
    s_add_u32 s54, s8, 0x180000
    s_addc_u32 s55, s9, 0
    s_mov_b32 m0, 61440
    s_nop 0
    global_load_lds_dwordx4 v106, s[54:55]
    s_add_u32 s54, s8, 0x188000
    s_addc_u32 s55, s9, 0
    s_mov_b32 m0, 62464
    s_nop 0
    global_load_lds_dwordx4 v106, s[54:55]
    s_add_u32 s54, s8, 0x190000
    s_addc_u32 s55, s9, 0
    s_mov_b32 m0, 63488
    s_nop 0
    global_load_lds_dwordx4 v106, s[54:55]
    s_add_u32 s54, s8, 0x198000
    s_addc_u32 s55, s9, 0
    s_mov_b32 m0, 64512
    s_nop 0
    global_load_lds_dwordx4 v106, s[54:55]
    ds_read_b64_tr_b16 a[128:129], v112 offset:0
    ds_read_b64_tr_b16 a[130:131], v112 offset:256
    ds_read_b64_tr_b16 a[132:133], v112 offset:2048
    ds_read_b64_tr_b16 a[134:135], v112 offset:2304
    ds_read_b64_tr_b16 a[176:177], v113 offset:0
    ds_read_b64_tr_b16 a[178:179], v113 offset:256
    ds_read_b64_tr_b16 a[180:181], v113 offset:2048
    ds_read_b64_tr_b16 a[182:183], v113 offset:2304
    s_waitcnt lgkmcnt(0)
    s_waitcnt vmcnt(28)
    s_barrier
    s_add_u32 s54, s8, 0x200000
    s_addc_u32 s55, s9, 0
    s_mov_b32 m0, 77824
    s_nop 0
    global_load_lds_dwordx4 v106, s[54:55]
    s_add_u32 s54, s8, 0x208000
    s_addc_u32 s55, s9, 0
    s_mov_b32 m0, 78848
    s_nop 0
    global_load_lds_dwordx4 v106, s[54:55]
    s_add_u32 s54, s8, 0x210000
    s_addc_u32 s55, s9, 0
    s_mov_b32 m0, 79872
    s_nop 0
    global_load_lds_dwordx4 v106, s[54:55]
    s_add_u32 s54, s8, 0x218000
    s_addc_u32 s55, s9, 0
    s_mov_b32 m0, 80896
    s_nop 0
    global_load_lds_dwordx4 v106, s[54:55]
    ds_read_b64_tr_b16 a[136:137], v112 offset:16384
    ds_read_b64_tr_b16 a[138:139], v112 offset:16640
    ds_read_b64_tr_b16 a[140:141], v112 offset:18432
    ds_read_b64_tr_b16 a[142:143], v112 offset:18688
    ds_read_b64_tr_b16 a[184:185], v113 offset:16384
    ds_read_b64_tr_b16 a[186:187], v113 offset:16640
    ds_read_b64_tr_b16 a[188:189], v113 offset:18432
    ds_read_b64_tr_b16 a[190:191], v113 offset:18688
    s_waitcnt lgkmcnt(0)
    s_waitcnt vmcnt(28)
    s_barrier
    s_add_u32 s54, s8, 0x280000
    s_addc_u32 s55, s9, 0
    s_mov_b32 m0, 94208
    s_nop 0
    global_load_lds_dwordx4 v106, s[54:55]
    s_add_u32 s54, s8, 0x288000
    s_addc_u32 s55, s9, 0
    s_mov_b32 m0, 95232
    s_nop 0
    global_load_lds_dwordx4 v106, s[54:55]
    s_add_u32 s54, s8, 0x290000
    s_addc_u32 s55, s9, 0
    s_mov_b32 m0, 96256
    s_nop 0
    global_load_lds_dwordx4 v106, s[54:55]
    s_add_u32 s54, s8, 0x298000
    s_addc_u32 s55, s9, 0
    s_mov_b32 m0, 97280
    s_nop 0
    global_load_lds_dwordx4 v106, s[54:55]
    ds_read_b64_tr_b16 v[56:57], v112 offset:32768
    ds_read_b64_tr_b16 v[58:59], v112 offset:33024
    ds_read_b64_tr_b16 v[60:61], v112 offset:34816
    ds_read_b64_tr_b16 v[62:63], v112 offset:35072
    ds_read_b64_tr_b16 v[64:65], v113 offset:32768
    ds_read_b64_tr_b16 v[66:67], v113 offset:33024
    ds_read_b64_tr_b16 v[68:69], v113 offset:34816
    ds_read_b64_tr_b16 v[70:71], v113 offset:35072
    s_waitcnt lgkmcnt(0)
    s_waitcnt vmcnt(28)
    s_barrier
    s_add_u32 s54, s8, 0x300000
    s_addc_u32 s55, s9, 0
    s_mov_b32 m0, 110592
    s_nop 0
    global_load_lds_dwordx4 v106, s[54:55]
    s_add_u32 s54, s8, 0x308000
    s_addc_u32 s55, s9, 0
    s_mov_b32 m0, 111616
    s_nop 0
    global_load_lds_dwordx4 v106, s[54:55]
    s_add_u32 s54, s8, 0x310000
    s_addc_u32 s55, s9, 0
    s_mov_b32 m0, 112640
    s_nop 0
    global_load_lds_dwordx4 v106, s[54:55]
    s_add_u32 s54, s8, 0x318000
    s_addc_u32 s55, s9, 0
    s_mov_b32 m0, 113664
    s_nop 0
    global_load_lds_dwordx4 v106, s[54:55]
    ds_read_b64_tr_b16 v[72:73], v112 offset:49152
    ds_read_b64_tr_b16 v[74:75], v112 offset:49408
    ds_read_b64_tr_b16 v[76:77], v112 offset:51200
    ds_read_b64_tr_b16 v[78:79], v112 offset:51456
    ds_read_b64_tr_b16 v[80:81], v113 offset:49152
    ds_read_b64_tr_b16 v[82:83], v113 offset:49408
    ds_read_b64_tr_b16 v[84:85], v113 offset:51200
    ds_read_b64_tr_b16 v[86:87], v113 offset:51456
    s_waitcnt lgkmcnt(0)
    s_waitcnt vmcnt(28)
    s_barrier
    s_add_u32 s54, s8, 0x380000
    s_addc_u32 s55, s9, 0
    s_mov_b32 m0, 126976
    s_nop 0
    global_load_lds_dwordx4 v106, s[54:55]
    s_add_u32 s54, s8, 0x388000
    s_addc_u32 s55, s9, 0
    s_mov_b32 m0, 128000
    s_nop 0
    global_load_lds_dwordx4 v106, s[54:55]
    s_add_u32 s54, s8, 0x390000
    s_addc_u32 s55, s9, 0
    s_mov_b32 m0, 129024
    s_nop 0
    global_load_lds_dwordx4 v106, s[54:55]
    s_add_u32 s54, s8, 0x398000
    s_addc_u32 s55, s9, 0
    s_mov_b32 m0, 130048
    s_nop 0
    global_load_lds_dwordx4 v106, s[54:55]
    ds_read_b64_tr_b16 a[192:193], v108 offset:0
    ds_read_b64_tr_b16 a[194:195], v108 offset:256
    ds_read_b64_tr_b16 a[196:197], v108 offset:2048
    ds_read_b64_tr_b16 a[198:199], v108 offset:2304
    ds_read_b64_tr_b16 v[128:129], v109 offset:0
    ds_read_b64_tr_b16 v[130:131], v109 offset:256
    ds_read_b64_tr_b16 v[132:133], v109 offset:2048
    ds_read_b64_tr_b16 v[134:135], v109 offset:2304
    s_waitcnt lgkmcnt(0)
    s_waitcnt vmcnt(28)
    s_barrier
    s_add_u32 s54, s10, 0x0
    s_addc_u32 s55, s11, 0
    s_mov_b32 m0, 12288
    s_nop 0
    global_load_lds_dwordx4 v107, s[54:55]
    s_add_u32 s54, s10, 0x1000
    s_addc_u32 s55, s11, 0
    s_mov_b32 m0, 13312
    s_nop 0
    global_load_lds_dwordx4 v107, s[54:55]
    s_add_u32 s54, s10, 0x2000
    s_addc_u32 s55, s11, 0
    s_mov_b32 m0, 14336
    s_nop 0
    global_load_lds_dwordx4 v107, s[54:55]
    s_add_u32 s54, s10, 0x3000
    s_addc_u32 s55, s11, 0
    s_mov_b32 m0, 15360
    s_nop 0
    global_load_lds_dwordx4 v107, s[54:55]
    ds_read_b64_tr_b16 a[200:201], v108 offset:16384
    ds_read_b64_tr_b16 a[202:203], v108 offset:16640
    ds_read_b64_tr_b16 a[204:205], v108 offset:18432
    ds_read_b64_tr_b16 a[206:207], v108 offset:18688
    ds_read_b64_tr_b16 v[136:137], v109 offset:16384
    ds_read_b64_tr_b16 v[138:139], v109 offset:16640
    ds_read_b64_tr_b16 v[140:141], v109 offset:18432
    ds_read_b64_tr_b16 v[142:143], v109 offset:18688
    s_waitcnt lgkmcnt(0)
    s_waitcnt vmcnt(24)
    s_barrier
    s_add_u32 s54, s10, 0x40
    s_addc_u32 s55, s11, 0
    s_mov_b32 m0, 28672
    s_nop 0
    global_load_lds_dwordx4 v107, s[54:55]
    s_add_u32 s54, s10, 0x1040
    s_addc_u32 s55, s11, 0
    s_mov_b32 m0, 29696
    s_nop 0
    global_load_lds_dwordx4 v107, s[54:55]
    s_add_u32 s54, s10, 0x2040
    s_addc_u32 s55, s11, 0
    s_mov_b32 m0, 30720
    s_nop 0
    global_load_lds_dwordx4 v107, s[54:55]
    s_add_u32 s54, s10, 0x3040
    s_addc_u32 s55, s11, 0
    s_mov_b32 m0, 31744
    s_nop 0
    global_load_lds_dwordx4 v107, s[54:55]
    ds_read_b64_tr_b16 a[208:209], v108 offset:32768
    ds_read_b64_tr_b16 a[210:211], v108 offset:33024
    ds_read_b64_tr_b16 a[212:213], v108 offset:34816
    ds_read_b64_tr_b16 a[214:215], v108 offset:35072
    ds_read_b64_tr_b16 v[144:145], v109 offset:32768
    ds_read_b64_tr_b16 v[146:147], v109 offset:33024
    ds_read_b64_tr_b16 v[148:149], v109 offset:34816
    ds_read_b64_tr_b16 v[150:151], v109 offset:35072
    s_waitcnt lgkmcnt(0)
    s_waitcnt vmcnt(24)
    s_barrier
    s_add_u32 s54, s10, 0x80
    s_addc_u32 s55, s11, 0
    s_mov_b32 m0, 45056
    s_nop 0
    global_load_lds_dwordx4 v107, s[54:55]
    s_add_u32 s54, s10, 0x1080
    s_addc_u32 s55, s11, 0
    s_mov_b32 m0, 46080
    s_nop 0
    global_load_lds_dwordx4 v107, s[54:55]
    s_add_u32 s54, s10, 0x2080
    s_addc_u32 s55, s11, 0
    s_mov_b32 m0, 47104
    s_nop 0
    global_load_lds_dwordx4 v107, s[54:55]
    s_add_u32 s54, s10, 0x3080
    s_addc_u32 s55, s11, 0
    s_mov_b32 m0, 48128
    s_nop 0
    global_load_lds_dwordx4 v107, s[54:55]
    ds_read_b64_tr_b16 a[216:217], v108 offset:49152
    ds_read_b64_tr_b16 a[218:219], v108 offset:49408
    ds_read_b64_tr_b16 a[220:221], v108 offset:51200
    ds_read_b64_tr_b16 a[222:223], v108 offset:51456
    ds_read_b64_tr_b16 v[152:153], v109 offset:49152
    ds_read_b64_tr_b16 v[154:155], v109 offset:49408
    ds_read_b64_tr_b16 v[156:157], v109 offset:51200
    ds_read_b64_tr_b16 v[158:159], v109 offset:51456
    s_waitcnt lgkmcnt(0)
    s_waitcnt vmcnt(24)
    s_barrier
    s_add_u32 s54, s10, 0xc0
    s_addc_u32 s55, s11, 0
    s_mov_b32 m0, 61440
    s_nop 0
    global_load_lds_dwordx4 v107, s[54:55]
    s_add_u32 s54, s10, 0x10c0
    s_addc_u32 s55, s11, 0
    s_mov_b32 m0, 62464
    s_nop 0
    global_load_lds_dwordx4 v107, s[54:55]
    s_add_u32 s54, s10, 0x20c0
    s_addc_u32 s55, s11, 0
    s_mov_b32 m0, 63488
    s_nop 0
    global_load_lds_dwordx4 v107, s[54:55]
    s_add_u32 s54, s10, 0x30c0
    s_addc_u32 s55, s11, 0
    s_mov_b32 m0, 64512
    s_nop 0
    global_load_lds_dwordx4 v107, s[54:55]
    ds_read_b64_tr_b16 a[224:225], v112 offset:0
    ds_read_b64_tr_b16 a[226:227], v112 offset:256
    ds_read_b64_tr_b16 a[228:229], v112 offset:2048
    ds_read_b64_tr_b16 a[230:231], v112 offset:2304
    ds_read_b64_tr_b16 v[160:161], v113 offset:0
    ds_read_b64_tr_b16 v[162:163], v113 offset:256
    ds_read_b64_tr_b16 v[164:165], v113 offset:2048
    ds_read_b64_tr_b16 v[166:167], v113 offset:2304
    s_waitcnt lgkmcnt(0)
    s_waitcnt vmcnt(24)
    s_barrier
    s_add_u32 s54, s10, 0x10000
    s_addc_u32 s55, s11, 0
    s_mov_b32 m0, 77824
    s_nop 0
    global_load_lds_dwordx4 v107, s[54:55]
    s_add_u32 s54, s10, 0x11000
    s_addc_u32 s55, s11, 0
    s_mov_b32 m0, 78848
    s_nop 0
    global_load_lds_dwordx4 v107, s[54:55]
    s_add_u32 s54, s10, 0x12000
    s_addc_u32 s55, s11, 0
    s_mov_b32 m0, 79872
    s_nop 0
    global_load_lds_dwordx4 v107, s[54:55]
    s_add_u32 s54, s10, 0x13000
    s_addc_u32 s55, s11, 0
    s_mov_b32 m0, 80896
    s_nop 0
    global_load_lds_dwordx4 v107, s[54:55]
    ds_read_b64_tr_b16 a[232:233], v112 offset:16384
    ds_read_b64_tr_b16 a[234:235], v112 offset:16640
    ds_read_b64_tr_b16 a[236:237], v112 offset:18432
    ds_read_b64_tr_b16 a[238:239], v112 offset:18688
    ds_read_b64_tr_b16 v[168:169], v113 offset:16384
    ds_read_b64_tr_b16 v[170:171], v113 offset:16640
    ds_read_b64_tr_b16 v[172:173], v113 offset:18432
    ds_read_b64_tr_b16 v[174:175], v113 offset:18688
    s_waitcnt lgkmcnt(0)
    s_waitcnt vmcnt(24)
    s_barrier
    ds_read_b64_tr_b16 a[240:241], v112 offset:32768
    ds_read_b64_tr_b16 a[242:243], v112 offset:33024
    ds_read_b64_tr_b16 a[244:245], v112 offset:34816
    ds_read_b64_tr_b16 a[246:247], v112 offset:35072
    ds_read_b64_tr_b16 v[176:177], v113 offset:32768
    ds_read_b64_tr_b16 v[178:179], v113 offset:33024
    ds_read_b64_tr_b16 v[180:181], v113 offset:34816
    ds_read_b64_tr_b16 v[182:183], v113 offset:35072
    s_waitcnt lgkmcnt(0)
    s_waitcnt vmcnt(20)
    s_barrier
    s_add_u32 s54, s10, 0x10040
    s_addc_u32 s55, s11, 0
    s_mov_b32 m0, 110592
    s_nop 0
    global_load_lds_dwordx4 v107, s[54:55]
    s_add_u32 s54, s10, 0x11040
    s_addc_u32 s55, s11, 0
    s_mov_b32 m0, 111616
    s_nop 0
    global_load_lds_dwordx4 v107, s[54:55]
    s_add_u32 s54, s10, 0x12040
    s_addc_u32 s55, s11, 0
    s_mov_b32 m0, 112640
    s_nop 0
    global_load_lds_dwordx4 v107, s[54:55]
    s_add_u32 s54, s10, 0x13040
    s_addc_u32 s55, s11, 0
    s_mov_b32 m0, 113664
    s_nop 0
    global_load_lds_dwordx4 v107, s[54:55]
    ds_read_b64_tr_b16 a[248:249], v112 offset:49152
    ds_read_b64_tr_b16 a[250:251], v112 offset:49408
    ds_read_b64_tr_b16 a[252:253], v112 offset:51200
    ds_read_b64_tr_b16 a[254:255], v112 offset:51456
    ds_read_b64_tr_b16 v[184:185], v113 offset:49152
    ds_read_b64_tr_b16 v[186:187], v113 offset:49408
    ds_read_b64_tr_b16 v[188:189], v113 offset:51200
    ds_read_b64_tr_b16 v[190:191], v113 offset:51456
    s_waitcnt lgkmcnt(0)
    s_waitcnt vmcnt(20)
    s_barrier
    ds_read_b64_tr_b16 v[192:193], v110 offset:0
    ds_read_b64_tr_b16 v[194:195], v110 offset:512
    ds_read_b64_tr_b16 v[196:197], v110 offset:2048
    ds_read_b64_tr_b16 v[198:199], v110 offset:2560
    ds_read_b64_tr_b16 v[200:201], v111 offset:0
    ds_read_b64_tr_b16 v[202:203], v111 offset:512
    ds_read_b64_tr_b16 v[204:205], v111 offset:2048
    ds_read_b64_tr_b16 v[206:207], v111 offset:2560
    s_waitcnt lgkmcnt(0)
    s_waitcnt vmcnt(16)
    s_barrier
    s_add_u32 s54, s10, 0x10080
    s_addc_u32 s55, s11, 0
    s_mov_b32 m0, 12288
    s_nop 0
    global_load_lds_dwordx4 v107, s[54:55]
    s_add_u32 s54, s10, 0x11080
    s_addc_u32 s55, s11, 0
    s_mov_b32 m0, 13312
    s_nop 0
    global_load_lds_dwordx4 v107, s[54:55]
    s_add_u32 s54, s10, 0x12080
    s_addc_u32 s55, s11, 0
    s_mov_b32 m0, 14336
    s_nop 0
    global_load_lds_dwordx4 v107, s[54:55]
    s_add_u32 s54, s10, 0x13080
    s_addc_u32 s55, s11, 0
    s_mov_b32 m0, 15360
    s_nop 0
    global_load_lds_dwordx4 v107, s[54:55]
    ds_read_b64_tr_b16 v[208:209], v110 offset:16384
    ds_read_b64_tr_b16 v[210:211], v110 offset:16896
    ds_read_b64_tr_b16 v[212:213], v110 offset:18432
    ds_read_b64_tr_b16 v[214:215], v110 offset:18944
    ds_read_b64_tr_b16 v[216:217], v111 offset:16384
    ds_read_b64_tr_b16 v[218:219], v111 offset:16896
    ds_read_b64_tr_b16 v[220:221], v111 offset:18432
    ds_read_b64_tr_b16 v[222:223], v111 offset:18944
    s_waitcnt lgkmcnt(0)
    s_waitcnt vmcnt(16)
    s_barrier
    ds_read_b64_tr_b16 v[224:225], v110 offset:32768
    ds_read_b64_tr_b16 v[226:227], v110 offset:33280
    ds_read_b64_tr_b16 v[228:229], v110 offset:34816
    ds_read_b64_tr_b16 v[230:231], v110 offset:35328
    ds_read_b64_tr_b16 v[232:233], v111 offset:32768
    ds_read_b64_tr_b16 v[234:235], v111 offset:33280
    ds_read_b64_tr_b16 v[236:237], v111 offset:34816
    ds_read_b64_tr_b16 v[238:239], v111 offset:35328
    s_waitcnt lgkmcnt(0)
    s_waitcnt vmcnt(12)
    s_barrier
    s_add_u32 s54, s10, 0x100c0
    s_addc_u32 s55, s11, 0
    s_mov_b32 m0, 45056
    s_nop 0
    global_load_lds_dwordx4 v107, s[54:55]
    s_add_u32 s54, s10, 0x110c0
    s_addc_u32 s55, s11, 0
    s_mov_b32 m0, 46080
    s_nop 0
    global_load_lds_dwordx4 v107, s[54:55]
    s_add_u32 s54, s10, 0x120c0
    s_addc_u32 s55, s11, 0
    s_mov_b32 m0, 47104
    s_nop 0
    global_load_lds_dwordx4 v107, s[54:55]
    s_add_u32 s54, s10, 0x130c0
    s_addc_u32 s55, s11, 0
    s_mov_b32 m0, 48128
    s_nop 0
    global_load_lds_dwordx4 v107, s[54:55]
    ds_read_b64_tr_b16 v[240:241], v110 offset:49152
    ds_read_b64_tr_b16 v[242:243], v110 offset:49664
    ds_read_b64_tr_b16 v[244:245], v110 offset:51200
    ds_read_b64_tr_b16 v[246:247], v110 offset:51712
    ds_read_b64_tr_b16 v[248:249], v111 offset:49152
    ds_read_b64_tr_b16 v[250:251], v111 offset:49664
    ds_read_b64_tr_b16 v[252:253], v111 offset:51200
    ds_read_b64_tr_b16 v[254:255], v111 offset:51712
    s_waitcnt lgkmcnt(0)
    s_waitcnt vmcnt(12)
    s_barrier
    ds_read_b64_tr_b16 v[88:89], v114 offset:0
    ds_read_b64_tr_b16 v[90:91], v114 offset:512
    ds_read_b64_tr_b16 v[92:93], v114 offset:2048
    ds_read_b64_tr_b16 v[94:95], v114 offset:2560
    ds_read_b64_tr_b16 v[116:117], v115 offset:0
    ds_read_b64_tr_b16 v[118:119], v115 offset:512
    ds_read_b64_tr_b16 v[120:121], v115 offset:2048
    ds_read_b64_tr_b16 v[122:123], v115 offset:2560
    s_waitcnt lgkmcnt(0)
    ds_write_b128 v14, v[88:91] offset:16384
    ds_write_b128 v14, v[92:95] offset:17408
    ds_write_b128 v14, v[116:119] offset:18432
    ds_write_b128 v14, v[120:123] offset:19456
    s_waitcnt lgkmcnt(0)
    s_waitcnt vmcnt(8)
    s_barrier
    ds_read_b64_tr_b16 v[88:89], v114 offset:32768
    ds_read_b64_tr_b16 v[90:91], v114 offset:33280
    ds_read_b64_tr_b16 v[92:93], v114 offset:34816
    ds_read_b64_tr_b16 v[94:95], v114 offset:35328
    ds_read_b64_tr_b16 v[116:117], v115 offset:32768
    ds_read_b64_tr_b16 v[118:119], v115 offset:33280
    ds_read_b64_tr_b16 v[120:121], v115 offset:34816
    ds_read_b64_tr_b16 v[122:123], v115 offset:35328
    s_waitcnt lgkmcnt(0)
    ds_write_b128 v14, v[88:91] offset:20480
    ds_write_b128 v14, v[92:95] offset:21504
    ds_write_b128 v14, v[116:119] offset:22528
    ds_write_b128 v14, v[120:123] offset:23552
    s_waitcnt lgkmcnt(0)
    s_waitcnt vmcnt(4)
    s_barrier
    ds_read_b64_tr_b16 v[88:89], v110 offset:0
    ds_read_b64_tr_b16 v[90:91], v110 offset:512
    ds_read_b64_tr_b16 v[92:93], v110 offset:2048
    ds_read_b64_tr_b16 v[94:95], v110 offset:2560
    ds_read_b64_tr_b16 v[116:117], v111 offset:0
    ds_read_b64_tr_b16 v[118:119], v111 offset:512
    ds_read_b64_tr_b16 v[120:121], v111 offset:2048
    ds_read_b64_tr_b16 v[122:123], v111 offset:2560
    s_waitcnt lgkmcnt(0)
    ds_write_b128 v14, v[88:91] offset:24576
    ds_write_b128 v14, v[92:95] offset:25600
    ds_write_b128 v14, v[116:119] offset:26624
    ds_write_b128 v14, v[120:123] offset:27648
    s_waitcnt lgkmcnt(0)
    s_waitcnt vmcnt(0)
    s_barrier
    ds_read_b64_tr_b16 v[88:89], v110 offset:32768
    ds_read_b64_tr_b16 v[90:91], v110 offset:33280
    ds_read_b64_tr_b16 v[92:93], v110 offset:34816
    ds_read_b64_tr_b16 v[94:95], v110 offset:35328
    ds_read_b64_tr_b16 v[116:117], v111 offset:32768
    ds_read_b64_tr_b16 v[118:119], v111 offset:33280
    ds_read_b64_tr_b16 v[120:121], v111 offset:34816
    ds_read_b64_tr_b16 v[122:123], v111 offset:35328
    s_waitcnt lgkmcnt(0)
    ds_write_b128 v14, v[88:91] offset:28672
    ds_write_b128 v14, v[92:95] offset:29696
    ds_write_b128 v14, v[116:119] offset:30720
    ds_write_b128 v14, v[120:123] offset:31744
    s_waitcnt lgkmcnt(0)
    s_barrier
    ds_write_b128 v14, v[24:27] offset:0
    ds_write_b128 v14, v[28:31] offset:1024
    ds_write_b128 v14, v[32:35] offset:2048
    ds_write_b128 v14, v[36:39] offset:3072
    ds_write_b128 v14, v[40:43] offset:4096
    ds_write_b128 v14, v[44:47] offset:5120
    ds_write_b128 v14, v[48:51] offset:6144
    ds_write_b128 v14, v[52:55] offset:7168
    ds_write_b128 v14, v[56:59] offset:8192
    ds_write_b128 v14, v[60:63] offset:9216
    ds_write_b128 v14, v[64:67] offset:10240
    ds_write_b128 v14, v[68:71] offset:11264
    ds_write_b128 v14, v[72:75] offset:12288
    ds_write_b128 v14, v[76:79] offset:13312
    ds_write_b128 v14, v[80:83] offset:14336
    ds_write_b128 v14, v[84:87] offset:15360
    s_waitcnt lgkmcnt(0)
L_c_loaded:
    s_waitcnt vmcnt(0)
    s_barrier
    s_cmp_eq_u32 s19, 0
    s_cbranch_scc0 L_c_larr
    s_add_u32 s56, s84, 40
    v_mov_b32 v106, s56
    v_mov_b32 v107, 1
    s_mov_b64 exec, 1
    global_atomic_add v106, v107, s[16:17]
    s_mov_b64 exec, -1
L_c_larr:
    s_mov_b32 s43, 0
L_c_chk:
    s_add_u32 s55, s76, 128
    buffer_load_dword v9, off, s[96:99], s76 sc1
    buffer_load_dword v103, off, s[96:99], s55 sc1
    v_mbcnt_lo_u32_b32 v102, -1, 0
    v_mbcnt_hi_u32_b32 v102, -1, v102
    v_lshlrev_b32 v106, 2, v102
    s_add_u32 s56, s84, 36
    s_add_u32 s57, s84, 32
    v_mov_b32 v107, s56
    v_cmp_eq_u32 vcc, 8, v102
    s_nop 1
    v_cndmask_b32 v106, v106, v107, vcc
    v_mov_b32 v107, s57
    v_cmp_le_u32 vcc, 9, v102
    s_nop 1
    v_cndmask_b32 v106, v106, v107, vcc
    global_load_dword v107, v106, s[16:17] sc1
    s_add_u32 s43, s43, 1
    s_cmp_gt_u32 s43, 400000
    s_cbranch_scc1 L_fail_c
    s_waitcnt vmcnt(0)
    v_mov_b32 v101, 32
    v_mov_b32 v104, 192
    v_cmp_le_u32 vcc, 9, v102
    s_nop 1
    v_cndmask_b32 v101, v101, v104, vcc
    s_cmp_eq_u32 s82, 0
    s_cbranch_scc1 L_c_cfast
    s_mov_b32 exec_lo, 0xffffff00
    s_mov_b32 exec_hi, -1
    v_cmp_gt_u32 vcc, v101, v107
    s_mov_b64 exec, -1
    s_cbranch_vccnz L_c_chk
    s_branch L_c_cok
L_c_cfast:
    s_mov_b64 exec, 0xff
    v_cmp_lt_u32 vcc, 32, v107
    s_mov_b64 exec, -1
    s_cbranch_vccnz L_fallback
    v_cmp_gt_u32 vcc, v101, v107
    s_cbranch_vccnz L_c_chk
L_c_cok:
    v_min_u32 v9, v9, v103
    s_nop 0
    v_readfirstlane_b32 s55, v9
    s_nop 3
    s_cmp_lg_u32 s55, 0
    s_cbranch_scc0 L_c_chk
    s_add_u32 s76, s76, 256
    s_mov_b32 s43, 0
    s_lshl_b32 s52, s19, 11
    s_add_u32 m0, s52, 145408
    s_nop 0
    global_load_lds_dwordx4 v0, s[34:35] sc1
    global_load_lds_dwordx4 v0, s[34:35] offset:1024 sc1
    s_add_u32 s34, s34, 0x40000
    s_addc_u32 s35, s35, 0
    s_mov_b32 s56, 0x05040100
    s_mov_b32 s57, 0x07060302
    v_perm_b32 v116, v98, v96, s56
    v_perm_b32 v117, v98, v96, s57
    v_perm_b32 v118, v99, v97, s56
    v_perm_b32 v119, v99, v97, s57
    v_perm_b32 v120, v126, v124, s56
    v_perm_b32 v121, v126, v124, s57
    v_perm_b32 v122, v127, v125, s56
    v_perm_b32 v123, v127, v125, s57
    s_cmp_eq_u32 s82, 0
    s_cselect_b32 s56, s19, 99
    s_cmp_eq_u32 s56, 0
    s_cbranch_scc1 L_c_start_F0
    s_cmp_eq_u32 s82, 0
    s_cselect_b32 s56, s19, 99
    s_cmp_eq_u32 s56, 1
    s_cbranch_scc1 L_c_start_F1
    s_cmp_eq_u32 s82, 0
    s_cselect_b32 s56, s19, 99
    s_cmp_eq_u32 s56, 2
    s_cbranch_scc1 L_c_start_F2
    s_cmp_eq_u32 s82, 0
    s_cselect_b32 s56, s19, 99
    s_cmp_eq_u32 s56, 3
    s_cbranch_scc1 L_c_start_F3
    s_cmp_eq_u32 s82, 1
    s_cselect_b32 s56, s19, 99
    s_cmp_eq_u32 s56, 0
    s_cbranch_scc1 L_c_start_S0
    s_cmp_eq_u32 s82, 1
    s_cselect_b32 s56, s19, 99
    s_cmp_eq_u32 s56, 1
    s_cbranch_scc1 L_c_start_S1
    s_cmp_eq_u32 s82, 1
    s_cselect_b32 s56, s19, 99
    s_cmp_eq_u32 s56, 2
    s_cbranch_scc1 L_c_start_S2
    s_cmp_eq_u32 s82, 1
    s_cselect_b32 s56, s19, 99
    s_cmp_eq_u32 s56, 3
    s_cbranch_scc1 L_c_start_S3
    s_endpgm
L_fail_c:
    v_mov_b32 v1, 240
    v_mov_b32 v2, 0xdead
    global_store_dword v1, v2, s[16:17]
    s_endpgm
L_c_start_F0:
    s_and_b32 s52, s20, 1
    s_lshl_b32 s52, s52, 18
    s_add_u32 s22, s14, s52
    s_addc_u32 s23, s15, 0
    s_add_u32 s24, s22, 0x8000
    s_addc_u32 s25, s23, 0
    s_lshl_b32 s52, s18, 13
    s_add_u32 s52, s52, 0
    s_add_u32 s26, s22, s52
    s_addc_u32 s27, s23, 0
    v_mov_b32 v24, v116
    v_mov_b32 v28, v120
    v_mov_b32 v25, v117
    v_mov_b32 v29, v121
    v_mov_b32 v26, v118
    v_mov_b32 v30, v122
    v_mov_b32 v27, v119
    v_mov_b32 v31, v123
    ds_read_b128 v[32:35], v14 offset:0
    ds_read_b128 v[36:39], v14 offset:1024
    ds_read_b128 v[40:43], v14 offset:2048
    ds_read_b128 v[44:47], v14 offset:3072
    ds_read_b128 v[80:83], v14 offset:4096
    ds_read_b128 v[84:87], v14 offset:5120
    ds_read_b128 v[88:91], v14 offset:6144
    ds_read_b128 v[92:95], v14 offset:7168
    ds_read_b128 v[96:99], v14 offset:8192
    ds_read_b128 v[100:103], v14 offset:9216
    ds_read_b128 v[104:107], v14 offset:10240
    ds_read_b128 v[108:111], v14 offset:11264
    ds_read_b128 v[112:115], v14 offset:12288
    ds_read_b128 v[116:119], v14 offset:13312
    ds_read_b128 v[120:123], v14 offset:14336
    ds_read_b128 v[124:127], v14 offset:15360
    v_mov_b64 v[56:57], 0
    v_mov_b64 v[58:59], 0
    v_mov_b64 v[60:61], 0
    v_mov_b64 v[62:63], 0
    v_mov_b64 v[64:65], 0
    v_mov_b64 v[66:67], 0
    v_mov_b64 v[68:69], 0
    v_mov_b64 v[70:71], 0
    v_mov_b64 v[72:73], 0
    v_mov_b64 v[74:75], 0
    v_mov_b64 v[76:77], 0
    v_mov_b64 v[78:79], 0
    s_waitcnt vmcnt(0) lgkmcnt(0)
    s_branch L_entry_FW0
L_pollG_FW0:
    global_load_dwordx4 v[24:27], v0, s[28:29] sc1
    global_load_dwordx4 v[28:31], v0, s[28:29] offset:1024 sc1
    s_add_u32 s43, s43, 1
    s_cmp_gt_u32 s43, 400000
    s_cbranch_scc1 L_F_fail
    s_waitcnt vmcnt(0)
    v_max_u32 v13, v24, v28
    v_cmp_eq_u32 vcc, -1, v13
    s_cbranch_vccnz L_pollG_FW0
L_entry_FW0:
    ds_write_b128 v2, v[24:27] offset:0
    ds_write_b128 v2, v[28:31] offset:1024
L_entry2_FW0:
    v_smfmac_f32_16x16x64_bf16 v[56:59], v[24:27], v[32:39], v15
    v_smfmac_f32_16x16x64_bf16 v[60:63], v[24:27], v[40:47], v15
    v_smfmac_f32_16x16x64_bf16 v[56:59], v[28:31], v[80:87], v15
    v_smfmac_f32_16x16x64_bf16 v[60:63], v[28:31], v[88:95], v15
    v_smfmac_f32_16x16x64_bf16 v[64:67], v[24:27], v[96:103], v15
    v_smfmac_f32_16x16x64_bf16 v[68:71], v[24:27], v[104:111], v15
    s_waitcnt vmcnt(0) lgkmcnt(0)
    s_barrier
    ds_read_b128 v[32:35], v2 offset:2048
    ds_read_b128 v[36:39], v2 offset:3072
    v_smfmac_f32_16x16x64_bf16 v[64:67], v[28:31], v[112:119], v15
    ds_read_b128 v[40:43], v2 offset:4096
    v_smfmac_f32_16x16x64_bf16 v[68:71], v[28:31], v[120:127], v15
    ds_read_b128 v[44:47], v2 offset:5120
    v_smfmac_f32_16x16x64_bf16 v[72:75], v[24:27], a[192:199], v15
    ds_read_b128 v[48:51], v2 offset:6144
    v_smfmac_f32_16x16x64_bf16 v[76:79], v[24:27], v[128:135], v15
    ds_read_b128 v[52:55], v2 offset:7168
    v_smfmac_f32_16x16x64_bf16 v[72:75], v[28:31], a[200:207], v15
    s_mov_b32 m0, 153600
    v_mov_b32 v13, -1
    v_smfmac_f32_16x16x64_bf16 v[76:79], v[28:31], v[136:143], v15
    global_load_lds_dwordx4 v0, s[36:37] sc1
    s_waitcnt lgkmcnt(5)
    v_smfmac_f32_16x16x64_bf16 v[56:59], v[32:35], a[0:7], v15
    ds_read_b128 v[80:83], v2 offset:14336
    v_smfmac_f32_16x16x64_bf16 v[60:63], v[32:35], a[48:55], v15
    ds_read_b128 v[96:99], v2 offset:18432
    s_waitcnt lgkmcnt(6)
    v_smfmac_f32_16x16x64_bf16 v[56:59], v[36:39], a[8:15], v15
    ds_read_b128 v[84:87], v2 offset:15360
    v_smfmac_f32_16x16x64_bf16 v[60:63], v[36:39], a[56:63], v15
    ds_read_b128 v[100:103], v2 offset:19456
    s_waitcnt lgkmcnt(7)
    v_smfmac_f32_16x16x64_bf16 v[56:59], v[40:43], a[16:23], v15
    ds_read_b128 v[88:91], v2 offset:16384
    v_smfmac_f32_16x16x64_bf16 v[60:63], v[40:43], a[64:71], v15
    ds_read_b128 v[104:107], v2 offset:20480
    s_waitcnt lgkmcnt(8)
    v_smfmac_f32_16x16x64_bf16 v[56:59], v[44:47], a[24:31], v15
    ds_read_b128 v[92:95], v2 offset:17408
    v_smfmac_f32_16x16x64_bf16 v[60:63], v[44:47], a[72:79], v15
    ds_read_b128 v[108:111], v2 offset:21504
    s_waitcnt lgkmcnt(9)
    v_smfmac_f32_16x16x64_bf16 v[56:59], v[48:51], a[32:39], v15
    global_load_lds_dwordx4 v0, s[36:37] offset:1024 sc1
    v_smfmac_f32_16x16x64_bf16 v[60:63], v[48:51], a[80:87], v15
    global_store_dword v10, v13, s[32:33]
    s_waitcnt lgkmcnt(8)
    v_smfmac_f32_16x16x64_bf16 v[56:59], v[52:55], a[40:47], v15
    buffer_load_dword v9, off, s[96:99], s76 sc1
    v_smfmac_f32_16x16x64_bf16 v[60:63], v[52:55], a[88:95], v15
    s_add_u32 s54, s36, 0x40000
    s_addc_u32 s55, s37, 0
    global_load_dword v13, v1, s[54:55] sc1
    v_smfmac_f32_16x16x64_bf16 v[64:67], v[32:35], a[96:103], v15
    v_smfmac_f32_16x16x64_bf16 v[68:71], v[32:35], a[144:151], v15
    s_nop 0
    v_add_f32 v56, v56, v58
    v_add_f32 v57, v57, v59
    v_smfmac_f32_16x16x64_bf16 v[64:67], v[36:39], a[104:111], v15
    v_add_f32 v60, v60, v62
    v_add_f32 v61, v61, v63
    v_cvt_pk_bf16_f32 v58, v56, v60
    v_cvt_pk_bf16_f32 v59, v57, v61
    ds_write_b32 v3, v58
    ds_write_b32 v4, v59
    v_smfmac_f32_16x16x64_bf16 v[68:71], v[36:39], a[152:159], v15
    v_mov_b32 v56, 1
    v_smfmac_f32_16x16x64_bf16 v[64:67], v[40:43], a[112:119], v15
    buffer_store_dword v56, off, s[96:99], s77 sc1
    v_smfmac_f32_16x16x64_bf16 v[68:71], v[40:43], a[160:167], v15
    s_mov_b32 m0, 145408
    v_smfmac_f32_16x16x64_bf16 v[64:67], v[44:47], a[120:127], v15
    v_smfmac_f32_16x16x64_bf16 v[68:71], v[44:47], a[168:175], v15
    v_smfmac_f32_16x16x64_bf16 v[64:67], v[48:51], a[128:135], v15
    s_waitcnt lgkmcnt(0)
    s_barrier
    ds_read_b128 v[112:115], v5 offset:0
    v_smfmac_f32_16x16x64_bf16 v[68:71], v[48:51], a[176:183], v15
    ds_read_b128 v[116:119], v5 offset:1024
    v_smfmac_f32_16x16x64_bf16 v[64:67], v[52:55], a[136:143], v15
    ds_read_b128 v[120:123], v5 offset:2048
    v_smfmac_f32_16x16x64_bf16 v[68:71], v[52:55], a[184:191], v15
    ds_read_b128 v[124:127], v5 offset:3072
    v_smfmac_f32_16x16x64_bf16 v[72:75], v[32:35], a[208:215], v15
    global_load_lds_dwordx4 v0, s[34:35] sc1
    v_smfmac_f32_16x16x64_bf16 v[76:79], v[32:35], v[144:151], v15
    global_load_lds_dwordx4 v0, s[34:35] offset:1024 sc1
    s_nop 0
    v_add_f32 v64, v64, v66
    v_add_f32 v65, v65, v67
    v_add_f32 v68, v68, v70
    v_add_f32 v69, v69, v71
    v_cvt_pk_bf16_f32 v66, v64, v68
    v_cvt_pk_bf16_f32 v67, v65, v69
    s_waitcnt lgkmcnt(0)
    ds_write_b32 v3, v66 offset:128
    ds_write_b32 v4, v67 offset:128
    v_mfma_f32_16x16x32_bf16 v[56:59], v[80:83], v[112:115], 0
    v_mfma_f32_16x16x32_bf16 v[60:63], v[96:99], v[112:115], 0
    v_mfma_f32_16x16x32_bf16 v[56:59], v[84:87], v[116:119], v[56:59]
    v_mfma_f32_16x16x32_bf16 v[60:63], v[100:103], v[116:119], v[60:63]
    v_mfma_f32_16x16x32_bf16 v[56:59], v[88:91], v[120:123], v[56:59]
    v_mfma_f32_16x16x32_bf16 v[60:63], v[104:107], v[120:123], v[60:63]
    v_mfma_f32_16x16x32_bf16 v[56:59], v[92:95], v[124:127], v[56:59]
    v_mfma_f32_16x16x32_bf16 v[60:63], v[108:111], v[124:127], v[60:63]
    s_waitcnt vmcnt(6) lgkmcnt(0)
    s_barrier
    ds_read_b128 v[80:83], v6 offset:0
    ds_read_b128 v[84:87], v6 offset:1024
    v_smfmac_f32_16x16x64_bf16 v[72:75], v[36:39], a[216:223], v15
    ds_read_b128 v[88:91], v6 offset:2048
    v_smfmac_f32_16x16x64_bf16 v[76:79], v[36:39], v[152:159], v15
    ds_read_b128 v[92:95], v6 offset:3072
    v_smfmac_f32_16x16x64_bf16 v[72:75], v[40:43], a[224:231], v15
    ds_read_b128 v[104:107], v2 offset:22528
    v_smfmac_f32_16x16x64_bf16 v[76:79], v[40:43], v[160:167], v15
    ds_read_b128 v[108:111], v2 offset:23552
    v_smfmac_f32_16x16x64_bf16 v[72:75], v[44:47], a[232:239], v15
    s_waitcnt lgkmcnt(5)
    v_mfma_f32_16x16x32_bf16 v[64:67], v[80:83], v[112:115], 0
    s_waitcnt lgkmcnt(4)
    v_mfma_f32_16x16x32_bf16 v[64:67], v[84:87], v[116:119], v[64:67]
    s_waitcnt lgkmcnt(3)
    v_mfma_f32_16x16x32_bf16 v[64:67], v[88:91], v[120:123], v[64:67]
    s_waitcnt lgkmcnt(2)
    v_mfma_f32_16x16x32_bf16 v[64:67], v[92:95], v[124:127], v[64:67]
    v_smfmac_f32_16x16x64_bf16 v[76:79], v[44:47], v[168:175], v15
    global_store_dwordx4 v11, v[80:83], s[38:39] sc1
    v_smfmac_f32_16x16x64_bf16 v[72:75], v[48:51], a[240:247], v15
    v_smfmac_f32_16x16x64_bf16 v[76:79], v[48:51], v[176:183], v15
    v_smfmac_f32_16x16x64_bf16 v[72:75], v[52:55], a[248:255], v15
    v_smfmac_f32_16x16x64_bf16 v[76:79], v[52:55], v[184:191], v15
    v_max3_f32 v68, v56, v57, v58
    v_max3_f32 v68, v68, v59, v60
    v_max3_f32 v68, v68, v61, v62
    v_max3_f32 v68, v68, v63, v64
    v_max_f32 v68, v68, v65
    v_mov_b32 v69, v68
    ds_read_b128 v[24:27], v14 offset:16384
    ds_read_b128 v[28:31], v14 offset:17408
    v_permlane32_swap_b32 v68, v69
    v_max_f32 v68, v68, v69
    v_mov_b32 v69, v68
    ds_read_b128 v[32:35], v14 offset:18432
    ds_read_b128 v[36:39], v14 offset:19456
    v_permlane16_swap_b32 v68, v69
    v_max_f32 v68, v68, v69
    v_mul_f32 v68, s44, v68
    v_pk_fma_f32 v[56:57], v[56:57], s[44:45], v[68:69] op_sel_hi:[1,0,0] neg_lo:[0,0,1] neg_hi:[0,0,1]
    v_pk_fma_f32 v[58:59], v[58:59], s[44:45], v[68:69] op_sel_hi:[1,0,0] neg_lo:[0,0,1] neg_hi:[0,0,1]
    v_pk_fma_f32 v[60:61], v[60:61], s[44:45], v[68:69] op_sel_hi:[1,0,0] neg_lo:[0,0,1] neg_hi:[0,0,1]
    v_pk_fma_f32 v[62:63], v[62:63], s[44:45], v[68:69] op_sel_hi:[1,0,0] neg_lo:[0,0,1] neg_hi:[0,0,1]
    v_pk_fma_f32 v[64:65], v[64:65], s[44:45], v[68:69] op_sel_hi:[1,0,0] neg_lo:[0,0,1] neg_hi:[0,0,1]
    v_exp_f32 v56, v56
    v_exp_f32 v57, v57
    v_exp_f32 v58, v58
    v_exp_f32 v59, v59
    v_exp_f32 v60, v60
    v_exp_f32 v61, v61
    v_exp_f32 v62, v62
    v_exp_f32 v63, v63
    v_exp_f32 v64, v64
    v_exp_f32 v65, v65
    v_cvt_pk_bf16_f32 v96, v56, v57
    v_cvt_pk_bf16_f32 v97, v58, v59
    v_cvt_pk_bf16_f32 v98, v60, v61
    v_cvt_pk_bf16_f32 v99, v62, v63
    v_cvt_pk_bf16_f32 v100, v64, v65
    v_mov_b32 v101, 0
    s_waitcnt lgkmcnt(4)
    v_mfma_f32_16x16x32_bf16 v[88:91], v[20:23], v[96:99], 0
    v_add_f32 v72, v72, v74
    v_add_f32 v73, v73, v75
    v_mfma_f32_16x16x32_bf16 v[80:83], v[104:107], v[96:99], 0
    v_add_f32 v76, v76, v78
    v_add_f32 v77, v77, v79
    v_mfma_f32_16x16x32_bf16 v[84:87], v[108:111], v[96:99], 0
    v_cvt_pk_bf16_f32 v112, v72, v73
    v_cvt_pk_bf16_f32 v114, v76, v77
    v_mov_b32 v113, 0
    v_mov_b32 v115, 0
    v_mfma_f32_16x16x16_bf16 v[88:91], v[20:21], v[100:101], v[88:91]
    ds_read_b128 v[40:43], v14 offset:20480
    ds_read_b128 v[44:47], v14 offset:21504
    v_mfma_f32_16x16x16_bf16 v[80:83], v[112:113], v[100:101], v[80:83]
    ds_read_b128 v[48:51], v14 offset:22528
    ds_read_b128 v[52:55], v14 offset:23552
    v_mfma_f32_16x16x16_bf16 v[84:87], v[114:115], v[100:101], v[84:87]
    ds_read_b128 v[56:59], v14 offset:24576
    ds_read_b128 v[60:63], v14 offset:25600
    global_store_dword v12, v112, s[40:41] sc1
    global_store_dword v12, v114, s[40:41] offset:256 sc1
    s_cmp_eq_u32 s20, 63
    s_cbranch_scc1 L_last_FW0
    v_rcp_f32 v92, v88
    ds_read_b128 v[64:67], v14 offset:26624
    ds_read_b128 v[68:71], v14 offset:27648
    v_pk_mul_f32 v[80:81], v[80:81], v[92:93] op_sel_hi:[1,0]
    v_pk_mul_f32 v[82:83], v[82:83], v[92:93] op_sel_hi:[1,0]
    v_pk_mul_f32 v[84:85], v[84:85], v[92:93] op_sel_hi:[1,0]
    v_pk_mul_f32 v[86:87], v[86:87], v[92:93] op_sel_hi:[1,0]
    v_cvt_pk_bf16_f32 v120, v80, v81
    v_cvt_pk_bf16_f32 v121, v82, v83
    v_cvt_pk_bf16_f32 v122, v84, v85
    v_cvt_pk_bf16_f32 v123, v86, v87
    ds_write_b128 v7, v[120:123]
    ds_read_b128 v[72:75], v14 offset:28672
    ds_read_b128 v[76:79], v14 offset:29696
    v_mov_b64 v[80:81], 0
    v_mov_b64 v[82:83], 0
    v_mov_b64 v[84:85], 0
    v_mov_b64 v[86:87], 0
    v_mov_b64 v[88:89], 0
    v_mov_b64 v[90:91], 0
    v_mov_b64 v[92:93], 0
    v_mov_b64 v[94:95], 0
    v_mov_b64 v[96:97], 0
    v_mov_b64 v[98:99], 0
    v_mov_b64 v[100:101], 0
    v_mov_b64 v[102:103], 0
    v_mov_b64 v[104:105], 0
    v_mov_b64 v[106:107], 0
    v_mov_b64 v[108:109], 0
    v_mov_b64 v[110:111], 0
    s_waitcnt lgkmcnt(0)
    s_barrier
    ds_read_b128 v[112:115], v2 offset:12288
    ds_read_b128 v[116:119], v2 offset:13312
    s_add_u32 s34, s34, 0x40000
    s_addc_u32 s35, s35, 0
    s_add_u32 s36, s36, 0x40000
    s_addc_u32 s37, s37, 0
    s_add_u32 s38, s38, 0x10000
    s_addc_u32 s39, s39, 0
    s_add_u32 s40, s40, 0x10000
    s_addc_u32 s41, s41, 0
    s_waitcnt lgkmcnt(0)
    v_smfmac_f32_16x16x64_bf16 v[80:83], v[112:115], v[192:199], v15
    v_smfmac_f32_16x16x64_bf16 v[80:83], v[116:119], v[24:31], v15
    ds_read_b128 v[24:27], v14 offset:30720
    ds_read_b128 v[28:31], v14 offset:31744
    v_smfmac_f32_16x16x64_bf16 v[84:87], v[112:115], v[200:207], v15
    v_smfmac_f32_16x16x64_bf16 v[84:87], v[116:119], v[32:39], v15
    v_smfmac_f32_16x16x64_bf16 v[88:91], v[112:115], v[208:215], v15
    v_add_f32 v80, v80, v82
    v_smfmac_f32_16x16x64_bf16 v[88:91], v[116:119], v[40:47], v15
    v_add_f32 v81, v81, v83
    v_cvt_pk_bf16_f32 v120, v80, v81
    v_smfmac_f32_16x16x64_bf16 v[92:95], v[112:115], v[216:223], v15
    v_add_f32 v84, v84, v86
    v_smfmac_f32_16x16x64_bf16 v[92:95], v[116:119], v[48:55], v15
    v_add_f32 v85, v85, v87
    v_cvt_pk_bf16_f32 v121, v84, v85
    v_smfmac_f32_16x16x64_bf16 v[96:99], v[112:115], v[224:231], v15
    v_add_f32 v88, v88, v90
    v_smfmac_f32_16x16x64_bf16 v[96:99], v[116:119], v[56:63], v15
    v_add_f32 v89, v89, v91
    v_cvt_pk_bf16_f32 v122, v88, v89
    v_smfmac_f32_16x16x64_bf16 v[100:103], v[112:115], v[232:239], v15
    v_add_f32 v92, v92, v94
    v_smfmac_f32_16x16x64_bf16 v[100:103], v[116:119], v[64:71], v15
    v_add_f32 v93, v93, v95
    v_cvt_pk_bf16_f32 v123, v92, v93
    v_smfmac_f32_16x16x64_bf16 v[104:107], v[112:115], v[240:247], v15
    v_add_f32 v96, v96, v98
    v_and_or_b32 v120, v120, -2, s42
    global_store_dwordx4 v8, v[120:123], s[22:23]
    v_smfmac_f32_16x16x64_bf16 v[104:107], v[116:119], v[72:79], v15
    v_add_f32 v97, v97, v99
    v_cvt_pk_bf16_f32 v124, v96, v97
    v_smfmac_f32_16x16x64_bf16 v[108:111], v[112:115], v[248:255], v15
    v_add_f32 v100, v100, v102
    s_waitcnt lgkmcnt(0)
    v_smfmac_f32_16x16x64_bf16 v[108:111], v[116:119], v[24:31], v15
    v_add_f32 v101, v101, v103
    v_cvt_pk_bf16_f32 v125, v100, v101
    s_nop 1
    v_add_f32 v104, v104, v106
    v_add_f32 v105, v105, v107
    v_cvt_pk_bf16_f32 v126, v104, v105
    s_nop 2
    v_add_f32 v108, v108, v110
    v_add_f32 v109, v109, v111
    v_cvt_pk_bf16_f32 v127, v108, v109
    v_and_or_b32 v124, v124, -2, s42
    global_store_dwordx4 v8, v[124:127], s[24:25]
    ds_read_b128 v[32:35], v14 offset:0
    ds_read_b128 v[36:39], v14 offset:1024
    ds_read_b128 v[40:43], v14 offset:2048
    ds_read_b128 v[44:47], v14 offset:3072
    ds_read_b128 v[80:83], v14 offset:4096
    ds_read_b128 v[84:87], v14 offset:5120
    ds_read_b128 v[88:91], v14 offset:6144
    ds_read_b128 v[92:95], v14 offset:7168
    ds_read_b128 v[96:99], v14 offset:8192
    ds_read_b128 v[100:103], v14 offset:9216
    ds_read_b128 v[104:107], v14 offset:10240
    ds_read_b128 v[108:111], v14 offset:11264
    ds_read_b128 v[112:115], v14 offset:12288
    ds_read_b128 v[116:119], v14 offset:13312
    ds_read_b128 v[120:123], v14 offset:14336
    ds_read_b128 v[124:127], v14 offset:15360
    s_nop 15
    global_load_dwordx4 v[56:59], v0, s[26:27] sc1
    global_load_dwordx4 v[60:63], v0, s[26:27] offset:1024 sc1
    s_add_u32 s20, s20, 1
    s_mov_b32 s32, s28
    s_mov_b32 s33, s29
    s_sub_u32 s32, s32, 0
    s_subb_u32 s33, s33, 0
    s_add_u32 s28, s30, 0x0
    s_addc_u32 s29, s31, 0
    s_nop 15
    s_nop 15
    global_load_dwordx4 v[68:71], v0, s[26:27] sc1
    global_load_dwordx4 v[72:75], v0, s[26:27] offset:1024 sc1
    s_waitcnt vmcnt(2)
    v_mfma_f32_16x16x32_bf16 v[64:67], v[16:19], v[56:59], 0
    v_bitop3_b32 v13, v56, v60, s42 bitop3:0x7e
    v_mfma_f32_16x16x32_bf16 v[64:67], v[16:19], v[60:63], v[64:67]
    v_and_b32 v13, 1, v13
    v_cmp_ne_u32 vcc, 0, v13
    s_cbranch_vccz L_okR_FW0
    s_waitcnt vmcnt(0)
    v_mfma_f32_16x16x32_bf16 v[64:67], v[16:19], v[68:71], 0
    v_bitop3_b32 v13, v68, v72, s42 bitop3:0x7e
    v_mfma_f32_16x16x32_bf16 v[64:67], v[16:19], v[72:75], v[64:67]
    v_and_b32 v13, 1, v13
    v_cmp_ne_u32 vcc, 0, v13
    s_cbranch_vccz L_okR_FW0
L_pollR_FW0:
    global_load_dwordx4 v[56:59], v0, s[26:27] sc1
    global_load_dwordx4 v[60:63], v0, s[26:27] offset:1024 sc1
    s_add_u32 s43, s43, 1
    s_cmp_gt_u32 s43, 400000
    s_cbranch_scc1 L_F_fail
L_chkR_FW0:
    s_waitcnt vmcnt(0)
    v_mfma_f32_16x16x32_bf16 v[64:67], v[16:19], v[56:59], 0
    v_bitop3_b32 v13, v56, v60, s42 bitop3:0x7e
    v_mfma_f32_16x16x32_bf16 v[64:67], v[16:19], v[60:63], v[64:67]
    v_and_b32 v13, 1, v13
    v_cmp_ne_u32 vcc, 0, v13
    s_cbranch_vccnz L_pollR_FW0
L_okR_FW0:
    s_nop 4
    v_add_f32_dpp v64, v64, v64 row_ror:8 row_mask:0xf bank_mask:0x3
    v_add_f32_dpp v65, v65, v65 row_ror:8 row_mask:0xf bank_mask:0x3
    v_add_f32_dpp v64, v66, v66 row_ror:8 row_mask:0xf bank_mask:0xc
    v_add_f32_dpp v65, v67, v67 row_ror:8 row_mask:0xf bank_mask:0xc
    s_nop 0
    v_add_f32_dpp v64, v64, v64 row_shl:4 row_mask:0xf bank_mask:0x5
    v_add_f32_dpp v64, v65, v65 row_shr:4 row_mask:0xf bank_mask:0xa
    s_nop 1
    v_mov_b32_dpp v65, v64 row_ror:8 row_mask:0xf bank_mask:0xf
    v_cvt_pk_bf16_f32 v64, v64, v65
    v_min_u32 v64, -2, v64
    global_store_dword v10, v64, s[30:31]
    v_readfirstlane_b32 s55, v9
    s_add_u32 s52, s20, 1
    s_and_b32 s52, s52, 3
    s_lshl_b32 s52, s52, 13
    s_add_u32 s52, s52, 0x80000
    s_add_u32 s30, s14, s52
    s_addc_u32 s31, s15, 0
    s_and_b32 s52, s20, 1
    s_lshl_b32 s52, s52, 18
    s_add_u32 s22, s14, s52
    s_addc_u32 s23, s15, 0
    s_add_u32 s24, s22, 0x8000
    s_addc_u32 s25, s23, 0
    s_lshl_b32 s52, s18, 13
    s_add_u32 s52, s52, 0
    s_add_u32 s26, s22, s52
    s_addc_u32 s27, s23, 0
    s_bfe_u32 s42, s20, 0x10001
    s_mov_b32 s43, 0
    s_add_u32 s76, s76, 128
    s_add_u32 s77, s77, 128
    s_cmp_lg_u32 s55, 0
    s_cbranch_scc1 L_kvok_FW0
    s_add_u32 s52, s20, 1
    s_cmp_lt_u32 s52, 64
    s_cbranch_scc0 L_kvok_FW0
    s_sub_u32 s52, s76, 128
L_kvspin_FW0:
    buffer_load_dword v9, off, s[96:99], s52 sc1
    s_add_u32 s43, s43, 1
    s_cmp_gt_u32 s43, 400000
    s_cbranch_scc1 L_F_fail
    s_waitcnt vmcnt(0)
    v_readfirstlane_b32 s55, v9
    s_nop 3
    s_cmp_lg_u32 s55, 0
    s_cbranch_scc0 L_kvspin_FW0
    s_mov_b32 s43, 0
L_kvok_FW0:
    s_nop 15
    s_nop 15
    global_load_dwordx4 v[24:27], v0, s[28:29] sc1
    global_load_dwordx4 v[28:31], v0, s[28:29] offset:1024 sc1
    s_waitcnt vmcnt(3)
    v_mov_b64 v[56:57], 0
    v_mov_b64 v[58:59], 0
    v_mov_b64 v[60:61], 0
    v_mov_b64 v[62:63], 0
    v_mov_b64 v[64:65], 0
    v_mov_b64 v[66:67], 0
    v_mov_b64 v[68:69], 0
    v_mov_b64 v[70:71], 0
    v_mov_b64 v[72:73], 0
    v_mov_b64 v[74:75], 0
    v_mov_b64 v[76:77], 0
    v_mov_b64 v[78:79], 0
    s_waitcnt lgkmcnt(0)
    s_nop 15
    s_nop 7
    global_load_dwordx4 v[48:51], v0, s[28:29] sc1
    global_load_dwordx4 v[52:55], v0, s[28:29] offset:1024 sc1
    s_waitcnt vmcnt(2)
    v_max_u32 v13, v24, v28
    v_cmp_eq_u32 vcc, -1, v13
    s_cbranch_vccz L_entry_FW0
    s_waitcnt vmcnt(0)
    v_max_u32 v13, v48, v52
    v_cmp_eq_u32 vcc, -1, v13
    s_cbranch_vccnz L_pollG_FW0
    ds_write_b128 v2, v[48:51] offset:0
    ds_write_b128 v2, v[52:55] offset:1024
    v_mov_b64 v[24:25], v[48:49]
    v_mov_b64 v[26:27], v[50:51]
    v_mov_b64 v[28:29], v[52:53]
    v_mov_b64 v[30:31], v[54:55]
    s_nop 0
    s_branch L_entry2_FW0
L_last_FW0:
    s_waitcnt vmcnt(0)
    s_barrier
    s_add_u32 s77, s77, 128
    v_mov_b32 v13, 1
    buffer_store_dword v13, off, s[96:99], s77 sc1
    s_waitcnt vmcnt(0)
    s_branch L_F_done
L_c_start_F1:
    s_and_b32 s52, s20, 1
    s_lshl_b32 s52, s52, 18
    s_add_u32 s22, s14, s52
    s_addc_u32 s23, s15, 0
    s_add_u32 s24, s22, 0x8000
    s_addc_u32 s25, s23, 0
    s_lshl_b32 s52, s18, 13
    s_add_u32 s52, s52, 2048
    s_add_u32 s26, s22, s52
    s_addc_u32 s27, s23, 0
    v_mov_b32 v32, v116
    v_mov_b32 v36, v120
    v_mov_b32 v33, v117
    v_mov_b32 v37, v121
    v_mov_b32 v34, v118
    v_mov_b32 v38, v122
    v_mov_b32 v35, v119
    v_mov_b32 v39, v123
    ds_read_b128 v[24:27], v14 offset:0
    ds_read_b128 v[28:31], v14 offset:1024
    ds_read_b128 v[40:43], v14 offset:2048
    ds_read_b128 v[44:47], v14 offset:3072
    ds_read_b128 v[80:83], v14 offset:4096
    ds_read_b128 v[84:87], v14 offset:5120
    ds_read_b128 v[88:91], v14 offset:6144
    ds_read_b128 v[92:95], v14 offset:7168
    ds_read_b128 v[96:99], v14 offset:8192
    ds_read_b128 v[100:103], v14 offset:9216
    ds_read_b128 v[104:107], v14 offset:10240
    ds_read_b128 v[108:111], v14 offset:11264
    ds_read_b128 v[112:115], v14 offset:12288
    ds_read_b128 v[116:119], v14 offset:13312
    ds_read_b128 v[120:123], v14 offset:14336
    ds_read_b128 v[124:127], v14 offset:15360
    v_mov_b64 v[56:57], 0
    v_mov_b64 v[58:59], 0
    v_mov_b64 v[60:61], 0
    v_mov_b64 v[62:63], 0
    v_mov_b64 v[64:65], 0
    v_mov_b64 v[66:67], 0
    v_mov_b64 v[68:69], 0
    v_mov_b64 v[70:71], 0
    v_mov_b64 v[72:73], 0
    v_mov_b64 v[74:75], 0
    v_mov_b64 v[76:77], 0
    v_mov_b64 v[78:79], 0
    s_waitcnt vmcnt(0) lgkmcnt(0)
    s_branch L_entry_FW1
L_pollG_FW1:
    global_load_dwordx4 v[32:35], v0, s[28:29] sc1
    global_load_dwordx4 v[36:39], v0, s[28:29] offset:1024 sc1
    s_add_u32 s43, s43, 1
    s_cmp_gt_u32 s43, 400000
    s_cbranch_scc1 L_F_fail
    s_waitcnt vmcnt(0)
    v_max_u32 v13, v32, v36
    v_cmp_eq_u32 vcc, -1, v13
    s_cbranch_vccnz L_pollG_FW1
L_entry_FW1:
    ds_write_b128 v2, v[32:35] offset:2048
    ds_write_b128 v2, v[36:39] offset:3072
L_entry2_FW1:
    v_smfmac_f32_16x16x64_bf16 v[56:59], v[32:35], v[24:31], v15
    v_smfmac_f32_16x16x64_bf16 v[60:63], v[32:35], v[40:47], v15
    v_smfmac_f32_16x16x64_bf16 v[56:59], v[36:39], v[80:87], v15
    v_smfmac_f32_16x16x64_bf16 v[60:63], v[36:39], v[88:95], v15
    v_smfmac_f32_16x16x64_bf16 v[64:67], v[32:35], v[96:103], v15
    v_smfmac_f32_16x16x64_bf16 v[68:71], v[32:35], v[104:111], v15
    s_waitcnt vmcnt(0) lgkmcnt(0)
    s_barrier
    ds_read_b128 v[40:43], v2 offset:4096
    ds_read_b128 v[44:47], v2 offset:5120
    v_smfmac_f32_16x16x64_bf16 v[64:67], v[36:39], v[112:119], v15
    ds_read_b128 v[48:51], v2 offset:6144
    v_smfmac_f32_16x16x64_bf16 v[68:71], v[36:39], v[120:127], v15
    ds_read_b128 v[52:55], v2 offset:7168
    v_smfmac_f32_16x16x64_bf16 v[72:75], v[32:35], a[208:215], v15
    ds_read_b128 v[24:27], v2 offset:0
    v_smfmac_f32_16x16x64_bf16 v[76:79], v[32:35], v[144:151], v15
    ds_read_b128 v[28:31], v2 offset:1024
    v_smfmac_f32_16x16x64_bf16 v[72:75], v[36:39], a[216:223], v15
    s_mov_b32 m0, 155648
    v_mov_b32 v13, -1
    v_smfmac_f32_16x16x64_bf16 v[76:79], v[36:39], v[152:159], v15
    global_load_lds_dwordx4 v0, s[36:37] sc1
    s_waitcnt lgkmcnt(5)
    v_smfmac_f32_16x16x64_bf16 v[56:59], v[40:43], a[0:7], v15
    ds_read_b128 v[80:83], v2 offset:14336
    v_smfmac_f32_16x16x64_bf16 v[60:63], v[40:43], a[48:55], v15
    ds_read_b128 v[96:99], v2 offset:18432
    s_waitcnt lgkmcnt(6)
    v_smfmac_f32_16x16x64_bf16 v[56:59], v[44:47], a[8:15], v15
    ds_read_b128 v[84:87], v2 offset:15360
    v_smfmac_f32_16x16x64_bf16 v[60:63], v[44:47], a[56:63], v15
    ds_read_b128 v[100:103], v2 offset:19456
    s_waitcnt lgkmcnt(7)
    v_smfmac_f32_16x16x64_bf16 v[56:59], v[48:51], a[16:23], v15
    ds_read_b128 v[88:91], v2 offset:16384
    v_smfmac_f32_16x16x64_bf16 v[60:63], v[48:51], a[64:71], v15
    ds_read_b128 v[104:107], v2 offset:20480
    s_waitcnt lgkmcnt(8)
    v_smfmac_f32_16x16x64_bf16 v[56:59], v[52:55], a[24:31], v15
    ds_read_b128 v[92:95], v2 offset:17408
    v_smfmac_f32_16x16x64_bf16 v[60:63], v[52:55], a[72:79], v15
    ds_read_b128 v[108:111], v2 offset:21504
    s_waitcnt lgkmcnt(9)
    v_smfmac_f32_16x16x64_bf16 v[56:59], v[24:27], a[32:39], v15
    global_load_lds_dwordx4 v0, s[36:37] offset:1024 sc1
    v_smfmac_f32_16x16x64_bf16 v[60:63], v[24:27], a[80:87], v15
    global_store_dword v10, v13, s[32:33]
    s_waitcnt lgkmcnt(8)
    v_smfmac_f32_16x16x64_bf16 v[56:59], v[28:31], a[40:47], v15
    buffer_load_dword v9, off, s[96:99], s76 sc1
    v_smfmac_f32_16x16x64_bf16 v[60:63], v[28:31], a[88:95], v15
    s_add_u32 s54, s36, 0x40000
    s_addc_u32 s55, s37, 0
    global_load_dword v13, v1, s[54:55] sc1
    v_smfmac_f32_16x16x64_bf16 v[64:67], v[40:43], a[96:103], v15
    v_smfmac_f32_16x16x64_bf16 v[68:71], v[40:43], a[144:151], v15
    s_nop 0
    v_add_f32 v56, v56, v58
    v_add_f32 v57, v57, v59
    v_smfmac_f32_16x16x64_bf16 v[64:67], v[44:47], a[104:111], v15
    v_add_f32 v60, v60, v62
    v_add_f32 v61, v61, v63
    v_cvt_pk_bf16_f32 v58, v56, v60
    v_cvt_pk_bf16_f32 v59, v57, v61
    ds_write_b32 v3, v58
    ds_write_b32 v4, v59
    v_smfmac_f32_16x16x64_bf16 v[68:71], v[44:47], a[152:159], v15
    s_mov_b32 m0, 147456
    v_smfmac_f32_16x16x64_bf16 v[64:67], v[48:51], a[112:119], v15
    v_smfmac_f32_16x16x64_bf16 v[68:71], v[48:51], a[160:167], v15
    v_smfmac_f32_16x16x64_bf16 v[64:67], v[52:55], a[120:127], v15
    v_smfmac_f32_16x16x64_bf16 v[68:71], v[52:55], a[168:175], v15
    v_smfmac_f32_16x16x64_bf16 v[64:67], v[24:27], a[128:135], v15
    s_waitcnt lgkmcnt(0)
    s_barrier
    ds_read_b128 v[112:115], v5 offset:0
    v_smfmac_f32_16x16x64_bf16 v[68:71], v[24:27], a[176:183], v15
    ds_read_b128 v[116:119], v5 offset:1024
    v_smfmac_f32_16x16x64_bf16 v[64:67], v[28:31], a[136:143], v15
    ds_read_b128 v[120:123], v5 offset:2048
    v_smfmac_f32_16x16x64_bf16 v[68:71], v[28:31], a[184:191], v15
    ds_read_b128 v[124:127], v5 offset:3072
    v_smfmac_f32_16x16x64_bf16 v[72:75], v[40:43], a[224:231], v15
    global_load_lds_dwordx4 v0, s[34:35] sc1
    v_smfmac_f32_16x16x64_bf16 v[76:79], v[40:43], v[160:167], v15
    global_load_lds_dwordx4 v0, s[34:35] offset:1024 sc1
    s_nop 0
    v_add_f32 v64, v64, v66
    v_add_f32 v65, v65, v67
    v_add_f32 v68, v68, v70
    v_add_f32 v69, v69, v71
    v_cvt_pk_bf16_f32 v66, v64, v68
    v_cvt_pk_bf16_f32 v67, v65, v69
    s_waitcnt lgkmcnt(0)
    ds_write_b32 v3, v66 offset:128
    ds_write_b32 v4, v67 offset:128
    v_mfma_f32_16x16x32_bf16 v[56:59], v[80:83], v[112:115], 0
    v_mfma_f32_16x16x32_bf16 v[60:63], v[96:99], v[112:115], 0
    v_mfma_f32_16x16x32_bf16 v[56:59], v[84:87], v[116:119], v[56:59]
    v_mfma_f32_16x16x32_bf16 v[60:63], v[100:103], v[116:119], v[60:63]
    v_mfma_f32_16x16x32_bf16 v[56:59], v[88:91], v[120:123], v[56:59]
    v_mfma_f32_16x16x32_bf16 v[60:63], v[104:107], v[120:123], v[60:63]
    v_mfma_f32_16x16x32_bf16 v[56:59], v[92:95], v[124:127], v[56:59]
    v_mfma_f32_16x16x32_bf16 v[60:63], v[108:111], v[124:127], v[60:63]
    s_waitcnt vmcnt(5) lgkmcnt(0)
    s_barrier
    ds_read_b128 v[80:83], v6 offset:0
    ds_read_b128 v[84:87], v6 offset:1024
    v_smfmac_f32_16x16x64_bf16 v[72:75], v[44:47], a[232:239], v15
    ds_read_b128 v[88:91], v6 offset:2048
    v_smfmac_f32_16x16x64_bf16 v[76:79], v[44:47], v[168:175], v15
    ds_read_b128 v[92:95], v6 offset:3072
    v_smfmac_f32_16x16x64_bf16 v[72:75], v[48:51], a[240:247], v15
    ds_read_b128 v[104:107], v2 offset:24576
    v_smfmac_f32_16x16x64_bf16 v[76:79], v[48:51], v[176:183], v15
    ds_read_b128 v[108:111], v2 offset:25600
    v_smfmac_f32_16x16x64_bf16 v[72:75], v[52:55], a[248:255], v15
    s_waitcnt lgkmcnt(5)
    v_mfma_f32_16x16x32_bf16 v[64:67], v[80:83], v[112:115], 0
    s_waitcnt lgkmcnt(4)
    v_mfma_f32_16x16x32_bf16 v[64:67], v[84:87], v[116:119], v[64:67]
    s_waitcnt lgkmcnt(3)
    v_mfma_f32_16x16x32_bf16 v[64:67], v[88:91], v[120:123], v[64:67]
    s_waitcnt lgkmcnt(2)
    v_mfma_f32_16x16x32_bf16 v[64:67], v[92:95], v[124:127], v[64:67]
    v_smfmac_f32_16x16x64_bf16 v[76:79], v[52:55], v[184:191], v15
    global_store_dwordx4 v11, v[84:87], s[38:39] sc1
    v_smfmac_f32_16x16x64_bf16 v[72:75], v[24:27], a[192:199], v15
    v_smfmac_f32_16x16x64_bf16 v[76:79], v[24:27], v[128:135], v15
    v_smfmac_f32_16x16x64_bf16 v[72:75], v[28:31], a[200:207], v15
    v_smfmac_f32_16x16x64_bf16 v[76:79], v[28:31], v[136:143], v15
    v_max3_f32 v68, v56, v57, v58
    v_max3_f32 v68, v68, v59, v60
    v_max3_f32 v68, v68, v61, v62
    v_max3_f32 v68, v68, v63, v64
    v_max_f32 v68, v68, v65
    v_mov_b32 v69, v68
    ds_read_b128 v[24:27], v14 offset:16384
    ds_read_b128 v[28:31], v14 offset:17408
    v_permlane32_swap_b32 v68, v69
    v_max_f32 v68, v68, v69
    v_mov_b32 v69, v68
    ds_read_b128 v[32:35], v14 offset:18432
    ds_read_b128 v[36:39], v14 offset:19456
    v_permlane16_swap_b32 v68, v69
    v_max_f32 v68, v68, v69
    v_mul_f32 v68, s44, v68
    v_pk_fma_f32 v[56:57], v[56:57], s[44:45], v[68:69] op_sel_hi:[1,0,0] neg_lo:[0,0,1] neg_hi:[0,0,1]
    v_pk_fma_f32 v[58:59], v[58:59], s[44:45], v[68:69] op_sel_hi:[1,0,0] neg_lo:[0,0,1] neg_hi:[0,0,1]
    v_pk_fma_f32 v[60:61], v[60:61], s[44:45], v[68:69] op_sel_hi:[1,0,0] neg_lo:[0,0,1] neg_hi:[0,0,1]
    v_pk_fma_f32 v[62:63], v[62:63], s[44:45], v[68:69] op_sel_hi:[1,0,0] neg_lo:[0,0,1] neg_hi:[0,0,1]
    v_pk_fma_f32 v[64:65], v[64:65], s[44:45], v[68:69] op_sel_hi:[1,0,0] neg_lo:[0,0,1] neg_hi:[0,0,1]
    v_exp_f32 v56, v56
    v_exp_f32 v57, v57
    v_exp_f32 v58, v58
    v_exp_f32 v59, v59
    v_exp_f32 v60, v60
    v_exp_f32 v61, v61
    v_exp_f32 v62, v62
    v_exp_f32 v63, v63
    v_exp_f32 v64, v64
    v_exp_f32 v65, v65
    v_cvt_pk_bf16_f32 v96, v56, v57
    v_cvt_pk_bf16_f32 v97, v58, v59
    v_cvt_pk_bf16_f32 v98, v60, v61
    v_cvt_pk_bf16_f32 v99, v62, v63
    v_cvt_pk_bf16_f32 v100, v64, v65
    v_mov_b32 v101, 0
    s_waitcnt lgkmcnt(4)
    v_mfma_f32_16x16x32_bf16 v[88:91], v[20:23], v[96:99], 0
    v_add_f32 v72, v72, v74
    v_add_f32 v73, v73, v75
    v_mfma_f32_16x16x32_bf16 v[80:83], v[104:107], v[96:99], 0
    v_add_f32 v76, v76, v78
    v_add_f32 v77, v77, v79
    v_mfma_f32_16x16x32_bf16 v[84:87], v[108:111], v[96:99], 0
    v_cvt_pk_bf16_f32 v112, v72, v73
    v_cvt_pk_bf16_f32 v114, v76, v77
    v_mov_b32 v113, 0
    v_mov_b32 v115, 0
    v_mfma_f32_16x16x16_bf16 v[88:91], v[20:21], v[100:101], v[88:91]
    ds_read_b128 v[40:43], v14 offset:20480
    ds_read_b128 v[44:47], v14 offset:21504
    v_mfma_f32_16x16x16_bf16 v[80:83], v[112:113], v[100:101], v[80:83]
    ds_read_b128 v[48:51], v14 offset:22528
    ds_read_b128 v[52:55], v14 offset:23552
    v_mfma_f32_16x16x16_bf16 v[84:87], v[114:115], v[100:101], v[84:87]
    ds_read_b128 v[56:59], v14 offset:24576
    ds_read_b128 v[60:63], v14 offset:25600
    global_store_dword v12, v112, s[40:41] sc1
    global_store_dword v12, v114, s[40:41] offset:256 sc1
    s_cmp_eq_u32 s20, 63
    s_cbranch_scc1 L_last_FW1
    v_rcp_f32 v92, v88
    ds_read_b128 v[64:67], v14 offset:26624
    ds_read_b128 v[68:71], v14 offset:27648
    v_pk_mul_f32 v[80:81], v[80:81], v[92:93] op_sel_hi:[1,0]
    v_pk_mul_f32 v[82:83], v[82:83], v[92:93] op_sel_hi:[1,0]
    v_pk_mul_f32 v[84:85], v[84:85], v[92:93] op_sel_hi:[1,0]
    v_pk_mul_f32 v[86:87], v[86:87], v[92:93] op_sel_hi:[1,0]
    v_cvt_pk_bf16_f32 v120, v80, v81
    v_cvt_pk_bf16_f32 v121, v82, v83
    v_cvt_pk_bf16_f32 v122, v84, v85
    v_cvt_pk_bf16_f32 v123, v86, v87
    ds_write_b128 v7, v[120:123]
    ds_read_b128 v[72:75], v14 offset:28672
    ds_read_b128 v[76:79], v14 offset:29696
    v_mov_b64 v[80:81], 0
    v_mov_b64 v[82:83], 0
    v_mov_b64 v[84:85], 0
    v_mov_b64 v[86:87], 0
    v_mov_b64 v[88:89], 0
    v_mov_b64 v[90:91], 0
    v_mov_b64 v[92:93], 0
    v_mov_b64 v[94:95], 0
    v_mov_b64 v[96:97], 0
    v_mov_b64 v[98:99], 0
    v_mov_b64 v[100:101], 0
    v_mov_b64 v[102:103], 0
    v_mov_b64 v[104:105], 0
    v_mov_b64 v[106:107], 0
    v_mov_b64 v[108:109], 0
    v_mov_b64 v[110:111], 0
    s_waitcnt lgkmcnt(0)
    s_barrier
    ds_read_b128 v[112:115], v2 offset:12288
    ds_read_b128 v[116:119], v2 offset:13312
    s_add_u32 s34, s34, 0x40000
    s_addc_u32 s35, s35, 0
    s_add_u32 s36, s36, 0x40000
    s_addc_u32 s37, s37, 0
    s_add_u32 s38, s38, 0x10000
    s_addc_u32 s39, s39, 0
    s_add_u32 s40, s40, 0x10000
    s_addc_u32 s41, s41, 0
    s_waitcnt lgkmcnt(0)
    v_smfmac_f32_16x16x64_bf16 v[80:83], v[112:115], v[192:199], v15
    v_smfmac_f32_16x16x64_bf16 v[80:83], v[116:119], v[24:31], v15
    ds_read_b128 v[24:27], v14 offset:30720
    ds_read_b128 v[28:31], v14 offset:31744
    v_smfmac_f32_16x16x64_bf16 v[84:87], v[112:115], v[200:207], v15
    v_smfmac_f32_16x16x64_bf16 v[84:87], v[116:119], v[32:39], v15
    v_smfmac_f32_16x16x64_bf16 v[88:91], v[112:115], v[208:215], v15
    v_add_f32 v80, v80, v82
    v_smfmac_f32_16x16x64_bf16 v[88:91], v[116:119], v[40:47], v15
    v_add_f32 v81, v81, v83
    v_cvt_pk_bf16_f32 v120, v80, v81
    v_smfmac_f32_16x16x64_bf16 v[92:95], v[112:115], v[216:223], v15
    v_add_f32 v84, v84, v86
    v_smfmac_f32_16x16x64_bf16 v[92:95], v[116:119], v[48:55], v15
    v_add_f32 v85, v85, v87
    v_cvt_pk_bf16_f32 v121, v84, v85
    v_smfmac_f32_16x16x64_bf16 v[96:99], v[112:115], v[224:231], v15
    v_add_f32 v88, v88, v90
    v_smfmac_f32_16x16x64_bf16 v[96:99], v[116:119], v[56:63], v15
    v_add_f32 v89, v89, v91
    v_cvt_pk_bf16_f32 v122, v88, v89
    v_smfmac_f32_16x16x64_bf16 v[100:103], v[112:115], v[232:239], v15
    v_add_f32 v92, v92, v94
    v_smfmac_f32_16x16x64_bf16 v[100:103], v[116:119], v[64:71], v15
    v_add_f32 v93, v93, v95
    v_cvt_pk_bf16_f32 v123, v92, v93
    v_smfmac_f32_16x16x64_bf16 v[104:107], v[112:115], v[240:247], v15
    v_add_f32 v96, v96, v98
    v_and_or_b32 v120, v120, -2, s42
    global_store_dwordx4 v8, v[120:123], s[22:23]
    v_smfmac_f32_16x16x64_bf16 v[104:107], v[116:119], v[72:79], v15
    v_add_f32 v97, v97, v99
    v_cvt_pk_bf16_f32 v124, v96, v97
    v_smfmac_f32_16x16x64_bf16 v[108:111], v[112:115], v[248:255], v15
    v_add_f32 v100, v100, v102
    s_waitcnt lgkmcnt(0)
    v_smfmac_f32_16x16x64_bf16 v[108:111], v[116:119], v[24:31], v15
    v_add_f32 v101, v101, v103
    v_cvt_pk_bf16_f32 v125, v100, v101
    s_nop 1
    v_add_f32 v104, v104, v106
    v_add_f32 v105, v105, v107
    v_cvt_pk_bf16_f32 v126, v104, v105
    s_nop 2
    v_add_f32 v108, v108, v110
    v_add_f32 v109, v109, v111
    v_cvt_pk_bf16_f32 v127, v108, v109
    v_and_or_b32 v124, v124, -2, s42
    global_store_dwordx4 v8, v[124:127], s[24:25]
    ds_read_b128 v[24:27], v14 offset:0
    ds_read_b128 v[28:31], v14 offset:1024
    ds_read_b128 v[40:43], v14 offset:2048
    ds_read_b128 v[44:47], v14 offset:3072
    ds_read_b128 v[80:83], v14 offset:4096
    ds_read_b128 v[84:87], v14 offset:5120
    ds_read_b128 v[88:91], v14 offset:6144
    ds_read_b128 v[92:95], v14 offset:7168
    ds_read_b128 v[96:99], v14 offset:8192
    ds_read_b128 v[100:103], v14 offset:9216
    ds_read_b128 v[104:107], v14 offset:10240
    ds_read_b128 v[108:111], v14 offset:11264
    ds_read_b128 v[112:115], v14 offset:12288
    ds_read_b128 v[116:119], v14 offset:13312
    ds_read_b128 v[120:123], v14 offset:14336
    ds_read_b128 v[124:127], v14 offset:15360
    s_nop 15
    global_load_dwordx4 v[56:59], v0, s[26:27] sc1
    global_load_dwordx4 v[60:63], v0, s[26:27] offset:1024 sc1
    s_add_u32 s20, s20, 1
    s_mov_b32 s32, s28
    s_mov_b32 s33, s29
    s_sub_u32 s32, s32, 2048
    s_subb_u32 s33, s33, 0
    s_add_u32 s28, s30, 0x800
    s_addc_u32 s29, s31, 0
    s_nop 15
    s_nop 15
    global_load_dwordx4 v[68:71], v0, s[26:27] sc1
    global_load_dwordx4 v[72:75], v0, s[26:27] offset:1024 sc1
    s_waitcnt vmcnt(2)
    v_mfma_f32_16x16x32_bf16 v[64:67], v[16:19], v[56:59], 0
    v_bitop3_b32 v13, v56, v60, s42 bitop3:0x7e
    v_mfma_f32_16x16x32_bf16 v[64:67], v[16:19], v[60:63], v[64:67]
    v_and_b32 v13, 1, v13
    v_cmp_ne_u32 vcc, 0, v13
    s_cbranch_vccz L_okR_FW1
    s_waitcnt vmcnt(0)
    v_mfma_f32_16x16x32_bf16 v[64:67], v[16:19], v[68:71], 0
    v_bitop3_b32 v13, v68, v72, s42 bitop3:0x7e
    v_mfma_f32_16x16x32_bf16 v[64:67], v[16:19], v[72:75], v[64:67]
    v_and_b32 v13, 1, v13
    v_cmp_ne_u32 vcc, 0, v13
    s_cbranch_vccz L_okR_FW1
L_pollR_FW1:
    global_load_dwordx4 v[56:59], v0, s[26:27] sc1
    global_load_dwordx4 v[60:63], v0, s[26:27] offset:1024 sc1
    s_add_u32 s43, s43, 1
    s_cmp_gt_u32 s43, 400000
    s_cbranch_scc1 L_F_fail
L_chkR_FW1:
    s_waitcnt vmcnt(0)
    v_mfma_f32_16x16x32_bf16 v[64:67], v[16:19], v[56:59], 0
    v_bitop3_b32 v13, v56, v60, s42 bitop3:0x7e
    v_mfma_f32_16x16x32_bf16 v[64:67], v[16:19], v[60:63], v[64:67]
    v_and_b32 v13, 1, v13
    v_cmp_ne_u32 vcc, 0, v13
    s_cbranch_vccnz L_pollR_FW1
L_okR_FW1:
    s_nop 4
    v_add_f32_dpp v64, v64, v64 row_ror:8 row_mask:0xf bank_mask:0x3
    v_add_f32_dpp v65, v65, v65 row_ror:8 row_mask:0xf bank_mask:0x3
    v_add_f32_dpp v64, v66, v66 row_ror:8 row_mask:0xf bank_mask:0xc
    v_add_f32_dpp v65, v67, v67 row_ror:8 row_mask:0xf bank_mask:0xc
    s_nop 0
    v_add_f32_dpp v64, v64, v64 row_shl:4 row_mask:0xf bank_mask:0x5
    v_add_f32_dpp v64, v65, v65 row_shr:4 row_mask:0xf bank_mask:0xa
    s_nop 1
    v_mov_b32_dpp v65, v64 row_ror:8 row_mask:0xf bank_mask:0xf
    v_cvt_pk_bf16_f32 v64, v64, v65
    v_min_u32 v64, -2, v64
    global_store_dword v10, v64, s[30:31]
    v_readfirstlane_b32 s55, v9
    s_add_u32 s52, s20, 1
    s_and_b32 s52, s52, 3
    s_lshl_b32 s52, s52, 13
    s_add_u32 s52, s52, 0x80000
    s_add_u32 s30, s14, s52
    s_addc_u32 s31, s15, 0
    s_and_b32 s52, s20, 1
    s_lshl_b32 s52, s52, 18
    s_add_u32 s22, s14, s52
    s_addc_u32 s23, s15, 0
    s_add_u32 s24, s22, 0x8000
    s_addc_u32 s25, s23, 0
    s_lshl_b32 s52, s18, 13
    s_add_u32 s52, s52, 2048
    s_add_u32 s26, s22, s52
    s_addc_u32 s27, s23, 0
    s_bfe_u32 s42, s20, 0x10001
    s_mov_b32 s43, 0
    s_add_u32 s76, s76, 128
    s_add_u32 s77, s77, 128
    s_cmp_lg_u32 s55, 0
    s_cbranch_scc1 L_kvok_FW1
    s_add_u32 s52, s20, 1
    s_cmp_lt_u32 s52, 64
    s_cbranch_scc0 L_kvok_FW1
    s_sub_u32 s52, s76, 128
L_kvspin_FW1:
    buffer_load_dword v9, off, s[96:99], s52 sc1
    s_add_u32 s43, s43, 1
    s_cmp_gt_u32 s43, 400000
    s_cbranch_scc1 L_F_fail
    s_waitcnt vmcnt(0)
    v_readfirstlane_b32 s55, v9
    s_nop 3
    s_cmp_lg_u32 s55, 0
    s_cbranch_scc0 L_kvspin_FW1
    s_mov_b32 s43, 0
L_kvok_FW1:
    s_nop 15
    s_nop 15
    global_load_dwordx4 v[32:35], v0, s[28:29] sc1
    global_load_dwordx4 v[36:39], v0, s[28:29] offset:1024 sc1
    s_waitcnt vmcnt(3)
    v_mov_b64 v[56:57], 0
    v_mov_b64 v[58:59], 0
    v_mov_b64 v[60:61], 0
    v_mov_b64 v[62:63], 0
    v_mov_b64 v[64:65], 0
    v_mov_b64 v[66:67], 0
    v_mov_b64 v[68:69], 0
    v_mov_b64 v[70:71], 0
    v_mov_b64 v[72:73], 0
    v_mov_b64 v[74:75], 0
    v_mov_b64 v[76:77], 0
    v_mov_b64 v[78:79], 0
    s_waitcnt lgkmcnt(0)
    s_nop 15
    s_nop 7
    global_load_dwordx4 v[48:51], v0, s[28:29] sc1
    global_load_dwordx4 v[52:55], v0, s[28:29] offset:1024 sc1
    s_waitcnt vmcnt(2)
    v_max_u32 v13, v32, v36
    v_cmp_eq_u32 vcc, -1, v13
    s_cbranch_vccz L_entry_FW1
    s_waitcnt vmcnt(0)
    v_max_u32 v13, v48, v52
    v_cmp_eq_u32 vcc, -1, v13
    s_cbranch_vccnz L_pollG_FW1
    ds_write_b128 v2, v[48:51] offset:2048
    ds_write_b128 v2, v[52:55] offset:3072
    v_mov_b64 v[32:33], v[48:49]
    v_mov_b64 v[34:35], v[50:51]
    v_mov_b64 v[36:37], v[52:53]
    v_mov_b64 v[38:39], v[54:55]
    s_nop 0
    s_branch L_entry2_FW1
L_last_FW1:
    s_waitcnt vmcnt(0)
    s_barrier
    s_branch L_F_done
L_c_start_F2:
    s_and_b32 s52, s20, 1
    s_lshl_b32 s52, s52, 18
    s_add_u32 s22, s14, s52
    s_addc_u32 s23, s15, 0
    s_add_u32 s24, s22, 0x8000
    s_addc_u32 s25, s23, 0
    s_lshl_b32 s52, s18, 13
    s_add_u32 s52, s52, 4096
    s_add_u32 s26, s22, s52
    s_addc_u32 s27, s23, 0
    v_mov_b32 v40, v116
    v_mov_b32 v44, v120
    v_mov_b32 v41, v117
    v_mov_b32 v45, v121
    v_mov_b32 v42, v118
    v_mov_b32 v46, v122
    v_mov_b32 v43, v119
    v_mov_b32 v47, v123
    ds_read_b128 v[24:27], v14 offset:0
    ds_read_b128 v[28:31], v14 offset:1024
    ds_read_b128 v[32:35], v14 offset:2048
    ds_read_b128 v[36:39], v14 offset:3072
    ds_read_b128 v[80:83], v14 offset:4096
    ds_read_b128 v[84:87], v14 offset:5120
    ds_read_b128 v[88:91], v14 offset:6144
    ds_read_b128 v[92:95], v14 offset:7168
    ds_read_b128 v[96:99], v14 offset:8192
    ds_read_b128 v[100:103], v14 offset:9216
    ds_read_b128 v[104:107], v14 offset:10240
    ds_read_b128 v[108:111], v14 offset:11264
    ds_read_b128 v[112:115], v14 offset:12288
    ds_read_b128 v[116:119], v14 offset:13312
    ds_read_b128 v[120:123], v14 offset:14336
    ds_read_b128 v[124:127], v14 offset:15360
    v_mov_b64 v[56:57], 0
    v_mov_b64 v[58:59], 0
    v_mov_b64 v[60:61], 0
    v_mov_b64 v[62:63], 0
    v_mov_b64 v[64:65], 0
    v_mov_b64 v[66:67], 0
    v_mov_b64 v[68:69], 0
    v_mov_b64 v[70:71], 0
    v_mov_b64 v[72:73], 0
    v_mov_b64 v[74:75], 0
    v_mov_b64 v[76:77], 0
    v_mov_b64 v[78:79], 0
    s_waitcnt vmcnt(0) lgkmcnt(0)
    s_branch L_entry_FW2
L_pollG_FW2:
    global_load_dwordx4 v[40:43], v0, s[28:29] sc1
    global_load_dwordx4 v[44:47], v0, s[28:29] offset:1024 sc1
    s_add_u32 s43, s43, 1
    s_cmp_gt_u32 s43, 400000
    s_cbranch_scc1 L_F_fail
    s_waitcnt vmcnt(0)
    v_max_u32 v13, v40, v44
    v_cmp_eq_u32 vcc, -1, v13
    s_cbranch_vccnz L_pollG_FW2
L_entry_FW2:
    ds_write_b128 v2, v[40:43] offset:4096
    ds_write_b128 v2, v[44:47] offset:5120
L_entry2_FW2:
    v_smfmac_f32_16x16x64_bf16 v[56:59], v[40:43], v[24:31], v15
    v_smfmac_f32_16x16x64_bf16 v[60:63], v[40:43], v[32:39], v15
    v_smfmac_f32_16x16x64_bf16 v[56:59], v[44:47], v[80:87], v15
    v_smfmac_f32_16x16x64_bf16 v[60:63], v[44:47], v[88:95], v15
    v_smfmac_f32_16x16x64_bf16 v[64:67], v[40:43], v[96:103], v15
    v_smfmac_f32_16x16x64_bf16 v[68:71], v[40:43], v[104:111], v15
    s_waitcnt vmcnt(0) lgkmcnt(0)
    s_barrier
    ds_read_b128 v[48:51], v2 offset:6144
    ds_read_b128 v[52:55], v2 offset:7168
    v_smfmac_f32_16x16x64_bf16 v[64:67], v[44:47], v[112:119], v15
    ds_read_b128 v[24:27], v2 offset:0
    v_smfmac_f32_16x16x64_bf16 v[68:71], v[44:47], v[120:127], v15
    ds_read_b128 v[28:31], v2 offset:1024
    v_smfmac_f32_16x16x64_bf16 v[72:75], v[40:43], a[224:231], v15
    ds_read_b128 v[32:35], v2 offset:2048
    v_smfmac_f32_16x16x64_bf16 v[76:79], v[40:43], v[160:167], v15
    ds_read_b128 v[36:39], v2 offset:3072
    v_smfmac_f32_16x16x64_bf16 v[72:75], v[44:47], a[232:239], v15
    s_mov_b32 m0, 157696
    v_mov_b32 v13, -1
    v_smfmac_f32_16x16x64_bf16 v[76:79], v[44:47], v[168:175], v15
    global_load_lds_dwordx4 v0, s[36:37] sc1
    s_waitcnt lgkmcnt(5)
    v_smfmac_f32_16x16x64_bf16 v[56:59], v[48:51], a[0:7], v15
    ds_read_b128 v[80:83], v2 offset:14336
    v_smfmac_f32_16x16x64_bf16 v[60:63], v[48:51], a[48:55], v15
    ds_read_b128 v[96:99], v2 offset:18432
    s_waitcnt lgkmcnt(6)
    v_smfmac_f32_16x16x64_bf16 v[56:59], v[52:55], a[8:15], v15
    ds_read_b128 v[84:87], v2 offset:15360
    v_smfmac_f32_16x16x64_bf16 v[60:63], v[52:55], a[56:63], v15
    ds_read_b128 v[100:103], v2 offset:19456
    s_waitcnt lgkmcnt(7)
    v_smfmac_f32_16x16x64_bf16 v[56:59], v[24:27], a[16:23], v15
    ds_read_b128 v[88:91], v2 offset:16384
    v_smfmac_f32_16x16x64_bf16 v[60:63], v[24:27], a[64:71], v15
    ds_read_b128 v[104:107], v2 offset:20480
    s_waitcnt lgkmcnt(8)
    v_smfmac_f32_16x16x64_bf16 v[56:59], v[28:31], a[24:31], v15
    ds_read_b128 v[92:95], v2 offset:17408
    v_smfmac_f32_16x16x64_bf16 v[60:63], v[28:31], a[72:79], v15
    ds_read_b128 v[108:111], v2 offset:21504
    s_waitcnt lgkmcnt(9)
    v_smfmac_f32_16x16x64_bf16 v[56:59], v[32:35], a[32:39], v15
    global_load_lds_dwordx4 v0, s[36:37] offset:1024 sc1
    v_smfmac_f32_16x16x64_bf16 v[60:63], v[32:35], a[80:87], v15
    global_store_dword v10, v13, s[32:33]
    s_waitcnt lgkmcnt(8)
    v_smfmac_f32_16x16x64_bf16 v[56:59], v[36:39], a[40:47], v15
    buffer_load_dword v9, off, s[96:99], s76 sc1
    v_smfmac_f32_16x16x64_bf16 v[60:63], v[36:39], a[88:95], v15
    s_add_u32 s54, s36, 0x40000
    s_addc_u32 s55, s37, 0
    global_load_dword v13, v1, s[54:55] sc1
    v_smfmac_f32_16x16x64_bf16 v[64:67], v[48:51], a[96:103], v15
    v_smfmac_f32_16x16x64_bf16 v[68:71], v[48:51], a[144:151], v15
    s_nop 0
    v_add_f32 v56, v56, v58
    v_add_f32 v57, v57, v59
    v_smfmac_f32_16x16x64_bf16 v[64:67], v[52:55], a[104:111], v15
    v_add_f32 v60, v60, v62
    v_add_f32 v61, v61, v63
    v_cvt_pk_bf16_f32 v58, v56, v60
    v_cvt_pk_bf16_f32 v59, v57, v61
    ds_write_b32 v3, v58
    ds_write_b32 v4, v59
    v_smfmac_f32_16x16x64_bf16 v[68:71], v[52:55], a[152:159], v15
    s_mov_b32 m0, 149504
    v_smfmac_f32_16x16x64_bf16 v[64:67], v[24:27], a[112:119], v15
    v_smfmac_f32_16x16x64_bf16 v[68:71], v[24:27], a[160:167], v15
    v_smfmac_f32_16x16x64_bf16 v[64:67], v[28:31], a[120:127], v15
    v_smfmac_f32_16x16x64_bf16 v[68:71], v[28:31], a[168:175], v15
    v_smfmac_f32_16x16x64_bf16 v[64:67], v[32:35], a[128:135], v15
    s_waitcnt lgkmcnt(0)
    s_barrier
    ds_read_b128 v[112:115], v5 offset:0
    v_smfmac_f32_16x16x64_bf16 v[68:71], v[32:35], a[176:183], v15
    ds_read_b128 v[116:119], v5 offset:1024
    v_smfmac_f32_16x16x64_bf16 v[64:67], v[36:39], a[136:143], v15
    ds_read_b128 v[120:123], v5 offset:2048
    v_smfmac_f32_16x16x64_bf16 v[68:71], v[36:39], a[184:191], v15
    ds_read_b128 v[124:127], v5 offset:3072
    v_smfmac_f32_16x16x64_bf16 v[72:75], v[48:51], a[240:247], v15
    global_load_lds_dwordx4 v0, s[34:35] sc1
    v_smfmac_f32_16x16x64_bf16 v[76:79], v[48:51], v[176:183], v15
    global_load_lds_dwordx4 v0, s[34:35] offset:1024 sc1
    s_nop 0
    v_add_f32 v64, v64, v66
    v_add_f32 v65, v65, v67
    v_add_f32 v68, v68, v70
    v_add_f32 v69, v69, v71
    v_cvt_pk_bf16_f32 v66, v64, v68
    v_cvt_pk_bf16_f32 v67, v65, v69
    s_waitcnt lgkmcnt(0)
    ds_write_b32 v3, v66 offset:128
    ds_write_b32 v4, v67 offset:128
    v_mfma_f32_16x16x32_bf16 v[56:59], v[80:83], v[112:115], 0
    v_mfma_f32_16x16x32_bf16 v[60:63], v[96:99], v[112:115], 0
    v_mfma_f32_16x16x32_bf16 v[56:59], v[84:87], v[116:119], v[56:59]
    v_mfma_f32_16x16x32_bf16 v[60:63], v[100:103], v[116:119], v[60:63]
    v_mfma_f32_16x16x32_bf16 v[56:59], v[88:91], v[120:123], v[56:59]
    v_mfma_f32_16x16x32_bf16 v[60:63], v[104:107], v[120:123], v[60:63]
    v_mfma_f32_16x16x32_bf16 v[56:59], v[92:95], v[124:127], v[56:59]
    v_mfma_f32_16x16x32_bf16 v[60:63], v[108:111], v[124:127], v[60:63]
    s_waitcnt vmcnt(5) lgkmcnt(0)
    s_barrier
    ds_read_b128 v[80:83], v6 offset:0
    ds_read_b128 v[84:87], v6 offset:1024
    v_smfmac_f32_16x16x64_bf16 v[72:75], v[52:55], a[248:255], v15
    ds_read_b128 v[88:91], v6 offset:2048
    v_smfmac_f32_16x16x64_bf16 v[76:79], v[52:55], v[184:191], v15
    ds_read_b128 v[92:95], v6 offset:3072
    v_smfmac_f32_16x16x64_bf16 v[72:75], v[24:27], a[192:199], v15
    ds_read_b128 v[104:107], v2 offset:26624
    v_smfmac_f32_16x16x64_bf16 v[76:79], v[24:27], v[128:135], v15
    ds_read_b128 v[108:111], v2 offset:27648
    v_smfmac_f32_16x16x64_bf16 v[72:75], v[28:31], a[200:207], v15
    s_waitcnt lgkmcnt(5)
    v_mfma_f32_16x16x32_bf16 v[64:67], v[80:83], v[112:115], 0
    s_waitcnt lgkmcnt(4)
    v_mfma_f32_16x16x32_bf16 v[64:67], v[84:87], v[116:119], v[64:67]
    s_waitcnt lgkmcnt(3)
    v_mfma_f32_16x16x32_bf16 v[64:67], v[88:91], v[120:123], v[64:67]
    s_waitcnt lgkmcnt(2)
    v_mfma_f32_16x16x32_bf16 v[64:67], v[92:95], v[124:127], v[64:67]
    v_smfmac_f32_16x16x64_bf16 v[76:79], v[28:31], v[136:143], v15
    global_store_dwordx4 v11, v[88:91], s[38:39] sc1
    v_smfmac_f32_16x16x64_bf16 v[72:75], v[32:35], a[208:215], v15
    v_smfmac_f32_16x16x64_bf16 v[76:79], v[32:35], v[144:151], v15
    v_smfmac_f32_16x16x64_bf16 v[72:75], v[36:39], a[216:223], v15
    v_smfmac_f32_16x16x64_bf16 v[76:79], v[36:39], v[152:159], v15
    v_max3_f32 v68, v56, v57, v58
    v_max3_f32 v68, v68, v59, v60
    v_max3_f32 v68, v68, v61, v62
    v_max3_f32 v68, v68, v63, v64
    v_max_f32 v68, v68, v65
    v_mov_b32 v69, v68
    ds_read_b128 v[24:27], v14 offset:16384
    ds_read_b128 v[28:31], v14 offset:17408
    v_permlane32_swap_b32 v68, v69
    v_max_f32 v68, v68, v69
    v_mov_b32 v69, v68
    ds_read_b128 v[32:35], v14 offset:18432
    ds_read_b128 v[36:39], v14 offset:19456
    v_permlane16_swap_b32 v68, v69
    v_max_f32 v68, v68, v69
    v_mul_f32 v68, s44, v68
    v_pk_fma_f32 v[56:57], v[56:57], s[44:45], v[68:69] op_sel_hi:[1,0,0] neg_lo:[0,0,1] neg_hi:[0,0,1]
    v_pk_fma_f32 v[58:59], v[58:59], s[44:45], v[68:69] op_sel_hi:[1,0,0] neg_lo:[0,0,1] neg_hi:[0,0,1]
    v_pk_fma_f32 v[60:61], v[60:61], s[44:45], v[68:69] op_sel_hi:[1,0,0] neg_lo:[0,0,1] neg_hi:[0,0,1]
    v_pk_fma_f32 v[62:63], v[62:63], s[44:45], v[68:69] op_sel_hi:[1,0,0] neg_lo:[0,0,1] neg_hi:[0,0,1]
    v_pk_fma_f32 v[64:65], v[64:65], s[44:45], v[68:69] op_sel_hi:[1,0,0] neg_lo:[0,0,1] neg_hi:[0,0,1]
    v_exp_f32 v56, v56
    v_exp_f32 v57, v57
    v_exp_f32 v58, v58
    v_exp_f32 v59, v59
    v_exp_f32 v60, v60
    v_exp_f32 v61, v61
    v_exp_f32 v62, v62
    v_exp_f32 v63, v63
    v_exp_f32 v64, v64
    v_exp_f32 v65, v65
    v_cvt_pk_bf16_f32 v96, v56, v57
    v_cvt_pk_bf16_f32 v97, v58, v59
    v_cvt_pk_bf16_f32 v98, v60, v61
    v_cvt_pk_bf16_f32 v99, v62, v63
    v_cvt_pk_bf16_f32 v100, v64, v65
    v_mov_b32 v101, 0
    s_waitcnt lgkmcnt(4)
    v_mfma_f32_16x16x32_bf16 v[88:91], v[20:23], v[96:99], 0
    v_add_f32 v72, v72, v74
    v_add_f32 v73, v73, v75
    v_mfma_f32_16x16x32_bf16 v[80:83], v[104:107], v[96:99], 0
    v_add_f32 v76, v76, v78
    v_add_f32 v77, v77, v79
    v_mfma_f32_16x16x32_bf16 v[84:87], v[108:111], v[96:99], 0
    v_cvt_pk_bf16_f32 v112, v72, v73
    v_cvt_pk_bf16_f32 v114, v76, v77
    v_mov_b32 v113, 0
    v_mov_b32 v115, 0
    v_mfma_f32_16x16x16_bf16 v[88:91], v[20:21], v[100:101], v[88:91]
    ds_read_b128 v[40:43], v14 offset:20480
    ds_read_b128 v[44:47], v14 offset:21504
    v_mfma_f32_16x16x16_bf16 v[80:83], v[112:113], v[100:101], v[80:83]
    ds_read_b128 v[48:51], v14 offset:22528
    ds_read_b128 v[52:55], v14 offset:23552
    v_mfma_f32_16x16x16_bf16 v[84:87], v[114:115], v[100:101], v[84:87]
    ds_read_b128 v[56:59], v14 offset:24576
    ds_read_b128 v[60:63], v14 offset:25600
    global_store_dword v12, v112, s[40:41] sc1
    global_store_dword v12, v114, s[40:41] offset:256 sc1
    s_cmp_eq_u32 s20, 63
    s_cbranch_scc1 L_last_FW2
    v_rcp_f32 v92, v88
    ds_read_b128 v[64:67], v14 offset:26624
    ds_read_b128 v[68:71], v14 offset:27648
    v_pk_mul_f32 v[80:81], v[80:81], v[92:93] op_sel_hi:[1,0]
    v_pk_mul_f32 v[82:83], v[82:83], v[92:93] op_sel_hi:[1,0]
    v_pk_mul_f32 v[84:85], v[84:85], v[92:93] op_sel_hi:[1,0]
    v_pk_mul_f32 v[86:87], v[86:87], v[92:93] op_sel_hi:[1,0]
    v_cvt_pk_bf16_f32 v120, v80, v81
    v_cvt_pk_bf16_f32 v121, v82, v83
    v_cvt_pk_bf16_f32 v122, v84, v85
    v_cvt_pk_bf16_f32 v123, v86, v87
    ds_write_b128 v7, v[120:123]
    ds_read_b128 v[72:75], v14 offset:28672
    ds_read_b128 v[76:79], v14 offset:29696
    v_mov_b64 v[80:81], 0
    v_mov_b64 v[82:83], 0
    v_mov_b64 v[84:85], 0
    v_mov_b64 v[86:87], 0
    v_mov_b64 v[88:89], 0
    v_mov_b64 v[90:91], 0
    v_mov_b64 v[92:93], 0
    v_mov_b64 v[94:95], 0
    v_mov_b64 v[96:97], 0
    v_mov_b64 v[98:99], 0
    v_mov_b64 v[100:101], 0
    v_mov_b64 v[102:103], 0
    v_mov_b64 v[104:105], 0
    v_mov_b64 v[106:107], 0
    v_mov_b64 v[108:109], 0
    v_mov_b64 v[110:111], 0
    s_waitcnt lgkmcnt(0)
    s_barrier
    ds_read_b128 v[112:115], v2 offset:12288
    ds_read_b128 v[116:119], v2 offset:13312
    s_add_u32 s34, s34, 0x40000
    s_addc_u32 s35, s35, 0
    s_add_u32 s36, s36, 0x40000
    s_addc_u32 s37, s37, 0
    s_add_u32 s38, s38, 0x10000
    s_addc_u32 s39, s39, 0
    s_add_u32 s40, s40, 0x10000
    s_addc_u32 s41, s41, 0
    s_waitcnt lgkmcnt(0)
    v_smfmac_f32_16x16x64_bf16 v[80:83], v[112:115], v[192:199], v15
    v_smfmac_f32_16x16x64_bf16 v[80:83], v[116:119], v[24:31], v15
    ds_read_b128 v[24:27], v14 offset:30720
    ds_read_b128 v[28:31], v14 offset:31744
    v_smfmac_f32_16x16x64_bf16 v[84:87], v[112:115], v[200:207], v15
    v_smfmac_f32_16x16x64_bf16 v[84:87], v[116:119], v[32:39], v15
    v_smfmac_f32_16x16x64_bf16 v[88:91], v[112:115], v[208:215], v15
    v_add_f32 v80, v80, v82
    v_smfmac_f32_16x16x64_bf16 v[88:91], v[116:119], v[40:47], v15
    v_add_f32 v81, v81, v83
    v_cvt_pk_bf16_f32 v120, v80, v81
    v_smfmac_f32_16x16x64_bf16 v[92:95], v[112:115], v[216:223], v15
    v_add_f32 v84, v84, v86
    v_smfmac_f32_16x16x64_bf16 v[92:95], v[116:119], v[48:55], v15
    v_add_f32 v85, v85, v87
    v_cvt_pk_bf16_f32 v121, v84, v85
    v_smfmac_f32_16x16x64_bf16 v[96:99], v[112:115], v[224:231], v15
    v_add_f32 v88, v88, v90
    v_smfmac_f32_16x16x64_bf16 v[96:99], v[116:119], v[56:63], v15
    v_add_f32 v89, v89, v91
    v_cvt_pk_bf16_f32 v122, v88, v89
    v_smfmac_f32_16x16x64_bf16 v[100:103], v[112:115], v[232:239], v15
    v_add_f32 v92, v92, v94
    v_smfmac_f32_16x16x64_bf16 v[100:103], v[116:119], v[64:71], v15
    v_add_f32 v93, v93, v95
    v_cvt_pk_bf16_f32 v123, v92, v93
    v_smfmac_f32_16x16x64_bf16 v[104:107], v[112:115], v[240:247], v15
    v_add_f32 v96, v96, v98
    v_and_or_b32 v120, v120, -2, s42
    global_store_dwordx4 v8, v[120:123], s[22:23]
    v_smfmac_f32_16x16x64_bf16 v[104:107], v[116:119], v[72:79], v15
    v_add_f32 v97, v97, v99
    v_cvt_pk_bf16_f32 v124, v96, v97
    v_smfmac_f32_16x16x64_bf16 v[108:111], v[112:115], v[248:255], v15
    v_add_f32 v100, v100, v102
    s_waitcnt lgkmcnt(0)
    v_smfmac_f32_16x16x64_bf16 v[108:111], v[116:119], v[24:31], v15
    v_add_f32 v101, v101, v103
    v_cvt_pk_bf16_f32 v125, v100, v101
    s_nop 1
    v_add_f32 v104, v104, v106
    v_add_f32 v105, v105, v107
    v_cvt_pk_bf16_f32 v126, v104, v105
    s_nop 2
    v_add_f32 v108, v108, v110
    v_add_f32 v109, v109, v111
    v_cvt_pk_bf16_f32 v127, v108, v109
    v_and_or_b32 v124, v124, -2, s42
    global_store_dwordx4 v8, v[124:127], s[24:25]
    ds_read_b128 v[24:27], v14 offset:0
    ds_read_b128 v[28:31], v14 offset:1024
    ds_read_b128 v[32:35], v14 offset:2048
    ds_read_b128 v[36:39], v14 offset:3072
    ds_read_b128 v[80:83], v14 offset:4096
    ds_read_b128 v[84:87], v14 offset:5120
    ds_read_b128 v[88:91], v14 offset:6144
    ds_read_b128 v[92:95], v14 offset:7168
    ds_read_b128 v[96:99], v14 offset:8192
    ds_read_b128 v[100:103], v14 offset:9216
    ds_read_b128 v[104:107], v14 offset:10240
    ds_read_b128 v[108:111], v14 offset:11264
    ds_read_b128 v[112:115], v14 offset:12288
    ds_read_b128 v[116:119], v14 offset:13312
    ds_read_b128 v[120:123], v14 offset:14336
    ds_read_b128 v[124:127], v14 offset:15360
    s_nop 15
    global_load_dwordx4 v[56:59], v0, s[26:27] sc1
    global_load_dwordx4 v[60:63], v0, s[26:27] offset:1024 sc1
    s_add_u32 s20, s20, 1
    s_mov_b32 s32, s28
    s_mov_b32 s33, s29
    s_sub_u32 s32, s32, 4096
    s_subb_u32 s33, s33, 0
    s_add_u32 s28, s30, 0x1000
    s_addc_u32 s29, s31, 0
    s_nop 15
    s_nop 15
    global_load_dwordx4 v[68:71], v0, s[26:27] sc1
    global_load_dwordx4 v[72:75], v0, s[26:27] offset:1024 sc1
    s_waitcnt vmcnt(2)
    v_mfma_f32_16x16x32_bf16 v[64:67], v[16:19], v[56:59], 0
    v_bitop3_b32 v13, v56, v60, s42 bitop3:0x7e
    v_mfma_f32_16x16x32_bf16 v[64:67], v[16:19], v[60:63], v[64:67]
    v_and_b32 v13, 1, v13
    v_cmp_ne_u32 vcc, 0, v13
    s_cbranch_vccz L_okR_FW2
    s_waitcnt vmcnt(0)
    v_mfma_f32_16x16x32_bf16 v[64:67], v[16:19], v[68:71], 0
    v_bitop3_b32 v13, v68, v72, s42 bitop3:0x7e
    v_mfma_f32_16x16x32_bf16 v[64:67], v[16:19], v[72:75], v[64:67]
    v_and_b32 v13, 1, v13
    v_cmp_ne_u32 vcc, 0, v13
    s_cbranch_vccz L_okR_FW2
L_pollR_FW2:
    global_load_dwordx4 v[56:59], v0, s[26:27] sc1
    global_load_dwordx4 v[60:63], v0, s[26:27] offset:1024 sc1
    s_add_u32 s43, s43, 1
    s_cmp_gt_u32 s43, 400000
    s_cbranch_scc1 L_F_fail
L_chkR_FW2:
    s_waitcnt vmcnt(0)
    v_mfma_f32_16x16x32_bf16 v[64:67], v[16:19], v[56:59], 0
    v_bitop3_b32 v13, v56, v60, s42 bitop3:0x7e
    v_mfma_f32_16x16x32_bf16 v[64:67], v[16:19], v[60:63], v[64:67]
    v_and_b32 v13, 1, v13
    v_cmp_ne_u32 vcc, 0, v13
    s_cbranch_vccnz L_pollR_FW2
L_okR_FW2:
    s_nop 4
    v_add_f32_dpp v64, v64, v64 row_ror:8 row_mask:0xf bank_mask:0x3
    v_add_f32_dpp v65, v65, v65 row_ror:8 row_mask:0xf bank_mask:0x3
    v_add_f32_dpp v64, v66, v66 row_ror:8 row_mask:0xf bank_mask:0xc
    v_add_f32_dpp v65, v67, v67 row_ror:8 row_mask:0xf bank_mask:0xc
    s_nop 0
    v_add_f32_dpp v64, v64, v64 row_shl:4 row_mask:0xf bank_mask:0x5
    v_add_f32_dpp v64, v65, v65 row_shr:4 row_mask:0xf bank_mask:0xa
    s_nop 1
    v_mov_b32_dpp v65, v64 row_ror:8 row_mask:0xf bank_mask:0xf
    v_cvt_pk_bf16_f32 v64, v64, v65
    v_min_u32 v64, -2, v64
    global_store_dword v10, v64, s[30:31]
    v_readfirstlane_b32 s55, v9
    s_add_u32 s52, s20, 1
    s_and_b32 s52, s52, 3
    s_lshl_b32 s52, s52, 13
    s_add_u32 s52, s52, 0x80000
    s_add_u32 s30, s14, s52
    s_addc_u32 s31, s15, 0
    s_and_b32 s52, s20, 1
    s_lshl_b32 s52, s52, 18
    s_add_u32 s22, s14, s52
    s_addc_u32 s23, s15, 0
    s_add_u32 s24, s22, 0x8000
    s_addc_u32 s25, s23, 0
    s_lshl_b32 s52, s18, 13
    s_add_u32 s52, s52, 4096
    s_add_u32 s26, s22, s52
    s_addc_u32 s27, s23, 0
    s_bfe_u32 s42, s20, 0x10001
    s_mov_b32 s43, 0
    s_add_u32 s76, s76, 128
    s_add_u32 s77, s77, 128
    s_cmp_lg_u32 s55, 0
    s_cbranch_scc1 L_kvok_FW2
    s_add_u32 s52, s20, 1
    s_cmp_lt_u32 s52, 64
    s_cbranch_scc0 L_kvok_FW2
    s_sub_u32 s52, s76, 128
L_kvspin_FW2:
    buffer_load_dword v9, off, s[96:99], s52 sc1
    s_add_u32 s43, s43, 1
    s_cmp_gt_u32 s43, 400000
    s_cbranch_scc1 L_F_fail
    s_waitcnt vmcnt(0)
    v_readfirstlane_b32 s55, v9
    s_nop 3
    s_cmp_lg_u32 s55, 0
    s_cbranch_scc0 L_kvspin_FW2
    s_mov_b32 s43, 0
L_kvok_FW2:
    s_nop 15
    s_nop 15
    global_load_dwordx4 v[40:43], v0, s[28:29] sc1
    global_load_dwordx4 v[44:47], v0, s[28:29] offset:1024 sc1
    s_waitcnt vmcnt(3)
    v_mov_b64 v[56:57], 0
    v_mov_b64 v[58:59], 0
    v_mov_b64 v[60:61], 0
    v_mov_b64 v[62:63], 0
    v_mov_b64 v[64:65], 0
    v_mov_b64 v[66:67], 0
    v_mov_b64 v[68:69], 0
    v_mov_b64 v[70:71], 0
    v_mov_b64 v[72:73], 0
    v_mov_b64 v[74:75], 0
    v_mov_b64 v[76:77], 0
    v_mov_b64 v[78:79], 0
    s_waitcnt lgkmcnt(0)
    s_nop 15
    s_nop 7
    global_load_dwordx4 v[48:51], v0, s[28:29] sc1
    global_load_dwordx4 v[52:55], v0, s[28:29] offset:1024 sc1
    s_waitcnt vmcnt(2)
    v_max_u32 v13, v40, v44
    v_cmp_eq_u32 vcc, -1, v13
    s_cbranch_vccz L_entry_FW2
    s_waitcnt vmcnt(0)
    v_max_u32 v13, v48, v52
    v_cmp_eq_u32 vcc, -1, v13
    s_cbranch_vccnz L_pollG_FW2
    ds_write_b128 v2, v[48:51] offset:4096
    ds_write_b128 v2, v[52:55] offset:5120
    v_mov_b64 v[40:41], v[48:49]
    v_mov_b64 v[42:43], v[50:51]
    v_mov_b64 v[44:45], v[52:53]
    v_mov_b64 v[46:47], v[54:55]
    s_nop 0
    s_branch L_entry2_FW2
L_last_FW2:
    s_waitcnt vmcnt(0)
    s_barrier
    s_branch L_F_done
L_c_start_F3:
    s_and_b32 s52, s20, 1
    s_lshl_b32 s52, s52, 18
    s_add_u32 s22, s14, s52
    s_addc_u32 s23, s15, 0
    s_add_u32 s24, s22, 0x8000
    s_addc_u32 s25, s23, 0
    s_lshl_b32 s52, s18, 13
    s_add_u32 s52, s52, 6144
    s_add_u32 s26, s22, s52
    s_addc_u32 s27, s23, 0
    v_mov_b32 v48, v116
    v_mov_b32 v52, v120
    v_mov_b32 v49, v117
    v_mov_b32 v53, v121
    v_mov_b32 v50, v118
    v_mov_b32 v54, v122
    v_mov_b32 v51, v119
    v_mov_b32 v55, v123
    ds_read_b128 v[24:27], v14 offset:0
    ds_read_b128 v[28:31], v14 offset:1024
    ds_read_b128 v[32:35], v14 offset:2048
    ds_read_b128 v[36:39], v14 offset:3072
    ds_read_b128 v[80:83], v14 offset:4096
    ds_read_b128 v[84:87], v14 offset:5120
    ds_read_b128 v[88:91], v14 offset:6144
    ds_read_b128 v[92:95], v14 offset:7168
    ds_read_b128 v[96:99], v14 offset:8192
    ds_read_b128 v[100:103], v14 offset:9216
    ds_read_b128 v[104:107], v14 offset:10240
    ds_read_b128 v[108:111], v14 offset:11264
    ds_read_b128 v[112:115], v14 offset:12288
    ds_read_b128 v[116:119], v14 offset:13312
    ds_read_b128 v[120:123], v14 offset:14336
    ds_read_b128 v[124:127], v14 offset:15360
    v_mov_b64 v[56:57], 0
    v_mov_b64 v[58:59], 0
    v_mov_b64 v[60:61], 0
    v_mov_b64 v[62:63], 0
    v_mov_b64 v[64:65], 0
    v_mov_b64 v[66:67], 0
    v_mov_b64 v[68:69], 0
    v_mov_b64 v[70:71], 0
    v_mov_b64 v[72:73], 0
    v_mov_b64 v[74:75], 0
    v_mov_b64 v[76:77], 0
    v_mov_b64 v[78:79], 0
    s_waitcnt vmcnt(0) lgkmcnt(0)
    s_branch L_entry_FW3
L_pollG_FW3:
    global_load_dwordx4 v[48:51], v0, s[28:29] sc1
    global_load_dwordx4 v[52:55], v0, s[28:29] offset:1024 sc1
    s_add_u32 s43, s43, 1
    s_cmp_gt_u32 s43, 400000
    s_cbranch_scc1 L_F_fail
    s_waitcnt vmcnt(0)
    v_max_u32 v13, v48, v52
    v_cmp_eq_u32 vcc, -1, v13
    s_cbranch_vccnz L_pollG_FW3
L_entry_FW3:
    ds_write_b128 v2, v[48:51] offset:6144
    ds_write_b128 v2, v[52:55] offset:7168
L_entry2_FW3:
    v_smfmac_f32_16x16x64_bf16 v[56:59], v[48:51], v[24:31], v15
    v_smfmac_f32_16x16x64_bf16 v[60:63], v[48:51], v[32:39], v15
    v_smfmac_f32_16x16x64_bf16 v[56:59], v[52:55], v[80:87], v15
    v_smfmac_f32_16x16x64_bf16 v[60:63], v[52:55], v[88:95], v15
    v_smfmac_f32_16x16x64_bf16 v[64:67], v[48:51], v[96:103], v15
    v_smfmac_f32_16x16x64_bf16 v[68:71], v[48:51], v[104:111], v15
    s_waitcnt vmcnt(0) lgkmcnt(0)
    s_barrier
    ds_read_b128 v[24:27], v2 offset:0
    ds_read_b128 v[28:31], v2 offset:1024
    v_smfmac_f32_16x16x64_bf16 v[64:67], v[52:55], v[112:119], v15
    ds_read_b128 v[32:35], v2 offset:2048
    v_smfmac_f32_16x16x64_bf16 v[68:71], v[52:55], v[120:127], v15
    ds_read_b128 v[36:39], v2 offset:3072
    v_smfmac_f32_16x16x64_bf16 v[72:75], v[48:51], a[240:247], v15
    ds_read_b128 v[40:43], v2 offset:4096
    v_smfmac_f32_16x16x64_bf16 v[76:79], v[48:51], v[176:183], v15
    ds_read_b128 v[44:47], v2 offset:5120
    v_smfmac_f32_16x16x64_bf16 v[72:75], v[52:55], a[248:255], v15
    s_mov_b32 m0, 159744
    v_mov_b32 v13, -1
    v_smfmac_f32_16x16x64_bf16 v[76:79], v[52:55], v[184:191], v15
    global_load_lds_dwordx4 v0, s[36:37] sc1
    s_waitcnt lgkmcnt(5)
    v_smfmac_f32_16x16x64_bf16 v[56:59], v[24:27], a[0:7], v15
    ds_read_b128 v[80:83], v2 offset:14336
    v_smfmac_f32_16x16x64_bf16 v[60:63], v[24:27], a[48:55], v15
    ds_read_b128 v[96:99], v2 offset:18432
    s_waitcnt lgkmcnt(6)
    v_smfmac_f32_16x16x64_bf16 v[56:59], v[28:31], a[8:15], v15
    ds_read_b128 v[84:87], v2 offset:15360
    v_smfmac_f32_16x16x64_bf16 v[60:63], v[28:31], a[56:63], v15
    ds_read_b128 v[100:103], v2 offset:19456
    s_waitcnt lgkmcnt(7)
    v_smfmac_f32_16x16x64_bf16 v[56:59], v[32:35], a[16:23], v15
    ds_read_b128 v[88:91], v2 offset:16384
    v_smfmac_f32_16x16x64_bf16 v[60:63], v[32:35], a[64:71], v15
    ds_read_b128 v[104:107], v2 offset:20480
    s_waitcnt lgkmcnt(8)
    v_smfmac_f32_16x16x64_bf16 v[56:59], v[36:39], a[24:31], v15
    ds_read_b128 v[92:95], v2 offset:17408
    v_smfmac_f32_16x16x64_bf16 v[60:63], v[36:39], a[72:79], v15
    ds_read_b128 v[108:111], v2 offset:21504
    s_waitcnt lgkmcnt(9)
    v_smfmac_f32_16x16x64_bf16 v[56:59], v[40:43], a[32:39], v15
    global_load_lds_dwordx4 v0, s[36:37] offset:1024 sc1
    v_smfmac_f32_16x16x64_bf16 v[60:63], v[40:43], a[80:87], v15
    global_store_dword v10, v13, s[32:33]
    s_waitcnt lgkmcnt(8)
    v_smfmac_f32_16x16x64_bf16 v[56:59], v[44:47], a[40:47], v15
    buffer_load_dword v9, off, s[96:99], s76 sc1
    v_smfmac_f32_16x16x64_bf16 v[60:63], v[44:47], a[88:95], v15
    s_add_u32 s54, s36, 0x40000
    s_addc_u32 s55, s37, 0
    global_load_dword v13, v1, s[54:55] sc1
    v_smfmac_f32_16x16x64_bf16 v[64:67], v[24:27], a[96:103], v15
    v_smfmac_f32_16x16x64_bf16 v[68:71], v[24:27], a[144:151], v15
    s_nop 0
    v_add_f32 v56, v56, v58
    v_add_f32 v57, v57, v59
    v_smfmac_f32_16x16x64_bf16 v[64:67], v[28:31], a[104:111], v15
    v_add_f32 v60, v60, v62
    v_add_f32 v61, v61, v63
    v_cvt_pk_bf16_f32 v58, v56, v60
    v_cvt_pk_bf16_f32 v59, v57, v61
    ds_write_b32 v3, v58
    ds_write_b32 v4, v59
    v_smfmac_f32_16x16x64_bf16 v[68:71], v[28:31], a[152:159], v15
    s_mov_b32 m0, 151552
    v_smfmac_f32_16x16x64_bf16 v[64:67], v[32:35], a[112:119], v15
    v_smfmac_f32_16x16x64_bf16 v[68:71], v[32:35], a[160:167], v15
    v_smfmac_f32_16x16x64_bf16 v[64:67], v[36:39], a[120:127], v15
    v_smfmac_f32_16x16x64_bf16 v[68:71], v[36:39], a[168:175], v15
    v_smfmac_f32_16x16x64_bf16 v[64:67], v[40:43], a[128:135], v15
    s_waitcnt lgkmcnt(0)
    s_barrier
    ds_read_b128 v[112:115], v5 offset:0
    v_smfmac_f32_16x16x64_bf16 v[68:71], v[40:43], a[176:183], v15
    ds_read_b128 v[116:119], v5 offset:1024
    v_smfmac_f32_16x16x64_bf16 v[64:67], v[44:47], a[136:143], v15
    ds_read_b128 v[120:123], v5 offset:2048
    v_smfmac_f32_16x16x64_bf16 v[68:71], v[44:47], a[184:191], v15
    ds_read_b128 v[124:127], v5 offset:3072
    v_smfmac_f32_16x16x64_bf16 v[72:75], v[24:27], a[192:199], v15
    global_load_lds_dwordx4 v0, s[34:35] sc1
    v_smfmac_f32_16x16x64_bf16 v[76:79], v[24:27], v[128:135], v15
    global_load_lds_dwordx4 v0, s[34:35] offset:1024 sc1
    s_nop 0
    v_add_f32 v64, v64, v66
    v_add_f32 v65, v65, v67
    v_add_f32 v68, v68, v70
    v_add_f32 v69, v69, v71
    v_cvt_pk_bf16_f32 v66, v64, v68
    v_cvt_pk_bf16_f32 v67, v65, v69
    s_waitcnt lgkmcnt(0)
    ds_write_b32 v3, v66 offset:128
    ds_write_b32 v4, v67 offset:128
    v_mfma_f32_16x16x32_bf16 v[56:59], v[80:83], v[112:115], 0
    v_mfma_f32_16x16x32_bf16 v[60:63], v[96:99], v[112:115], 0
    v_mfma_f32_16x16x32_bf16 v[56:59], v[84:87], v[116:119], v[56:59]
    v_mfma_f32_16x16x32_bf16 v[60:63], v[100:103], v[116:119], v[60:63]
    v_mfma_f32_16x16x32_bf16 v[56:59], v[88:91], v[120:123], v[56:59]
    v_mfma_f32_16x16x32_bf16 v[60:63], v[104:107], v[120:123], v[60:63]
    v_mfma_f32_16x16x32_bf16 v[56:59], v[92:95], v[124:127], v[56:59]
    v_mfma_f32_16x16x32_bf16 v[60:63], v[108:111], v[124:127], v[60:63]
    s_waitcnt vmcnt(5) lgkmcnt(0)
    s_barrier
    ds_read_b128 v[80:83], v6 offset:0
    ds_read_b128 v[84:87], v6 offset:1024
    v_smfmac_f32_16x16x64_bf16 v[72:75], v[28:31], a[200:207], v15
    ds_read_b128 v[88:91], v6 offset:2048
    v_smfmac_f32_16x16x64_bf16 v[76:79], v[28:31], v[136:143], v15
    ds_read_b128 v[92:95], v6 offset:3072
    v_smfmac_f32_16x16x64_bf16 v[72:75], v[32:35], a[208:215], v15
    ds_read_b128 v[104:107], v2 offset:28672
    v_smfmac_f32_16x16x64_bf16 v[76:79], v[32:35], v[144:151], v15
    ds_read_b128 v[108:111], v2 offset:29696
    v_smfmac_f32_16x16x64_bf16 v[72:75], v[36:39], a[216:223], v15
    s_waitcnt lgkmcnt(5)
    v_mfma_f32_16x16x32_bf16 v[64:67], v[80:83], v[112:115], 0
    s_waitcnt lgkmcnt(4)
    v_mfma_f32_16x16x32_bf16 v[64:67], v[84:87], v[116:119], v[64:67]
    s_waitcnt lgkmcnt(3)
    v_mfma_f32_16x16x32_bf16 v[64:67], v[88:91], v[120:123], v[64:67]
    s_waitcnt lgkmcnt(2)
    v_mfma_f32_16x16x32_bf16 v[64:67], v[92:95], v[124:127], v[64:67]
    v_smfmac_f32_16x16x64_bf16 v[76:79], v[36:39], v[152:159], v15
    global_store_dwordx4 v11, v[92:95], s[38:39] sc1
    v_smfmac_f32_16x16x64_bf16 v[72:75], v[40:43], a[224:231], v15
    v_smfmac_f32_16x16x64_bf16 v[76:79], v[40:43], v[160:167], v15
    v_smfmac_f32_16x16x64_bf16 v[72:75], v[44:47], a[232:239], v15
    v_smfmac_f32_16x16x64_bf16 v[76:79], v[44:47], v[168:175], v15
    v_max3_f32 v68, v56, v57, v58
    v_max3_f32 v68, v68, v59, v60
    v_max3_f32 v68, v68, v61, v62
    v_max3_f32 v68, v68, v63, v64
    v_max_f32 v68, v68, v65
    v_mov_b32 v69, v68
    ds_read_b128 v[24:27], v14 offset:16384
    ds_read_b128 v[28:31], v14 offset:17408
    v_permlane32_swap_b32 v68, v69
    v_max_f32 v68, v68, v69
    v_mov_b32 v69, v68
    ds_read_b128 v[32:35], v14 offset:18432
    ds_read_b128 v[36:39], v14 offset:19456
    v_permlane16_swap_b32 v68, v69
    v_max_f32 v68, v68, v69
    v_mul_f32 v68, s44, v68
    v_pk_fma_f32 v[56:57], v[56:57], s[44:45], v[68:69] op_sel_hi:[1,0,0] neg_lo:[0,0,1] neg_hi:[0,0,1]
    v_pk_fma_f32 v[58:59], v[58:59], s[44:45], v[68:69] op_sel_hi:[1,0,0] neg_lo:[0,0,1] neg_hi:[0,0,1]
    v_pk_fma_f32 v[60:61], v[60:61], s[44:45], v[68:69] op_sel_hi:[1,0,0] neg_lo:[0,0,1] neg_hi:[0,0,1]
    v_pk_fma_f32 v[62:63], v[62:63], s[44:45], v[68:69] op_sel_hi:[1,0,0] neg_lo:[0,0,1] neg_hi:[0,0,1]
    v_pk_fma_f32 v[64:65], v[64:65], s[44:45], v[68:69] op_sel_hi:[1,0,0] neg_lo:[0,0,1] neg_hi:[0,0,1]
    v_exp_f32 v56, v56
    v_exp_f32 v57, v57
    v_exp_f32 v58, v58
    v_exp_f32 v59, v59
    v_exp_f32 v60, v60
    v_exp_f32 v61, v61
    v_exp_f32 v62, v62
    v_exp_f32 v63, v63
    v_exp_f32 v64, v64
    v_exp_f32 v65, v65
    v_cvt_pk_bf16_f32 v96, v56, v57
    v_cvt_pk_bf16_f32 v97, v58, v59
    v_cvt_pk_bf16_f32 v98, v60, v61
    v_cvt_pk_bf16_f32 v99, v62, v63
    v_cvt_pk_bf16_f32 v100, v64, v65
    v_mov_b32 v101, 0
    s_waitcnt lgkmcnt(4)
    v_mfma_f32_16x16x32_bf16 v[88:91], v[20:23], v[96:99], 0
    v_add_f32 v72, v72, v74
    v_add_f32 v73, v73, v75
    v_mfma_f32_16x16x32_bf16 v[80:83], v[104:107], v[96:99], 0
    v_add_f32 v76, v76, v78
    v_add_f32 v77, v77, v79
    v_mfma_f32_16x16x32_bf16 v[84:87], v[108:111], v[96:99], 0
    v_cvt_pk_bf16_f32 v112, v72, v73
    v_cvt_pk_bf16_f32 v114, v76, v77
    v_mov_b32 v113, 0
    v_mov_b32 v115, 0
    v_mfma_f32_16x16x16_bf16 v[88:91], v[20:21], v[100:101], v[88:91]
    ds_read_b128 v[40:43], v14 offset:20480
    ds_read_b128 v[44:47], v14 offset:21504
    v_mfma_f32_16x16x16_bf16 v[80:83], v[112:113], v[100:101], v[80:83]
    ds_read_b128 v[48:51], v14 offset:22528
    ds_read_b128 v[52:55], v14 offset:23552
    v_mfma_f32_16x16x16_bf16 v[84:87], v[114:115], v[100:101], v[84:87]
    ds_read_b128 v[56:59], v14 offset:24576
    ds_read_b128 v[60:63], v14 offset:25600
    global_store_dword v12, v112, s[40:41] sc1
    global_store_dword v12, v114, s[40:41] offset:256 sc1
    s_cmp_eq_u32 s20, 63
    s_cbranch_scc1 L_last_FW3
    v_rcp_f32 v92, v88
    ds_read_b128 v[64:67], v14 offset:26624
    ds_read_b128 v[68:71], v14 offset:27648
    v_pk_mul_f32 v[80:81], v[80:81], v[92:93] op_sel_hi:[1,0]
    v_pk_mul_f32 v[82:83], v[82:83], v[92:93] op_sel_hi:[1,0]
    v_pk_mul_f32 v[84:85], v[84:85], v[92:93] op_sel_hi:[1,0]
    v_pk_mul_f32 v[86:87], v[86:87], v[92:93] op_sel_hi:[1,0]
    v_cvt_pk_bf16_f32 v120, v80, v81
    v_cvt_pk_bf16_f32 v121, v82, v83
    v_cvt_pk_bf16_f32 v122, v84, v85
    v_cvt_pk_bf16_f32 v123, v86, v87
    ds_write_b128 v7, v[120:123]
    ds_read_b128 v[72:75], v14 offset:28672
    ds_read_b128 v[76:79], v14 offset:29696
    v_mov_b64 v[80:81], 0
    v_mov_b64 v[82:83], 0
    v_mov_b64 v[84:85], 0
    v_mov_b64 v[86:87], 0
    v_mov_b64 v[88:89], 0
    v_mov_b64 v[90:91], 0
    v_mov_b64 v[92:93], 0
    v_mov_b64 v[94:95], 0
    v_mov_b64 v[96:97], 0
    v_mov_b64 v[98:99], 0
    v_mov_b64 v[100:101], 0
    v_mov_b64 v[102:103], 0
    v_mov_b64 v[104:105], 0
    v_mov_b64 v[106:107], 0
    v_mov_b64 v[108:109], 0
    v_mov_b64 v[110:111], 0
    s_waitcnt lgkmcnt(0)
    s_barrier
    ds_read_b128 v[112:115], v2 offset:12288
    ds_read_b128 v[116:119], v2 offset:13312
    s_add_u32 s34, s34, 0x40000
    s_addc_u32 s35, s35, 0
    s_add_u32 s36, s36, 0x40000
    s_addc_u32 s37, s37, 0
    s_add_u32 s38, s38, 0x10000
    s_addc_u32 s39, s39, 0
    s_add_u32 s40, s40, 0x10000
    s_addc_u32 s41, s41, 0
    s_waitcnt lgkmcnt(0)
    v_smfmac_f32_16x16x64_bf16 v[80:83], v[112:115], v[192:199], v15
    v_smfmac_f32_16x16x64_bf16 v[80:83], v[116:119], v[24:31], v15
    ds_read_b128 v[24:27], v14 offset:30720
    ds_read_b128 v[28:31], v14 offset:31744
    v_smfmac_f32_16x16x64_bf16 v[84:87], v[112:115], v[200:207], v15
    v_smfmac_f32_16x16x64_bf16 v[84:87], v[116:119], v[32:39], v15
    v_smfmac_f32_16x16x64_bf16 v[88:91], v[112:115], v[208:215], v15
    v_add_f32 v80, v80, v82
    v_smfmac_f32_16x16x64_bf16 v[88:91], v[116:119], v[40:47], v15
    v_add_f32 v81, v81, v83
    v_cvt_pk_bf16_f32 v120, v80, v81
    v_smfmac_f32_16x16x64_bf16 v[92:95], v[112:115], v[216:223], v15
    v_add_f32 v84, v84, v86
    v_smfmac_f32_16x16x64_bf16 v[92:95], v[116:119], v[48:55], v15
    v_add_f32 v85, v85, v87
    v_cvt_pk_bf16_f32 v121, v84, v85
    v_smfmac_f32_16x16x64_bf16 v[96:99], v[112:115], v[224:231], v15
    v_add_f32 v88, v88, v90
    v_smfmac_f32_16x16x64_bf16 v[96:99], v[116:119], v[56:63], v15
    v_add_f32 v89, v89, v91
    v_cvt_pk_bf16_f32 v122, v88, v89
    v_smfmac_f32_16x16x64_bf16 v[100:103], v[112:115], v[232:239], v15
    v_add_f32 v92, v92, v94
    v_smfmac_f32_16x16x64_bf16 v[100:103], v[116:119], v[64:71], v15
    v_add_f32 v93, v93, v95
    v_cvt_pk_bf16_f32 v123, v92, v93
    v_smfmac_f32_16x16x64_bf16 v[104:107], v[112:115], v[240:247], v15
    v_add_f32 v96, v96, v98
    v_and_or_b32 v120, v120, -2, s42
    global_store_dwordx4 v8, v[120:123], s[22:23]
    v_smfmac_f32_16x16x64_bf16 v[104:107], v[116:119], v[72:79], v15
    v_add_f32 v97, v97, v99
    v_cvt_pk_bf16_f32 v124, v96, v97
    v_smfmac_f32_16x16x64_bf16 v[108:111], v[112:115], v[248:255], v15
    v_add_f32 v100, v100, v102
    s_waitcnt lgkmcnt(0)
    v_smfmac_f32_16x16x64_bf16 v[108:111], v[116:119], v[24:31], v15
    v_add_f32 v101, v101, v103
    v_cvt_pk_bf16_f32 v125, v100, v101
    s_nop 1
    v_add_f32 v104, v104, v106
    v_add_f32 v105, v105, v107
    v_cvt_pk_bf16_f32 v126, v104, v105
    s_nop 2
    v_add_f32 v108, v108, v110
    v_add_f32 v109, v109, v111
    v_cvt_pk_bf16_f32 v127, v108, v109
    v_and_or_b32 v124, v124, -2, s42
    global_store_dwordx4 v8, v[124:127], s[24:25]
    ds_read_b128 v[24:27], v14 offset:0
    ds_read_b128 v[28:31], v14 offset:1024
    ds_read_b128 v[32:35], v14 offset:2048
    ds_read_b128 v[36:39], v14 offset:3072
    ds_read_b128 v[80:83], v14 offset:4096
    ds_read_b128 v[84:87], v14 offset:5120
    ds_read_b128 v[88:91], v14 offset:6144
    ds_read_b128 v[92:95], v14 offset:7168
    ds_read_b128 v[96:99], v14 offset:8192
    ds_read_b128 v[100:103], v14 offset:9216
    ds_read_b128 v[104:107], v14 offset:10240
    ds_read_b128 v[108:111], v14 offset:11264
    ds_read_b128 v[112:115], v14 offset:12288
    ds_read_b128 v[116:119], v14 offset:13312
    ds_read_b128 v[120:123], v14 offset:14336
    ds_read_b128 v[124:127], v14 offset:15360
    s_nop 15
    global_load_dwordx4 v[56:59], v0, s[26:27] sc1
    global_load_dwordx4 v[60:63], v0, s[26:27] offset:1024 sc1
    s_add_u32 s20, s20, 1
    s_mov_b32 s32, s28
    s_mov_b32 s33, s29
    s_sub_u32 s32, s32, 6144
    s_subb_u32 s33, s33, 0
    s_add_u32 s28, s30, 0x1800
    s_addc_u32 s29, s31, 0
    s_nop 15
    s_nop 15
    global_load_dwordx4 v[68:71], v0, s[26:27] sc1
    global_load_dwordx4 v[72:75], v0, s[26:27] offset:1024 sc1
    s_waitcnt vmcnt(2)
    v_mfma_f32_16x16x32_bf16 v[64:67], v[16:19], v[56:59], 0
    v_bitop3_b32 v13, v56, v60, s42 bitop3:0x7e
    v_mfma_f32_16x16x32_bf16 v[64:67], v[16:19], v[60:63], v[64:67]
    v_and_b32 v13, 1, v13
    v_cmp_ne_u32 vcc, 0, v13
    s_cbranch_vccz L_okR_FW3
    s_waitcnt vmcnt(0)
    v_mfma_f32_16x16x32_bf16 v[64:67], v[16:19], v[68:71], 0
    v_bitop3_b32 v13, v68, v72, s42 bitop3:0x7e
    v_mfma_f32_16x16x32_bf16 v[64:67], v[16:19], v[72:75], v[64:67]
    v_and_b32 v13, 1, v13
    v_cmp_ne_u32 vcc, 0, v13
    s_cbranch_vccz L_okR_FW3
L_pollR_FW3:
    global_load_dwordx4 v[56:59], v0, s[26:27] sc1
    global_load_dwordx4 v[60:63], v0, s[26:27] offset:1024 sc1
    s_add_u32 s43, s43, 1
    s_cmp_gt_u32 s43, 400000
    s_cbranch_scc1 L_F_fail
L_chkR_FW3:
    s_waitcnt vmcnt(0)
    v_mfma_f32_16x16x32_bf16 v[64:67], v[16:19], v[56:59], 0
    v_bitop3_b32 v13, v56, v60, s42 bitop3:0x7e
    v_mfma_f32_16x16x32_bf16 v[64:67], v[16:19], v[60:63], v[64:67]
    v_and_b32 v13, 1, v13
    v_cmp_ne_u32 vcc, 0, v13
    s_cbranch_vccnz L_pollR_FW3
L_okR_FW3:
    s_nop 4
    v_add_f32_dpp v64, v64, v64 row_ror:8 row_mask:0xf bank_mask:0x3
    v_add_f32_dpp v65, v65, v65 row_ror:8 row_mask:0xf bank_mask:0x3
    v_add_f32_dpp v64, v66, v66 row_ror:8 row_mask:0xf bank_mask:0xc
    v_add_f32_dpp v65, v67, v67 row_ror:8 row_mask:0xf bank_mask:0xc
    s_nop 0
    v_add_f32_dpp v64, v64, v64 row_shl:4 row_mask:0xf bank_mask:0x5
    v_add_f32_dpp v64, v65, v65 row_shr:4 row_mask:0xf bank_mask:0xa
    s_nop 1
    v_mov_b32_dpp v65, v64 row_ror:8 row_mask:0xf bank_mask:0xf
    v_cvt_pk_bf16_f32 v64, v64, v65
    v_min_u32 v64, -2, v64
    global_store_dword v10, v64, s[30:31]
    v_readfirstlane_b32 s55, v9
    s_add_u32 s52, s20, 1
    s_and_b32 s52, s52, 3
    s_lshl_b32 s52, s52, 13
    s_add_u32 s52, s52, 0x80000
    s_add_u32 s30, s14, s52
    s_addc_u32 s31, s15, 0
    s_and_b32 s52, s20, 1
    s_lshl_b32 s52, s52, 18
    s_add_u32 s22, s14, s52
    s_addc_u32 s23, s15, 0
    s_add_u32 s24, s22, 0x8000
    s_addc_u32 s25, s23, 0
    s_lshl_b32 s52, s18, 13
    s_add_u32 s52, s52, 6144
    s_add_u32 s26, s22, s52
    s_addc_u32 s27, s23, 0
    s_bfe_u32 s42, s20, 0x10001
    s_mov_b32 s43, 0
    s_add_u32 s76, s76, 128
    s_add_u32 s77, s77, 128
    s_cmp_lg_u32 s55, 0
    s_cbranch_scc1 L_kvok_FW3
    s_add_u32 s52, s20, 1
    s_cmp_lt_u32 s52, 64
    s_cbranch_scc0 L_kvok_FW3
    s_sub_u32 s52, s76, 128
L_kvspin_FW3:
    buffer_load_dword v9, off, s[96:99], s52 sc1
    s_add_u32 s43, s43, 1
    s_cmp_gt_u32 s43, 400000
    s_cbranch_scc1 L_F_fail
    s_waitcnt vmcnt(0)
    v_readfirstlane_b32 s55, v9
    s_nop 3
    s_cmp_lg_u32 s55, 0
    s_cbranch_scc0 L_kvspin_FW3
    s_mov_b32 s43, 0
L_kvok_FW3:
    s_nop 15
    s_nop 15
    global_load_dwordx4 v[48:51], v0, s[28:29] sc1
    global_load_dwordx4 v[52:55], v0, s[28:29] offset:1024 sc1
    s_waitcnt vmcnt(3)
    v_mov_b64 v[56:57], 0
    v_mov_b64 v[58:59], 0
    v_mov_b64 v[60:61], 0
    v_mov_b64 v[62:63], 0
    v_mov_b64 v[64:65], 0
    v_mov_b64 v[66:67], 0
    v_mov_b64 v[68:69], 0
    v_mov_b64 v[70:71], 0
    v_mov_b64 v[72:73], 0
    v_mov_b64 v[74:75], 0
    v_mov_b64 v[76:77], 0
    v_mov_b64 v[78:79], 0
    s_waitcnt lgkmcnt(0)
    s_nop 15
    s_nop 7
    global_load_dwordx4 v[40:43], v0, s[28:29] sc1
    global_load_dwordx4 v[44:47], v0, s[28:29] offset:1024 sc1
    s_waitcnt vmcnt(2)
    v_max_u32 v13, v48, v52
    v_cmp_eq_u32 vcc, -1, v13
    s_cbranch_vccz L_entry_FW3
    s_waitcnt vmcnt(0)
    v_max_u32 v13, v40, v44
    v_cmp_eq_u32 vcc, -1, v13
    s_cbranch_vccnz L_pollG_FW3
    ds_write_b128 v2, v[40:43] offset:6144
    ds_write_b128 v2, v[44:47] offset:7168
    v_mov_b64 v[48:49], v[40:41]
    v_mov_b64 v[50:51], v[42:43]
    v_mov_b64 v[52:53], v[44:45]
    v_mov_b64 v[54:55], v[46:47]
    s_nop 0
    s_branch L_entry2_FW3
L_last_FW3:
    s_waitcnt vmcnt(0)
    s_barrier
    s_branch L_F_done
L_F_fail:
    v_mov_b32 v1, 240
    v_mov_b32 v2, 0xdead
    global_store_dword v1, v2, s[16:17]
L_F_done:
    s_endpgm
L_c_start_S0:
    s_and_b32 s52, s20, 1
    s_lshl_b32 s52, s52, 18
    s_add_u32 s22, s14, s52
    s_addc_u32 s23, s15, 0
    s_add_u32 s24, s22, 0x8000
    s_addc_u32 s25, s23, 0
    s_lshl_b32 s52, s18, 13
    s_add_u32 s52, s52, 0
    s_add_u32 s26, s22, s52
    s_addc_u32 s27, s23, 0
    v_mov_b32 v24, v116
    v_mov_b32 v28, v120
    v_mov_b32 v25, v117
    v_mov_b32 v29, v121
    v_mov_b32 v26, v118
    v_mov_b32 v30, v122
    v_mov_b32 v27, v119
    v_mov_b32 v31, v123
    ds_read_b128 v[32:35], v14 offset:0
    ds_read_b128 v[36:39], v14 offset:1024
    ds_read_b128 v[40:43], v14 offset:2048
    ds_read_b128 v[44:47], v14 offset:3072
    ds_read_b128 v[80:83], v14 offset:4096
    ds_read_b128 v[84:87], v14 offset:5120
    ds_read_b128 v[88:91], v14 offset:6144
    ds_read_b128 v[92:95], v14 offset:7168
    ds_read_b128 v[96:99], v14 offset:8192
    ds_read_b128 v[100:103], v14 offset:9216
    ds_read_b128 v[104:107], v14 offset:10240
    ds_read_b128 v[108:111], v14 offset:11264
    ds_read_b128 v[112:115], v14 offset:12288
    ds_read_b128 v[116:119], v14 offset:13312
    ds_read_b128 v[120:123], v14 offset:14336
    ds_read_b128 v[124:127], v14 offset:15360
    v_mov_b64 v[56:57], 0
    v_mov_b64 v[58:59], 0
    v_mov_b64 v[60:61], 0
    v_mov_b64 v[62:63], 0
    v_mov_b64 v[64:65], 0
    v_mov_b64 v[66:67], 0
    v_mov_b64 v[68:69], 0
    v_mov_b64 v[70:71], 0
    v_mov_b64 v[72:73], 0
    v_mov_b64 v[74:75], 0
    v_mov_b64 v[76:77], 0
    v_mov_b64 v[78:79], 0
    s_waitcnt vmcnt(0) lgkmcnt(0)
    s_branch L_entry_SW0
L_pollG_SW0:
    global_load_dwordx4 v[24:27], v0, s[28:29] sc1
    global_load_dwordx4 v[28:31], v0, s[28:29] offset:1024 sc1
    s_add_u32 s43, s43, 1
    s_cmp_gt_u32 s43, 400000
    s_cbranch_scc1 L_S_fail
    s_waitcnt vmcnt(0)
    v_max_u32 v13, v24, v28
    v_cmp_eq_u32 vcc, -1, v13
    s_cbranch_vccnz L_pollG_SW0
L_entry_SW0:
    ds_write_b128 v2, v[24:27] offset:0
    ds_write_b128 v2, v[28:31] offset:1024
L_entry2_SW0:
    v_smfmac_f32_16x16x64_bf16 v[56:59], v[24:27], v[32:39], v15
    v_smfmac_f32_16x16x64_bf16 v[60:63], v[24:27], v[40:47], v15
    v_smfmac_f32_16x16x64_bf16 v[56:59], v[28:31], v[80:87], v15
    v_smfmac_f32_16x16x64_bf16 v[60:63], v[28:31], v[88:95], v15
    v_smfmac_f32_16x16x64_bf16 v[64:67], v[24:27], v[96:103], v15
    v_smfmac_f32_16x16x64_bf16 v[68:71], v[24:27], v[104:111], v15
    s_waitcnt vmcnt(0) lgkmcnt(0)
    s_barrier
    ds_read_b128 v[32:35], v2 offset:2048
    ds_read_b128 v[36:39], v2 offset:3072
    v_smfmac_f32_16x16x64_bf16 v[64:67], v[28:31], v[112:119], v15
    ds_read_b128 v[40:43], v2 offset:4096
    v_smfmac_f32_16x16x64_bf16 v[68:71], v[28:31], v[120:127], v15
    ds_read_b128 v[44:47], v2 offset:5120
    v_smfmac_f32_16x16x64_bf16 v[72:75], v[24:27], a[192:199], v15
    ds_read_b128 v[48:51], v2 offset:6144
    v_smfmac_f32_16x16x64_bf16 v[76:79], v[24:27], v[128:135], v15
    ds_read_b128 v[52:55], v2 offset:7168
    v_smfmac_f32_16x16x64_bf16 v[72:75], v[28:31], a[200:207], v15
    s_mov_b32 m0, 153600
    v_mov_b32 v13, -1
    v_smfmac_f32_16x16x64_bf16 v[76:79], v[28:31], v[136:143], v15
    global_load_lds_dwordx4 v0, s[36:37] sc1
    s_waitcnt lgkmcnt(5)
    v_smfmac_f32_16x16x64_bf16 v[56:59], v[32:35], a[0:7], v15
    ds_read_b128 v[80:83], v2 offset:14336
    v_smfmac_f32_16x16x64_bf16 v[60:63], v[32:35], a[48:55], v15
    ds_read_b128 v[96:99], v2 offset:18432
    s_waitcnt lgkmcnt(6)
    v_smfmac_f32_16x16x64_bf16 v[56:59], v[36:39], a[8:15], v15
    ds_read_b128 v[84:87], v2 offset:15360
    v_smfmac_f32_16x16x64_bf16 v[60:63], v[36:39], a[56:63], v15
    ds_read_b128 v[100:103], v2 offset:19456
    s_waitcnt lgkmcnt(7)
    v_smfmac_f32_16x16x64_bf16 v[56:59], v[40:43], a[16:23], v15
    ds_read_b128 v[88:91], v2 offset:16384
    v_smfmac_f32_16x16x64_bf16 v[60:63], v[40:43], a[64:71], v15
    ds_read_b128 v[104:107], v2 offset:20480
    s_waitcnt lgkmcnt(8)
    v_smfmac_f32_16x16x64_bf16 v[56:59], v[44:47], a[24:31], v15
    ds_read_b128 v[92:95], v2 offset:17408
    v_smfmac_f32_16x16x64_bf16 v[60:63], v[44:47], a[72:79], v15
    ds_read_b128 v[108:111], v2 offset:21504
    s_waitcnt lgkmcnt(9)
    v_smfmac_f32_16x16x64_bf16 v[56:59], v[48:51], a[32:39], v15
    global_load_lds_dwordx4 v0, s[36:37] offset:1024 sc1
    v_smfmac_f32_16x16x64_bf16 v[60:63], v[48:51], a[80:87], v15
    global_store_dword v10, v13, s[32:33] sc1
    s_waitcnt lgkmcnt(8)
    v_smfmac_f32_16x16x64_bf16 v[56:59], v[52:55], a[40:47], v15
    buffer_load_dword v9, off, s[96:99], s76 sc1
    v_smfmac_f32_16x16x64_bf16 v[60:63], v[52:55], a[88:95], v15
    s_add_u32 s54, s36, 0x40000
    s_addc_u32 s55, s37, 0
    global_load_dword v13, v1, s[54:55] sc1
    v_smfmac_f32_16x16x64_bf16 v[64:67], v[32:35], a[96:103], v15
    v_smfmac_f32_16x16x64_bf16 v[68:71], v[32:35], a[144:151], v15
    s_nop 0
    v_add_f32 v56, v56, v58
    v_add_f32 v57, v57, v59
    v_smfmac_f32_16x16x64_bf16 v[64:67], v[36:39], a[104:111], v15
    v_add_f32 v60, v60, v62
    v_add_f32 v61, v61, v63
    v_cvt_pk_bf16_f32 v58, v56, v60
    v_cvt_pk_bf16_f32 v59, v57, v61
    ds_write_b32 v3, v58
    ds_write_b32 v4, v59
    v_smfmac_f32_16x16x64_bf16 v[68:71], v[36:39], a[152:159], v15
    v_mov_b32 v56, 1
    v_smfmac_f32_16x16x64_bf16 v[64:67], v[40:43], a[112:119], v15
    buffer_store_dword v56, off, s[96:99], s77 sc1
    v_smfmac_f32_16x16x64_bf16 v[68:71], v[40:43], a[160:167], v15
    s_mov_b32 m0, 145408
    v_smfmac_f32_16x16x64_bf16 v[64:67], v[44:47], a[120:127], v15
    v_smfmac_f32_16x16x64_bf16 v[68:71], v[44:47], a[168:175], v15
    v_smfmac_f32_16x16x64_bf16 v[64:67], v[48:51], a[128:135], v15
    s_waitcnt lgkmcnt(0)
    s_barrier
    ds_read_b128 v[112:115], v5 offset:0
    v_smfmac_f32_16x16x64_bf16 v[68:71], v[48:51], a[176:183], v15
    ds_read_b128 v[116:119], v5 offset:1024
    v_smfmac_f32_16x16x64_bf16 v[64:67], v[52:55], a[136:143], v15
    ds_read_b128 v[120:123], v5 offset:2048
    v_smfmac_f32_16x16x64_bf16 v[68:71], v[52:55], a[184:191], v15
    ds_read_b128 v[124:127], v5 offset:3072
    v_smfmac_f32_16x16x64_bf16 v[72:75], v[32:35], a[208:215], v15
    global_load_lds_dwordx4 v0, s[34:35] sc1
    v_smfmac_f32_16x16x64_bf16 v[76:79], v[32:35], v[144:151], v15
    global_load_lds_dwordx4 v0, s[34:35] offset:1024 sc1
    s_nop 0
    v_add_f32 v64, v64, v66
    v_add_f32 v65, v65, v67
    v_add_f32 v68, v68, v70
    v_add_f32 v69, v69, v71
    v_cvt_pk_bf16_f32 v66, v64, v68
    v_cvt_pk_bf16_f32 v67, v65, v69
    s_waitcnt lgkmcnt(0)
    ds_write_b32 v3, v66 offset:128
    ds_write_b32 v4, v67 offset:128
    v_mfma_f32_16x16x32_bf16 v[56:59], v[80:83], v[112:115], 0
    v_mfma_f32_16x16x32_bf16 v[60:63], v[96:99], v[112:115], 0
    v_mfma_f32_16x16x32_bf16 v[56:59], v[84:87], v[116:119], v[56:59]
    v_mfma_f32_16x16x32_bf16 v[60:63], v[100:103], v[116:119], v[60:63]
    v_mfma_f32_16x16x32_bf16 v[56:59], v[88:91], v[120:123], v[56:59]
    v_mfma_f32_16x16x32_bf16 v[60:63], v[104:107], v[120:123], v[60:63]
    v_mfma_f32_16x16x32_bf16 v[56:59], v[92:95], v[124:127], v[56:59]
    v_mfma_f32_16x16x32_bf16 v[60:63], v[108:111], v[124:127], v[60:63]
    s_waitcnt vmcnt(6) lgkmcnt(0)
    s_barrier
    ds_read_b128 v[80:83], v6 offset:0
    ds_read_b128 v[84:87], v6 offset:1024
    v_smfmac_f32_16x16x64_bf16 v[72:75], v[36:39], a[216:223], v15
    ds_read_b128 v[88:91], v6 offset:2048
    v_smfmac_f32_16x16x64_bf16 v[76:79], v[36:39], v[152:159], v15
    ds_read_b128 v[92:95], v6 offset:3072
    v_smfmac_f32_16x16x64_bf16 v[72:75], v[40:43], a[224:231], v15
    ds_read_b128 v[104:107], v2 offset:22528
    v_smfmac_f32_16x16x64_bf16 v[76:79], v[40:43], v[160:167], v15
    ds_read_b128 v[108:111], v2 offset:23552
    v_smfmac_f32_16x16x64_bf16 v[72:75], v[44:47], a[232:239], v15
    s_waitcnt lgkmcnt(5)
    v_mfma_f32_16x16x32_bf16 v[64:67], v[80:83], v[112:115], 0
    s_waitcnt lgkmcnt(4)
    v_mfma_f32_16x16x32_bf16 v[64:67], v[84:87], v[116:119], v[64:67]
    s_waitcnt lgkmcnt(3)
    v_mfma_f32_16x16x32_bf16 v[64:67], v[88:91], v[120:123], v[64:67]
    s_waitcnt lgkmcnt(2)
    v_mfma_f32_16x16x32_bf16 v[64:67], v[92:95], v[124:127], v[64:67]
    v_smfmac_f32_16x16x64_bf16 v[76:79], v[44:47], v[168:175], v15
    global_store_dwordx4 v11, v[80:83], s[38:39] sc1
    v_smfmac_f32_16x16x64_bf16 v[72:75], v[48:51], a[240:247], v15
    v_smfmac_f32_16x16x64_bf16 v[76:79], v[48:51], v[176:183], v15
    v_smfmac_f32_16x16x64_bf16 v[72:75], v[52:55], a[248:255], v15
    v_smfmac_f32_16x16x64_bf16 v[76:79], v[52:55], v[184:191], v15
    v_max3_f32 v68, v56, v57, v58
    v_max3_f32 v68, v68, v59, v60
    v_max3_f32 v68, v68, v61, v62
    v_max3_f32 v68, v68, v63, v64
    v_max_f32 v68, v68, v65
    v_mov_b32 v69, v68
    ds_read_b128 v[24:27], v14 offset:16384
    ds_read_b128 v[28:31], v14 offset:17408
    v_permlane32_swap_b32 v68, v69
    v_max_f32 v68, v68, v69
    v_mov_b32 v69, v68
    ds_read_b128 v[32:35], v14 offset:18432
    ds_read_b128 v[36:39], v14 offset:19456
    v_permlane16_swap_b32 v68, v69
    v_max_f32 v68, v68, v69
    v_mul_f32 v68, s44, v68
    v_pk_fma_f32 v[56:57], v[56:57], s[44:45], v[68:69] op_sel_hi:[1,0,0] neg_lo:[0,0,1] neg_hi:[0,0,1]
    v_pk_fma_f32 v[58:59], v[58:59], s[44:45], v[68:69] op_sel_hi:[1,0,0] neg_lo:[0,0,1] neg_hi:[0,0,1]
    v_pk_fma_f32 v[60:61], v[60:61], s[44:45], v[68:69] op_sel_hi:[1,0,0] neg_lo:[0,0,1] neg_hi:[0,0,1]
    v_pk_fma_f32 v[62:63], v[62:63], s[44:45], v[68:69] op_sel_hi:[1,0,0] neg_lo:[0,0,1] neg_hi:[0,0,1]
    v_pk_fma_f32 v[64:65], v[64:65], s[44:45], v[68:69] op_sel_hi:[1,0,0] neg_lo:[0,0,1] neg_hi:[0,0,1]
    v_exp_f32 v56, v56
    v_exp_f32 v57, v57
    v_exp_f32 v58, v58
    v_exp_f32 v59, v59
    v_exp_f32 v60, v60
    v_exp_f32 v61, v61
    v_exp_f32 v62, v62
    v_exp_f32 v63, v63
    v_exp_f32 v64, v64
    v_exp_f32 v65, v65
    v_cvt_pk_bf16_f32 v96, v56, v57
    v_cvt_pk_bf16_f32 v97, v58, v59
    v_cvt_pk_bf16_f32 v98, v60, v61
    v_cvt_pk_bf16_f32 v99, v62, v63
    v_cvt_pk_bf16_f32 v100, v64, v65
    v_mov_b32 v101, 0
    s_waitcnt lgkmcnt(4)
    v_mfma_f32_16x16x32_bf16 v[88:91], v[20:23], v[96:99], 0
    v_add_f32 v72, v72, v74
    v_add_f32 v73, v73, v75
    v_mfma_f32_16x16x32_bf16 v[80:83], v[104:107], v[96:99], 0
    v_add_f32 v76, v76, v78
    v_add_f32 v77, v77, v79
    v_mfma_f32_16x16x32_bf16 v[84:87], v[108:111], v[96:99], 0
    v_cvt_pk_bf16_f32 v112, v72, v73
    v_cvt_pk_bf16_f32 v114, v76, v77
    v_mov_b32 v113, 0
    v_mov_b32 v115, 0
    v_mfma_f32_16x16x16_bf16 v[88:91], v[20:21], v[100:101], v[88:91]
    ds_read_b128 v[40:43], v14 offset:20480
    ds_read_b128 v[44:47], v14 offset:21504
    v_mfma_f32_16x16x16_bf16 v[80:83], v[112:113], v[100:101], v[80:83]
    ds_read_b128 v[48:51], v14 offset:22528
    ds_read_b128 v[52:55], v14 offset:23552
    v_mfma_f32_16x16x16_bf16 v[84:87], v[114:115], v[100:101], v[84:87]
    ds_read_b128 v[56:59], v14 offset:24576
    ds_read_b128 v[60:63], v14 offset:25600
    global_store_dword v12, v112, s[40:41] sc1
    global_store_dword v12, v114, s[40:41] offset:256 sc1
    s_cmp_eq_u32 s20, 63
    s_cbranch_scc1 L_last_SW0
    v_rcp_f32 v92, v88
    ds_read_b128 v[64:67], v14 offset:26624
    ds_read_b128 v[68:71], v14 offset:27648
    v_pk_mul_f32 v[80:81], v[80:81], v[92:93] op_sel_hi:[1,0]
    v_pk_mul_f32 v[82:83], v[82:83], v[92:93] op_sel_hi:[1,0]
    v_pk_mul_f32 v[84:85], v[84:85], v[92:93] op_sel_hi:[1,0]
    v_pk_mul_f32 v[86:87], v[86:87], v[92:93] op_sel_hi:[1,0]
    v_cvt_pk_bf16_f32 v120, v80, v81
    v_cvt_pk_bf16_f32 v121, v82, v83
    v_cvt_pk_bf16_f32 v122, v84, v85
    v_cvt_pk_bf16_f32 v123, v86, v87
    ds_write_b128 v7, v[120:123]
    ds_read_b128 v[72:75], v14 offset:28672
    ds_read_b128 v[76:79], v14 offset:29696
    v_mov_b64 v[80:81], 0
    v_mov_b64 v[82:83], 0
    v_mov_b64 v[84:85], 0
    v_mov_b64 v[86:87], 0
    v_mov_b64 v[88:89], 0
    v_mov_b64 v[90:91], 0
    v_mov_b64 v[92:93], 0
    v_mov_b64 v[94:95], 0
    v_mov_b64 v[96:97], 0
    v_mov_b64 v[98:99], 0
    v_mov_b64 v[100:101], 0
    v_mov_b64 v[102:103], 0
    v_mov_b64 v[104:105], 0
    v_mov_b64 v[106:107], 0
    v_mov_b64 v[108:109], 0
    v_mov_b64 v[110:111], 0
    s_waitcnt lgkmcnt(0)
    s_barrier
    ds_read_b128 v[112:115], v2 offset:12288
    ds_read_b128 v[116:119], v2 offset:13312
    s_add_u32 s34, s34, 0x40000
    s_addc_u32 s35, s35, 0
    s_add_u32 s36, s36, 0x40000
    s_addc_u32 s37, s37, 0
    s_add_u32 s38, s38, 0x10000
    s_addc_u32 s39, s39, 0
    s_add_u32 s40, s40, 0x10000
    s_addc_u32 s41, s41, 0
    s_waitcnt lgkmcnt(0)
    v_smfmac_f32_16x16x64_bf16 v[80:83], v[112:115], v[192:199], v15
    v_smfmac_f32_16x16x64_bf16 v[80:83], v[116:119], v[24:31], v15
    ds_read_b128 v[24:27], v14 offset:30720
    ds_read_b128 v[28:31], v14 offset:31744
    v_smfmac_f32_16x16x64_bf16 v[84:87], v[112:115], v[200:207], v15
    v_smfmac_f32_16x16x64_bf16 v[84:87], v[116:119], v[32:39], v15
    v_smfmac_f32_16x16x64_bf16 v[88:91], v[112:115], v[208:215], v15
    v_add_f32 v80, v80, v82
    v_smfmac_f32_16x16x64_bf16 v[88:91], v[116:119], v[40:47], v15
    v_add_f32 v81, v81, v83
    v_cvt_pk_bf16_f32 v120, v80, v81
    v_smfmac_f32_16x16x64_bf16 v[92:95], v[112:115], v[216:223], v15
    v_add_f32 v84, v84, v86
    v_smfmac_f32_16x16x64_bf16 v[92:95], v[116:119], v[48:55], v15
    v_add_f32 v85, v85, v87
    v_cvt_pk_bf16_f32 v121, v84, v85
    v_smfmac_f32_16x16x64_bf16 v[96:99], v[112:115], v[224:231], v15
    v_add_f32 v88, v88, v90
    v_smfmac_f32_16x16x64_bf16 v[96:99], v[116:119], v[56:63], v15
    v_add_f32 v89, v89, v91
    v_cvt_pk_bf16_f32 v122, v88, v89
    v_smfmac_f32_16x16x64_bf16 v[100:103], v[112:115], v[232:239], v15
    v_add_f32 v92, v92, v94
    v_smfmac_f32_16x16x64_bf16 v[100:103], v[116:119], v[64:71], v15
    v_add_f32 v93, v93, v95
    v_cvt_pk_bf16_f32 v123, v92, v93
    v_smfmac_f32_16x16x64_bf16 v[104:107], v[112:115], v[240:247], v15
    v_add_f32 v96, v96, v98
    v_and_or_b32 v120, v120, -2, s42
    global_store_dwordx4 v8, v[120:123], s[22:23] sc1
    v_smfmac_f32_16x16x64_bf16 v[104:107], v[116:119], v[72:79], v15
    v_add_f32 v97, v97, v99
    v_cvt_pk_bf16_f32 v124, v96, v97
    v_smfmac_f32_16x16x64_bf16 v[108:111], v[112:115], v[248:255], v15
    v_add_f32 v100, v100, v102
    s_waitcnt lgkmcnt(0)
    v_smfmac_f32_16x16x64_bf16 v[108:111], v[116:119], v[24:31], v15
    v_add_f32 v101, v101, v103
    v_cvt_pk_bf16_f32 v125, v100, v101
    s_nop 1
    v_add_f32 v104, v104, v106
    v_add_f32 v105, v105, v107
    v_cvt_pk_bf16_f32 v126, v104, v105
    s_nop 2
    v_add_f32 v108, v108, v110
    v_add_f32 v109, v109, v111
    v_cvt_pk_bf16_f32 v127, v108, v109
    v_and_or_b32 v124, v124, -2, s42
    global_store_dwordx4 v8, v[124:127], s[24:25] sc1
    ds_read_b128 v[32:35], v14 offset:0
    ds_read_b128 v[36:39], v14 offset:1024
    ds_read_b128 v[40:43], v14 offset:2048
    ds_read_b128 v[44:47], v14 offset:3072
    ds_read_b128 v[80:83], v14 offset:4096
    ds_read_b128 v[84:87], v14 offset:5120
    ds_read_b128 v[88:91], v14 offset:6144
    ds_read_b128 v[92:95], v14 offset:7168
    ds_read_b128 v[96:99], v14 offset:8192
    ds_read_b128 v[100:103], v14 offset:9216
    ds_read_b128 v[104:107], v14 offset:10240
    ds_read_b128 v[108:111], v14 offset:11264
    ds_read_b128 v[112:115], v14 offset:12288
    ds_read_b128 v[116:119], v14 offset:13312
    ds_read_b128 v[120:123], v14 offset:14336
    ds_read_b128 v[124:127], v14 offset:15360
    s_nop 15
    global_load_dwordx4 v[56:59], v0, s[26:27] sc1
    global_load_dwordx4 v[60:63], v0, s[26:27] offset:1024 sc1
    s_add_u32 s20, s20, 1
    s_mov_b32 s32, s28
    s_mov_b32 s33, s29
    s_sub_u32 s32, s32, 0
    s_subb_u32 s33, s33, 0
    s_add_u32 s28, s30, 0x0
    s_addc_u32 s29, s31, 0
    s_nop 15
    s_nop 15
    global_load_dwordx4 v[68:71], v0, s[26:27] sc1
    global_load_dwordx4 v[72:75], v0, s[26:27] offset:1024 sc1
    s_waitcnt vmcnt(2)
    v_mfma_f32_16x16x32_bf16 v[64:67], v[16:19], v[56:59], 0
    v_bitop3_b32 v13, v56, v60, s42 bitop3:0x7e
    v_mfma_f32_16x16x32_bf16 v[64:67], v[16:19], v[60:63], v[64:67]
    v_and_b32 v13, 1, v13
    v_cmp_ne_u32 vcc, 0, v13
    s_cbranch_vccz L_okR_SW0
    s_waitcnt vmcnt(0)
    v_mfma_f32_16x16x32_bf16 v[64:67], v[16:19], v[68:71], 0
    v_bitop3_b32 v13, v68, v72, s42 bitop3:0x7e
    v_mfma_f32_16x16x32_bf16 v[64:67], v[16:19], v[72:75], v[64:67]
    v_and_b32 v13, 1, v13
    v_cmp_ne_u32 vcc, 0, v13
    s_cbranch_vccz L_okR_SW0
L_pollR_SW0:
    global_load_dwordx4 v[56:59], v0, s[26:27] sc1
    global_load_dwordx4 v[60:63], v0, s[26:27] offset:1024 sc1
    s_add_u32 s43, s43, 1
    s_cmp_gt_u32 s43, 400000
    s_cbranch_scc1 L_S_fail
L_chkR_SW0:
    s_waitcnt vmcnt(0)
    v_mfma_f32_16x16x32_bf16 v[64:67], v[16:19], v[56:59], 0
    v_bitop3_b32 v13, v56, v60, s42 bitop3:0x7e
    v_mfma_f32_16x16x32_bf16 v[64:67], v[16:19], v[60:63], v[64:67]
    v_and_b32 v13, 1, v13
    v_cmp_ne_u32 vcc, 0, v13
    s_cbranch_vccnz L_pollR_SW0
L_okR_SW0:
    s_nop 4
    v_add_f32_dpp v64, v64, v64 row_ror:8 row_mask:0xf bank_mask:0x3
    v_add_f32_dpp v65, v65, v65 row_ror:8 row_mask:0xf bank_mask:0x3
    v_add_f32_dpp v64, v66, v66 row_ror:8 row_mask:0xf bank_mask:0xc
    v_add_f32_dpp v65, v67, v67 row_ror:8 row_mask:0xf bank_mask:0xc
    s_nop 0
    v_add_f32_dpp v64, v64, v64 row_shl:4 row_mask:0xf bank_mask:0x5
    v_add_f32_dpp v64, v65, v65 row_shr:4 row_mask:0xf bank_mask:0xa
    s_nop 1
    v_mov_b32_dpp v65, v64 row_ror:8 row_mask:0xf bank_mask:0xf
    v_cvt_pk_bf16_f32 v64, v64, v65
    v_min_u32 v64, -2, v64
    global_store_dword v10, v64, s[30:31] sc1
    v_readfirstlane_b32 s55, v9
    s_add_u32 s52, s20, 1
    s_and_b32 s52, s52, 3
    s_lshl_b32 s52, s52, 13
    s_add_u32 s52, s52, 0x80000
    s_add_u32 s30, s14, s52
    s_addc_u32 s31, s15, 0
    s_and_b32 s52, s20, 1
    s_lshl_b32 s52, s52, 18
    s_add_u32 s22, s14, s52
    s_addc_u32 s23, s15, 0
    s_add_u32 s24, s22, 0x8000
    s_addc_u32 s25, s23, 0
    s_lshl_b32 s52, s18, 13
    s_add_u32 s52, s52, 0
    s_add_u32 s26, s22, s52
    s_addc_u32 s27, s23, 0
    s_bfe_u32 s42, s20, 0x10001
    s_mov_b32 s43, 0
    s_add_u32 s76, s76, 128
    s_add_u32 s77, s77, 128
    s_cmp_lg_u32 s55, 0
    s_cbranch_scc1 L_kvok_SW0
    s_add_u32 s52, s20, 1
    s_cmp_lt_u32 s52, 64
    s_cbranch_scc0 L_kvok_SW0
    s_sub_u32 s52, s76, 128
L_kvspin_SW0:
    buffer_load_dword v9, off, s[96:99], s52 sc1
    s_add_u32 s43, s43, 1
    s_cmp_gt_u32 s43, 400000
    s_cbranch_scc1 L_S_fail
    s_waitcnt vmcnt(0)
    v_readfirstlane_b32 s55, v9
    s_nop 3
    s_cmp_lg_u32 s55, 0
    s_cbranch_scc0 L_kvspin_SW0
    s_mov_b32 s43, 0
L_kvok_SW0:
    s_nop 15
    s_nop 15
    global_load_dwordx4 v[24:27], v0, s[28:29] sc1
    global_load_dwordx4 v[28:31], v0, s[28:29] offset:1024 sc1
    s_waitcnt vmcnt(3)
    v_mov_b64 v[56:57], 0
    v_mov_b64 v[58:59], 0
    v_mov_b64 v[60:61], 0
    v_mov_b64 v[62:63], 0
    v_mov_b64 v[64:65], 0
    v_mov_b64 v[66:67], 0
    v_mov_b64 v[68:69], 0
    v_mov_b64 v[70:71], 0
    v_mov_b64 v[72:73], 0
    v_mov_b64 v[74:75], 0
    v_mov_b64 v[76:77], 0
    v_mov_b64 v[78:79], 0
    s_waitcnt lgkmcnt(0)
    s_nop 15
    s_nop 7
    global_load_dwordx4 v[48:51], v0, s[28:29] sc1
    global_load_dwordx4 v[52:55], v0, s[28:29] offset:1024 sc1
    s_waitcnt vmcnt(2)
    v_max_u32 v13, v24, v28
    v_cmp_eq_u32 vcc, -1, v13
    s_cbranch_vccz L_entry_SW0
    s_waitcnt vmcnt(0)
    v_max_u32 v13, v48, v52
    v_cmp_eq_u32 vcc, -1, v13
    s_cbranch_vccnz L_pollG_SW0
    ds_write_b128 v2, v[48:51] offset:0
    ds_write_b128 v2, v[52:55] offset:1024
    v_mov_b64 v[24:25], v[48:49]
    v_mov_b64 v[26:27], v[50:51]
    v_mov_b64 v[28:29], v[52:53]
    v_mov_b64 v[30:31], v[54:55]
    s_nop 0
    s_branch L_entry2_SW0
L_last_SW0:
    s_waitcnt vmcnt(0)
    s_barrier
    s_add_u32 s77, s77, 128
    v_mov_b32 v13, 1
    buffer_store_dword v13, off, s[96:99], s77 sc1
    s_waitcnt vmcnt(0)
    s_branch L_S_done
L_c_start_S1:
    s_and_b32 s52, s20, 1
    s_lshl_b32 s52, s52, 18
    s_add_u32 s22, s14, s52
    s_addc_u32 s23, s15, 0
    s_add_u32 s24, s22, 0x8000
    s_addc_u32 s25, s23, 0
    s_lshl_b32 s52, s18, 13
    s_add_u32 s52, s52, 2048
    s_add_u32 s26, s22, s52
    s_addc_u32 s27, s23, 0
    v_mov_b32 v32, v116
    v_mov_b32 v36, v120
    v_mov_b32 v33, v117
    v_mov_b32 v37, v121
    v_mov_b32 v34, v118
    v_mov_b32 v38, v122
    v_mov_b32 v35, v119
    v_mov_b32 v39, v123
    ds_read_b128 v[24:27], v14 offset:0
    ds_read_b128 v[28:31], v14 offset:1024
    ds_read_b128 v[40:43], v14 offset:2048
    ds_read_b128 v[44:47], v14 offset:3072
    ds_read_b128 v[80:83], v14 offset:4096
    ds_read_b128 v[84:87], v14 offset:5120
    ds_read_b128 v[88:91], v14 offset:6144
    ds_read_b128 v[92:95], v14 offset:7168
    ds_read_b128 v[96:99], v14 offset:8192
    ds_read_b128 v[100:103], v14 offset:9216
    ds_read_b128 v[104:107], v14 offset:10240
    ds_read_b128 v[108:111], v14 offset:11264
    ds_read_b128 v[112:115], v14 offset:12288
    ds_read_b128 v[116:119], v14 offset:13312
    ds_read_b128 v[120:123], v14 offset:14336
    ds_read_b128 v[124:127], v14 offset:15360
    v_mov_b64 v[56:57], 0
    v_mov_b64 v[58:59], 0
    v_mov_b64 v[60:61], 0
    v_mov_b64 v[62:63], 0
    v_mov_b64 v[64:65], 0
    v_mov_b64 v[66:67], 0
    v_mov_b64 v[68:69], 0
    v_mov_b64 v[70:71], 0
    v_mov_b64 v[72:73], 0
    v_mov_b64 v[74:75], 0
    v_mov_b64 v[76:77], 0
    v_mov_b64 v[78:79], 0
    s_waitcnt vmcnt(0) lgkmcnt(0)
    s_branch L_entry_SW1
L_pollG_SW1:
    global_load_dwordx4 v[32:35], v0, s[28:29] sc1
    global_load_dwordx4 v[36:39], v0, s[28:29] offset:1024 sc1
    s_add_u32 s43, s43, 1
    s_cmp_gt_u32 s43, 400000
    s_cbranch_scc1 L_S_fail
    s_waitcnt vmcnt(0)
    v_max_u32 v13, v32, v36
    v_cmp_eq_u32 vcc, -1, v13
    s_cbranch_vccnz L_pollG_SW1
L_entry_SW1:
    ds_write_b128 v2, v[32:35] offset:2048
    ds_write_b128 v2, v[36:39] offset:3072
L_entry2_SW1:
    v_smfmac_f32_16x16x64_bf16 v[56:59], v[32:35], v[24:31], v15
    v_smfmac_f32_16x16x64_bf16 v[60:63], v[32:35], v[40:47], v15
    v_smfmac_f32_16x16x64_bf16 v[56:59], v[36:39], v[80:87], v15
    v_smfmac_f32_16x16x64_bf16 v[60:63], v[36:39], v[88:95], v15
    v_smfmac_f32_16x16x64_bf16 v[64:67], v[32:35], v[96:103], v15
    v_smfmac_f32_16x16x64_bf16 v[68:71], v[32:35], v[104:111], v15
    s_waitcnt vmcnt(0) lgkmcnt(0)
    s_barrier
    ds_read_b128 v[40:43], v2 offset:4096
    ds_read_b128 v[44:47], v2 offset:5120
    v_smfmac_f32_16x16x64_bf16 v[64:67], v[36:39], v[112:119], v15
    ds_read_b128 v[48:51], v2 offset:6144
    v_smfmac_f32_16x16x64_bf16 v[68:71], v[36:39], v[120:127], v15
    ds_read_b128 v[52:55], v2 offset:7168
    v_smfmac_f32_16x16x64_bf16 v[72:75], v[32:35], a[208:215], v15
    ds_read_b128 v[24:27], v2 offset:0
    v_smfmac_f32_16x16x64_bf16 v[76:79], v[32:35], v[144:151], v15
    ds_read_b128 v[28:31], v2 offset:1024
    v_smfmac_f32_16x16x64_bf16 v[72:75], v[36:39], a[216:223], v15
    s_mov_b32 m0, 155648
    v_mov_b32 v13, -1
    v_smfmac_f32_16x16x64_bf16 v[76:79], v[36:39], v[152:159], v15
    global_load_lds_dwordx4 v0, s[36:37] sc1
    s_waitcnt lgkmcnt(5)
    v_smfmac_f32_16x16x64_bf16 v[56:59], v[40:43], a[0:7], v15
    ds_read_b128 v[80:83], v2 offset:14336
    v_smfmac_f32_16x16x64_bf16 v[60:63], v[40:43], a[48:55], v15
    ds_read_b128 v[96:99], v2 offset:18432
    s_waitcnt lgkmcnt(6)
    v_smfmac_f32_16x16x64_bf16 v[56:59], v[44:47], a[8:15], v15
    ds_read_b128 v[84:87], v2 offset:15360
    v_smfmac_f32_16x16x64_bf16 v[60:63], v[44:47], a[56:63], v15
    ds_read_b128 v[100:103], v2 offset:19456
    s_waitcnt lgkmcnt(7)
    v_smfmac_f32_16x16x64_bf16 v[56:59], v[48:51], a[16:23], v15
    ds_read_b128 v[88:91], v2 offset:16384
    v_smfmac_f32_16x16x64_bf16 v[60:63], v[48:51], a[64:71], v15
    ds_read_b128 v[104:107], v2 offset:20480
    s_waitcnt lgkmcnt(8)
    v_smfmac_f32_16x16x64_bf16 v[56:59], v[52:55], a[24:31], v15
    ds_read_b128 v[92:95], v2 offset:17408
    v_smfmac_f32_16x16x64_bf16 v[60:63], v[52:55], a[72:79], v15
    ds_read_b128 v[108:111], v2 offset:21504
    s_waitcnt lgkmcnt(9)
    v_smfmac_f32_16x16x64_bf16 v[56:59], v[24:27], a[32:39], v15
    global_load_lds_dwordx4 v0, s[36:37] offset:1024 sc1
    v_smfmac_f32_16x16x64_bf16 v[60:63], v[24:27], a[80:87], v15
    global_store_dword v10, v13, s[32:33] sc1
    s_waitcnt lgkmcnt(8)
    v_smfmac_f32_16x16x64_bf16 v[56:59], v[28:31], a[40:47], v15
    buffer_load_dword v9, off, s[96:99], s76 sc1
    v_smfmac_f32_16x16x64_bf16 v[60:63], v[28:31], a[88:95], v15
    s_add_u32 s54, s36, 0x40000
    s_addc_u32 s55, s37, 0
    global_load_dword v13, v1, s[54:55] sc1
    v_smfmac_f32_16x16x64_bf16 v[64:67], v[40:43], a[96:103], v15
    v_smfmac_f32_16x16x64_bf16 v[68:71], v[40:43], a[144:151], v15
    s_nop 0
    v_add_f32 v56, v56, v58
    v_add_f32 v57, v57, v59
    v_smfmac_f32_16x16x64_bf16 v[64:67], v[44:47], a[104:111], v15
    v_add_f32 v60, v60, v62
    v_add_f32 v61, v61, v63
    v_cvt_pk_bf16_f32 v58, v56, v60
    v_cvt_pk_bf16_f32 v59, v57, v61
    ds_write_b32 v3, v58
    ds_write_b32 v4, v59
    v_smfmac_f32_16x16x64_bf16 v[68:71], v[44:47], a[152:159], v15
    s_mov_b32 m0, 147456
    v_smfmac_f32_16x16x64_bf16 v[64:67], v[48:51], a[112:119], v15
    v_smfmac_f32_16x16x64_bf16 v[68:71], v[48:51], a[160:167], v15
    v_smfmac_f32_16x16x64_bf16 v[64:67], v[52:55], a[120:127], v15
    v_smfmac_f32_16x16x64_bf16 v[68:71], v[52:55], a[168:175], v15
    v_smfmac_f32_16x16x64_bf16 v[64:67], v[24:27], a[128:135], v15
    s_waitcnt lgkmcnt(0)
    s_barrier
    ds_read_b128 v[112:115], v5 offset:0
    v_smfmac_f32_16x16x64_bf16 v[68:71], v[24:27], a[176:183], v15
    ds_read_b128 v[116:119], v5 offset:1024
    v_smfmac_f32_16x16x64_bf16 v[64:67], v[28:31], a[136:143], v15
    ds_read_b128 v[120:123], v5 offset:2048
    v_smfmac_f32_16x16x64_bf16 v[68:71], v[28:31], a[184:191], v15
    ds_read_b128 v[124:127], v5 offset:3072
    v_smfmac_f32_16x16x64_bf16 v[72:75], v[40:43], a[224:231], v15
    global_load_lds_dwordx4 v0, s[34:35] sc1
    v_smfmac_f32_16x16x64_bf16 v[76:79], v[40:43], v[160:167], v15
    global_load_lds_dwordx4 v0, s[34:35] offset:1024 sc1
    s_nop 0
    v_add_f32 v64, v64, v66
    v_add_f32 v65, v65, v67
    v_add_f32 v68, v68, v70
    v_add_f32 v69, v69, v71
    v_cvt_pk_bf16_f32 v66, v64, v68
    v_cvt_pk_bf16_f32 v67, v65, v69
    s_waitcnt lgkmcnt(0)
    ds_write_b32 v3, v66 offset:128
    ds_write_b32 v4, v67 offset:128
    v_mfma_f32_16x16x32_bf16 v[56:59], v[80:83], v[112:115], 0
    v_mfma_f32_16x16x32_bf16 v[60:63], v[96:99], v[112:115], 0
    v_mfma_f32_16x16x32_bf16 v[56:59], v[84:87], v[116:119], v[56:59]
    v_mfma_f32_16x16x32_bf16 v[60:63], v[100:103], v[116:119], v[60:63]
    v_mfma_f32_16x16x32_bf16 v[56:59], v[88:91], v[120:123], v[56:59]
    v_mfma_f32_16x16x32_bf16 v[60:63], v[104:107], v[120:123], v[60:63]
    v_mfma_f32_16x16x32_bf16 v[56:59], v[92:95], v[124:127], v[56:59]
    v_mfma_f32_16x16x32_bf16 v[60:63], v[108:111], v[124:127], v[60:63]
    s_waitcnt vmcnt(5) lgkmcnt(0)
    s_barrier
    ds_read_b128 v[80:83], v6 offset:0
    ds_read_b128 v[84:87], v6 offset:1024
    v_smfmac_f32_16x16x64_bf16 v[72:75], v[44:47], a[232:239], v15
    ds_read_b128 v[88:91], v6 offset:2048
    v_smfmac_f32_16x16x64_bf16 v[76:79], v[44:47], v[168:175], v15
    ds_read_b128 v[92:95], v6 offset:3072
    v_smfmac_f32_16x16x64_bf16 v[72:75], v[48:51], a[240:247], v15
    ds_read_b128 v[104:107], v2 offset:24576
    v_smfmac_f32_16x16x64_bf16 v[76:79], v[48:51], v[176:183], v15
    ds_read_b128 v[108:111], v2 offset:25600
    v_smfmac_f32_16x16x64_bf16 v[72:75], v[52:55], a[248:255], v15
    s_waitcnt lgkmcnt(5)
    v_mfma_f32_16x16x32_bf16 v[64:67], v[80:83], v[112:115], 0
    s_waitcnt lgkmcnt(4)
    v_mfma_f32_16x16x32_bf16 v[64:67], v[84:87], v[116:119], v[64:67]
    s_waitcnt lgkmcnt(3)
    v_mfma_f32_16x16x32_bf16 v[64:67], v[88:91], v[120:123], v[64:67]
    s_waitcnt lgkmcnt(2)
    v_mfma_f32_16x16x32_bf16 v[64:67], v[92:95], v[124:127], v[64:67]
    v_smfmac_f32_16x16x64_bf16 v[76:79], v[52:55], v[184:191], v15
    global_store_dwordx4 v11, v[84:87], s[38:39] sc1
    v_smfmac_f32_16x16x64_bf16 v[72:75], v[24:27], a[192:199], v15
    v_smfmac_f32_16x16x64_bf16 v[76:79], v[24:27], v[128:135], v15
    v_smfmac_f32_16x16x64_bf16 v[72:75], v[28:31], a[200:207], v15
    v_smfmac_f32_16x16x64_bf16 v[76:79], v[28:31], v[136:143], v15
    v_max3_f32 v68, v56, v57, v58
    v_max3_f32 v68, v68, v59, v60
    v_max3_f32 v68, v68, v61, v62
    v_max3_f32 v68, v68, v63, v64
    v_max_f32 v68, v68, v65
    v_mov_b32 v69, v68
    ds_read_b128 v[24:27], v14 offset:16384
    ds_read_b128 v[28:31], v14 offset:17408
    v_permlane32_swap_b32 v68, v69
    v_max_f32 v68, v68, v69
    v_mov_b32 v69, v68
    ds_read_b128 v[32:35], v14 offset:18432
    ds_read_b128 v[36:39], v14 offset:19456
    v_permlane16_swap_b32 v68, v69
    v_max_f32 v68, v68, v69
    v_mul_f32 v68, s44, v68
    v_pk_fma_f32 v[56:57], v[56:57], s[44:45], v[68:69] op_sel_hi:[1,0,0] neg_lo:[0,0,1] neg_hi:[0,0,1]
    v_pk_fma_f32 v[58:59], v[58:59], s[44:45], v[68:69] op_sel_hi:[1,0,0] neg_lo:[0,0,1] neg_hi:[0,0,1]
    v_pk_fma_f32 v[60:61], v[60:61], s[44:45], v[68:69] op_sel_hi:[1,0,0] neg_lo:[0,0,1] neg_hi:[0,0,1]
    v_pk_fma_f32 v[62:63], v[62:63], s[44:45], v[68:69] op_sel_hi:[1,0,0] neg_lo:[0,0,1] neg_hi:[0,0,1]
    v_pk_fma_f32 v[64:65], v[64:65], s[44:45], v[68:69] op_sel_hi:[1,0,0] neg_lo:[0,0,1] neg_hi:[0,0,1]
    v_exp_f32 v56, v56
    v_exp_f32 v57, v57
    v_exp_f32 v58, v58
    v_exp_f32 v59, v59
    v_exp_f32 v60, v60
    v_exp_f32 v61, v61
    v_exp_f32 v62, v62
    v_exp_f32 v63, v63
    v_exp_f32 v64, v64
    v_exp_f32 v65, v65
    v_cvt_pk_bf16_f32 v96, v56, v57
    v_cvt_pk_bf16_f32 v97, v58, v59
    v_cvt_pk_bf16_f32 v98, v60, v61
    v_cvt_pk_bf16_f32 v99, v62, v63
    v_cvt_pk_bf16_f32 v100, v64, v65
    v_mov_b32 v101, 0
    s_waitcnt lgkmcnt(4)
    v_mfma_f32_16x16x32_bf16 v[88:91], v[20:23], v[96:99], 0
    v_add_f32 v72, v72, v74
    v_add_f32 v73, v73, v75
    v_mfma_f32_16x16x32_bf16 v[80:83], v[104:107], v[96:99], 0
    v_add_f32 v76, v76, v78
    v_add_f32 v77, v77, v79
    v_mfma_f32_16x16x32_bf16 v[84:87], v[108:111], v[96:99], 0
    v_cvt_pk_bf16_f32 v112, v72, v73
    v_cvt_pk_bf16_f32 v114, v76, v77
    v_mov_b32 v113, 0
    v_mov_b32 v115, 0
    v_mfma_f32_16x16x16_bf16 v[88:91], v[20:21], v[100:101], v[88:91]
    ds_read_b128 v[40:43], v14 offset:20480
    ds_read_b128 v[44:47], v14 offset:21504
    v_mfma_f32_16x16x16_bf16 v[80:83], v[112:113], v[100:101], v[80:83]
    ds_read_b128 v[48:51], v14 offset:22528
    ds_read_b128 v[52:55], v14 offset:23552
    v_mfma_f32_16x16x16_bf16 v[84:87], v[114:115], v[100:101], v[84:87]
    ds_read_b128 v[56:59], v14 offset:24576
    ds_read_b128 v[60:63], v14 offset:25600
    global_store_dword v12, v112, s[40:41] sc1
    global_store_dword v12, v114, s[40:41] offset:256 sc1
    s_cmp_eq_u32 s20, 63
    s_cbranch_scc1 L_last_SW1
    v_rcp_f32 v92, v88
    ds_read_b128 v[64:67], v14 offset:26624
    ds_read_b128 v[68:71], v14 offset:27648
    v_pk_mul_f32 v[80:81], v[80:81], v[92:93] op_sel_hi:[1,0]
    v_pk_mul_f32 v[82:83], v[82:83], v[92:93] op_sel_hi:[1,0]
    v_pk_mul_f32 v[84:85], v[84:85], v[92:93] op_sel_hi:[1,0]
    v_pk_mul_f32 v[86:87], v[86:87], v[92:93] op_sel_hi:[1,0]
    v_cvt_pk_bf16_f32 v120, v80, v81
    v_cvt_pk_bf16_f32 v121, v82, v83
    v_cvt_pk_bf16_f32 v122, v84, v85
    v_cvt_pk_bf16_f32 v123, v86, v87
    ds_write_b128 v7, v[120:123]
    ds_read_b128 v[72:75], v14 offset:28672
    ds_read_b128 v[76:79], v14 offset:29696
    v_mov_b64 v[80:81], 0
    v_mov_b64 v[82:83], 0
    v_mov_b64 v[84:85], 0
    v_mov_b64 v[86:87], 0
    v_mov_b64 v[88:89], 0
    v_mov_b64 v[90:91], 0
    v_mov_b64 v[92:93], 0
    v_mov_b64 v[94:95], 0
    v_mov_b64 v[96:97], 0
    v_mov_b64 v[98:99], 0
    v_mov_b64 v[100:101], 0
    v_mov_b64 v[102:103], 0
    v_mov_b64 v[104:105], 0
    v_mov_b64 v[106:107], 0
    v_mov_b64 v[108:109], 0
    v_mov_b64 v[110:111], 0
    s_waitcnt lgkmcnt(0)
    s_barrier
    ds_read_b128 v[112:115], v2 offset:12288
    ds_read_b128 v[116:119], v2 offset:13312
    s_add_u32 s34, s34, 0x40000
    s_addc_u32 s35, s35, 0
    s_add_u32 s36, s36, 0x40000
    s_addc_u32 s37, s37, 0
    s_add_u32 s38, s38, 0x10000
    s_addc_u32 s39, s39, 0
    s_add_u32 s40, s40, 0x10000
    s_addc_u32 s41, s41, 0
    s_waitcnt lgkmcnt(0)
    v_smfmac_f32_16x16x64_bf16 v[80:83], v[112:115], v[192:199], v15
    v_smfmac_f32_16x16x64_bf16 v[80:83], v[116:119], v[24:31], v15
    ds_read_b128 v[24:27], v14 offset:30720
    ds_read_b128 v[28:31], v14 offset:31744
    v_smfmac_f32_16x16x64_bf16 v[84:87], v[112:115], v[200:207], v15
    v_smfmac_f32_16x16x64_bf16 v[84:87], v[116:119], v[32:39], v15
    v_smfmac_f32_16x16x64_bf16 v[88:91], v[112:115], v[208:215], v15
    v_add_f32 v80, v80, v82
    v_smfmac_f32_16x16x64_bf16 v[88:91], v[116:119], v[40:47], v15
    v_add_f32 v81, v81, v83
    v_cvt_pk_bf16_f32 v120, v80, v81
    v_smfmac_f32_16x16x64_bf16 v[92:95], v[112:115], v[216:223], v15
    v_add_f32 v84, v84, v86
    v_smfmac_f32_16x16x64_bf16 v[92:95], v[116:119], v[48:55], v15
    v_add_f32 v85, v85, v87
    v_cvt_pk_bf16_f32 v121, v84, v85
    v_smfmac_f32_16x16x64_bf16 v[96:99], v[112:115], v[224:231], v15
    v_add_f32 v88, v88, v90
    v_smfmac_f32_16x16x64_bf16 v[96:99], v[116:119], v[56:63], v15
    v_add_f32 v89, v89, v91
    v_cvt_pk_bf16_f32 v122, v88, v89
    v_smfmac_f32_16x16x64_bf16 v[100:103], v[112:115], v[232:239], v15
    v_add_f32 v92, v92, v94
    v_smfmac_f32_16x16x64_bf16 v[100:103], v[116:119], v[64:71], v15
    v_add_f32 v93, v93, v95
    v_cvt_pk_bf16_f32 v123, v92, v93
    v_smfmac_f32_16x16x64_bf16 v[104:107], v[112:115], v[240:247], v15
    v_add_f32 v96, v96, v98
    v_and_or_b32 v120, v120, -2, s42
    global_store_dwordx4 v8, v[120:123], s[22:23] sc1
    v_smfmac_f32_16x16x64_bf16 v[104:107], v[116:119], v[72:79], v15
    v_add_f32 v97, v97, v99
    v_cvt_pk_bf16_f32 v124, v96, v97
    v_smfmac_f32_16x16x64_bf16 v[108:111], v[112:115], v[248:255], v15
    v_add_f32 v100, v100, v102
    s_waitcnt lgkmcnt(0)
    v_smfmac_f32_16x16x64_bf16 v[108:111], v[116:119], v[24:31], v15
    v_add_f32 v101, v101, v103
    v_cvt_pk_bf16_f32 v125, v100, v101
    s_nop 1
    v_add_f32 v104, v104, v106
    v_add_f32 v105, v105, v107
    v_cvt_pk_bf16_f32 v126, v104, v105
    s_nop 2
    v_add_f32 v108, v108, v110
    v_add_f32 v109, v109, v111
    v_cvt_pk_bf16_f32 v127, v108, v109
    v_and_or_b32 v124, v124, -2, s42
    global_store_dwordx4 v8, v[124:127], s[24:25] sc1
    ds_read_b128 v[24:27], v14 offset:0
    ds_read_b128 v[28:31], v14 offset:1024
    ds_read_b128 v[40:43], v14 offset:2048
    ds_read_b128 v[44:47], v14 offset:3072
    ds_read_b128 v[80:83], v14 offset:4096
    ds_read_b128 v[84:87], v14 offset:5120
    ds_read_b128 v[88:91], v14 offset:6144
    ds_read_b128 v[92:95], v14 offset:7168
    ds_read_b128 v[96:99], v14 offset:8192
    ds_read_b128 v[100:103], v14 offset:9216
    ds_read_b128 v[104:107], v14 offset:10240
    ds_read_b128 v[108:111], v14 offset:11264
    ds_read_b128 v[112:115], v14 offset:12288
    ds_read_b128 v[116:119], v14 offset:13312
    ds_read_b128 v[120:123], v14 offset:14336
    ds_read_b128 v[124:127], v14 offset:15360
    s_nop 15
    global_load_dwordx4 v[56:59], v0, s[26:27] sc1
    global_load_dwordx4 v[60:63], v0, s[26:27] offset:1024 sc1
    s_add_u32 s20, s20, 1
    s_mov_b32 s32, s28
    s_mov_b32 s33, s29
    s_sub_u32 s32, s32, 2048
    s_subb_u32 s33, s33, 0
    s_add_u32 s28, s30, 0x800
    s_addc_u32 s29, s31, 0
    s_nop 15
    s_nop 15
    global_load_dwordx4 v[68:71], v0, s[26:27] sc1
    global_load_dwordx4 v[72:75], v0, s[26:27] offset:1024 sc1
    s_waitcnt vmcnt(2)
    v_mfma_f32_16x16x32_bf16 v[64:67], v[16:19], v[56:59], 0
    v_bitop3_b32 v13, v56, v60, s42 bitop3:0x7e
    v_mfma_f32_16x16x32_bf16 v[64:67], v[16:19], v[60:63], v[64:67]
    v_and_b32 v13, 1, v13
    v_cmp_ne_u32 vcc, 0, v13
    s_cbranch_vccz L_okR_SW1
    s_waitcnt vmcnt(0)
    v_mfma_f32_16x16x32_bf16 v[64:67], v[16:19], v[68:71], 0
    v_bitop3_b32 v13, v68, v72, s42 bitop3:0x7e
    v_mfma_f32_16x16x32_bf16 v[64:67], v[16:19], v[72:75], v[64:67]
    v_and_b32 v13, 1, v13
    v_cmp_ne_u32 vcc, 0, v13
    s_cbranch_vccz L_okR_SW1
L_pollR_SW1:
    global_load_dwordx4 v[56:59], v0, s[26:27] sc1
    global_load_dwordx4 v[60:63], v0, s[26:27] offset:1024 sc1
    s_add_u32 s43, s43, 1
    s_cmp_gt_u32 s43, 400000
    s_cbranch_scc1 L_S_fail
L_chkR_SW1:
    s_waitcnt vmcnt(0)
    v_mfma_f32_16x16x32_bf16 v[64:67], v[16:19], v[56:59], 0
    v_bitop3_b32 v13, v56, v60, s42 bitop3:0x7e
    v_mfma_f32_16x16x32_bf16 v[64:67], v[16:19], v[60:63], v[64:67]
    v_and_b32 v13, 1, v13
    v_cmp_ne_u32 vcc, 0, v13
    s_cbranch_vccnz L_pollR_SW1
L_okR_SW1:
    s_nop 4
    v_add_f32_dpp v64, v64, v64 row_ror:8 row_mask:0xf bank_mask:0x3
    v_add_f32_dpp v65, v65, v65 row_ror:8 row_mask:0xf bank_mask:0x3
    v_add_f32_dpp v64, v66, v66 row_ror:8 row_mask:0xf bank_mask:0xc
    v_add_f32_dpp v65, v67, v67 row_ror:8 row_mask:0xf bank_mask:0xc
    s_nop 0
    v_add_f32_dpp v64, v64, v64 row_shl:4 row_mask:0xf bank_mask:0x5
    v_add_f32_dpp v64, v65, v65 row_shr:4 row_mask:0xf bank_mask:0xa
    s_nop 1
    v_mov_b32_dpp v65, v64 row_ror:8 row_mask:0xf bank_mask:0xf
    v_cvt_pk_bf16_f32 v64, v64, v65
    v_min_u32 v64, -2, v64
    global_store_dword v10, v64, s[30:31] sc1
    v_readfirstlane_b32 s55, v9
    s_add_u32 s52, s20, 1
    s_and_b32 s52, s52, 3
    s_lshl_b32 s52, s52, 13
    s_add_u32 s52, s52, 0x80000
    s_add_u32 s30, s14, s52
    s_addc_u32 s31, s15, 0
    s_and_b32 s52, s20, 1
    s_lshl_b32 s52, s52, 18
    s_add_u32 s22, s14, s52
    s_addc_u32 s23, s15, 0
    s_add_u32 s24, s22, 0x8000
    s_addc_u32 s25, s23, 0
    s_lshl_b32 s52, s18, 13
    s_add_u32 s52, s52, 2048
    s_add_u32 s26, s22, s52
    s_addc_u32 s27, s23, 0
    s_bfe_u32 s42, s20, 0x10001
    s_mov_b32 s43, 0
    s_add_u32 s76, s76, 128
    s_add_u32 s77, s77, 128
    s_cmp_lg_u32 s55, 0
    s_cbranch_scc1 L_kvok_SW1
    s_add_u32 s52, s20, 1
    s_cmp_lt_u32 s52, 64
    s_cbranch_scc0 L_kvok_SW1
    s_sub_u32 s52, s76, 128
L_kvspin_SW1:
    buffer_load_dword v9, off, s[96:99], s52 sc1
    s_add_u32 s43, s43, 1
    s_cmp_gt_u32 s43, 400000
    s_cbranch_scc1 L_S_fail
    s_waitcnt vmcnt(0)
    v_readfirstlane_b32 s55, v9
    s_nop 3
    s_cmp_lg_u32 s55, 0
    s_cbranch_scc0 L_kvspin_SW1
    s_mov_b32 s43, 0
L_kvok_SW1:
    s_nop 15
    s_nop 15
    global_load_dwordx4 v[32:35], v0, s[28:29] sc1
    global_load_dwordx4 v[36:39], v0, s[28:29] offset:1024 sc1
    s_waitcnt vmcnt(3)
    v_mov_b64 v[56:57], 0
    v_mov_b64 v[58:59], 0
    v_mov_b64 v[60:61], 0
    v_mov_b64 v[62:63], 0
    v_mov_b64 v[64:65], 0
    v_mov_b64 v[66:67], 0
    v_mov_b64 v[68:69], 0
    v_mov_b64 v[70:71], 0
    v_mov_b64 v[72:73], 0
    v_mov_b64 v[74:75], 0
    v_mov_b64 v[76:77], 0
    v_mov_b64 v[78:79], 0
    s_waitcnt lgkmcnt(0)
    s_nop 15
    s_nop 7
    global_load_dwordx4 v[48:51], v0, s[28:29] sc1
    global_load_dwordx4 v[52:55], v0, s[28:29] offset:1024 sc1
    s_waitcnt vmcnt(2)
    v_max_u32 v13, v32, v36
    v_cmp_eq_u32 vcc, -1, v13
    s_cbranch_vccz L_entry_SW1
    s_waitcnt vmcnt(0)
    v_max_u32 v13, v48, v52
    v_cmp_eq_u32 vcc, -1, v13
    s_cbranch_vccnz L_pollG_SW1
    ds_write_b128 v2, v[48:51] offset:2048
    ds_write_b128 v2, v[52:55] offset:3072
    v_mov_b64 v[32:33], v[48:49]
    v_mov_b64 v[34:35], v[50:51]
    v_mov_b64 v[36:37], v[52:53]
    v_mov_b64 v[38:39], v[54:55]
    s_nop 0
    s_branch L_entry2_SW1
L_last_SW1:
    s_waitcnt vmcnt(0)
    s_barrier
    s_branch L_S_done
L_c_start_S2:
    s_and_b32 s52, s20, 1
    s_lshl_b32 s52, s52, 18
    s_add_u32 s22, s14, s52
    s_addc_u32 s23, s15, 0
    s_add_u32 s24, s22, 0x8000
    s_addc_u32 s25, s23, 0
    s_lshl_b32 s52, s18, 13
    s_add_u32 s52, s52, 4096
    s_add_u32 s26, s22, s52
    s_addc_u32 s27, s23, 0
    v_mov_b32 v40, v116
    v_mov_b32 v44, v120
    v_mov_b32 v41, v117
    v_mov_b32 v45, v121
    v_mov_b32 v42, v118
    v_mov_b32 v46, v122
    v_mov_b32 v43, v119
    v_mov_b32 v47, v123
    ds_read_b128 v[24:27], v14 offset:0
    ds_read_b128 v[28:31], v14 offset:1024
    ds_read_b128 v[32:35], v14 offset:2048
    ds_read_b128 v[36:39], v14 offset:3072
    ds_read_b128 v[80:83], v14 offset:4096
    ds_read_b128 v[84:87], v14 offset:5120
    ds_read_b128 v[88:91], v14 offset:6144
    ds_read_b128 v[92:95], v14 offset:7168
    ds_read_b128 v[96:99], v14 offset:8192
    ds_read_b128 v[100:103], v14 offset:9216
    ds_read_b128 v[104:107], v14 offset:10240
    ds_read_b128 v[108:111], v14 offset:11264
    ds_read_b128 v[112:115], v14 offset:12288
    ds_read_b128 v[116:119], v14 offset:13312
    ds_read_b128 v[120:123], v14 offset:14336
    ds_read_b128 v[124:127], v14 offset:15360
    v_mov_b64 v[56:57], 0
    v_mov_b64 v[58:59], 0
    v_mov_b64 v[60:61], 0
    v_mov_b64 v[62:63], 0
    v_mov_b64 v[64:65], 0
    v_mov_b64 v[66:67], 0
    v_mov_b64 v[68:69], 0
    v_mov_b64 v[70:71], 0
    v_mov_b64 v[72:73], 0
    v_mov_b64 v[74:75], 0
    v_mov_b64 v[76:77], 0
    v_mov_b64 v[78:79], 0
    s_waitcnt vmcnt(0) lgkmcnt(0)
    s_branch L_entry_SW2
L_pollG_SW2:
    global_load_dwordx4 v[40:43], v0, s[28:29] sc1
    global_load_dwordx4 v[44:47], v0, s[28:29] offset:1024 sc1
    s_add_u32 s43, s43, 1
    s_cmp_gt_u32 s43, 400000
    s_cbranch_scc1 L_S_fail
    s_waitcnt vmcnt(0)
    v_max_u32 v13, v40, v44
    v_cmp_eq_u32 vcc, -1, v13
    s_cbranch_vccnz L_pollG_SW2
L_entry_SW2:
    ds_write_b128 v2, v[40:43] offset:4096
    ds_write_b128 v2, v[44:47] offset:5120
L_entry2_SW2:
    v_smfmac_f32_16x16x64_bf16 v[56:59], v[40:43], v[24:31], v15
    v_smfmac_f32_16x16x64_bf16 v[60:63], v[40:43], v[32:39], v15
    v_smfmac_f32_16x16x64_bf16 v[56:59], v[44:47], v[80:87], v15
    v_smfmac_f32_16x16x64_bf16 v[60:63], v[44:47], v[88:95], v15
    v_smfmac_f32_16x16x64_bf16 v[64:67], v[40:43], v[96:103], v15
    v_smfmac_f32_16x16x64_bf16 v[68:71], v[40:43], v[104:111], v15
    s_waitcnt vmcnt(0) lgkmcnt(0)
    s_barrier
    ds_read_b128 v[48:51], v2 offset:6144
    ds_read_b128 v[52:55], v2 offset:7168
    v_smfmac_f32_16x16x64_bf16 v[64:67], v[44:47], v[112:119], v15
    ds_read_b128 v[24:27], v2 offset:0
    v_smfmac_f32_16x16x64_bf16 v[68:71], v[44:47], v[120:127], v15
    ds_read_b128 v[28:31], v2 offset:1024
    v_smfmac_f32_16x16x64_bf16 v[72:75], v[40:43], a[224:231], v15
    ds_read_b128 v[32:35], v2 offset:2048
    v_smfmac_f32_16x16x64_bf16 v[76:79], v[40:43], v[160:167], v15
    ds_read_b128 v[36:39], v2 offset:3072
    v_smfmac_f32_16x16x64_bf16 v[72:75], v[44:47], a[232:239], v15
    s_mov_b32 m0, 157696
    v_mov_b32 v13, -1
    v_smfmac_f32_16x16x64_bf16 v[76:79], v[44:47], v[168:175], v15
    global_load_lds_dwordx4 v0, s[36:37] sc1
    s_waitcnt lgkmcnt(5)
    v_smfmac_f32_16x16x64_bf16 v[56:59], v[48:51], a[0:7], v15
    ds_read_b128 v[80:83], v2 offset:14336
    v_smfmac_f32_16x16x64_bf16 v[60:63], v[48:51], a[48:55], v15
    ds_read_b128 v[96:99], v2 offset:18432
    s_waitcnt lgkmcnt(6)
    v_smfmac_f32_16x16x64_bf16 v[56:59], v[52:55], a[8:15], v15
    ds_read_b128 v[84:87], v2 offset:15360
    v_smfmac_f32_16x16x64_bf16 v[60:63], v[52:55], a[56:63], v15
    ds_read_b128 v[100:103], v2 offset:19456
    s_waitcnt lgkmcnt(7)
    v_smfmac_f32_16x16x64_bf16 v[56:59], v[24:27], a[16:23], v15
    ds_read_b128 v[88:91], v2 offset:16384
    v_smfmac_f32_16x16x64_bf16 v[60:63], v[24:27], a[64:71], v15
    ds_read_b128 v[104:107], v2 offset:20480
    s_waitcnt lgkmcnt(8)
    v_smfmac_f32_16x16x64_bf16 v[56:59], v[28:31], a[24:31], v15
    ds_read_b128 v[92:95], v2 offset:17408
    v_smfmac_f32_16x16x64_bf16 v[60:63], v[28:31], a[72:79], v15
    ds_read_b128 v[108:111], v2 offset:21504
    s_waitcnt lgkmcnt(9)
    v_smfmac_f32_16x16x64_bf16 v[56:59], v[32:35], a[32:39], v15
    global_load_lds_dwordx4 v0, s[36:37] offset:1024 sc1
    v_smfmac_f32_16x16x64_bf16 v[60:63], v[32:35], a[80:87], v15
    global_store_dword v10, v13, s[32:33] sc1
    s_waitcnt lgkmcnt(8)
    v_smfmac_f32_16x16x64_bf16 v[56:59], v[36:39], a[40:47], v15
    buffer_load_dword v9, off, s[96:99], s76 sc1
    v_smfmac_f32_16x16x64_bf16 v[60:63], v[36:39], a[88:95], v15
    s_add_u32 s54, s36, 0x40000
    s_addc_u32 s55, s37, 0
    global_load_dword v13, v1, s[54:55] sc1
    v_smfmac_f32_16x16x64_bf16 v[64:67], v[48:51], a[96:103], v15
    v_smfmac_f32_16x16x64_bf16 v[68:71], v[48:51], a[144:151], v15
    s_nop 0
    v_add_f32 v56, v56, v58
    v_add_f32 v57, v57, v59
    v_smfmac_f32_16x16x64_bf16 v[64:67], v[52:55], a[104:111], v15
    v_add_f32 v60, v60, v62
    v_add_f32 v61, v61, v63
    v_cvt_pk_bf16_f32 v58, v56, v60
    v_cvt_pk_bf16_f32 v59, v57, v61
    ds_write_b32 v3, v58
    ds_write_b32 v4, v59
    v_smfmac_f32_16x16x64_bf16 v[68:71], v[52:55], a[152:159], v15
    s_mov_b32 m0, 149504
    v_smfmac_f32_16x16x64_bf16 v[64:67], v[24:27], a[112:119], v15
    v_smfmac_f32_16x16x64_bf16 v[68:71], v[24:27], a[160:167], v15
    v_smfmac_f32_16x16x64_bf16 v[64:67], v[28:31], a[120:127], v15
    v_smfmac_f32_16x16x64_bf16 v[68:71], v[28:31], a[168:175], v15
    v_smfmac_f32_16x16x64_bf16 v[64:67], v[32:35], a[128:135], v15
    s_waitcnt lgkmcnt(0)
    s_barrier
    ds_read_b128 v[112:115], v5 offset:0
    v_smfmac_f32_16x16x64_bf16 v[68:71], v[32:35], a[176:183], v15
    ds_read_b128 v[116:119], v5 offset:1024
    v_smfmac_f32_16x16x64_bf16 v[64:67], v[36:39], a[136:143], v15
    ds_read_b128 v[120:123], v5 offset:2048
    v_smfmac_f32_16x16x64_bf16 v[68:71], v[36:39], a[184:191], v15
    ds_read_b128 v[124:127], v5 offset:3072
    v_smfmac_f32_16x16x64_bf16 v[72:75], v[48:51], a[240:247], v15
    global_load_lds_dwordx4 v0, s[34:35] sc1
    v_smfmac_f32_16x16x64_bf16 v[76:79], v[48:51], v[176:183], v15
    global_load_lds_dwordx4 v0, s[34:35] offset:1024 sc1
    s_nop 0
    v_add_f32 v64, v64, v66
    v_add_f32 v65, v65, v67
    v_add_f32 v68, v68, v70
    v_add_f32 v69, v69, v71
    v_cvt_pk_bf16_f32 v66, v64, v68
    v_cvt_pk_bf16_f32 v67, v65, v69
    s_waitcnt lgkmcnt(0)
    ds_write_b32 v3, v66 offset:128
    ds_write_b32 v4, v67 offset:128
    v_mfma_f32_16x16x32_bf16 v[56:59], v[80:83], v[112:115], 0
    v_mfma_f32_16x16x32_bf16 v[60:63], v[96:99], v[112:115], 0
    v_mfma_f32_16x16x32_bf16 v[56:59], v[84:87], v[116:119], v[56:59]
    v_mfma_f32_16x16x32_bf16 v[60:63], v[100:103], v[116:119], v[60:63]
    v_mfma_f32_16x16x32_bf16 v[56:59], v[88:91], v[120:123], v[56:59]
    v_mfma_f32_16x16x32_bf16 v[60:63], v[104:107], v[120:123], v[60:63]
    v_mfma_f32_16x16x32_bf16 v[56:59], v[92:95], v[124:127], v[56:59]
    v_mfma_f32_16x16x32_bf16 v[60:63], v[108:111], v[124:127], v[60:63]
    s_waitcnt vmcnt(5) lgkmcnt(0)
    s_barrier
    ds_read_b128 v[80:83], v6 offset:0
    ds_read_b128 v[84:87], v6 offset:1024
    v_smfmac_f32_16x16x64_bf16 v[72:75], v[52:55], a[248:255], v15
    ds_read_b128 v[88:91], v6 offset:2048
    v_smfmac_f32_16x16x64_bf16 v[76:79], v[52:55], v[184:191], v15
    ds_read_b128 v[92:95], v6 offset:3072
    v_smfmac_f32_16x16x64_bf16 v[72:75], v[24:27], a[192:199], v15
    ds_read_b128 v[104:107], v2 offset:26624
    v_smfmac_f32_16x16x64_bf16 v[76:79], v[24:27], v[128:135], v15
    ds_read_b128 v[108:111], v2 offset:27648
    v_smfmac_f32_16x16x64_bf16 v[72:75], v[28:31], a[200:207], v15
    s_waitcnt lgkmcnt(5)
    v_mfma_f32_16x16x32_bf16 v[64:67], v[80:83], v[112:115], 0
    s_waitcnt lgkmcnt(4)
    v_mfma_f32_16x16x32_bf16 v[64:67], v[84:87], v[116:119], v[64:67]
    s_waitcnt lgkmcnt(3)
    v_mfma_f32_16x16x32_bf16 v[64:67], v[88:91], v[120:123], v[64:67]
    s_waitcnt lgkmcnt(2)
    v_mfma_f32_16x16x32_bf16 v[64:67], v[92:95], v[124:127], v[64:67]
    v_smfmac_f32_16x16x64_bf16 v[76:79], v[28:31], v[136:143], v15
    global_store_dwordx4 v11, v[88:91], s[38:39] sc1
    v_smfmac_f32_16x16x64_bf16 v[72:75], v[32:35], a[208:215], v15
    v_smfmac_f32_16x16x64_bf16 v[76:79], v[32:35], v[144:151], v15
    v_smfmac_f32_16x16x64_bf16 v[72:75], v[36:39], a[216:223], v15
    v_smfmac_f32_16x16x64_bf16 v[76:79], v[36:39], v[152:159], v15
    v_max3_f32 v68, v56, v57, v58
    v_max3_f32 v68, v68, v59, v60
    v_max3_f32 v68, v68, v61, v62
    v_max3_f32 v68, v68, v63, v64
    v_max_f32 v68, v68, v65
    v_mov_b32 v69, v68
    ds_read_b128 v[24:27], v14 offset:16384
    ds_read_b128 v[28:31], v14 offset:17408
    v_permlane32_swap_b32 v68, v69
    v_max_f32 v68, v68, v69
    v_mov_b32 v69, v68
    ds_read_b128 v[32:35], v14 offset:18432
    ds_read_b128 v[36:39], v14 offset:19456
    v_permlane16_swap_b32 v68, v69
    v_max_f32 v68, v68, v69
    v_mul_f32 v68, s44, v68
    v_pk_fma_f32 v[56:57], v[56:57], s[44:45], v[68:69] op_sel_hi:[1,0,0] neg_lo:[0,0,1] neg_hi:[0,0,1]
    v_pk_fma_f32 v[58:59], v[58:59], s[44:45], v[68:69] op_sel_hi:[1,0,0] neg_lo:[0,0,1] neg_hi:[0,0,1]
    v_pk_fma_f32 v[60:61], v[60:61], s[44:45], v[68:69] op_sel_hi:[1,0,0] neg_lo:[0,0,1] neg_hi:[0,0,1]
    v_pk_fma_f32 v[62:63], v[62:63], s[44:45], v[68:69] op_sel_hi:[1,0,0] neg_lo:[0,0,1] neg_hi:[0,0,1]
    v_pk_fma_f32 v[64:65], v[64:65], s[44:45], v[68:69] op_sel_hi:[1,0,0] neg_lo:[0,0,1] neg_hi:[0,0,1]
    v_exp_f32 v56, v56
    v_exp_f32 v57, v57
    v_exp_f32 v58, v58
    v_exp_f32 v59, v59
    v_exp_f32 v60, v60
    v_exp_f32 v61, v61
    v_exp_f32 v62, v62
    v_exp_f32 v63, v63
    v_exp_f32 v64, v64
    v_exp_f32 v65, v65
    v_cvt_pk_bf16_f32 v96, v56, v57
    v_cvt_pk_bf16_f32 v97, v58, v59
    v_cvt_pk_bf16_f32 v98, v60, v61
    v_cvt_pk_bf16_f32 v99, v62, v63
    v_cvt_pk_bf16_f32 v100, v64, v65
    v_mov_b32 v101, 0
    s_waitcnt lgkmcnt(4)
    v_mfma_f32_16x16x32_bf16 v[88:91], v[20:23], v[96:99], 0
    v_add_f32 v72, v72, v74
    v_add_f32 v73, v73, v75
    v_mfma_f32_16x16x32_bf16 v[80:83], v[104:107], v[96:99], 0
    v_add_f32 v76, v76, v78
    v_add_f32 v77, v77, v79
    v_mfma_f32_16x16x32_bf16 v[84:87], v[108:111], v[96:99], 0
    v_cvt_pk_bf16_f32 v112, v72, v73
    v_cvt_pk_bf16_f32 v114, v76, v77
    v_mov_b32 v113, 0
    v_mov_b32 v115, 0
    v_mfma_f32_16x16x16_bf16 v[88:91], v[20:21], v[100:101], v[88:91]
    ds_read_b128 v[40:43], v14 offset:20480
    ds_read_b128 v[44:47], v14 offset:21504
    v_mfma_f32_16x16x16_bf16 v[80:83], v[112:113], v[100:101], v[80:83]
    ds_read_b128 v[48:51], v14 offset:22528
    ds_read_b128 v[52:55], v14 offset:23552
    v_mfma_f32_16x16x16_bf16 v[84:87], v[114:115], v[100:101], v[84:87]
    ds_read_b128 v[56:59], v14 offset:24576
    ds_read_b128 v[60:63], v14 offset:25600
    global_store_dword v12, v112, s[40:41] sc1
    global_store_dword v12, v114, s[40:41] offset:256 sc1
    s_cmp_eq_u32 s20, 63
    s_cbranch_scc1 L_last_SW2
    v_rcp_f32 v92, v88
    ds_read_b128 v[64:67], v14 offset:26624
    ds_read_b128 v[68:71], v14 offset:27648
    v_pk_mul_f32 v[80:81], v[80:81], v[92:93] op_sel_hi:[1,0]
    v_pk_mul_f32 v[82:83], v[82:83], v[92:93] op_sel_hi:[1,0]
    v_pk_mul_f32 v[84:85], v[84:85], v[92:93] op_sel_hi:[1,0]
    v_pk_mul_f32 v[86:87], v[86:87], v[92:93] op_sel_hi:[1,0]
    v_cvt_pk_bf16_f32 v120, v80, v81
    v_cvt_pk_bf16_f32 v121, v82, v83
    v_cvt_pk_bf16_f32 v122, v84, v85
    v_cvt_pk_bf16_f32 v123, v86, v87
    ds_write_b128 v7, v[120:123]
    ds_read_b128 v[72:75], v14 offset:28672
    ds_read_b128 v[76:79], v14 offset:29696
    v_mov_b64 v[80:81], 0
    v_mov_b64 v[82:83], 0
    v_mov_b64 v[84:85], 0
    v_mov_b64 v[86:87], 0
    v_mov_b64 v[88:89], 0
    v_mov_b64 v[90:91], 0
    v_mov_b64 v[92:93], 0
    v_mov_b64 v[94:95], 0
    v_mov_b64 v[96:97], 0
    v_mov_b64 v[98:99], 0
    v_mov_b64 v[100:101], 0
    v_mov_b64 v[102:103], 0
    v_mov_b64 v[104:105], 0
    v_mov_b64 v[106:107], 0
    v_mov_b64 v[108:109], 0
    v_mov_b64 v[110:111], 0
    s_waitcnt lgkmcnt(0)
    s_barrier
    ds_read_b128 v[112:115], v2 offset:12288
    ds_read_b128 v[116:119], v2 offset:13312
    s_add_u32 s34, s34, 0x40000
    s_addc_u32 s35, s35, 0
    s_add_u32 s36, s36, 0x40000
    s_addc_u32 s37, s37, 0
    s_add_u32 s38, s38, 0x10000
    s_addc_u32 s39, s39, 0
    s_add_u32 s40, s40, 0x10000
    s_addc_u32 s41, s41, 0
    s_waitcnt lgkmcnt(0)
    v_smfmac_f32_16x16x64_bf16 v[80:83], v[112:115], v[192:199], v15
    v_smfmac_f32_16x16x64_bf16 v[80:83], v[116:119], v[24:31], v15
    ds_read_b128 v[24:27], v14 offset:30720
    ds_read_b128 v[28:31], v14 offset:31744
    v_smfmac_f32_16x16x64_bf16 v[84:87], v[112:115], v[200:207], v15
    v_smfmac_f32_16x16x64_bf16 v[84:87], v[116:119], v[32:39], v15
    v_smfmac_f32_16x16x64_bf16 v[88:91], v[112:115], v[208:215], v15
    v_add_f32 v80, v80, v82
    v_smfmac_f32_16x16x64_bf16 v[88:91], v[116:119], v[40:47], v15
    v_add_f32 v81, v81, v83
    v_cvt_pk_bf16_f32 v120, v80, v81
    v_smfmac_f32_16x16x64_bf16 v[92:95], v[112:115], v[216:223], v15
    v_add_f32 v84, v84, v86
    v_smfmac_f32_16x16x64_bf16 v[92:95], v[116:119], v[48:55], v15
    v_add_f32 v85, v85, v87
    v_cvt_pk_bf16_f32 v121, v84, v85
    v_smfmac_f32_16x16x64_bf16 v[96:99], v[112:115], v[224:231], v15
    v_add_f32 v88, v88, v90
    v_smfmac_f32_16x16x64_bf16 v[96:99], v[116:119], v[56:63], v15
    v_add_f32 v89, v89, v91
    v_cvt_pk_bf16_f32 v122, v88, v89
    v_smfmac_f32_16x16x64_bf16 v[100:103], v[112:115], v[232:239], v15
    v_add_f32 v92, v92, v94
    v_smfmac_f32_16x16x64_bf16 v[100:103], v[116:119], v[64:71], v15
    v_add_f32 v93, v93, v95
    v_cvt_pk_bf16_f32 v123, v92, v93
    v_smfmac_f32_16x16x64_bf16 v[104:107], v[112:115], v[240:247], v15
    v_add_f32 v96, v96, v98
    v_and_or_b32 v120, v120, -2, s42
    global_store_dwordx4 v8, v[120:123], s[22:23] sc1
    v_smfmac_f32_16x16x64_bf16 v[104:107], v[116:119], v[72:79], v15
    v_add_f32 v97, v97, v99
    v_cvt_pk_bf16_f32 v124, v96, v97
    v_smfmac_f32_16x16x64_bf16 v[108:111], v[112:115], v[248:255], v15
    v_add_f32 v100, v100, v102
    s_waitcnt lgkmcnt(0)
    v_smfmac_f32_16x16x64_bf16 v[108:111], v[116:119], v[24:31], v15
    v_add_f32 v101, v101, v103
    v_cvt_pk_bf16_f32 v125, v100, v101
    s_nop 1
    v_add_f32 v104, v104, v106
    v_add_f32 v105, v105, v107
    v_cvt_pk_bf16_f32 v126, v104, v105
    s_nop 2
    v_add_f32 v108, v108, v110
    v_add_f32 v109, v109, v111
    v_cvt_pk_bf16_f32 v127, v108, v109
    v_and_or_b32 v124, v124, -2, s42
    global_store_dwordx4 v8, v[124:127], s[24:25] sc1
    ds_read_b128 v[24:27], v14 offset:0
    ds_read_b128 v[28:31], v14 offset:1024
    ds_read_b128 v[32:35], v14 offset:2048
    ds_read_b128 v[36:39], v14 offset:3072
    ds_read_b128 v[80:83], v14 offset:4096
    ds_read_b128 v[84:87], v14 offset:5120
    ds_read_b128 v[88:91], v14 offset:6144
    ds_read_b128 v[92:95], v14 offset:7168
    ds_read_b128 v[96:99], v14 offset:8192
    ds_read_b128 v[100:103], v14 offset:9216
    ds_read_b128 v[104:107], v14 offset:10240
    ds_read_b128 v[108:111], v14 offset:11264
    ds_read_b128 v[112:115], v14 offset:12288
    ds_read_b128 v[116:119], v14 offset:13312
    ds_read_b128 v[120:123], v14 offset:14336
    ds_read_b128 v[124:127], v14 offset:15360
    s_nop 15
    global_load_dwordx4 v[56:59], v0, s[26:27] sc1
    global_load_dwordx4 v[60:63], v0, s[26:27] offset:1024 sc1
    s_add_u32 s20, s20, 1
    s_mov_b32 s32, s28
    s_mov_b32 s33, s29
    s_sub_u32 s32, s32, 4096
    s_subb_u32 s33, s33, 0
    s_add_u32 s28, s30, 0x1000
    s_addc_u32 s29, s31, 0
    s_nop 15
    s_nop 15
    global_load_dwordx4 v[68:71], v0, s[26:27] sc1
    global_load_dwordx4 v[72:75], v0, s[26:27] offset:1024 sc1
    s_waitcnt vmcnt(2)
    v_mfma_f32_16x16x32_bf16 v[64:67], v[16:19], v[56:59], 0
    v_bitop3_b32 v13, v56, v60, s42 bitop3:0x7e
    v_mfma_f32_16x16x32_bf16 v[64:67], v[16:19], v[60:63], v[64:67]
    v_and_b32 v13, 1, v13
    v_cmp_ne_u32 vcc, 0, v13
    s_cbranch_vccz L_okR_SW2
    s_waitcnt vmcnt(0)
    v_mfma_f32_16x16x32_bf16 v[64:67], v[16:19], v[68:71], 0
    v_bitop3_b32 v13, v68, v72, s42 bitop3:0x7e
    v_mfma_f32_16x16x32_bf16 v[64:67], v[16:19], v[72:75], v[64:67]
    v_and_b32 v13, 1, v13
    v_cmp_ne_u32 vcc, 0, v13
    s_cbranch_vccz L_okR_SW2
L_pollR_SW2:
    global_load_dwordx4 v[56:59], v0, s[26:27] sc1
    global_load_dwordx4 v[60:63], v0, s[26:27] offset:1024 sc1
    s_add_u32 s43, s43, 1
    s_cmp_gt_u32 s43, 400000
    s_cbranch_scc1 L_S_fail
L_chkR_SW2:
    s_waitcnt vmcnt(0)
    v_mfma_f32_16x16x32_bf16 v[64:67], v[16:19], v[56:59], 0
    v_bitop3_b32 v13, v56, v60, s42 bitop3:0x7e
    v_mfma_f32_16x16x32_bf16 v[64:67], v[16:19], v[60:63], v[64:67]
    v_and_b32 v13, 1, v13
    v_cmp_ne_u32 vcc, 0, v13
    s_cbranch_vccnz L_pollR_SW2
L_okR_SW2:
    s_nop 4
    v_add_f32_dpp v64, v64, v64 row_ror:8 row_mask:0xf bank_mask:0x3
    v_add_f32_dpp v65, v65, v65 row_ror:8 row_mask:0xf bank_mask:0x3
    v_add_f32_dpp v64, v66, v66 row_ror:8 row_mask:0xf bank_mask:0xc
    v_add_f32_dpp v65, v67, v67 row_ror:8 row_mask:0xf bank_mask:0xc
    s_nop 0
    v_add_f32_dpp v64, v64, v64 row_shl:4 row_mask:0xf bank_mask:0x5
    v_add_f32_dpp v64, v65, v65 row_shr:4 row_mask:0xf bank_mask:0xa
    s_nop 1
    v_mov_b32_dpp v65, v64 row_ror:8 row_mask:0xf bank_mask:0xf
    v_cvt_pk_bf16_f32 v64, v64, v65
    v_min_u32 v64, -2, v64
    global_store_dword v10, v64, s[30:31] sc1
    v_readfirstlane_b32 s55, v9
    s_add_u32 s52, s20, 1
    s_and_b32 s52, s52, 3
    s_lshl_b32 s52, s52, 13
    s_add_u32 s52, s52, 0x80000
    s_add_u32 s30, s14, s52
    s_addc_u32 s31, s15, 0
    s_and_b32 s52, s20, 1
    s_lshl_b32 s52, s52, 18
    s_add_u32 s22, s14, s52
    s_addc_u32 s23, s15, 0
    s_add_u32 s24, s22, 0x8000
    s_addc_u32 s25, s23, 0
    s_lshl_b32 s52, s18, 13
    s_add_u32 s52, s52, 4096
    s_add_u32 s26, s22, s52
    s_addc_u32 s27, s23, 0
    s_bfe_u32 s42, s20, 0x10001
    s_mov_b32 s43, 0
    s_add_u32 s76, s76, 128
    s_add_u32 s77, s77, 128
    s_cmp_lg_u32 s55, 0
    s_cbranch_scc1 L_kvok_SW2
    s_add_u32 s52, s20, 1
    s_cmp_lt_u32 s52, 64
    s_cbranch_scc0 L_kvok_SW2
    s_sub_u32 s52, s76, 128
L_kvspin_SW2:
    buffer_load_dword v9, off, s[96:99], s52 sc1
    s_add_u32 s43, s43, 1
    s_cmp_gt_u32 s43, 400000
    s_cbranch_scc1 L_S_fail
    s_waitcnt vmcnt(0)
    v_readfirstlane_b32 s55, v9
    s_nop 3
    s_cmp_lg_u32 s55, 0
    s_cbranch_scc0 L_kvspin_SW2
    s_mov_b32 s43, 0
L_kvok_SW2:
    s_nop 15
    s_nop 15
    global_load_dwordx4 v[40:43], v0, s[28:29] sc1
    global_load_dwordx4 v[44:47], v0, s[28:29] offset:1024 sc1
    s_waitcnt vmcnt(3)
    v_mov_b64 v[56:57], 0
    v_mov_b64 v[58:59], 0
    v_mov_b64 v[60:61], 0
    v_mov_b64 v[62:63], 0
    v_mov_b64 v[64:65], 0
    v_mov_b64 v[66:67], 0
    v_mov_b64 v[68:69], 0
    v_mov_b64 v[70:71], 0
    v_mov_b64 v[72:73], 0
    v_mov_b64 v[74:75], 0
    v_mov_b64 v[76:77], 0
    v_mov_b64 v[78:79], 0
    s_waitcnt lgkmcnt(0)
    s_nop 15
    s_nop 7
    global_load_dwordx4 v[48:51], v0, s[28:29] sc1
    global_load_dwordx4 v[52:55], v0, s[28:29] offset:1024 sc1
    s_waitcnt vmcnt(2)
    v_max_u32 v13, v40, v44
    v_cmp_eq_u32 vcc, -1, v13
    s_cbranch_vccz L_entry_SW2
    s_waitcnt vmcnt(0)
    v_max_u32 v13, v48, v52
    v_cmp_eq_u32 vcc, -1, v13
    s_cbranch_vccnz L_pollG_SW2
    ds_write_b128 v2, v[48:51] offset:4096
    ds_write_b128 v2, v[52:55] offset:5120
    v_mov_b64 v[40:41], v[48:49]
    v_mov_b64 v[42:43], v[50:51]
    v_mov_b64 v[44:45], v[52:53]
    v_mov_b64 v[46:47], v[54:55]
    s_nop 0
    s_branch L_entry2_SW2
L_last_SW2:
    s_waitcnt vmcnt(0)
    s_barrier
    s_branch L_S_done
L_c_start_S3:
    s_and_b32 s52, s20, 1
    s_lshl_b32 s52, s52, 18
    s_add_u32 s22, s14, s52
    s_addc_u32 s23, s15, 0
    s_add_u32 s24, s22, 0x8000
    s_addc_u32 s25, s23, 0
    s_lshl_b32 s52, s18, 13
    s_add_u32 s52, s52, 6144
    s_add_u32 s26, s22, s52
    s_addc_u32 s27, s23, 0
    v_mov_b32 v48, v116
    v_mov_b32 v52, v120
    v_mov_b32 v49, v117
    v_mov_b32 v53, v121
    v_mov_b32 v50, v118
    v_mov_b32 v54, v122
    v_mov_b32 v51, v119
    v_mov_b32 v55, v123
    ds_read_b128 v[24:27], v14 offset:0
    ds_read_b128 v[28:31], v14 offset:1024
    ds_read_b128 v[32:35], v14 offset:2048
    ds_read_b128 v[36:39], v14 offset:3072
    ds_read_b128 v[80:83], v14 offset:4096
    ds_read_b128 v[84:87], v14 offset:5120
    ds_read_b128 v[88:91], v14 offset:6144
    ds_read_b128 v[92:95], v14 offset:7168
    ds_read_b128 v[96:99], v14 offset:8192
    ds_read_b128 v[100:103], v14 offset:9216
    ds_read_b128 v[104:107], v14 offset:10240
    ds_read_b128 v[108:111], v14 offset:11264
    ds_read_b128 v[112:115], v14 offset:12288
    ds_read_b128 v[116:119], v14 offset:13312
    ds_read_b128 v[120:123], v14 offset:14336
    ds_read_b128 v[124:127], v14 offset:15360
    v_mov_b64 v[56:57], 0
    v_mov_b64 v[58:59], 0
    v_mov_b64 v[60:61], 0
    v_mov_b64 v[62:63], 0
    v_mov_b64 v[64:65], 0
    v_mov_b64 v[66:67], 0
    v_mov_b64 v[68:69], 0
    v_mov_b64 v[70:71], 0
    v_mov_b64 v[72:73], 0
    v_mov_b64 v[74:75], 0
    v_mov_b64 v[76:77], 0
    v_mov_b64 v[78:79], 0
    s_waitcnt vmcnt(0) lgkmcnt(0)
    s_branch L_entry_SW3
L_pollG_SW3:
    global_load_dwordx4 v[48:51], v0, s[28:29] sc1
    global_load_dwordx4 v[52:55], v0, s[28:29] offset:1024 sc1
    s_add_u32 s43, s43, 1
    s_cmp_gt_u32 s43, 400000
    s_cbranch_scc1 L_S_fail
    s_waitcnt vmcnt(0)
    v_max_u32 v13, v48, v52
    v_cmp_eq_u32 vcc, -1, v13
    s_cbranch_vccnz L_pollG_SW3
L_entry_SW3:
    ds_write_b128 v2, v[48:51] offset:6144
    ds_write_b128 v2, v[52:55] offset:7168
L_entry2_SW3:
    v_smfmac_f32_16x16x64_bf16 v[56:59], v[48:51], v[24:31], v15
    v_smfmac_f32_16x16x64_bf16 v[60:63], v[48:51], v[32:39], v15
    v_smfmac_f32_16x16x64_bf16 v[56:59], v[52:55], v[80:87], v15
    v_smfmac_f32_16x16x64_bf16 v[60:63], v[52:55], v[88:95], v15
    v_smfmac_f32_16x16x64_bf16 v[64:67], v[48:51], v[96:103], v15
    v_smfmac_f32_16x16x64_bf16 v[68:71], v[48:51], v[104:111], v15
    s_waitcnt vmcnt(0) lgkmcnt(0)
    s_barrier
    ds_read_b128 v[24:27], v2 offset:0
    ds_read_b128 v[28:31], v2 offset:1024
    v_smfmac_f32_16x16x64_bf16 v[64:67], v[52:55], v[112:119], v15
    ds_read_b128 v[32:35], v2 offset:2048
    v_smfmac_f32_16x16x64_bf16 v[68:71], v[52:55], v[120:127], v15
    ds_read_b128 v[36:39], v2 offset:3072
    v_smfmac_f32_16x16x64_bf16 v[72:75], v[48:51], a[240:247], v15
    ds_read_b128 v[40:43], v2 offset:4096
    v_smfmac_f32_16x16x64_bf16 v[76:79], v[48:51], v[176:183], v15
    ds_read_b128 v[44:47], v2 offset:5120
    v_smfmac_f32_16x16x64_bf16 v[72:75], v[52:55], a[248:255], v15
    s_mov_b32 m0, 159744
    v_mov_b32 v13, -1
    v_smfmac_f32_16x16x64_bf16 v[76:79], v[52:55], v[184:191], v15
    global_load_lds_dwordx4 v0, s[36:37] sc1
    s_waitcnt lgkmcnt(5)
    v_smfmac_f32_16x16x64_bf16 v[56:59], v[24:27], a[0:7], v15
    ds_read_b128 v[80:83], v2 offset:14336
    v_smfmac_f32_16x16x64_bf16 v[60:63], v[24:27], a[48:55], v15
    ds_read_b128 v[96:99], v2 offset:18432
    s_waitcnt lgkmcnt(6)
    v_smfmac_f32_16x16x64_bf16 v[56:59], v[28:31], a[8:15], v15
    ds_read_b128 v[84:87], v2 offset:15360
    v_smfmac_f32_16x16x64_bf16 v[60:63], v[28:31], a[56:63], v15
    ds_read_b128 v[100:103], v2 offset:19456
    s_waitcnt lgkmcnt(7)
    v_smfmac_f32_16x16x64_bf16 v[56:59], v[32:35], a[16:23], v15
    ds_read_b128 v[88:91], v2 offset:16384
    v_smfmac_f32_16x16x64_bf16 v[60:63], v[32:35], a[64:71], v15
    ds_read_b128 v[104:107], v2 offset:20480
    s_waitcnt lgkmcnt(8)
    v_smfmac_f32_16x16x64_bf16 v[56:59], v[36:39], a[24:31], v15
    ds_read_b128 v[92:95], v2 offset:17408
    v_smfmac_f32_16x16x64_bf16 v[60:63], v[36:39], a[72:79], v15
    ds_read_b128 v[108:111], v2 offset:21504
    s_waitcnt lgkmcnt(9)
    v_smfmac_f32_16x16x64_bf16 v[56:59], v[40:43], a[32:39], v15
    global_load_lds_dwordx4 v0, s[36:37] offset:1024 sc1
    v_smfmac_f32_16x16x64_bf16 v[60:63], v[40:43], a[80:87], v15
    global_store_dword v10, v13, s[32:33] sc1
    s_waitcnt lgkmcnt(8)
    v_smfmac_f32_16x16x64_bf16 v[56:59], v[44:47], a[40:47], v15
    buffer_load_dword v9, off, s[96:99], s76 sc1
    v_smfmac_f32_16x16x64_bf16 v[60:63], v[44:47], a[88:95], v15
    s_add_u32 s54, s36, 0x40000
    s_addc_u32 s55, s37, 0
    global_load_dword v13, v1, s[54:55] sc1
    v_smfmac_f32_16x16x64_bf16 v[64:67], v[24:27], a[96:103], v15
    v_smfmac_f32_16x16x64_bf16 v[68:71], v[24:27], a[144:151], v15
    s_nop 0
    v_add_f32 v56, v56, v58
    v_add_f32 v57, v57, v59
    v_smfmac_f32_16x16x64_bf16 v[64:67], v[28:31], a[104:111], v15
    v_add_f32 v60, v60, v62
    v_add_f32 v61, v61, v63
    v_cvt_pk_bf16_f32 v58, v56, v60
    v_cvt_pk_bf16_f32 v59, v57, v61
    ds_write_b32 v3, v58
    ds_write_b32 v4, v59
    v_smfmac_f32_16x16x64_bf16 v[68:71], v[28:31], a[152:159], v15
    s_mov_b32 m0, 151552
    v_smfmac_f32_16x16x64_bf16 v[64:67], v[32:35], a[112:119], v15
    v_smfmac_f32_16x16x64_bf16 v[68:71], v[32:35], a[160:167], v15
    v_smfmac_f32_16x16x64_bf16 v[64:67], v[36:39], a[120:127], v15
    v_smfmac_f32_16x16x64_bf16 v[68:71], v[36:39], a[168:175], v15
    v_smfmac_f32_16x16x64_bf16 v[64:67], v[40:43], a[128:135], v15
    s_waitcnt lgkmcnt(0)
    s_barrier
    ds_read_b128 v[112:115], v5 offset:0
    v_smfmac_f32_16x16x64_bf16 v[68:71], v[40:43], a[176:183], v15
    ds_read_b128 v[116:119], v5 offset:1024
    v_smfmac_f32_16x16x64_bf16 v[64:67], v[44:47], a[136:143], v15
    ds_read_b128 v[120:123], v5 offset:2048
    v_smfmac_f32_16x16x64_bf16 v[68:71], v[44:47], a[184:191], v15
    ds_read_b128 v[124:127], v5 offset:3072
    v_smfmac_f32_16x16x64_bf16 v[72:75], v[24:27], a[192:199], v15
    global_load_lds_dwordx4 v0, s[34:35] sc1
    v_smfmac_f32_16x16x64_bf16 v[76:79], v[24:27], v[128:135], v15
    global_load_lds_dwordx4 v0, s[34:35] offset:1024 sc1
    s_nop 0
    v_add_f32 v64, v64, v66
    v_add_f32 v65, v65, v67
    v_add_f32 v68, v68, v70
    v_add_f32 v69, v69, v71
    v_cvt_pk_bf16_f32 v66, v64, v68
    v_cvt_pk_bf16_f32 v67, v65, v69
    s_waitcnt lgkmcnt(0)
    ds_write_b32 v3, v66 offset:128
    ds_write_b32 v4, v67 offset:128
    v_mfma_f32_16x16x32_bf16 v[56:59], v[80:83], v[112:115], 0
    v_mfma_f32_16x16x32_bf16 v[60:63], v[96:99], v[112:115], 0
    v_mfma_f32_16x16x32_bf16 v[56:59], v[84:87], v[116:119], v[56:59]
    v_mfma_f32_16x16x32_bf16 v[60:63], v[100:103], v[116:119], v[60:63]
    v_mfma_f32_16x16x32_bf16 v[56:59], v[88:91], v[120:123], v[56:59]
    v_mfma_f32_16x16x32_bf16 v[60:63], v[104:107], v[120:123], v[60:63]
    v_mfma_f32_16x16x32_bf16 v[56:59], v[92:95], v[124:127], v[56:59]
    v_mfma_f32_16x16x32_bf16 v[60:63], v[108:111], v[124:127], v[60:63]
    s_waitcnt vmcnt(5) lgkmcnt(0)
    s_barrier
    ds_read_b128 v[80:83], v6 offset:0
    ds_read_b128 v[84:87], v6 offset:1024
    v_smfmac_f32_16x16x64_bf16 v[72:75], v[28:31], a[200:207], v15
    ds_read_b128 v[88:91], v6 offset:2048
    v_smfmac_f32_16x16x64_bf16 v[76:79], v[28:31], v[136:143], v15
    ds_read_b128 v[92:95], v6 offset:3072
    v_smfmac_f32_16x16x64_bf16 v[72:75], v[32:35], a[208:215], v15
    ds_read_b128 v[104:107], v2 offset:28672
    v_smfmac_f32_16x16x64_bf16 v[76:79], v[32:35], v[144:151], v15
    ds_read_b128 v[108:111], v2 offset:29696
    v_smfmac_f32_16x16x64_bf16 v[72:75], v[36:39], a[216:223], v15
    s_waitcnt lgkmcnt(5)
    v_mfma_f32_16x16x32_bf16 v[64:67], v[80:83], v[112:115], 0
    s_waitcnt lgkmcnt(4)
    v_mfma_f32_16x16x32_bf16 v[64:67], v[84:87], v[116:119], v[64:67]
    s_waitcnt lgkmcnt(3)
    v_mfma_f32_16x16x32_bf16 v[64:67], v[88:91], v[120:123], v[64:67]
    s_waitcnt lgkmcnt(2)
    v_mfma_f32_16x16x32_bf16 v[64:67], v[92:95], v[124:127], v[64:67]
    v_smfmac_f32_16x16x64_bf16 v[76:79], v[36:39], v[152:159], v15
    global_store_dwordx4 v11, v[92:95], s[38:39] sc1
    v_smfmac_f32_16x16x64_bf16 v[72:75], v[40:43], a[224:231], v15
    v_smfmac_f32_16x16x64_bf16 v[76:79], v[40:43], v[160:167], v15
    v_smfmac_f32_16x16x64_bf16 v[72:75], v[44:47], a[232:239], v15
    v_smfmac_f32_16x16x64_bf16 v[76:79], v[44:47], v[168:175], v15
    v_max3_f32 v68, v56, v57, v58
    v_max3_f32 v68, v68, v59, v60
    v_max3_f32 v68, v68, v61, v62
    v_max3_f32 v68, v68, v63, v64
    v_max_f32 v68, v68, v65
    v_mov_b32 v69, v68
    ds_read_b128 v[24:27], v14 offset:16384
    ds_read_b128 v[28:31], v14 offset:17408
    v_permlane32_swap_b32 v68, v69
    v_max_f32 v68, v68, v69
    v_mov_b32 v69, v68
    ds_read_b128 v[32:35], v14 offset:18432
    ds_read_b128 v[36:39], v14 offset:19456
    v_permlane16_swap_b32 v68, v69
    v_max_f32 v68, v68, v69
    v_mul_f32 v68, s44, v68
    v_pk_fma_f32 v[56:57], v[56:57], s[44:45], v[68:69] op_sel_hi:[1,0,0] neg_lo:[0,0,1] neg_hi:[0,0,1]
    v_pk_fma_f32 v[58:59], v[58:59], s[44:45], v[68:69] op_sel_hi:[1,0,0] neg_lo:[0,0,1] neg_hi:[0,0,1]
    v_pk_fma_f32 v[60:61], v[60:61], s[44:45], v[68:69] op_sel_hi:[1,0,0] neg_lo:[0,0,1] neg_hi:[0,0,1]
    v_pk_fma_f32 v[62:63], v[62:63], s[44:45], v[68:69] op_sel_hi:[1,0,0] neg_lo:[0,0,1] neg_hi:[0,0,1]
    v_pk_fma_f32 v[64:65], v[64:65], s[44:45], v[68:69] op_sel_hi:[1,0,0] neg_lo:[0,0,1] neg_hi:[0,0,1]
    v_exp_f32 v56, v56
    v_exp_f32 v57, v57
    v_exp_f32 v58, v58
    v_exp_f32 v59, v59
    v_exp_f32 v60, v60
    v_exp_f32 v61, v61
    v_exp_f32 v62, v62
    v_exp_f32 v63, v63
    v_exp_f32 v64, v64
    v_exp_f32 v65, v65
    v_cvt_pk_bf16_f32 v96, v56, v57
    v_cvt_pk_bf16_f32 v97, v58, v59
    v_cvt_pk_bf16_f32 v98, v60, v61
    v_cvt_pk_bf16_f32 v99, v62, v63
    v_cvt_pk_bf16_f32 v100, v64, v65
    v_mov_b32 v101, 0
    s_waitcnt lgkmcnt(4)
    v_mfma_f32_16x16x32_bf16 v[88:91], v[20:23], v[96:99], 0
    v_add_f32 v72, v72, v74
    v_add_f32 v73, v73, v75
    v_mfma_f32_16x16x32_bf16 v[80:83], v[104:107], v[96:99], 0
    v_add_f32 v76, v76, v78
    v_add_f32 v77, v77, v79
    v_mfma_f32_16x16x32_bf16 v[84:87], v[108:111], v[96:99], 0
    v_cvt_pk_bf16_f32 v112, v72, v73
    v_cvt_pk_bf16_f32 v114, v76, v77
    v_mov_b32 v113, 0
    v_mov_b32 v115, 0
    v_mfma_f32_16x16x16_bf16 v[88:91], v[20:21], v[100:101], v[88:91]
    ds_read_b128 v[40:43], v14 offset:20480
    ds_read_b128 v[44:47], v14 offset:21504
    v_mfma_f32_16x16x16_bf16 v[80:83], v[112:113], v[100:101], v[80:83]
    ds_read_b128 v[48:51], v14 offset:22528
    ds_read_b128 v[52:55], v14 offset:23552
    v_mfma_f32_16x16x16_bf16 v[84:87], v[114:115], v[100:101], v[84:87]
    ds_read_b128 v[56:59], v14 offset:24576
    ds_read_b128 v[60:63], v14 offset:25600
    global_store_dword v12, v112, s[40:41] sc1
    global_store_dword v12, v114, s[40:41] offset:256 sc1
    s_cmp_eq_u32 s20, 63
    s_cbranch_scc1 L_last_SW3
    v_rcp_f32 v92, v88
    ds_read_b128 v[64:67], v14 offset:26624
    ds_read_b128 v[68:71], v14 offset:27648
    v_pk_mul_f32 v[80:81], v[80:81], v[92:93] op_sel_hi:[1,0]
    v_pk_mul_f32 v[82:83], v[82:83], v[92:93] op_sel_hi:[1,0]
    v_pk_mul_f32 v[84:85], v[84:85], v[92:93] op_sel_hi:[1,0]
    v_pk_mul_f32 v[86:87], v[86:87], v[92:93] op_sel_hi:[1,0]
    v_cvt_pk_bf16_f32 v120, v80, v81
    v_cvt_pk_bf16_f32 v121, v82, v83
    v_cvt_pk_bf16_f32 v122, v84, v85
    v_cvt_pk_bf16_f32 v123, v86, v87
    ds_write_b128 v7, v[120:123]
    ds_read_b128 v[72:75], v14 offset:28672
    ds_read_b128 v[76:79], v14 offset:29696
    v_mov_b64 v[80:81], 0
    v_mov_b64 v[82:83], 0
    v_mov_b64 v[84:85], 0
    v_mov_b64 v[86:87], 0
    v_mov_b64 v[88:89], 0
    v_mov_b64 v[90:91], 0
    v_mov_b64 v[92:93], 0
    v_mov_b64 v[94:95], 0
    v_mov_b64 v[96:97], 0
    v_mov_b64 v[98:99], 0
    v_mov_b64 v[100:101], 0
    v_mov_b64 v[102:103], 0
    v_mov_b64 v[104:105], 0
    v_mov_b64 v[106:107], 0
    v_mov_b64 v[108:109], 0
    v_mov_b64 v[110:111], 0
    s_waitcnt lgkmcnt(0)
    s_barrier
    ds_read_b128 v[112:115], v2 offset:12288
    ds_read_b128 v[116:119], v2 offset:13312
    s_add_u32 s34, s34, 0x40000
    s_addc_u32 s35, s35, 0
    s_add_u32 s36, s36, 0x40000
    s_addc_u32 s37, s37, 0
    s_add_u32 s38, s38, 0x10000
    s_addc_u32 s39, s39, 0
    s_add_u32 s40, s40, 0x10000
    s_addc_u32 s41, s41, 0
    s_waitcnt lgkmcnt(0)
    v_smfmac_f32_16x16x64_bf16 v[80:83], v[112:115], v[192:199], v15
    v_smfmac_f32_16x16x64_bf16 v[80:83], v[116:119], v[24:31], v15
    ds_read_b128 v[24:27], v14 offset:30720
    ds_read_b128 v[28:31], v14 offset:31744
    v_smfmac_f32_16x16x64_bf16 v[84:87], v[112:115], v[200:207], v15
    v_smfmac_f32_16x16x64_bf16 v[84:87], v[116:119], v[32:39], v15
    v_smfmac_f32_16x16x64_bf16 v[88:91], v[112:115], v[208:215], v15
    v_add_f32 v80, v80, v82
    v_smfmac_f32_16x16x64_bf16 v[88:91], v[116:119], v[40:47], v15
    v_add_f32 v81, v81, v83
    v_cvt_pk_bf16_f32 v120, v80, v81
    v_smfmac_f32_16x16x64_bf16 v[92:95], v[112:115], v[216:223], v15
    v_add_f32 v84, v84, v86
    v_smfmac_f32_16x16x64_bf16 v[92:95], v[116:119], v[48:55], v15
    v_add_f32 v85, v85, v87
    v_cvt_pk_bf16_f32 v121, v84, v85
    v_smfmac_f32_16x16x64_bf16 v[96:99], v[112:115], v[224:231], v15
    v_add_f32 v88, v88, v90
    v_smfmac_f32_16x16x64_bf16 v[96:99], v[116:119], v[56:63], v15
    v_add_f32 v89, v89, v91
    v_cvt_pk_bf16_f32 v122, v88, v89
    v_smfmac_f32_16x16x64_bf16 v[100:103], v[112:115], v[232:239], v15
    v_add_f32 v92, v92, v94
    v_smfmac_f32_16x16x64_bf16 v[100:103], v[116:119], v[64:71], v15
    v_add_f32 v93, v93, v95
    v_cvt_pk_bf16_f32 v123, v92, v93
    v_smfmac_f32_16x16x64_bf16 v[104:107], v[112:115], v[240:247], v15
    v_add_f32 v96, v96, v98
    v_and_or_b32 v120, v120, -2, s42
    global_store_dwordx4 v8, v[120:123], s[22:23] sc1
    v_smfmac_f32_16x16x64_bf16 v[104:107], v[116:119], v[72:79], v15
    v_add_f32 v97, v97, v99
    v_cvt_pk_bf16_f32 v124, v96, v97
    v_smfmac_f32_16x16x64_bf16 v[108:111], v[112:115], v[248:255], v15
    v_add_f32 v100, v100, v102
    s_waitcnt lgkmcnt(0)
    v_smfmac_f32_16x16x64_bf16 v[108:111], v[116:119], v[24:31], v15
    v_add_f32 v101, v101, v103
    v_cvt_pk_bf16_f32 v125, v100, v101
    s_nop 1
    v_add_f32 v104, v104, v106
    v_add_f32 v105, v105, v107
    v_cvt_pk_bf16_f32 v126, v104, v105
    s_nop 2
    v_add_f32 v108, v108, v110
    v_add_f32 v109, v109, v111
    v_cvt_pk_bf16_f32 v127, v108, v109
    v_and_or_b32 v124, v124, -2, s42
    global_store_dwordx4 v8, v[124:127], s[24:25] sc1
    ds_read_b128 v[24:27], v14 offset:0
    ds_read_b128 v[28:31], v14 offset:1024
    ds_read_b128 v[32:35], v14 offset:2048
    ds_read_b128 v[36:39], v14 offset:3072
    ds_read_b128 v[80:83], v14 offset:4096
    ds_read_b128 v[84:87], v14 offset:5120
    ds_read_b128 v[88:91], v14 offset:6144
    ds_read_b128 v[92:95], v14 offset:7168
    ds_read_b128 v[96:99], v14 offset:8192
    ds_read_b128 v[100:103], v14 offset:9216
    ds_read_b128 v[104:107], v14 offset:10240
    ds_read_b128 v[108:111], v14 offset:11264
    ds_read_b128 v[112:115], v14 offset:12288
    ds_read_b128 v[116:119], v14 offset:13312
    ds_read_b128 v[120:123], v14 offset:14336
    ds_read_b128 v[124:127], v14 offset:15360
    s_nop 15
    global_load_dwordx4 v[56:59], v0, s[26:27] sc1
    global_load_dwordx4 v[60:63], v0, s[26:27] offset:1024 sc1
    s_add_u32 s20, s20, 1
    s_mov_b32 s32, s28
    s_mov_b32 s33, s29
    s_sub_u32 s32, s32, 6144
    s_subb_u32 s33, s33, 0
    s_add_u32 s28, s30, 0x1800
    s_addc_u32 s29, s31, 0
    s_nop 15
    s_nop 15
    global_load_dwordx4 v[68:71], v0, s[26:27] sc1
    global_load_dwordx4 v[72:75], v0, s[26:27] offset:1024 sc1
    s_waitcnt vmcnt(2)
    v_mfma_f32_16x16x32_bf16 v[64:67], v[16:19], v[56:59], 0
    v_bitop3_b32 v13, v56, v60, s42 bitop3:0x7e
    v_mfma_f32_16x16x32_bf16 v[64:67], v[16:19], v[60:63], v[64:67]
    v_and_b32 v13, 1, v13
    v_cmp_ne_u32 vcc, 0, v13
    s_cbranch_vccz L_okR_SW3
    s_waitcnt vmcnt(0)
    v_mfma_f32_16x16x32_bf16 v[64:67], v[16:19], v[68:71], 0
    v_bitop3_b32 v13, v68, v72, s42 bitop3:0x7e
    v_mfma_f32_16x16x32_bf16 v[64:67], v[16:19], v[72:75], v[64:67]
    v_and_b32 v13, 1, v13
    v_cmp_ne_u32 vcc, 0, v13
    s_cbranch_vccz L_okR_SW3
L_pollR_SW3:
    global_load_dwordx4 v[56:59], v0, s[26:27] sc1
    global_load_dwordx4 v[60:63], v0, s[26:27] offset:1024 sc1
    s_add_u32 s43, s43, 1
    s_cmp_gt_u32 s43, 400000
    s_cbranch_scc1 L_S_fail
L_chkR_SW3:
    s_waitcnt vmcnt(0)
    v_mfma_f32_16x16x32_bf16 v[64:67], v[16:19], v[56:59], 0
    v_bitop3_b32 v13, v56, v60, s42 bitop3:0x7e
    v_mfma_f32_16x16x32_bf16 v[64:67], v[16:19], v[60:63], v[64:67]
    v_and_b32 v13, 1, v13
    v_cmp_ne_u32 vcc, 0, v13
    s_cbranch_vccnz L_pollR_SW3
L_okR_SW3:
    s_nop 4
    v_add_f32_dpp v64, v64, v64 row_ror:8 row_mask:0xf bank_mask:0x3
    v_add_f32_dpp v65, v65, v65 row_ror:8 row_mask:0xf bank_mask:0x3
    v_add_f32_dpp v64, v66, v66 row_ror:8 row_mask:0xf bank_mask:0xc
    v_add_f32_dpp v65, v67, v67 row_ror:8 row_mask:0xf bank_mask:0xc
    s_nop 0
    v_add_f32_dpp v64, v64, v64 row_shl:4 row_mask:0xf bank_mask:0x5
    v_add_f32_dpp v64, v65, v65 row_shr:4 row_mask:0xf bank_mask:0xa
    s_nop 1
    v_mov_b32_dpp v65, v64 row_ror:8 row_mask:0xf bank_mask:0xf
    v_cvt_pk_bf16_f32 v64, v64, v65
    v_min_u32 v64, -2, v64
    global_store_dword v10, v64, s[30:31] sc1
    v_readfirstlane_b32 s55, v9
    s_add_u32 s52, s20, 1
    s_and_b32 s52, s52, 3
    s_lshl_b32 s52, s52, 13
    s_add_u32 s52, s52, 0x80000
    s_add_u32 s30, s14, s52
    s_addc_u32 s31, s15, 0
    s_and_b32 s52, s20, 1
    s_lshl_b32 s52, s52, 18
    s_add_u32 s22, s14, s52
    s_addc_u32 s23, s15, 0
    s_add_u32 s24, s22, 0x8000
    s_addc_u32 s25, s23, 0
    s_lshl_b32 s52, s18, 13
    s_add_u32 s52, s52, 6144
    s_add_u32 s26, s22, s52
    s_addc_u32 s27, s23, 0
    s_bfe_u32 s42, s20, 0x10001
    s_mov_b32 s43, 0
    s_add_u32 s76, s76, 128
    s_add_u32 s77, s77, 128
    s_cmp_lg_u32 s55, 0
    s_cbranch_scc1 L_kvok_SW3
    s_add_u32 s52, s20, 1
    s_cmp_lt_u32 s52, 64
    s_cbranch_scc0 L_kvok_SW3
    s_sub_u32 s52, s76, 128
L_kvspin_SW3:
    buffer_load_dword v9, off, s[96:99], s52 sc1
    s_add_u32 s43, s43, 1
    s_cmp_gt_u32 s43, 400000
    s_cbranch_scc1 L_S_fail
    s_waitcnt vmcnt(0)
    v_readfirstlane_b32 s55, v9
    s_nop 3
    s_cmp_lg_u32 s55, 0
    s_cbranch_scc0 L_kvspin_SW3
    s_mov_b32 s43, 0
L_kvok_SW3:
    s_nop 15
    s_nop 15
    global_load_dwordx4 v[48:51], v0, s[28:29] sc1
    global_load_dwordx4 v[52:55], v0, s[28:29] offset:1024 sc1
    s_waitcnt vmcnt(3)
    v_mov_b64 v[56:57], 0
    v_mov_b64 v[58:59], 0
    v_mov_b64 v[60:61], 0
    v_mov_b64 v[62:63], 0
    v_mov_b64 v[64:65], 0
    v_mov_b64 v[66:67], 0
    v_mov_b64 v[68:69], 0
    v_mov_b64 v[70:71], 0
    v_mov_b64 v[72:73], 0
    v_mov_b64 v[74:75], 0
    v_mov_b64 v[76:77], 0
    v_mov_b64 v[78:79], 0
    s_waitcnt lgkmcnt(0)
    s_nop 15
    s_nop 7
    global_load_dwordx4 v[40:43], v0, s[28:29] sc1
    global_load_dwordx4 v[44:47], v0, s[28:29] offset:1024 sc1
    s_waitcnt vmcnt(2)
    v_max_u32 v13, v48, v52
    v_cmp_eq_u32 vcc, -1, v13
    s_cbranch_vccz L_entry_SW3
    s_waitcnt vmcnt(0)
    v_max_u32 v13, v40, v44
    v_cmp_eq_u32 vcc, -1, v13
    s_cbranch_vccnz L_pollG_SW3
    ds_write_b128 v2, v[40:43] offset:6144
    ds_write_b128 v2, v[44:47] offset:7168
    v_mov_b64 v[48:49], v[40:41]
    v_mov_b64 v[50:51], v[42:43]
    v_mov_b64 v[52:53], v[44:45]
    v_mov_b64 v[54:55], v[46:47]
    s_nop 0
    s_branch L_entry2_SW3
L_last_SW3:
    s_waitcnt vmcnt(0)
    s_barrier
    s_branch L_S_done
L_S_fail:
    v_mov_b32 v1, 240
    v_mov_b32 v2, 0xdead
    global_store_dword v1, v2, s[16:17]
L_S_done:
    s_endpgm
L_fallback:
    s_mov_b64 exec, -1
    s_waitcnt vmcnt(0) lgkmcnt(0)
    buffer_wbl2 sc1
    s_waitcnt vmcnt(0)
    s_mov_b32 s84, 0
    s_waitcnt vmcnt(0)
    s_barrier
    s_cmp_eq_u32 s19, 0
    s_cbranch_scc0 L_fb_arr
    s_add_u32 s56, s84, 64
    v_mov_b32 v1, s56
    v_mov_b32 v2, 1
    s_mov_b64 exec, 1
    global_atomic_add v1, v2, s[16:17]
    s_mov_b64 exec, -1
L_fb_arr:
    s_cmp_eq_u32 s19, 0
    s_cbranch_scc0 L_fb_wait_ok
    s_add_u32 s56, s84, 64
    v_mov_b32 v1, s56
    s_mov_b32 s56, 0
L_fb_wait:
    global_load_dword v2, v1, s[16:17] sc1
    s_add_u32 s56, s56, 1
    s_cmp_gt_u32 s56, 400000
    s_cbranch_scc1 L_fail0
    s_waitcnt vmcnt(0)
    v_readfirstlane_b32 s57, v2
    s_nop 3
    s_cmp_ge_u32 s57, 256
    s_cbranch_scc1 L_fb_wait_ok
    s_sleep 16
    s_branch L_fb_wait
L_fb_wait_ok:
    s_barrier
    buffer_inv sc1
    s_waitcnt vmcnt(0)
    v_mbcnt_lo_u32_b32 v1, -1, 0
    v_mbcnt_hi_u32_b32 v1, -1, v1
    v_and_b32 v1, 7, v1
    v_lshlrev_b32 v1, 2, v1
    global_load_dword v2, v1, s[16:17] sc1
    s_waitcnt vmcnt(0)
    s_mov_b32 s58, s81
    v_readlane_b32 s57, v2, 0
    s_nop 3
    s_cmp_gt_u32 s80, 0
    s_cselect_b32 s57, s57, 0
    s_add_u32 s58, s58, s57
    v_readlane_b32 s57, v2, 1
    s_nop 3
    s_cmp_gt_u32 s80, 1
    s_cselect_b32 s57, s57, 0
    s_add_u32 s58, s58, s57
    v_readlane_b32 s57, v2, 2
    s_nop 3
    s_cmp_gt_u32 s80, 2
    s_cselect_b32 s57, s57, 0
    s_add_u32 s58, s58, s57
    v_readlane_b32 s57, v2, 3
    s_nop 3
    s_cmp_gt_u32 s80, 3
    s_cselect_b32 s57, s57, 0
    s_add_u32 s58, s58, s57
    v_readlane_b32 s57, v2, 4
    s_nop 3
    s_cmp_gt_u32 s80, 4
    s_cselect_b32 s57, s57, 0
    s_add_u32 s58, s58, s57
    v_readlane_b32 s57, v2, 5
    s_nop 3
    s_cmp_gt_u32 s80, 5
    s_cselect_b32 s57, s57, 0
    s_add_u32 s58, s58, s57
    v_readlane_b32 s57, v2, 6
    s_nop 3
    s_cmp_gt_u32 s80, 6
    s_cselect_b32 s57, s57, 0
    s_add_u32 s58, s58, s57
    s_lshr_b32 s83, s58, 5
    s_and_b32 s18, s58, 31
    s_mov_b32 s82, 1
    s_mov_b32 s84, 128
    v_mbcnt_lo_u32_b32 v0, -1, 0
    v_mbcnt_hi_u32_b32 v0, -1, v0
    s_load_dwordx8 s[4:11], s[0:1], 16
    s_load_dwordx2 s[12:13], s[0:1], 8
    s_waitcnt lgkmcnt(0)
    s_barrier
    s_branch L_dispatch
L_fail0:
    v_mov_b32 v1, 252
    v_mov_b32 v2, 0xdead
    global_store_dword v1, v2, s[16:17]
    s_endpgm
L_exit:
    s_endpgm
L_role_kv:
    s_cmp_eq_u32 s82, 0
    s_cbranch_scc0 L_kv_ok
    s_cmp_eq_u32 s19, 0
    s_cbranch_scc0 L_kv_b
    v_mbcnt_lo_u32_b32 v1, -1, 0
    v_mbcnt_hi_u32_b32 v1, -1, v1
    v_and_b32 v1, 7, v1
    v_lshlrev_b32 v1, 2, v1
    s_mov_b32 s56, 0
L_kv_v:
    global_load_dword v2, v1, s[16:17] sc1
    s_add_u32 s56, s56, 1
    s_cmp_gt_u32 s56, 400000
    s_cbranch_scc1 L_fail_kv
    s_waitcnt vmcnt(0)
    s_mov_b32 s57, 1
    v_cmp_lt_u32 vcc, 32, v2
    s_cbranch_vccnz L_kv_w
    s_mov_b32 s57, 0
    v_cmp_ne_u32 vcc, 32, v2
    s_cbranch_vccz L_kv_w
    s_sleep 4
    s_branch L_kv_v
L_kv_w:
    v_mov_b32 v1, 163832
    v_mov_b32 v2, s57
    ds_write_b32 v1, v2
    s_waitcnt lgkmcnt(0)
L_kv_b:
    s_barrier
    v_mov_b32 v1, 163832
    ds_read_b32 v2, v1
    s_waitcnt lgkmcnt(0)
    v_readfirstlane_b32 s57, v2
    s_nop 3
    s_barrier
    s_cmp_eq_u32 s57, 0
    s_cbranch_scc0 L_fallback
L_kv_ok:
    s_lshl_b32 s53, s18, 8
    v_mov_b32 v100, v0
    v_lshrrev_b32 v101, 4, v100
    v_lshlrev_b32 v102, 1, v101
    v_and_b32 v103, 15, v100
    v_xor_b32 v102, v102, v103
    s_lshl_b32 s52, s19, 4
    v_add_u32 v101, s52, v101
    v_lshlrev_b32 v101, 13, v101
    v_add_u32 v101, s53, v101
    v_lshl_add_u32 v2, v102, 4, v101
    v_xor_b32 v102, 8, v102
    v_lshl_add_u32 v3, v102, 4, v101
    v_lshrrev_b32 v101, 4, v100
    v_bfe_u32 v102, v100, 2, 2
    v_lshl_add_u32 v103, v101, 3, v102
    v_lshlrev_b32 v103, 8, v103
    v_and_b32 v101, 1, v101
    v_lshlrev_b32 v101, 3, v101
    v_lshl_add_u32 v101, v102, 1, v101
    v_bfe_u32 v102, v100, 1, 1
    s_lshl_b32 s52, s19, 2
    v_or_b32 v102, s52, v102
    v_xor_b32 v101, v101, v102
    v_lshl_add_u32 v103, v101, 4, v103
    v_and_b32 v101, 1, v100
    v_lshl_add_u32 v4, v101, 3, v103
    v_xor_b32 v5, 32, v4
    v_add_u32 v6, 0x10000, v4
    v_add_u32 v7, 0x10000, v5
    s_add_u32 s54, s6, 0x0
    s_addc_u32 s55, s7, 0
    s_lshl_b32 s52, s19, 12
    s_add_u32 m0, s52, 0
    s_nop 0
    global_load_lds_dwordx4 v2, s[54:55]
    s_add_u32 s54, s6, 0x8000
    s_addc_u32 s55, s7, 0
    s_lshl_b32 s52, s19, 12
    s_add_u32 m0, s52, 1024
    s_nop 0
    global_load_lds_dwordx4 v2, s[54:55]
    s_add_u32 s54, s6, 0x10000
    s_addc_u32 s55, s7, 0
    s_lshl_b32 s52, s19, 12
    s_add_u32 m0, s52, 2048
    s_nop 0
    global_load_lds_dwordx4 v3, s[54:55]
    s_add_u32 s54, s6, 0x18000
    s_addc_u32 s55, s7, 0
    s_lshl_b32 s52, s19, 12
    s_add_u32 m0, s52, 3072
    s_nop 0
    global_load_lds_dwordx4 v3, s[54:55]
    s_add_u32 s54, s6, 0x80000
    s_addc_u32 s55, s7, 0
    s_lshl_b32 s52, s19, 12
    s_add_u32 m0, s52, 16384
    s_nop 0
    global_load_lds_dwordx4 v2, s[54:55]
    s_add_u32 s54, s6, 0x88000
    s_addc_u32 s55, s7, 0
    s_lshl_b32 s52, s19, 12
    s_add_u32 m0, s52, 17408
    s_nop 0
    global_load_lds_dwordx4 v2, s[54:55]
    s_add_u32 s54, s6, 0x90000
    s_addc_u32 s55, s7, 0
    s_lshl_b32 s52, s19, 12
    s_add_u32 m0, s52, 18432
    s_nop 0
    global_load_lds_dwordx4 v3, s[54:55]
    s_add_u32 s54, s6, 0x98000
    s_addc_u32 s55, s7, 0
    s_lshl_b32 s52, s19, 12
    s_add_u32 m0, s52, 19456
    s_nop 0
    global_load_lds_dwordx4 v3, s[54:55]
    s_add_u32 s54, s6, 0x100000
    s_addc_u32 s55, s7, 0
    s_lshl_b32 s52, s19, 12
    s_add_u32 m0, s52, 32768
    s_nop 0
    global_load_lds_dwordx4 v2, s[54:55]
    s_add_u32 s54, s6, 0x108000
    s_addc_u32 s55, s7, 0
    s_lshl_b32 s52, s19, 12
    s_add_u32 m0, s52, 33792
    s_nop 0
    global_load_lds_dwordx4 v2, s[54:55]
    s_add_u32 s54, s6, 0x110000
    s_addc_u32 s55, s7, 0
    s_lshl_b32 s52, s19, 12
    s_add_u32 m0, s52, 34816
    s_nop 0
    global_load_lds_dwordx4 v3, s[54:55]
    s_add_u32 s54, s6, 0x118000
    s_addc_u32 s55, s7, 0
    s_lshl_b32 s52, s19, 12
    s_add_u32 m0, s52, 35840
    s_nop 0
    global_load_lds_dwordx4 v3, s[54:55]
    s_add_u32 s54, s6, 0x180000
    s_addc_u32 s55, s7, 0
    s_lshl_b32 s52, s19, 12
    s_add_u32 m0, s52, 49152
    s_nop 0
    global_load_lds_dwordx4 v2, s[54:55]
    s_add_u32 s54, s6, 0x188000
    s_addc_u32 s55, s7, 0
    s_lshl_b32 s52, s19, 12
    s_add_u32 m0, s52, 50176
    s_nop 0
    global_load_lds_dwordx4 v2, s[54:55]
    s_add_u32 s54, s6, 0x190000
    s_addc_u32 s55, s7, 0
    s_lshl_b32 s52, s19, 12
    s_add_u32 m0, s52, 51200
    s_nop 0
    global_load_lds_dwordx4 v3, s[54:55]
    s_add_u32 s54, s6, 0x198000
    s_addc_u32 s55, s7, 0
    s_lshl_b32 s52, s19, 12
    s_add_u32 m0, s52, 52224
    s_nop 0
    global_load_lds_dwordx4 v3, s[54:55]
    s_add_u32 s54, s6, 0x200000
    s_addc_u32 s55, s7, 0
    s_lshl_b32 s52, s19, 12
    s_add_u32 m0, s52, 65536
    s_nop 0
    global_load_lds_dwordx4 v2, s[54:55]
    s_add_u32 s54, s6, 0x208000
    s_addc_u32 s55, s7, 0
    s_lshl_b32 s52, s19, 12
    s_add_u32 m0, s52, 66560
    s_nop 0
    global_load_lds_dwordx4 v2, s[54:55]
    s_add_u32 s54, s6, 0x210000
    s_addc_u32 s55, s7, 0
    s_lshl_b32 s52, s19, 12
    s_add_u32 m0, s52, 67584
    s_nop 0
    global_load_lds_dwordx4 v3, s[54:55]
    s_add_u32 s54, s6, 0x218000
    s_addc_u32 s55, s7, 0
    s_lshl_b32 s52, s19, 12
    s_add_u32 m0, s52, 68608
    s_nop 0
    global_load_lds_dwordx4 v3, s[54:55]
    s_add_u32 s54, s6, 0x280000
    s_addc_u32 s55, s7, 0
    s_lshl_b32 s52, s19, 12
    s_add_u32 m0, s52, 81920
    s_nop 0
    global_load_lds_dwordx4 v2, s[54:55]
    s_add_u32 s54, s6, 0x288000
    s_addc_u32 s55, s7, 0
    s_lshl_b32 s52, s19, 12
    s_add_u32 m0, s52, 82944
    s_nop 0
    global_load_lds_dwordx4 v2, s[54:55]
    s_add_u32 s54, s6, 0x290000
    s_addc_u32 s55, s7, 0
    s_lshl_b32 s52, s19, 12
    s_add_u32 m0, s52, 83968
    s_nop 0
    global_load_lds_dwordx4 v3, s[54:55]
    s_add_u32 s54, s6, 0x298000
    s_addc_u32 s55, s7, 0
    s_lshl_b32 s52, s19, 12
    s_add_u32 m0, s52, 84992
    s_nop 0
    global_load_lds_dwordx4 v3, s[54:55]
    s_add_u32 s54, s6, 0x300000
    s_addc_u32 s55, s7, 0
    s_lshl_b32 s52, s19, 12
    s_add_u32 m0, s52, 98304
    s_nop 0
    global_load_lds_dwordx4 v2, s[54:55]
    s_add_u32 s54, s6, 0x308000
    s_addc_u32 s55, s7, 0
    s_lshl_b32 s52, s19, 12
    s_add_u32 m0, s52, 99328
    s_nop 0
    global_load_lds_dwordx4 v2, s[54:55]
    s_add_u32 s54, s6, 0x310000
    s_addc_u32 s55, s7, 0
    s_lshl_b32 s52, s19, 12
    s_add_u32 m0, s52, 100352
    s_nop 0
    global_load_lds_dwordx4 v3, s[54:55]
    s_add_u32 s54, s6, 0x318000
    s_addc_u32 s55, s7, 0
    s_lshl_b32 s52, s19, 12
    s_add_u32 m0, s52, 101376
    s_nop 0
    global_load_lds_dwordx4 v3, s[54:55]
    s_waitcnt vmcnt(24)
    s_barrier
    s_add_u32 s54, s6, 0x380000
    s_addc_u32 s55, s7, 0
    s_lshl_b32 s52, s19, 12
    s_add_u32 m0, s52, 114688
    s_nop 0
    global_load_lds_dwordx4 v2, s[54:55]
    s_add_u32 s54, s6, 0x388000
    s_addc_u32 s55, s7, 0
    s_lshl_b32 s52, s19, 12
    s_add_u32 m0, s52, 115712
    s_nop 0
    global_load_lds_dwordx4 v2, s[54:55]
    s_add_u32 s54, s6, 0x390000
    s_addc_u32 s55, s7, 0
    s_lshl_b32 s52, s19, 12
    s_add_u32 m0, s52, 116736
    s_nop 0
    global_load_lds_dwordx4 v3, s[54:55]
    s_add_u32 s54, s6, 0x398000
    s_addc_u32 s55, s7, 0
    s_lshl_b32 s52, s19, 12
    s_add_u32 m0, s52, 117760
    s_nop 0
    global_load_lds_dwordx4 v3, s[54:55]
    ds_read_b64_tr_b16 a[0:1], v4 offset:0
    ds_read_b64_tr_b16 a[2:3], v4 offset:1024
    ds_read_b64_tr_b16 a[4:5], v4 offset:8192
    ds_read_b64_tr_b16 a[6:7], v4 offset:9216
    ds_read_b64_tr_b16 a[64:65], v5 offset:0
    ds_read_b64_tr_b16 a[66:67], v5 offset:1024
    ds_read_b64_tr_b16 a[68:69], v5 offset:8192
    ds_read_b64_tr_b16 a[70:71], v5 offset:9216
    s_waitcnt lgkmcnt(0)
    s_waitcnt vmcnt(24)
    s_barrier
    s_add_u32 s54, s8, 0x0
    s_addc_u32 s55, s9, 0
    s_lshl_b32 s52, s19, 12
    s_add_u32 m0, s52, 0
    s_nop 0
    global_load_lds_dwordx4 v2, s[54:55]
    s_add_u32 s54, s8, 0x8000
    s_addc_u32 s55, s9, 0
    s_lshl_b32 s52, s19, 12
    s_add_u32 m0, s52, 1024
    s_nop 0
    global_load_lds_dwordx4 v2, s[54:55]
    s_add_u32 s54, s8, 0x10000
    s_addc_u32 s55, s9, 0
    s_lshl_b32 s52, s19, 12
    s_add_u32 m0, s52, 2048
    s_nop 0
    global_load_lds_dwordx4 v3, s[54:55]
    s_add_u32 s54, s8, 0x18000
    s_addc_u32 s55, s9, 0
    s_lshl_b32 s52, s19, 12
    s_add_u32 m0, s52, 3072
    s_nop 0
    global_load_lds_dwordx4 v3, s[54:55]
    ds_read_b64_tr_b16 a[8:9], v4 offset:16384
    ds_read_b64_tr_b16 a[10:11], v4 offset:17408
    ds_read_b64_tr_b16 a[12:13], v4 offset:24576
    ds_read_b64_tr_b16 a[14:15], v4 offset:25600
    ds_read_b64_tr_b16 a[72:73], v5 offset:16384
    ds_read_b64_tr_b16 a[74:75], v5 offset:17408
    ds_read_b64_tr_b16 a[76:77], v5 offset:24576
    ds_read_b64_tr_b16 a[78:79], v5 offset:25600
    s_waitcnt lgkmcnt(0)
    s_waitcnt vmcnt(24)
    s_barrier
    s_add_u32 s54, s8, 0x80000
    s_addc_u32 s55, s9, 0
    s_lshl_b32 s52, s19, 12
    s_add_u32 m0, s52, 16384
    s_nop 0
    global_load_lds_dwordx4 v2, s[54:55]
    s_add_u32 s54, s8, 0x88000
    s_addc_u32 s55, s9, 0
    s_lshl_b32 s52, s19, 12
    s_add_u32 m0, s52, 17408
    s_nop 0
    global_load_lds_dwordx4 v2, s[54:55]
    s_add_u32 s54, s8, 0x90000
    s_addc_u32 s55, s9, 0
    s_lshl_b32 s52, s19, 12
    s_add_u32 m0, s52, 18432
    s_nop 0
    global_load_lds_dwordx4 v3, s[54:55]
    s_add_u32 s54, s8, 0x98000
    s_addc_u32 s55, s9, 0
    s_lshl_b32 s52, s19, 12
    s_add_u32 m0, s52, 19456
    s_nop 0
    global_load_lds_dwordx4 v3, s[54:55]
    ds_read_b64_tr_b16 a[16:17], v4 offset:32768
    ds_read_b64_tr_b16 a[18:19], v4 offset:33792
    ds_read_b64_tr_b16 a[20:21], v4 offset:40960
    ds_read_b64_tr_b16 a[22:23], v4 offset:41984
    ds_read_b64_tr_b16 a[80:81], v5 offset:32768
    ds_read_b64_tr_b16 a[82:83], v5 offset:33792
    ds_read_b64_tr_b16 a[84:85], v5 offset:40960
    ds_read_b64_tr_b16 a[86:87], v5 offset:41984
    s_waitcnt lgkmcnt(0)
    s_waitcnt vmcnt(24)
    s_barrier
    s_add_u32 s54, s8, 0x100000
    s_addc_u32 s55, s9, 0
    s_lshl_b32 s52, s19, 12
    s_add_u32 m0, s52, 32768
    s_nop 0
    global_load_lds_dwordx4 v2, s[54:55]
    s_add_u32 s54, s8, 0x108000
    s_addc_u32 s55, s9, 0
    s_lshl_b32 s52, s19, 12
    s_add_u32 m0, s52, 33792
    s_nop 0
    global_load_lds_dwordx4 v2, s[54:55]
    s_add_u32 s54, s8, 0x110000
    s_addc_u32 s55, s9, 0
    s_lshl_b32 s52, s19, 12
    s_add_u32 m0, s52, 34816
    s_nop 0
    global_load_lds_dwordx4 v3, s[54:55]
    s_add_u32 s54, s8, 0x118000
    s_addc_u32 s55, s9, 0
    s_lshl_b32 s52, s19, 12
    s_add_u32 m0, s52, 35840
    s_nop 0
    global_load_lds_dwordx4 v3, s[54:55]
    ds_read_b64_tr_b16 a[24:25], v4 offset:49152
    ds_read_b64_tr_b16 a[26:27], v4 offset:50176
    ds_read_b64_tr_b16 a[28:29], v4 offset:57344
    ds_read_b64_tr_b16 a[30:31], v4 offset:58368
    ds_read_b64_tr_b16 a[88:89], v5 offset:49152
    ds_read_b64_tr_b16 a[90:91], v5 offset:50176
    ds_read_b64_tr_b16 a[92:93], v5 offset:57344
    ds_read_b64_tr_b16 a[94:95], v5 offset:58368
    s_waitcnt lgkmcnt(0)
    s_waitcnt vmcnt(24)
    s_barrier
    s_add_u32 s54, s8, 0x180000
    s_addc_u32 s55, s9, 0
    s_lshl_b32 s52, s19, 12
    s_add_u32 m0, s52, 49152
    s_nop 0
    global_load_lds_dwordx4 v2, s[54:55]
    s_add_u32 s54, s8, 0x188000
    s_addc_u32 s55, s9, 0
    s_lshl_b32 s52, s19, 12
    s_add_u32 m0, s52, 50176
    s_nop 0
    global_load_lds_dwordx4 v2, s[54:55]
    s_add_u32 s54, s8, 0x190000
    s_addc_u32 s55, s9, 0
    s_lshl_b32 s52, s19, 12
    s_add_u32 m0, s52, 51200
    s_nop 0
    global_load_lds_dwordx4 v3, s[54:55]
    s_add_u32 s54, s8, 0x198000
    s_addc_u32 s55, s9, 0
    s_lshl_b32 s52, s19, 12
    s_add_u32 m0, s52, 52224
    s_nop 0
    global_load_lds_dwordx4 v3, s[54:55]
    ds_read_b64_tr_b16 a[32:33], v6 offset:0
    ds_read_b64_tr_b16 a[34:35], v6 offset:1024
    ds_read_b64_tr_b16 a[36:37], v6 offset:8192
    ds_read_b64_tr_b16 a[38:39], v6 offset:9216
    ds_read_b64_tr_b16 a[96:97], v7 offset:0
    ds_read_b64_tr_b16 a[98:99], v7 offset:1024
    ds_read_b64_tr_b16 a[100:101], v7 offset:8192
    ds_read_b64_tr_b16 a[102:103], v7 offset:9216
    s_waitcnt lgkmcnt(0)
    s_waitcnt vmcnt(24)
    s_barrier
    s_add_u32 s54, s8, 0x200000
    s_addc_u32 s55, s9, 0
    s_lshl_b32 s52, s19, 12
    s_add_u32 m0, s52, 65536
    s_nop 0
    global_load_lds_dwordx4 v2, s[54:55]
    s_add_u32 s54, s8, 0x208000
    s_addc_u32 s55, s9, 0
    s_lshl_b32 s52, s19, 12
    s_add_u32 m0, s52, 66560
    s_nop 0
    global_load_lds_dwordx4 v2, s[54:55]
    s_add_u32 s54, s8, 0x210000
    s_addc_u32 s55, s9, 0
    s_lshl_b32 s52, s19, 12
    s_add_u32 m0, s52, 67584
    s_nop 0
    global_load_lds_dwordx4 v3, s[54:55]
    s_add_u32 s54, s8, 0x218000
    s_addc_u32 s55, s9, 0
    s_lshl_b32 s52, s19, 12
    s_add_u32 m0, s52, 68608
    s_nop 0
    global_load_lds_dwordx4 v3, s[54:55]
    ds_read_b64_tr_b16 a[40:41], v6 offset:16384
    ds_read_b64_tr_b16 a[42:43], v6 offset:17408
    ds_read_b64_tr_b16 a[44:45], v6 offset:24576
    ds_read_b64_tr_b16 a[46:47], v6 offset:25600
    ds_read_b64_tr_b16 a[104:105], v7 offset:16384
    ds_read_b64_tr_b16 a[106:107], v7 offset:17408
    ds_read_b64_tr_b16 a[108:109], v7 offset:24576
    ds_read_b64_tr_b16 a[110:111], v7 offset:25600
    s_waitcnt lgkmcnt(0)
    s_waitcnt vmcnt(24)
    s_barrier
    s_add_u32 s54, s8, 0x280000
    s_addc_u32 s55, s9, 0
    s_lshl_b32 s52, s19, 12
    s_add_u32 m0, s52, 81920
    s_nop 0
    global_load_lds_dwordx4 v2, s[54:55]
    s_add_u32 s54, s8, 0x288000
    s_addc_u32 s55, s9, 0
    s_lshl_b32 s52, s19, 12
    s_add_u32 m0, s52, 82944
    s_nop 0
    global_load_lds_dwordx4 v2, s[54:55]
    s_add_u32 s54, s8, 0x290000
    s_addc_u32 s55, s9, 0
    s_lshl_b32 s52, s19, 12
    s_add_u32 m0, s52, 83968
    s_nop 0
    global_load_lds_dwordx4 v3, s[54:55]
    s_add_u32 s54, s8, 0x298000
    s_addc_u32 s55, s9, 0
    s_lshl_b32 s52, s19, 12
    s_add_u32 m0, s52, 84992
    s_nop 0
    global_load_lds_dwordx4 v3, s[54:55]
    ds_read_b64_tr_b16 a[48:49], v6 offset:32768
    ds_read_b64_tr_b16 a[50:51], v6 offset:33792
    ds_read_b64_tr_b16 a[52:53], v6 offset:40960
    ds_read_b64_tr_b16 a[54:55], v6 offset:41984
    ds_read_b64_tr_b16 a[112:113], v7 offset:32768
    ds_read_b64_tr_b16 a[114:115], v7 offset:33792
    ds_read_b64_tr_b16 a[116:117], v7 offset:40960
    ds_read_b64_tr_b16 a[118:119], v7 offset:41984
    s_waitcnt lgkmcnt(0)
    s_waitcnt vmcnt(24)
    s_barrier
    s_add_u32 s54, s8, 0x300000
    s_addc_u32 s55, s9, 0
    s_lshl_b32 s52, s19, 12
    s_add_u32 m0, s52, 98304
    s_nop 0
    global_load_lds_dwordx4 v2, s[54:55]
    s_add_u32 s54, s8, 0x308000
    s_addc_u32 s55, s9, 0
    s_lshl_b32 s52, s19, 12
    s_add_u32 m0, s52, 99328
    s_nop 0
    global_load_lds_dwordx4 v2, s[54:55]
    s_add_u32 s54, s8, 0x310000
    s_addc_u32 s55, s9, 0
    s_lshl_b32 s52, s19, 12
    s_add_u32 m0, s52, 100352
    s_nop 0
    global_load_lds_dwordx4 v3, s[54:55]
    s_add_u32 s54, s8, 0x318000
    s_addc_u32 s55, s9, 0
    s_lshl_b32 s52, s19, 12
    s_add_u32 m0, s52, 101376
    s_nop 0
    global_load_lds_dwordx4 v3, s[54:55]
    ds_read_b64_tr_b16 a[56:57], v6 offset:49152
    ds_read_b64_tr_b16 a[58:59], v6 offset:50176
    ds_read_b64_tr_b16 a[60:61], v6 offset:57344
    ds_read_b64_tr_b16 a[62:63], v6 offset:58368
    ds_read_b64_tr_b16 a[120:121], v7 offset:49152
    ds_read_b64_tr_b16 a[122:123], v7 offset:50176
    ds_read_b64_tr_b16 a[124:125], v7 offset:57344
    ds_read_b64_tr_b16 a[126:127], v7 offset:58368
    s_waitcnt lgkmcnt(0)
    s_waitcnt vmcnt(24)
    s_barrier
    s_add_u32 s54, s8, 0x380000
    s_addc_u32 s55, s9, 0
    s_lshl_b32 s52, s19, 12
    s_add_u32 m0, s52, 114688
    s_nop 0
    global_load_lds_dwordx4 v2, s[54:55]
    s_add_u32 s54, s8, 0x388000
    s_addc_u32 s55, s9, 0
    s_lshl_b32 s52, s19, 12
    s_add_u32 m0, s52, 115712
    s_nop 0
    global_load_lds_dwordx4 v2, s[54:55]
    s_add_u32 s54, s8, 0x390000
    s_addc_u32 s55, s9, 0
    s_lshl_b32 s52, s19, 12
    s_add_u32 m0, s52, 116736
    s_nop 0
    global_load_lds_dwordx4 v3, s[54:55]
    s_add_u32 s54, s8, 0x398000
    s_addc_u32 s55, s9, 0
    s_lshl_b32 s52, s19, 12
    s_add_u32 m0, s52, 117760
    s_nop 0
    global_load_lds_dwordx4 v3, s[54:55]
    ds_read_b64_tr_b16 a[128:129], v4 offset:0
    ds_read_b64_tr_b16 a[130:131], v4 offset:1024
    ds_read_b64_tr_b16 a[132:133], v4 offset:8192
    ds_read_b64_tr_b16 a[134:135], v4 offset:9216
    ds_read_b64_tr_b16 a[192:193], v5 offset:0
    ds_read_b64_tr_b16 a[194:195], v5 offset:1024
    ds_read_b64_tr_b16 a[196:197], v5 offset:8192
    ds_read_b64_tr_b16 a[198:199], v5 offset:9216
    s_waitcnt lgkmcnt(0)
    s_waitcnt vmcnt(24)
    s_barrier
    ds_read_b64_tr_b16 a[136:137], v4 offset:16384
    ds_read_b64_tr_b16 a[138:139], v4 offset:17408
    ds_read_b64_tr_b16 a[140:141], v4 offset:24576
    ds_read_b64_tr_b16 a[142:143], v4 offset:25600
    ds_read_b64_tr_b16 a[200:201], v5 offset:16384
    ds_read_b64_tr_b16 a[202:203], v5 offset:17408
    ds_read_b64_tr_b16 a[204:205], v5 offset:24576
    ds_read_b64_tr_b16 a[206:207], v5 offset:25600
    s_waitcnt lgkmcnt(0)
    s_waitcnt vmcnt(20)
    s_barrier
    ds_read_b64_tr_b16 a[144:145], v4 offset:32768
    ds_read_b64_tr_b16 a[146:147], v4 offset:33792
    ds_read_b64_tr_b16 a[148:149], v4 offset:40960
    ds_read_b64_tr_b16 a[150:151], v4 offset:41984
    ds_read_b64_tr_b16 a[208:209], v5 offset:32768
    ds_read_b64_tr_b16 a[210:211], v5 offset:33792
    ds_read_b64_tr_b16 a[212:213], v5 offset:40960
    ds_read_b64_tr_b16 a[214:215], v5 offset:41984
    s_waitcnt lgkmcnt(0)
    s_waitcnt vmcnt(16)
    s_barrier
    ds_read_b64_tr_b16 a[152:153], v4 offset:49152
    ds_read_b64_tr_b16 a[154:155], v4 offset:50176
    ds_read_b64_tr_b16 a[156:157], v4 offset:57344
    ds_read_b64_tr_b16 a[158:159], v4 offset:58368
    ds_read_b64_tr_b16 a[216:217], v5 offset:49152
    ds_read_b64_tr_b16 a[218:219], v5 offset:50176
    ds_read_b64_tr_b16 a[220:221], v5 offset:57344
    ds_read_b64_tr_b16 a[222:223], v5 offset:58368
    s_waitcnt lgkmcnt(0)
    s_waitcnt vmcnt(12)
    s_barrier
    ds_read_b64_tr_b16 a[160:161], v6 offset:0
    ds_read_b64_tr_b16 a[162:163], v6 offset:1024
    ds_read_b64_tr_b16 a[164:165], v6 offset:8192
    ds_read_b64_tr_b16 a[166:167], v6 offset:9216
    ds_read_b64_tr_b16 a[224:225], v7 offset:0
    ds_read_b64_tr_b16 a[226:227], v7 offset:1024
    ds_read_b64_tr_b16 a[228:229], v7 offset:8192
    ds_read_b64_tr_b16 a[230:231], v7 offset:9216
    s_waitcnt lgkmcnt(0)
    s_waitcnt vmcnt(8)
    s_barrier
    ds_read_b64_tr_b16 a[168:169], v6 offset:16384
    ds_read_b64_tr_b16 a[170:171], v6 offset:17408
    ds_read_b64_tr_b16 a[172:173], v6 offset:24576
    ds_read_b64_tr_b16 a[174:175], v6 offset:25600
    ds_read_b64_tr_b16 a[232:233], v7 offset:16384
    ds_read_b64_tr_b16 a[234:235], v7 offset:17408
    ds_read_b64_tr_b16 a[236:237], v7 offset:24576
    ds_read_b64_tr_b16 a[238:239], v7 offset:25600
    s_waitcnt lgkmcnt(0)
    s_waitcnt vmcnt(4)
    s_barrier
    ds_read_b64_tr_b16 a[176:177], v6 offset:32768
    ds_read_b64_tr_b16 a[178:179], v6 offset:33792
    ds_read_b64_tr_b16 a[180:181], v6 offset:40960
    ds_read_b64_tr_b16 a[182:183], v6 offset:41984
    ds_read_b64_tr_b16 a[240:241], v7 offset:32768
    ds_read_b64_tr_b16 a[242:243], v7 offset:33792
    ds_read_b64_tr_b16 a[244:245], v7 offset:40960
    ds_read_b64_tr_b16 a[246:247], v7 offset:41984
    s_waitcnt lgkmcnt(0)
    s_waitcnt vmcnt(0)
    s_barrier
    ds_read_b64_tr_b16 a[184:185], v6 offset:49152
    ds_read_b64_tr_b16 a[186:187], v6 offset:50176
    ds_read_b64_tr_b16 a[188:189], v6 offset:57344
    ds_read_b64_tr_b16 a[190:191], v6 offset:58368
    ds_read_b64_tr_b16 a[248:249], v7 offset:49152
    ds_read_b64_tr_b16 a[250:251], v7 offset:50176
    ds_read_b64_tr_b16 a[252:253], v7 offset:57344
    ds_read_b64_tr_b16 a[254:255], v7 offset:58368
    s_waitcnt lgkmcnt(0)
    s_barrier
    s_cmp_eq_u32 s19, 0
    s_cbranch_scc0 L_kv_ln_ok
    s_add_u32 s56, s84, 32
    v_mov_b32 v1, s56
    s_mov_b32 s56, 0
L_kv_ln:
    global_load_dword v2, v1, s[16:17] sc1
    s_add_u32 s56, s56, 1
    s_cmp_gt_u32 s56, 400000
    s_cbranch_scc1 L_fail_kv
    s_waitcnt vmcnt(0)
    v_readfirstlane_b32 s57, v2
    s_nop 3
    s_cmp_ge_u32 s57, 192
    s_cbranch_scc1 L_kv_ln_ok
    s_sleep 16
    s_branch L_kv_ln
L_kv_ln_ok:
    s_barrier
    s_sub_u32 s42, s83, 1
    v_lshlrev_b32 v1, 4, v0
    s_mov_b32 s31, 0
    s_mov_b32 s30, -1
    s_lshl_b32 s52, s42, 15
    s_add_u32 s52, s52, 0x3800000
    s_add_u32 s22, s14, s52
    s_addc_u32 s23, s15, 0
    s_lshl_b32 s52, s19, 13
    s_add_u32 s52, s52, 0
    s_add_u32 m0, s52, s31
    s_add_u32 s54, s22, s52
    s_addc_u32 s55, s23, 0
    global_load_lds_dwordx4 v1, s[54:55] offset:0 sc1
    global_load_lds_dwordx4 v1, s[54:55] offset:1024 sc1
    global_load_lds_dwordx4 v1, s[54:55] offset:2048 sc1
    global_load_lds_dwordx4 v1, s[54:55] offset:3072 sc1
    s_lshl_b32 s52, s19, 13
    s_add_u32 s52, s52, 4096
    s_add_u32 m0, s52, s31
    s_add_u32 s54, s22, s52
    s_addc_u32 s55, s23, 0
    global_load_lds_dwordx4 v1, s[54:55] offset:0 sc1
    global_load_lds_dwordx4 v1, s[54:55] offset:1024 sc1
    global_load_lds_dwordx4 v1, s[54:55] offset:2048 sc1
    global_load_lds_dwordx4 v1, s[54:55] offset:3072 sc1
L_KV_loop:
    s_cmp_eq_u32 s30, -1
    s_cbranch_scc1 L_KV_w0
    s_waitcnt vmcnt(4)
    s_branch L_KV_w1
L_KV_w0:
    s_waitcnt vmcnt(0)
L_KV_w1:
    s_barrier
    s_add_u32 s55, s42, 1
    s_cmp_lt_u32 s55, 64
    s_cbranch_scc1 L_KV_dodma
    s_waitcnt vmcnt(0)
    s_branch L_KV_nodma
L_KV_dodma:
    s_mov_b32 s32, s55
    s_lshl_b32 s52, s32, 15
    s_add_u32 s52, s52, 0x3800000
    s_add_u32 s22, s14, s52
    s_addc_u32 s23, s15, 0
    s_xor_b32 s33, s31, 32768
    s_lshl_b32 s52, s19, 13
    s_add_u32 s52, s52, 0
    s_add_u32 m0, s52, s33
    s_add_u32 s54, s22, s52
    s_addc_u32 s55, s23, 0
    global_load_lds_dwordx4 v1, s[54:55] offset:0 sc1
    global_load_lds_dwordx4 v1, s[54:55] offset:1024 sc1
    global_load_lds_dwordx4 v1, s[54:55] offset:2048 sc1
    global_load_lds_dwordx4 v1, s[54:55] offset:3072 sc1
    s_lshl_b32 s52, s19, 13
    s_add_u32 s52, s52, 4096
    s_add_u32 m0, s52, s33
    s_add_u32 s54, s22, s52
    s_addc_u32 s55, s23, 0
    global_load_lds_dwordx4 v1, s[54:55] offset:0 sc1
    global_load_lds_dwordx4 v1, s[54:55] offset:1024 sc1
    global_load_lds_dwordx4 v1, s[54:55] offset:2048 sc1
    global_load_lds_dwordx4 v1, s[54:55] offset:3072 sc1
L_KV_nodma:
    v_add_u32 v64, s31, v1
    ds_read_b128 v[72:75], v64 offset:0
    ds_read_b128 v[76:79], v64 offset:1024
    ds_read_b128 v[80:83], v64 offset:2048
    ds_read_b128 v[84:87], v64 offset:3072
    s_waitcnt lgkmcnt(3)
    v_mfma_f32_16x16x32_bf16 v[16:19], a[0:3], v[72:75], 0
    v_mfma_f32_16x16x32_bf16 v[24:27], a[64:67], v[72:75], 0
    v_mfma_f32_16x16x32_bf16 v[32:35], v[72:75], a[128:131], 0
    v_mfma_f32_16x16x32_bf16 v[40:43], v[72:75], a[192:195], 0
    ds_read_b128 v[72:75], v64 offset:4096
    s_waitcnt lgkmcnt(3)
    v_mfma_f32_16x16x32_bf16 v[16:19], a[4:7], v[76:79], v[16:19]
    v_mfma_f32_16x16x32_bf16 v[24:27], a[68:71], v[76:79], v[24:27]
    v_mfma_f32_16x16x32_bf16 v[32:35], v[76:79], a[132:135], v[32:35]
    v_mfma_f32_16x16x32_bf16 v[40:43], v[76:79], a[196:199], v[40:43]
    ds_read_b128 v[76:79], v64 offset:5120
    s_waitcnt lgkmcnt(3)
    v_mfma_f32_16x16x32_bf16 v[16:19], a[8:11], v[80:83], v[16:19]
    v_mfma_f32_16x16x32_bf16 v[24:27], a[72:75], v[80:83], v[24:27]
    v_mfma_f32_16x16x32_bf16 v[32:35], v[80:83], a[136:139], v[32:35]
    v_mfma_f32_16x16x32_bf16 v[40:43], v[80:83], a[200:203], v[40:43]
    ds_read_b128 v[80:83], v64 offset:6144
    s_waitcnt lgkmcnt(3)
    v_mfma_f32_16x16x32_bf16 v[16:19], a[12:15], v[84:87], v[16:19]
    v_mfma_f32_16x16x32_bf16 v[24:27], a[76:79], v[84:87], v[24:27]
    v_mfma_f32_16x16x32_bf16 v[32:35], v[84:87], a[140:143], v[32:35]
    v_mfma_f32_16x16x32_bf16 v[40:43], v[84:87], a[204:207], v[40:43]
    ds_read_b128 v[84:87], v64 offset:7168
    s_waitcnt lgkmcnt(3)
    v_mfma_f32_16x16x32_bf16 v[16:19], a[16:19], v[72:75], v[16:19]
    v_mfma_f32_16x16x32_bf16 v[24:27], a[80:83], v[72:75], v[24:27]
    v_mfma_f32_16x16x32_bf16 v[32:35], v[72:75], a[144:147], v[32:35]
    v_mfma_f32_16x16x32_bf16 v[40:43], v[72:75], a[208:211], v[40:43]
    ds_read_b128 v[72:75], v64 offset:8192
    s_waitcnt lgkmcnt(3)
    v_mfma_f32_16x16x32_bf16 v[16:19], a[20:23], v[76:79], v[16:19]
    v_mfma_f32_16x16x32_bf16 v[24:27], a[84:87], v[76:79], v[24:27]
    v_mfma_f32_16x16x32_bf16 v[32:35], v[76:79], a[148:151], v[32:35]
    v_mfma_f32_16x16x32_bf16 v[40:43], v[76:79], a[212:215], v[40:43]
    ds_read_b128 v[76:79], v64 offset:9216
    s_waitcnt lgkmcnt(3)
    v_mfma_f32_16x16x32_bf16 v[16:19], a[24:27], v[80:83], v[16:19]
    v_mfma_f32_16x16x32_bf16 v[24:27], a[88:91], v[80:83], v[24:27]
    v_mfma_f32_16x16x32_bf16 v[32:35], v[80:83], a[152:155], v[32:35]
    v_mfma_f32_16x16x32_bf16 v[40:43], v[80:83], a[216:219], v[40:43]
    ds_read_b128 v[80:83], v64 offset:10240
    s_waitcnt lgkmcnt(3)
    v_mfma_f32_16x16x32_bf16 v[16:19], a[28:31], v[84:87], v[16:19]
    v_mfma_f32_16x16x32_bf16 v[24:27], a[92:95], v[84:87], v[24:27]
    v_mfma_f32_16x16x32_bf16 v[32:35], v[84:87], a[156:159], v[32:35]
    v_mfma_f32_16x16x32_bf16 v[40:43], v[84:87], a[220:223], v[40:43]
    ds_read_b128 v[84:87], v64 offset:11264
    s_waitcnt lgkmcnt(3)
    v_mfma_f32_16x16x32_bf16 v[16:19], a[32:35], v[72:75], v[16:19]
    v_mfma_f32_16x16x32_bf16 v[24:27], a[96:99], v[72:75], v[24:27]
    v_mfma_f32_16x16x32_bf16 v[32:35], v[72:75], a[160:163], v[32:35]
    v_mfma_f32_16x16x32_bf16 v[40:43], v[72:75], a[224:227], v[40:43]
    ds_read_b128 v[72:75], v64 offset:12288
    s_waitcnt lgkmcnt(3)
    v_mfma_f32_16x16x32_bf16 v[16:19], a[36:39], v[76:79], v[16:19]
    v_mfma_f32_16x16x32_bf16 v[24:27], a[100:103], v[76:79], v[24:27]
    v_mfma_f32_16x16x32_bf16 v[32:35], v[76:79], a[164:167], v[32:35]
    v_mfma_f32_16x16x32_bf16 v[40:43], v[76:79], a[228:231], v[40:43]
    ds_read_b128 v[76:79], v64 offset:13312
    s_waitcnt lgkmcnt(3)
    v_mfma_f32_16x16x32_bf16 v[16:19], a[40:43], v[80:83], v[16:19]
    v_mfma_f32_16x16x32_bf16 v[24:27], a[104:107], v[80:83], v[24:27]
    v_mfma_f32_16x16x32_bf16 v[32:35], v[80:83], a[168:171], v[32:35]
    v_mfma_f32_16x16x32_bf16 v[40:43], v[80:83], a[232:235], v[40:43]
    ds_read_b128 v[80:83], v64 offset:14336
    s_waitcnt lgkmcnt(3)
    v_mfma_f32_16x16x32_bf16 v[16:19], a[44:47], v[84:87], v[16:19]
    v_mfma_f32_16x16x32_bf16 v[24:27], a[108:111], v[84:87], v[24:27]
    v_mfma_f32_16x16x32_bf16 v[32:35], v[84:87], a[172:175], v[32:35]
    v_mfma_f32_16x16x32_bf16 v[40:43], v[84:87], a[236:239], v[40:43]
    ds_read_b128 v[84:87], v64 offset:15360
    s_waitcnt lgkmcnt(3)
    v_mfma_f32_16x16x32_bf16 v[16:19], a[48:51], v[72:75], v[16:19]
    v_mfma_f32_16x16x32_bf16 v[24:27], a[112:115], v[72:75], v[24:27]
    v_mfma_f32_16x16x32_bf16 v[32:35], v[72:75], a[176:179], v[32:35]
    v_mfma_f32_16x16x32_bf16 v[40:43], v[72:75], a[240:243], v[40:43]
    ds_read_b128 v[72:75], v64 offset:16384
    s_waitcnt lgkmcnt(3)
    v_mfma_f32_16x16x32_bf16 v[16:19], a[52:55], v[76:79], v[16:19]
    v_mfma_f32_16x16x32_bf16 v[24:27], a[116:119], v[76:79], v[24:27]
    v_mfma_f32_16x16x32_bf16 v[32:35], v[76:79], a[180:183], v[32:35]
    v_mfma_f32_16x16x32_bf16 v[40:43], v[76:79], a[244:247], v[40:43]
    ds_read_b128 v[76:79], v64 offset:17408
    s_waitcnt lgkmcnt(3)
    v_mfma_f32_16x16x32_bf16 v[16:19], a[56:59], v[80:83], v[16:19]
    v_mfma_f32_16x16x32_bf16 v[24:27], a[120:123], v[80:83], v[24:27]
    v_mfma_f32_16x16x32_bf16 v[32:35], v[80:83], a[184:187], v[32:35]
    v_mfma_f32_16x16x32_bf16 v[40:43], v[80:83], a[248:251], v[40:43]
    ds_read_b128 v[80:83], v64 offset:18432
    s_waitcnt lgkmcnt(3)
    v_mfma_f32_16x16x32_bf16 v[16:19], a[60:63], v[84:87], v[16:19]
    v_mfma_f32_16x16x32_bf16 v[24:27], a[124:127], v[84:87], v[24:27]
    v_mfma_f32_16x16x32_bf16 v[32:35], v[84:87], a[188:191], v[32:35]
    v_mfma_f32_16x16x32_bf16 v[40:43], v[84:87], a[252:255], v[40:43]
    ds_read_b128 v[84:87], v64 offset:19456
    s_waitcnt lgkmcnt(3)
    v_mfma_f32_16x16x32_bf16 v[20:23], a[0:3], v[72:75], 0
    v_mfma_f32_16x16x32_bf16 v[28:31], a[64:67], v[72:75], 0
    v_mfma_f32_16x16x32_bf16 v[36:39], v[72:75], a[128:131], 0
    v_mfma_f32_16x16x32_bf16 v[44:47], v[72:75], a[192:195], 0
    ds_read_b128 v[72:75], v64 offset:20480
    s_waitcnt lgkmcnt(3)
    v_mfma_f32_16x16x32_bf16 v[20:23], a[4:7], v[76:79], v[20:23]
    v_mfma_f32_16x16x32_bf16 v[28:31], a[68:71], v[76:79], v[28:31]
    v_mfma_f32_16x16x32_bf16 v[36:39], v[76:79], a[132:135], v[36:39]
    v_mfma_f32_16x16x32_bf16 v[44:47], v[76:79], a[196:199], v[44:47]
    ds_read_b128 v[76:79], v64 offset:21504
    s_waitcnt lgkmcnt(3)
    v_mfma_f32_16x16x32_bf16 v[20:23], a[8:11], v[80:83], v[20:23]
    v_mfma_f32_16x16x32_bf16 v[28:31], a[72:75], v[80:83], v[28:31]
    v_mfma_f32_16x16x32_bf16 v[36:39], v[80:83], a[136:139], v[36:39]
    v_mfma_f32_16x16x32_bf16 v[44:47], v[80:83], a[200:203], v[44:47]
    ds_read_b128 v[80:83], v64 offset:22528
    s_waitcnt lgkmcnt(3)
    v_mfma_f32_16x16x32_bf16 v[20:23], a[12:15], v[84:87], v[20:23]
    v_mfma_f32_16x16x32_bf16 v[28:31], a[76:79], v[84:87], v[28:31]
    v_mfma_f32_16x16x32_bf16 v[36:39], v[84:87], a[140:143], v[36:39]
    v_mfma_f32_16x16x32_bf16 v[44:47], v[84:87], a[204:207], v[44:47]
    ds_read_b128 v[84:87], v64 offset:23552
    s_waitcnt lgkmcnt(3)
    v_mfma_f32_16x16x32_bf16 v[20:23], a[16:19], v[72:75], v[20:23]
    v_mfma_f32_16x16x32_bf16 v[28:31], a[80:83], v[72:75], v[28:31]
    v_mfma_f32_16x16x32_bf16 v[36:39], v[72:75], a[144:147], v[36:39]
    v_mfma_f32_16x16x32_bf16 v[44:47], v[72:75], a[208:211], v[44:47]
    ds_read_b128 v[72:75], v64 offset:24576
    s_waitcnt lgkmcnt(3)
    v_mfma_f32_16x16x32_bf16 v[20:23], a[20:23], v[76:79], v[20:23]
    v_mfma_f32_16x16x32_bf16 v[28:31], a[84:87], v[76:79], v[28:31]
    v_mfma_f32_16x16x32_bf16 v[36:39], v[76:79], a[148:151], v[36:39]
    v_mfma_f32_16x16x32_bf16 v[44:47], v[76:79], a[212:215], v[44:47]
    ds_read_b128 v[76:79], v64 offset:25600
    s_waitcnt lgkmcnt(3)
    v_mfma_f32_16x16x32_bf16 v[20:23], a[24:27], v[80:83], v[20:23]
    v_mfma_f32_16x16x32_bf16 v[28:31], a[88:91], v[80:83], v[28:31]
    v_mfma_f32_16x16x32_bf16 v[36:39], v[80:83], a[152:155], v[36:39]
    v_mfma_f32_16x16x32_bf16 v[44:47], v[80:83], a[216:219], v[44:47]
    ds_read_b128 v[80:83], v64 offset:26624
    s_waitcnt lgkmcnt(3)
    v_mfma_f32_16x16x32_bf16 v[20:23], a[28:31], v[84:87], v[20:23]
    v_mfma_f32_16x16x32_bf16 v[28:31], a[92:95], v[84:87], v[28:31]
    v_mfma_f32_16x16x32_bf16 v[36:39], v[84:87], a[156:159], v[36:39]
    v_mfma_f32_16x16x32_bf16 v[44:47], v[84:87], a[220:223], v[44:47]
    ds_read_b128 v[84:87], v64 offset:27648
    s_waitcnt lgkmcnt(3)
    v_mfma_f32_16x16x32_bf16 v[20:23], a[32:35], v[72:75], v[20:23]
    v_mfma_f32_16x16x32_bf16 v[28:31], a[96:99], v[72:75], v[28:31]
    v_mfma_f32_16x16x32_bf16 v[36:39], v[72:75], a[160:163], v[36:39]
    v_mfma_f32_16x16x32_bf16 v[44:47], v[72:75], a[224:227], v[44:47]
    ds_read_b128 v[72:75], v64 offset:28672
    s_waitcnt lgkmcnt(3)
    v_mfma_f32_16x16x32_bf16 v[20:23], a[36:39], v[76:79], v[20:23]
    v_mfma_f32_16x16x32_bf16 v[28:31], a[100:103], v[76:79], v[28:31]
    v_mfma_f32_16x16x32_bf16 v[36:39], v[76:79], a[164:167], v[36:39]
    v_mfma_f32_16x16x32_bf16 v[44:47], v[76:79], a[228:231], v[44:47]
    ds_read_b128 v[76:79], v64 offset:29696
    s_waitcnt lgkmcnt(3)
    v_mfma_f32_16x16x32_bf16 v[20:23], a[40:43], v[80:83], v[20:23]
    v_mfma_f32_16x16x32_bf16 v[28:31], a[104:107], v[80:83], v[28:31]
    v_mfma_f32_16x16x32_bf16 v[36:39], v[80:83], a[168:171], v[36:39]
    v_mfma_f32_16x16x32_bf16 v[44:47], v[80:83], a[232:235], v[44:47]
    ds_read_b128 v[80:83], v64 offset:30720
    s_waitcnt lgkmcnt(3)
    v_mfma_f32_16x16x32_bf16 v[20:23], a[44:47], v[84:87], v[20:23]
    v_mfma_f32_16x16x32_bf16 v[28:31], a[108:111], v[84:87], v[28:31]
    v_mfma_f32_16x16x32_bf16 v[36:39], v[84:87], a[172:175], v[36:39]
    v_mfma_f32_16x16x32_bf16 v[44:47], v[84:87], a[236:239], v[44:47]
    ds_read_b128 v[84:87], v64 offset:31744
    s_waitcnt lgkmcnt(3)
    v_mfma_f32_16x16x32_bf16 v[20:23], a[48:51], v[72:75], v[20:23]
    v_mfma_f32_16x16x32_bf16 v[28:31], a[112:115], v[72:75], v[28:31]
    v_mfma_f32_16x16x32_bf16 v[36:39], v[72:75], a[176:179], v[36:39]
    v_mfma_f32_16x16x32_bf16 v[44:47], v[72:75], a[240:243], v[44:47]
    s_waitcnt lgkmcnt(2)
    v_mfma_f32_16x16x32_bf16 v[20:23], a[52:55], v[76:79], v[20:23]
    v_mfma_f32_16x16x32_bf16 v[28:31], a[116:119], v[76:79], v[28:31]
    v_mfma_f32_16x16x32_bf16 v[36:39], v[76:79], a[180:183], v[36:39]
    v_mfma_f32_16x16x32_bf16 v[44:47], v[76:79], a[244:247], v[44:47]
    s_waitcnt lgkmcnt(1)
    v_mfma_f32_16x16x32_bf16 v[20:23], a[56:59], v[80:83], v[20:23]
    v_mfma_f32_16x16x32_bf16 v[28:31], a[120:123], v[80:83], v[28:31]
    v_mfma_f32_16x16x32_bf16 v[36:39], v[80:83], a[184:187], v[36:39]
    v_mfma_f32_16x16x32_bf16 v[44:47], v[80:83], a[248:251], v[44:47]
    s_waitcnt lgkmcnt(0)
    v_mfma_f32_16x16x32_bf16 v[20:23], a[60:63], v[84:87], v[20:23]
    v_mfma_f32_16x16x32_bf16 v[28:31], a[124:127], v[84:87], v[28:31]
    v_mfma_f32_16x16x32_bf16 v[36:39], v[84:87], a[188:191], v[36:39]
    v_mfma_f32_16x16x32_bf16 v[44:47], v[84:87], a[252:255], v[44:47]
    s_nop 7
    v_cvt_pk_bf16_f32 v48, v16, v24
    v_cvt_pk_bf16_f32 v49, v17, v25
    v_cvt_pk_bf16_f32 v50, v18, v26
    v_cvt_pk_bf16_f32 v51, v19, v27
    v_cvt_pk_bf16_f32 v52, v20, v28
    v_cvt_pk_bf16_f32 v53, v21, v29
    v_cvt_pk_bf16_f32 v54, v22, v30
    v_cvt_pk_bf16_f32 v55, v23, v31
    v_cvt_pk_bf16_f32 v56, v32, v33
    v_cvt_pk_bf16_f32 v57, v34, v35
    v_cvt_pk_bf16_f32 v58, v36, v37
    v_cvt_pk_bf16_f32 v59, v38, v39
    v_cvt_pk_bf16_f32 v60, v40, v41
    v_cvt_pk_bf16_f32 v61, v42, v43
    v_cvt_pk_bf16_f32 v62, v44, v45
    v_cvt_pk_bf16_f32 v63, v46, v47
    s_waitcnt vmcnt(8)
    s_barrier
    s_cmp_eq_u32 s30, -1
    s_cbranch_scc1 L_KV_noflag
    s_cmp_eq_u32 s19, 0
    s_cbranch_scc0 L_KVa_fl_skip
    s_lshl_b32 s52, s30, 5
    s_add_u32 s52, s52, s18
    s_lshl_b32 s52, s52, 2
    s_add_u32 s52, s52, 0xa0000
    v_mov_b32 v66, s52
    v_mov_b32 v67, 1
    s_mov_b64 exec, 1
    global_store_dword v66, v67, s[14:15] sc1
    s_mov_b64 exec, -1
L_KVa_fl_skip:
L_KV_noflag:
    s_lshl_b32 s52, s42, 5
    s_add_u32 s52, s52, s18
    s_lshl_b32 s52, s52, 13
    s_lshl_b32 s53, s19, 10
    s_add_u32 s53, s53, s52
    s_add_u32 s53, s53, 0x1000000
    s_add_u32 s24, s14, s53
    s_addc_u32 s25, s15, 0
    s_lshl_b32 s53, s19, 11
    s_add_u32 s53, s53, s52
    s_add_u32 s53, s53, 0x2000000
    s_add_u32 s26, s14, s53
    s_addc_u32 s27, s15, 0
    global_store_dwordx4 v1, v[48:51], s[24:25] sc1
    s_add_u32 s24, s24, 0x1000
    s_addc_u32 s25, s25, 0
    global_store_dwordx4 v1, v[52:55], s[24:25] sc1
    global_store_dwordx4 v1, v[56:59], s[26:27] sc1
    global_store_dwordx4 v1, v[60:63], s[26:27] offset:1024 sc1
    s_mov_b32 s30, s42
    s_xor_b32 s31, s31, 32768
    s_add_u32 s42, s42, 1
    s_cmp_lt_u32 s42, 64
    s_cbranch_scc1 L_KV_loop
    s_waitcnt vmcnt(0)
    s_barrier
    s_cmp_eq_u32 s19, 0
    s_cbranch_scc0 L_KVb_fl_skip
    s_lshl_b32 s52, s30, 5
    s_add_u32 s52, s52, s18
    s_lshl_b32 s52, s52, 2
    s_add_u32 s52, s52, 0xa0000
    v_mov_b32 v66, s52
    v_mov_b32 v67, 1
    s_mov_b64 exec, 1
    global_store_dword v66, v67, s[14:15] sc1
    s_mov_b64 exec, -1
L_KVb_fl_skip:
    s_endpgm
L_fail_kv:
    v_mov_b32 v1, 248
    v_mov_b32 v2, 0xdead
    global_store_dword v1, v2, s[16:17]
    s_endpgm
L_role_x:
    s_load_dwordx2 s[4:5], s[0:1], 0
    s_load_dwordx2 s[6:7], s[0:1], 16
    s_load_dwordx2 s[8:9], s[0:1], 40
    s_load_dwordx2 s[10:11], s[0:1], 64
    s_load_dwordx2 s[12:13], s[0:1], 72
    s_load_dwordx2 s[20:21], s[0:1], 80
    s_load_dwordx2 s[22:23], s[0:1], 88
    s_waitcnt lgkmcnt(0)
    s_cmp_eq_u32 s82, 0
    s_cbranch_scc0 L_x_ok
    s_cmp_eq_u32 s19, 0
    s_cbranch_scc0 L_x_b
    v_mbcnt_lo_u32_b32 v1, -1, 0
    v_mbcnt_hi_u32_b32 v1, -1, v1
    v_and_b32 v1, 7, v1
    v_lshlrev_b32 v1, 2, v1
    s_mov_b32 s56, 0
L_x_v:
    global_load_dword v2, v1, s[16:17] sc1
    s_add_u32 s56, s56, 1
    s_cmp_gt_u32 s56, 400000
    s_cbranch_scc1 L_fail
    s_waitcnt vmcnt(0)
    s_mov_b32 s57, 1
    v_cmp_lt_u32 vcc, 32, v2
    s_cbranch_vccnz L_x_w
    s_mov_b32 s57, 0
    v_cmp_ne_u32 vcc, 32, v2
    s_cbranch_vccz L_x_w
    s_sleep 4
    s_branch L_x_v
L_x_w:
    v_mov_b32 v1, 163832
    v_mov_b32 v2, s57
    ds_write_b32 v1, v2
    s_waitcnt lgkmcnt(0)
L_x_b:
    s_barrier
    v_mov_b32 v1, 163832
    ds_read_b32 v2, v1
    s_waitcnt lgkmcnt(0)
    v_readfirstlane_b32 s57, v2
    s_nop 3
    s_barrier
    s_cmp_eq_u32 s57, 0
    s_cbranch_scc0 L_fallback
L_x_ok:
    s_sub_u32 s42, s83, 2
    s_lshl_b32 s40, s42, 5
    s_add_u32 s40, s40, s18
    s_cmp_eq_u32 s19, 1
    s_cbranch_scc0 L_x_nozero
    s_cmp_lt_u32 s40, 32
    s_cbranch_scc0 L_x_nozero
    s_lshl_b32 s41, s40, 10
    s_add_u32 s41, s41, 0xa0000
    v_lshlrev_b32 v1, 4, v0
    v_add_u32 v1, s41, v1
    v_mov_b64 v[4:5], 0
    v_mov_b64 v[6:7], 0
    global_store_dwordx4 v1, v[4:7], s[14:15] sc1
L_x_nozero:
    s_cmp_eq_u32 s19, 0
    s_cbranch_scc0 L_x_noln
    s_cmp_lt_u32 s40, 128
    s_cbranch_scc0 L_x_noln
    v_and_b32 v1, 15, v0
    v_lshrrev_b32 v2, 4, v0
    s_lshl_b32 s52, s40, 14
    v_lshlrev_b32 v3, 10, v1
    v_lshl_add_u32 v3, v2, 4, v3
    v_add_u32 v3, s52, v3
    global_load_dwordx4 v[8:11], v3, s[4:5] offset:0
    global_load_dwordx4 v[12:15], v3, s[4:5] offset:64
    global_load_dwordx4 v[16:19], v3, s[4:5] offset:128
    global_load_dwordx4 v[20:23], v3, s[4:5] offset:192
    global_load_dwordx4 v[24:27], v3, s[4:5] offset:256
    global_load_dwordx4 v[28:31], v3, s[4:5] offset:320
    global_load_dwordx4 v[32:35], v3, s[4:5] offset:384
    global_load_dwordx4 v[36:39], v3, s[4:5] offset:448
    global_load_dwordx4 v[40:43], v3, s[4:5] offset:512
    global_load_dwordx4 v[44:47], v3, s[4:5] offset:576
    global_load_dwordx4 v[48:51], v3, s[4:5] offset:640
    global_load_dwordx4 v[52:55], v3, s[4:5] offset:704
    global_load_dwordx4 v[56:59], v3, s[4:5] offset:768
    global_load_dwordx4 v[60:63], v3, s[4:5] offset:832
    global_load_dwordx4 v[64:67], v3, s[4:5] offset:896
    global_load_dwordx4 v[68:71], v3, s[4:5] offset:960
    v_mov_b32 v4, 0
    v_mov_b32 v5, 0
    s_mov_b32 s53, 0xffff0000
    s_waitcnt vmcnt(0)
    v_lshlrev_b32 v72, 16, v8
    v_and_b32 v73, s53, v8
    v_add_f32 v4, v4, v72
    v_add_f32 v5, v5, v73
    v_lshlrev_b32 v72, 16, v9
    v_and_b32 v73, s53, v9
    v_add_f32 v4, v4, v72
    v_add_f32 v5, v5, v73
    v_lshlrev_b32 v72, 16, v10
    v_and_b32 v73, s53, v10
    v_add_f32 v4, v4, v72
    v_add_f32 v5, v5, v73
    v_lshlrev_b32 v72, 16, v11
    v_and_b32 v73, s53, v11
    v_add_f32 v4, v4, v72
    v_add_f32 v5, v5, v73
    v_lshlrev_b32 v72, 16, v12
    v_and_b32 v73, s53, v12
    v_add_f32 v4, v4, v72
    v_add_f32 v5, v5, v73
    v_lshlrev_b32 v72, 16, v13
    v_and_b32 v73, s53, v13
    v_add_f32 v4, v4, v72
    v_add_f32 v5, v5, v73
    v_lshlrev_b32 v72, 16, v14
    v_and_b32 v73, s53, v14
    v_add_f32 v4, v4, v72
    v_add_f32 v5, v5, v73
    v_lshlrev_b32 v72, 16, v15
    v_and_b32 v73, s53, v15
    v_add_f32 v4, v4, v72
    v_add_f32 v5, v5, v73
    v_lshlrev_b32 v72, 16, v16
    v_and_b32 v73, s53, v16
    v_add_f32 v4, v4, v72
    v_add_f32 v5, v5, v73
    v_lshlrev_b32 v72, 16, v17
    v_and_b32 v73, s53, v17
    v_add_f32 v4, v4, v72
    v_add_f32 v5, v5, v73
    v_lshlrev_b32 v72, 16, v18
    v_and_b32 v73, s53, v18
    v_add_f32 v4, v4, v72
    v_add_f32 v5, v5, v73
    v_lshlrev_b32 v72, 16, v19
    v_and_b32 v73, s53, v19
    v_add_f32 v4, v4, v72
    v_add_f32 v5, v5, v73
    v_lshlrev_b32 v72, 16, v20
    v_and_b32 v73, s53, v20
    v_add_f32 v4, v4, v72
    v_add_f32 v5, v5, v73
    v_lshlrev_b32 v72, 16, v21
    v_and_b32 v73, s53, v21
    v_add_f32 v4, v4, v72
    v_add_f32 v5, v5, v73
    v_lshlrev_b32 v72, 16, v22
    v_and_b32 v73, s53, v22
    v_add_f32 v4, v4, v72
    v_add_f32 v5, v5, v73
    v_lshlrev_b32 v72, 16, v23
    v_and_b32 v73, s53, v23
    v_add_f32 v4, v4, v72
    v_add_f32 v5, v5, v73
    v_lshlrev_b32 v72, 16, v24
    v_and_b32 v73, s53, v24
    v_add_f32 v4, v4, v72
    v_add_f32 v5, v5, v73
    v_lshlrev_b32 v72, 16, v25
    v_and_b32 v73, s53, v25
    v_add_f32 v4, v4, v72
    v_add_f32 v5, v5, v73
    v_lshlrev_b32 v72, 16, v26
    v_and_b32 v73, s53, v26
    v_add_f32 v4, v4, v72
    v_add_f32 v5, v5, v73
    v_lshlrev_b32 v72, 16, v27
    v_and_b32 v73, s53, v27
    v_add_f32 v4, v4, v72
    v_add_f32 v5, v5, v73
    v_lshlrev_b32 v72, 16, v28
    v_and_b32 v73, s53, v28
    v_add_f32 v4, v4, v72
    v_add_f32 v5, v5, v73
    v_lshlrev_b32 v72, 16, v29
    v_and_b32 v73, s53, v29
    v_add_f32 v4, v4, v72
    v_add_f32 v5, v5, v73
    v_lshlrev_b32 v72, 16, v30
    v_and_b32 v73, s53, v30
    v_add_f32 v4, v4, v72
    v_add_f32 v5, v5, v73
    v_lshlrev_b32 v72, 16, v31
    v_and_b32 v73, s53, v31
    v_add_f32 v4, v4, v72
    v_add_f32 v5, v5, v73
    v_lshlrev_b32 v72, 16, v32
    v_and_b32 v73, s53, v32
    v_add_f32 v4, v4, v72
    v_add_f32 v5, v5, v73
    v_lshlrev_b32 v72, 16, v33
    v_and_b32 v73, s53, v33
    v_add_f32 v4, v4, v72
    v_add_f32 v5, v5, v73
    v_lshlrev_b32 v72, 16, v34
    v_and_b32 v73, s53, v34
    v_add_f32 v4, v4, v72
    v_add_f32 v5, v5, v73
    v_lshlrev_b32 v72, 16, v35
    v_and_b32 v73, s53, v35
    v_add_f32 v4, v4, v72
    v_add_f32 v5, v5, v73
    v_lshlrev_b32 v72, 16, v36
    v_and_b32 v73, s53, v36
    v_add_f32 v4, v4, v72
    v_add_f32 v5, v5, v73
    v_lshlrev_b32 v72, 16, v37
    v_and_b32 v73, s53, v37
    v_add_f32 v4, v4, v72
    v_add_f32 v5, v5, v73
    v_lshlrev_b32 v72, 16, v38
    v_and_b32 v73, s53, v38
    v_add_f32 v4, v4, v72
    v_add_f32 v5, v5, v73
    v_lshlrev_b32 v72, 16, v39
    v_and_b32 v73, s53, v39
    v_add_f32 v4, v4, v72
    v_add_f32 v5, v5, v73
    v_lshlrev_b32 v72, 16, v40
    v_and_b32 v73, s53, v40
    v_add_f32 v4, v4, v72
    v_add_f32 v5, v5, v73
    v_lshlrev_b32 v72, 16, v41
    v_and_b32 v73, s53, v41
    v_add_f32 v4, v4, v72
    v_add_f32 v5, v5, v73
    v_lshlrev_b32 v72, 16, v42
    v_and_b32 v73, s53, v42
    v_add_f32 v4, v4, v72
    v_add_f32 v5, v5, v73
    v_lshlrev_b32 v72, 16, v43
    v_and_b32 v73, s53, v43
    v_add_f32 v4, v4, v72
    v_add_f32 v5, v5, v73
    v_lshlrev_b32 v72, 16, v44
    v_and_b32 v73, s53, v44
    v_add_f32 v4, v4, v72
    v_add_f32 v5, v5, v73
    v_lshlrev_b32 v72, 16, v45
    v_and_b32 v73, s53, v45
    v_add_f32 v4, v4, v72
    v_add_f32 v5, v5, v73
    v_lshlrev_b32 v72, 16, v46
    v_and_b32 v73, s53, v46
    v_add_f32 v4, v4, v72
    v_add_f32 v5, v5, v73
    v_lshlrev_b32 v72, 16, v47
    v_and_b32 v73, s53, v47
    v_add_f32 v4, v4, v72
    v_add_f32 v5, v5, v73
    v_lshlrev_b32 v72, 16, v48
    v_and_b32 v73, s53, v48
    v_add_f32 v4, v4, v72
    v_add_f32 v5, v5, v73
    v_lshlrev_b32 v72, 16, v49
    v_and_b32 v73, s53, v49
    v_add_f32 v4, v4, v72
    v_add_f32 v5, v5, v73
    v_lshlrev_b32 v72, 16, v50
    v_and_b32 v73, s53, v50
    v_add_f32 v4, v4, v72
    v_add_f32 v5, v5, v73
    v_lshlrev_b32 v72, 16, v51
    v_and_b32 v73, s53, v51
    v_add_f32 v4, v4, v72
    v_add_f32 v5, v5, v73
    v_lshlrev_b32 v72, 16, v52
    v_and_b32 v73, s53, v52
    v_add_f32 v4, v4, v72
    v_add_f32 v5, v5, v73
    v_lshlrev_b32 v72, 16, v53
    v_and_b32 v73, s53, v53
    v_add_f32 v4, v4, v72
    v_add_f32 v5, v5, v73
    v_lshlrev_b32 v72, 16, v54
    v_and_b32 v73, s53, v54
    v_add_f32 v4, v4, v72
    v_add_f32 v5, v5, v73
    v_lshlrev_b32 v72, 16, v55
    v_and_b32 v73, s53, v55
    v_add_f32 v4, v4, v72
    v_add_f32 v5, v5, v73
    v_lshlrev_b32 v72, 16, v56
    v_and_b32 v73, s53, v56
    v_add_f32 v4, v4, v72
    v_add_f32 v5, v5, v73
    v_lshlrev_b32 v72, 16, v57
    v_and_b32 v73, s53, v57
    v_add_f32 v4, v4, v72
    v_add_f32 v5, v5, v73
    v_lshlrev_b32 v72, 16, v58
    v_and_b32 v73, s53, v58
    v_add_f32 v4, v4, v72
    v_add_f32 v5, v5, v73
    v_lshlrev_b32 v72, 16, v59
    v_and_b32 v73, s53, v59
    v_add_f32 v4, v4, v72
    v_add_f32 v5, v5, v73
    v_lshlrev_b32 v72, 16, v60
    v_and_b32 v73, s53, v60
    v_add_f32 v4, v4, v72
    v_add_f32 v5, v5, v73
    v_lshlrev_b32 v72, 16, v61
    v_and_b32 v73, s53, v61
    v_add_f32 v4, v4, v72
    v_add_f32 v5, v5, v73
    v_lshlrev_b32 v72, 16, v62
    v_and_b32 v73, s53, v62
    v_add_f32 v4, v4, v72
    v_add_f32 v5, v5, v73
    v_lshlrev_b32 v72, 16, v63
    v_and_b32 v73, s53, v63
    v_add_f32 v4, v4, v72
    v_add_f32 v5, v5, v73
    v_lshlrev_b32 v72, 16, v64
    v_and_b32 v73, s53, v64
    v_add_f32 v4, v4, v72
    v_add_f32 v5, v5, v73
    v_lshlrev_b32 v72, 16, v65
    v_and_b32 v73, s53, v65
    v_add_f32 v4, v4, v72
    v_add_f32 v5, v5, v73
    v_lshlrev_b32 v72, 16, v66
    v_and_b32 v73, s53, v66
    v_add_f32 v4, v4, v72
    v_add_f32 v5, v5, v73
    v_lshlrev_b32 v72, 16, v67
    v_and_b32 v73, s53, v67
    v_add_f32 v4, v4, v72
    v_add_f32 v5, v5, v73
    v_lshlrev_b32 v72, 16, v68
    v_and_b32 v73, s53, v68
    v_add_f32 v4, v4, v72
    v_add_f32 v5, v5, v73
    v_lshlrev_b32 v72, 16, v69
    v_and_b32 v73, s53, v69
    v_add_f32 v4, v4, v72
    v_add_f32 v5, v5, v73
    v_lshlrev_b32 v72, 16, v70
    v_and_b32 v73, s53, v70
    v_add_f32 v4, v4, v72
    v_add_f32 v5, v5, v73
    v_lshlrev_b32 v72, 16, v71
    v_and_b32 v73, s53, v71
    v_add_f32 v4, v4, v72
    v_add_f32 v5, v5, v73
    v_add_f32 v4, v4, v5
    v_mov_b32 v5, v4
    s_nop 1
    v_permlane32_swap_b32 v4, v5
    v_add_f32 v4, v4, v5
    v_mov_b32 v5, v4
    s_nop 1
    v_permlane16_swap_b32 v4, v5
    v_add_f32 v4, v4, v5
    v_mul_f32 v4, 0x3b000000, v4
    v_mov_b32 v5, 0
    v_mov_b32 v6, 0
    v_lshlrev_b32 v72, 16, v8
    v_and_b32 v73, s53, v8
    v_sub_f32 v72, v72, v4
    v_sub_f32 v73, v73, v4
    v_fmac_f32 v5, v72, v72
    v_fmac_f32 v6, v73, v73
    v_lshlrev_b32 v72, 16, v9
    v_and_b32 v73, s53, v9
    v_sub_f32 v72, v72, v4
    v_sub_f32 v73, v73, v4
    v_fmac_f32 v5, v72, v72
    v_fmac_f32 v6, v73, v73
    v_lshlrev_b32 v72, 16, v10
    v_and_b32 v73, s53, v10
    v_sub_f32 v72, v72, v4
    v_sub_f32 v73, v73, v4
    v_fmac_f32 v5, v72, v72
    v_fmac_f32 v6, v73, v73
    v_lshlrev_b32 v72, 16, v11
    v_and_b32 v73, s53, v11
    v_sub_f32 v72, v72, v4
    v_sub_f32 v73, v73, v4
    v_fmac_f32 v5, v72, v72
    v_fmac_f32 v6, v73, v73
    v_lshlrev_b32 v72, 16, v12
    v_and_b32 v73, s53, v12
    v_sub_f32 v72, v72, v4
    v_sub_f32 v73, v73, v4
    v_fmac_f32 v5, v72, v72
    v_fmac_f32 v6, v73, v73
    v_lshlrev_b32 v72, 16, v13
    v_and_b32 v73, s53, v13
    v_sub_f32 v72, v72, v4
    v_sub_f32 v73, v73, v4
    v_fmac_f32 v5, v72, v72
    v_fmac_f32 v6, v73, v73
    v_lshlrev_b32 v72, 16, v14
    v_and_b32 v73, s53, v14
    v_sub_f32 v72, v72, v4
    v_sub_f32 v73, v73, v4
    v_fmac_f32 v5, v72, v72
    v_fmac_f32 v6, v73, v73
    v_lshlrev_b32 v72, 16, v15
    v_and_b32 v73, s53, v15
    v_sub_f32 v72, v72, v4
    v_sub_f32 v73, v73, v4
    v_fmac_f32 v5, v72, v72
    v_fmac_f32 v6, v73, v73
    v_lshlrev_b32 v72, 16, v16
    v_and_b32 v73, s53, v16
    v_sub_f32 v72, v72, v4
    v_sub_f32 v73, v73, v4
    v_fmac_f32 v5, v72, v72
    v_fmac_f32 v6, v73, v73
    v_lshlrev_b32 v72, 16, v17
    v_and_b32 v73, s53, v17
    v_sub_f32 v72, v72, v4
    v_sub_f32 v73, v73, v4
    v_fmac_f32 v5, v72, v72
    v_fmac_f32 v6, v73, v73
    v_lshlrev_b32 v72, 16, v18
    v_and_b32 v73, s53, v18
    v_sub_f32 v72, v72, v4
    v_sub_f32 v73, v73, v4
    v_fmac_f32 v5, v72, v72
    v_fmac_f32 v6, v73, v73
    v_lshlrev_b32 v72, 16, v19
    v_and_b32 v73, s53, v19
    v_sub_f32 v72, v72, v4
    v_sub_f32 v73, v73, v4
    v_fmac_f32 v5, v72, v72
    v_fmac_f32 v6, v73, v73
    v_lshlrev_b32 v72, 16, v20
    v_and_b32 v73, s53, v20
    v_sub_f32 v72, v72, v4
    v_sub_f32 v73, v73, v4
    v_fmac_f32 v5, v72, v72
    v_fmac_f32 v6, v73, v73
    v_lshlrev_b32 v72, 16, v21
    v_and_b32 v73, s53, v21
    v_sub_f32 v72, v72, v4
    v_sub_f32 v73, v73, v4
    v_fmac_f32 v5, v72, v72
    v_fmac_f32 v6, v73, v73
    v_lshlrev_b32 v72, 16, v22
    v_and_b32 v73, s53, v22
    v_sub_f32 v72, v72, v4
    v_sub_f32 v73, v73, v4
    v_fmac_f32 v5, v72, v72
    v_fmac_f32 v6, v73, v73
    v_lshlrev_b32 v72, 16, v23
    v_and_b32 v73, s53, v23
    v_sub_f32 v72, v72, v4
    v_sub_f32 v73, v73, v4
    v_fmac_f32 v5, v72, v72
    v_fmac_f32 v6, v73, v73
    v_lshlrev_b32 v72, 16, v24
    v_and_b32 v73, s53, v24
    v_sub_f32 v72, v72, v4
    v_sub_f32 v73, v73, v4
    v_fmac_f32 v5, v72, v72
    v_fmac_f32 v6, v73, v73
    v_lshlrev_b32 v72, 16, v25
    v_and_b32 v73, s53, v25
    v_sub_f32 v72, v72, v4
    v_sub_f32 v73, v73, v4
    v_fmac_f32 v5, v72, v72
    v_fmac_f32 v6, v73, v73
    v_lshlrev_b32 v72, 16, v26
    v_and_b32 v73, s53, v26
    v_sub_f32 v72, v72, v4
    v_sub_f32 v73, v73, v4
    v_fmac_f32 v5, v72, v72
    v_fmac_f32 v6, v73, v73
    v_lshlrev_b32 v72, 16, v27
    v_and_b32 v73, s53, v27
    v_sub_f32 v72, v72, v4
    v_sub_f32 v73, v73, v4
    v_fmac_f32 v5, v72, v72
    v_fmac_f32 v6, v73, v73
    v_lshlrev_b32 v72, 16, v28
    v_and_b32 v73, s53, v28
    v_sub_f32 v72, v72, v4
    v_sub_f32 v73, v73, v4
    v_fmac_f32 v5, v72, v72
    v_fmac_f32 v6, v73, v73
    v_lshlrev_b32 v72, 16, v29
    v_and_b32 v73, s53, v29
    v_sub_f32 v72, v72, v4
    v_sub_f32 v73, v73, v4
    v_fmac_f32 v5, v72, v72
    v_fmac_f32 v6, v73, v73
    v_lshlrev_b32 v72, 16, v30
    v_and_b32 v73, s53, v30
    v_sub_f32 v72, v72, v4
    v_sub_f32 v73, v73, v4
    v_fmac_f32 v5, v72, v72
    v_fmac_f32 v6, v73, v73
    v_lshlrev_b32 v72, 16, v31
    v_and_b32 v73, s53, v31
    v_sub_f32 v72, v72, v4
    v_sub_f32 v73, v73, v4
    v_fmac_f32 v5, v72, v72
    v_fmac_f32 v6, v73, v73
    v_lshlrev_b32 v72, 16, v32
    v_and_b32 v73, s53, v32
    v_sub_f32 v72, v72, v4
    v_sub_f32 v73, v73, v4
    v_fmac_f32 v5, v72, v72
    v_fmac_f32 v6, v73, v73
    v_lshlrev_b32 v72, 16, v33
    v_and_b32 v73, s53, v33
    v_sub_f32 v72, v72, v4
    v_sub_f32 v73, v73, v4
    v_fmac_f32 v5, v72, v72
    v_fmac_f32 v6, v73, v73
    v_lshlrev_b32 v72, 16, v34
    v_and_b32 v73, s53, v34
    v_sub_f32 v72, v72, v4
    v_sub_f32 v73, v73, v4
    v_fmac_f32 v5, v72, v72
    v_fmac_f32 v6, v73, v73
    v_lshlrev_b32 v72, 16, v35
    v_and_b32 v73, s53, v35
    v_sub_f32 v72, v72, v4
    v_sub_f32 v73, v73, v4
    v_fmac_f32 v5, v72, v72
    v_fmac_f32 v6, v73, v73
    v_lshlrev_b32 v72, 16, v36
    v_and_b32 v73, s53, v36
    v_sub_f32 v72, v72, v4
    v_sub_f32 v73, v73, v4
    v_fmac_f32 v5, v72, v72
    v_fmac_f32 v6, v73, v73
    v_lshlrev_b32 v72, 16, v37
    v_and_b32 v73, s53, v37
    v_sub_f32 v72, v72, v4
    v_sub_f32 v73, v73, v4
    v_fmac_f32 v5, v72, v72
    v_fmac_f32 v6, v73, v73
    v_lshlrev_b32 v72, 16, v38
    v_and_b32 v73, s53, v38
    v_sub_f32 v72, v72, v4
    v_sub_f32 v73, v73, v4
    v_fmac_f32 v5, v72, v72
    v_fmac_f32 v6, v73, v73
    v_lshlrev_b32 v72, 16, v39
    v_and_b32 v73, s53, v39
    v_sub_f32 v72, v72, v4
    v_sub_f32 v73, v73, v4
    v_fmac_f32 v5, v72, v72
    v_fmac_f32 v6, v73, v73
    v_lshlrev_b32 v72, 16, v40
    v_and_b32 v73, s53, v40
    v_sub_f32 v72, v72, v4
    v_sub_f32 v73, v73, v4
    v_fmac_f32 v5, v72, v72
    v_fmac_f32 v6, v73, v73
    v_lshlrev_b32 v72, 16, v41
    v_and_b32 v73, s53, v41
    v_sub_f32 v72, v72, v4
    v_sub_f32 v73, v73, v4
    v_fmac_f32 v5, v72, v72
    v_fmac_f32 v6, v73, v73
    v_lshlrev_b32 v72, 16, v42
    v_and_b32 v73, s53, v42
    v_sub_f32 v72, v72, v4
    v_sub_f32 v73, v73, v4
    v_fmac_f32 v5, v72, v72
    v_fmac_f32 v6, v73, v73
    v_lshlrev_b32 v72, 16, v43
    v_and_b32 v73, s53, v43
    v_sub_f32 v72, v72, v4
    v_sub_f32 v73, v73, v4
    v_fmac_f32 v5, v72, v72
    v_fmac_f32 v6, v73, v73
    v_lshlrev_b32 v72, 16, v44
    v_and_b32 v73, s53, v44
    v_sub_f32 v72, v72, v4
    v_sub_f32 v73, v73, v4
    v_fmac_f32 v5, v72, v72
    v_fmac_f32 v6, v73, v73
    v_lshlrev_b32 v72, 16, v45
    v_and_b32 v73, s53, v45
    v_sub_f32 v72, v72, v4
    v_sub_f32 v73, v73, v4
    v_fmac_f32 v5, v72, v72
    v_fmac_f32 v6, v73, v73
    v_lshlrev_b32 v72, 16, v46
    v_and_b32 v73, s53, v46
    v_sub_f32 v72, v72, v4
    v_sub_f32 v73, v73, v4
    v_fmac_f32 v5, v72, v72
    v_fmac_f32 v6, v73, v73
    v_lshlrev_b32 v72, 16, v47
    v_and_b32 v73, s53, v47
    v_sub_f32 v72, v72, v4
    v_sub_f32 v73, v73, v4
    v_fmac_f32 v5, v72, v72
    v_fmac_f32 v6, v73, v73
    v_lshlrev_b32 v72, 16, v48
    v_and_b32 v73, s53, v48
    v_sub_f32 v72, v72, v4
    v_sub_f32 v73, v73, v4
    v_fmac_f32 v5, v72, v72
    v_fmac_f32 v6, v73, v73
    v_lshlrev_b32 v72, 16, v49
    v_and_b32 v73, s53, v49
    v_sub_f32 v72, v72, v4
    v_sub_f32 v73, v73, v4
    v_fmac_f32 v5, v72, v72
    v_fmac_f32 v6, v73, v73
    v_lshlrev_b32 v72, 16, v50
    v_and_b32 v73, s53, v50
    v_sub_f32 v72, v72, v4
    v_sub_f32 v73, v73, v4
    v_fmac_f32 v5, v72, v72
    v_fmac_f32 v6, v73, v73
    v_lshlrev_b32 v72, 16, v51
    v_and_b32 v73, s53, v51
    v_sub_f32 v72, v72, v4
    v_sub_f32 v73, v73, v4
    v_fmac_f32 v5, v72, v72
    v_fmac_f32 v6, v73, v73
    v_lshlrev_b32 v72, 16, v52
    v_and_b32 v73, s53, v52
    v_sub_f32 v72, v72, v4
    v_sub_f32 v73, v73, v4
    v_fmac_f32 v5, v72, v72
    v_fmac_f32 v6, v73, v73
    v_lshlrev_b32 v72, 16, v53
    v_and_b32 v73, s53, v53
    v_sub_f32 v72, v72, v4
    v_sub_f32 v73, v73, v4
    v_fmac_f32 v5, v72, v72
    v_fmac_f32 v6, v73, v73
    v_lshlrev_b32 v72, 16, v54
    v_and_b32 v73, s53, v54
    v_sub_f32 v72, v72, v4
    v_sub_f32 v73, v73, v4
    v_fmac_f32 v5, v72, v72
    v_fmac_f32 v6, v73, v73
    v_lshlrev_b32 v72, 16, v55
    v_and_b32 v73, s53, v55
    v_sub_f32 v72, v72, v4
    v_sub_f32 v73, v73, v4
    v_fmac_f32 v5, v72, v72
    v_fmac_f32 v6, v73, v73
    v_lshlrev_b32 v72, 16, v56
    v_and_b32 v73, s53, v56
    v_sub_f32 v72, v72, v4
    v_sub_f32 v73, v73, v4
    v_fmac_f32 v5, v72, v72
    v_fmac_f32 v6, v73, v73
    v_lshlrev_b32 v72, 16, v57
    v_and_b32 v73, s53, v57
    v_sub_f32 v72, v72, v4
    v_sub_f32 v73, v73, v4
    v_fmac_f32 v5, v72, v72
    v_fmac_f32 v6, v73, v73
    v_lshlrev_b32 v72, 16, v58
    v_and_b32 v73, s53, v58
    v_sub_f32 v72, v72, v4
    v_sub_f32 v73, v73, v4
    v_fmac_f32 v5, v72, v72
    v_fmac_f32 v6, v73, v73
    v_lshlrev_b32 v72, 16, v59
    v_and_b32 v73, s53, v59
    v_sub_f32 v72, v72, v4
    v_sub_f32 v73, v73, v4
    v_fmac_f32 v5, v72, v72
    v_fmac_f32 v6, v73, v73
    v_lshlrev_b32 v72, 16, v60
    v_and_b32 v73, s53, v60
    v_sub_f32 v72, v72, v4
    v_sub_f32 v73, v73, v4
    v_fmac_f32 v5, v72, v72
    v_fmac_f32 v6, v73, v73
    v_lshlrev_b32 v72, 16, v61
    v_and_b32 v73, s53, v61
    v_sub_f32 v72, v72, v4
    v_sub_f32 v73, v73, v4
    v_fmac_f32 v5, v72, v72
    v_fmac_f32 v6, v73, v73
    v_lshlrev_b32 v72, 16, v62
    v_and_b32 v73, s53, v62
    v_sub_f32 v72, v72, v4
    v_sub_f32 v73, v73, v4
    v_fmac_f32 v5, v72, v72
    v_fmac_f32 v6, v73, v73
    v_lshlrev_b32 v72, 16, v63
    v_and_b32 v73, s53, v63
    v_sub_f32 v72, v72, v4
    v_sub_f32 v73, v73, v4
    v_fmac_f32 v5, v72, v72
    v_fmac_f32 v6, v73, v73
    v_lshlrev_b32 v72, 16, v64
    v_and_b32 v73, s53, v64
    v_sub_f32 v72, v72, v4
    v_sub_f32 v73, v73, v4
    v_fmac_f32 v5, v72, v72
    v_fmac_f32 v6, v73, v73
    v_lshlrev_b32 v72, 16, v65
    v_and_b32 v73, s53, v65
    v_sub_f32 v72, v72, v4
    v_sub_f32 v73, v73, v4
    v_fmac_f32 v5, v72, v72
    v_fmac_f32 v6, v73, v73
    v_lshlrev_b32 v72, 16, v66
    v_and_b32 v73, s53, v66
    v_sub_f32 v72, v72, v4
    v_sub_f32 v73, v73, v4
    v_fmac_f32 v5, v72, v72
    v_fmac_f32 v6, v73, v73
    v_lshlrev_b32 v72, 16, v67
    v_and_b32 v73, s53, v67
    v_sub_f32 v72, v72, v4
    v_sub_f32 v73, v73, v4
    v_fmac_f32 v5, v72, v72
    v_fmac_f32 v6, v73, v73
    v_lshlrev_b32 v72, 16, v68
    v_and_b32 v73, s53, v68
    v_sub_f32 v72, v72, v4
    v_sub_f32 v73, v73, v4
    v_fmac_f32 v5, v72, v72
    v_fmac_f32 v6, v73, v73
    v_lshlrev_b32 v72, 16, v69
    v_and_b32 v73, s53, v69
    v_sub_f32 v72, v72, v4
    v_sub_f32 v73, v73, v4
    v_fmac_f32 v5, v72, v72
    v_fmac_f32 v6, v73, v73
    v_lshlrev_b32 v72, 16, v70
    v_and_b32 v73, s53, v70
    v_sub_f32 v72, v72, v4
    v_sub_f32 v73, v73, v4
    v_fmac_f32 v5, v72, v72
    v_fmac_f32 v6, v73, v73
    v_lshlrev_b32 v72, 16, v71
    v_and_b32 v73, s53, v71
    v_sub_f32 v72, v72, v4
    v_sub_f32 v73, v73, v4
    v_fmac_f32 v5, v72, v72
    v_fmac_f32 v6, v73, v73
    v_add_f32 v5, v5, v6
    v_mov_b32 v6, v5
    s_nop 1
    v_permlane32_swap_b32 v5, v6
    v_add_f32 v5, v5, v6
    v_mov_b32 v6, v5
    s_nop 1
    v_permlane16_swap_b32 v5, v6
    v_add_f32 v5, v5, v6
    v_mov_b32 v6, 0x3727c5ac
    v_fmac_f32 v6, 0x3b000000, v5
    v_rsq_f32 v5, v6
    s_lshl_b32 s52, s40, 14
    s_add_u32 s52, s52, 0x3800000
    s_add_u32 s54, s14, s52
    s_addc_u32 s55, s15, 0
    v_lshlrev_b32 v3, 4, v0
    v_lshlrev_b32 v72, 16, v8
    v_and_b32 v73, s53, v8
    v_sub_f32 v72, v72, v4
    v_sub_f32 v73, v73, v4
    v_mul_f32 v72, v72, v5
    v_mul_f32 v73, v73, v5
    v_cvt_pk_bf16_f32 v8, v72, v73
    v_lshlrev_b32 v72, 16, v9
    v_and_b32 v73, s53, v9
    v_sub_f32 v72, v72, v4
    v_sub_f32 v73, v73, v4
    v_mul_f32 v72, v72, v5
    v_mul_f32 v73, v73, v5
    v_cvt_pk_bf16_f32 v9, v72, v73
    v_lshlrev_b32 v72, 16, v10
    v_and_b32 v73, s53, v10
    v_sub_f32 v72, v72, v4
    v_sub_f32 v73, v73, v4
    v_mul_f32 v72, v72, v5
    v_mul_f32 v73, v73, v5
    v_cvt_pk_bf16_f32 v10, v72, v73
    v_lshlrev_b32 v72, 16, v11
    v_and_b32 v73, s53, v11
    v_sub_f32 v72, v72, v4
    v_sub_f32 v73, v73, v4
    v_mul_f32 v72, v72, v5
    v_mul_f32 v73, v73, v5
    v_cvt_pk_bf16_f32 v11, v72, v73
    global_store_dwordx4 v3, v[8:11], s[54:55] offset:0 sc1
    v_lshlrev_b32 v72, 16, v12
    v_and_b32 v73, s53, v12
    v_sub_f32 v72, v72, v4
    v_sub_f32 v73, v73, v4
    v_mul_f32 v72, v72, v5
    v_mul_f32 v73, v73, v5
    v_cvt_pk_bf16_f32 v12, v72, v73
    v_lshlrev_b32 v72, 16, v13
    v_and_b32 v73, s53, v13
    v_sub_f32 v72, v72, v4
    v_sub_f32 v73, v73, v4
    v_mul_f32 v72, v72, v5
    v_mul_f32 v73, v73, v5
    v_cvt_pk_bf16_f32 v13, v72, v73
    v_lshlrev_b32 v72, 16, v14
    v_and_b32 v73, s53, v14
    v_sub_f32 v72, v72, v4
    v_sub_f32 v73, v73, v4
    v_mul_f32 v72, v72, v5
    v_mul_f32 v73, v73, v5
    v_cvt_pk_bf16_f32 v14, v72, v73
    v_lshlrev_b32 v72, 16, v15
    v_and_b32 v73, s53, v15
    v_sub_f32 v72, v72, v4
    v_sub_f32 v73, v73, v4
    v_mul_f32 v72, v72, v5
    v_mul_f32 v73, v73, v5
    v_cvt_pk_bf16_f32 v15, v72, v73
    global_store_dwordx4 v3, v[12:15], s[54:55] offset:1024 sc1
    v_lshlrev_b32 v72, 16, v16
    v_and_b32 v73, s53, v16
    v_sub_f32 v72, v72, v4
    v_sub_f32 v73, v73, v4
    v_mul_f32 v72, v72, v5
    v_mul_f32 v73, v73, v5
    v_cvt_pk_bf16_f32 v16, v72, v73
    v_lshlrev_b32 v72, 16, v17
    v_and_b32 v73, s53, v17
    v_sub_f32 v72, v72, v4
    v_sub_f32 v73, v73, v4
    v_mul_f32 v72, v72, v5
    v_mul_f32 v73, v73, v5
    v_cvt_pk_bf16_f32 v17, v72, v73
    v_lshlrev_b32 v72, 16, v18
    v_and_b32 v73, s53, v18
    v_sub_f32 v72, v72, v4
    v_sub_f32 v73, v73, v4
    v_mul_f32 v72, v72, v5
    v_mul_f32 v73, v73, v5
    v_cvt_pk_bf16_f32 v18, v72, v73
    v_lshlrev_b32 v72, 16, v19
    v_and_b32 v73, s53, v19
    v_sub_f32 v72, v72, v4
    v_sub_f32 v73, v73, v4
    v_mul_f32 v72, v72, v5
    v_mul_f32 v73, v73, v5
    v_cvt_pk_bf16_f32 v19, v72, v73
    global_store_dwordx4 v3, v[16:19], s[54:55] offset:2048 sc1
    v_lshlrev_b32 v72, 16, v20
    v_and_b32 v73, s53, v20
    v_sub_f32 v72, v72, v4
    v_sub_f32 v73, v73, v4
    v_mul_f32 v72, v72, v5
    v_mul_f32 v73, v73, v5
    v_cvt_pk_bf16_f32 v20, v72, v73
    v_lshlrev_b32 v72, 16, v21
    v_and_b32 v73, s53, v21
    v_sub_f32 v72, v72, v4
    v_sub_f32 v73, v73, v4
    v_mul_f32 v72, v72, v5
    v_mul_f32 v73, v73, v5
    v_cvt_pk_bf16_f32 v21, v72, v73
    v_lshlrev_b32 v72, 16, v22
    v_and_b32 v73, s53, v22
    v_sub_f32 v72, v72, v4
    v_sub_f32 v73, v73, v4
    v_mul_f32 v72, v72, v5
    v_mul_f32 v73, v73, v5
    v_cvt_pk_bf16_f32 v22, v72, v73
    v_lshlrev_b32 v72, 16, v23
    v_and_b32 v73, s53, v23
    v_sub_f32 v72, v72, v4
    v_sub_f32 v73, v73, v4
    v_mul_f32 v72, v72, v5
    v_mul_f32 v73, v73, v5
    v_cvt_pk_bf16_f32 v23, v72, v73
    global_store_dwordx4 v3, v[20:23], s[54:55] offset:3072 sc1
    v_lshlrev_b32 v72, 16, v24
    v_and_b32 v73, s53, v24
    v_sub_f32 v72, v72, v4
    v_sub_f32 v73, v73, v4
    v_mul_f32 v72, v72, v5
    v_mul_f32 v73, v73, v5
    v_cvt_pk_bf16_f32 v24, v72, v73
    v_lshlrev_b32 v72, 16, v25
    v_and_b32 v73, s53, v25
    v_sub_f32 v72, v72, v4
    v_sub_f32 v73, v73, v4
    v_mul_f32 v72, v72, v5
    v_mul_f32 v73, v73, v5
    v_cvt_pk_bf16_f32 v25, v72, v73
    v_lshlrev_b32 v72, 16, v26
    v_and_b32 v73, s53, v26
    v_sub_f32 v72, v72, v4
    v_sub_f32 v73, v73, v4
    v_mul_f32 v72, v72, v5
    v_mul_f32 v73, v73, v5
    v_cvt_pk_bf16_f32 v26, v72, v73
    v_lshlrev_b32 v72, 16, v27
    v_and_b32 v73, s53, v27
    v_sub_f32 v72, v72, v4
    v_sub_f32 v73, v73, v4
    v_mul_f32 v72, v72, v5
    v_mul_f32 v73, v73, v5
    v_cvt_pk_bf16_f32 v27, v72, v73
    v_add_u32 v3, 4096, v3
    global_store_dwordx4 v3, v[24:27], s[54:55] offset:0 sc1
    v_lshlrev_b32 v72, 16, v28
    v_and_b32 v73, s53, v28
    v_sub_f32 v72, v72, v4
    v_sub_f32 v73, v73, v4
    v_mul_f32 v72, v72, v5
    v_mul_f32 v73, v73, v5
    v_cvt_pk_bf16_f32 v28, v72, v73
    v_lshlrev_b32 v72, 16, v29
    v_and_b32 v73, s53, v29
    v_sub_f32 v72, v72, v4
    v_sub_f32 v73, v73, v4
    v_mul_f32 v72, v72, v5
    v_mul_f32 v73, v73, v5
    v_cvt_pk_bf16_f32 v29, v72, v73
    v_lshlrev_b32 v72, 16, v30
    v_and_b32 v73, s53, v30
    v_sub_f32 v72, v72, v4
    v_sub_f32 v73, v73, v4
    v_mul_f32 v72, v72, v5
    v_mul_f32 v73, v73, v5
    v_cvt_pk_bf16_f32 v30, v72, v73
    v_lshlrev_b32 v72, 16, v31
    v_and_b32 v73, s53, v31
    v_sub_f32 v72, v72, v4
    v_sub_f32 v73, v73, v4
    v_mul_f32 v72, v72, v5
    v_mul_f32 v73, v73, v5
    v_cvt_pk_bf16_f32 v31, v72, v73
    global_store_dwordx4 v3, v[28:31], s[54:55] offset:1024 sc1
    v_lshlrev_b32 v72, 16, v32
    v_and_b32 v73, s53, v32
    v_sub_f32 v72, v72, v4
    v_sub_f32 v73, v73, v4
    v_mul_f32 v72, v72, v5
    v_mul_f32 v73, v73, v5
    v_cvt_pk_bf16_f32 v32, v72, v73
    v_lshlrev_b32 v72, 16, v33
    v_and_b32 v73, s53, v33
    v_sub_f32 v72, v72, v4
    v_sub_f32 v73, v73, v4
    v_mul_f32 v72, v72, v5
    v_mul_f32 v73, v73, v5
    v_cvt_pk_bf16_f32 v33, v72, v73
    v_lshlrev_b32 v72, 16, v34
    v_and_b32 v73, s53, v34
    v_sub_f32 v72, v72, v4
    v_sub_f32 v73, v73, v4
    v_mul_f32 v72, v72, v5
    v_mul_f32 v73, v73, v5
    v_cvt_pk_bf16_f32 v34, v72, v73
    v_lshlrev_b32 v72, 16, v35
    v_and_b32 v73, s53, v35
    v_sub_f32 v72, v72, v4
    v_sub_f32 v73, v73, v4
    v_mul_f32 v72, v72, v5
    v_mul_f32 v73, v73, v5
    v_cvt_pk_bf16_f32 v35, v72, v73
    global_store_dwordx4 v3, v[32:35], s[54:55] offset:2048 sc1
    v_lshlrev_b32 v72, 16, v36
    v_and_b32 v73, s53, v36
    v_sub_f32 v72, v72, v4
    v_sub_f32 v73, v73, v4
    v_mul_f32 v72, v72, v5
    v_mul_f32 v73, v73, v5
    v_cvt_pk_bf16_f32 v36, v72, v73
    v_lshlrev_b32 v72, 16, v37
    v_and_b32 v73, s53, v37
    v_sub_f32 v72, v72, v4
    v_sub_f32 v73, v73, v4
    v_mul_f32 v72, v72, v5
    v_mul_f32 v73, v73, v5
    v_cvt_pk_bf16_f32 v37, v72, v73
    v_lshlrev_b32 v72, 16, v38
    v_and_b32 v73, s53, v38
    v_sub_f32 v72, v72, v4
    v_sub_f32 v73, v73, v4
    v_mul_f32 v72, v72, v5
    v_mul_f32 v73, v73, v5
    v_cvt_pk_bf16_f32 v38, v72, v73
    v_lshlrev_b32 v72, 16, v39
    v_and_b32 v73, s53, v39
    v_sub_f32 v72, v72, v4
    v_sub_f32 v73, v73, v4
    v_mul_f32 v72, v72, v5
    v_mul_f32 v73, v73, v5
    v_cvt_pk_bf16_f32 v39, v72, v73
    global_store_dwordx4 v3, v[36:39], s[54:55] offset:3072 sc1
    v_lshlrev_b32 v72, 16, v40
    v_and_b32 v73, s53, v40
    v_sub_f32 v72, v72, v4
    v_sub_f32 v73, v73, v4
    v_mul_f32 v72, v72, v5
    v_mul_f32 v73, v73, v5
    v_cvt_pk_bf16_f32 v40, v72, v73
    v_lshlrev_b32 v72, 16, v41
    v_and_b32 v73, s53, v41
    v_sub_f32 v72, v72, v4
    v_sub_f32 v73, v73, v4
    v_mul_f32 v72, v72, v5
    v_mul_f32 v73, v73, v5
    v_cvt_pk_bf16_f32 v41, v72, v73
    v_lshlrev_b32 v72, 16, v42
    v_and_b32 v73, s53, v42
    v_sub_f32 v72, v72, v4
    v_sub_f32 v73, v73, v4
    v_mul_f32 v72, v72, v5
    v_mul_f32 v73, v73, v5
    v_cvt_pk_bf16_f32 v42, v72, v73
    v_lshlrev_b32 v72, 16, v43
    v_and_b32 v73, s53, v43
    v_sub_f32 v72, v72, v4
    v_sub_f32 v73, v73, v4
    v_mul_f32 v72, v72, v5
    v_mul_f32 v73, v73, v5
    v_cvt_pk_bf16_f32 v43, v72, v73
    v_add_u32 v3, 4096, v3
    global_store_dwordx4 v3, v[40:43], s[54:55] offset:0 sc1
    v_lshlrev_b32 v72, 16, v44
    v_and_b32 v73, s53, v44
    v_sub_f32 v72, v72, v4
    v_sub_f32 v73, v73, v4
    v_mul_f32 v72, v72, v5
    v_mul_f32 v73, v73, v5
    v_cvt_pk_bf16_f32 v44, v72, v73
    v_lshlrev_b32 v72, 16, v45
    v_and_b32 v73, s53, v45
    v_sub_f32 v72, v72, v4
    v_sub_f32 v73, v73, v4
    v_mul_f32 v72, v72, v5
    v_mul_f32 v73, v73, v5
    v_cvt_pk_bf16_f32 v45, v72, v73
    v_lshlrev_b32 v72, 16, v46
    v_and_b32 v73, s53, v46
    v_sub_f32 v72, v72, v4
    v_sub_f32 v73, v73, v4
    v_mul_f32 v72, v72, v5
    v_mul_f32 v73, v73, v5
    v_cvt_pk_bf16_f32 v46, v72, v73
    v_lshlrev_b32 v72, 16, v47
    v_and_b32 v73, s53, v47
    v_sub_f32 v72, v72, v4
    v_sub_f32 v73, v73, v4
    v_mul_f32 v72, v72, v5
    v_mul_f32 v73, v73, v5
    v_cvt_pk_bf16_f32 v47, v72, v73
    global_store_dwordx4 v3, v[44:47], s[54:55] offset:1024 sc1
    v_lshlrev_b32 v72, 16, v48
    v_and_b32 v73, s53, v48
    v_sub_f32 v72, v72, v4
    v_sub_f32 v73, v73, v4
    v_mul_f32 v72, v72, v5
    v_mul_f32 v73, v73, v5
    v_cvt_pk_bf16_f32 v48, v72, v73
    v_lshlrev_b32 v72, 16, v49
    v_and_b32 v73, s53, v49
    v_sub_f32 v72, v72, v4
    v_sub_f32 v73, v73, v4
    v_mul_f32 v72, v72, v5
    v_mul_f32 v73, v73, v5
    v_cvt_pk_bf16_f32 v49, v72, v73
    v_lshlrev_b32 v72, 16, v50
    v_and_b32 v73, s53, v50
    v_sub_f32 v72, v72, v4
    v_sub_f32 v73, v73, v4
    v_mul_f32 v72, v72, v5
    v_mul_f32 v73, v73, v5
    v_cvt_pk_bf16_f32 v50, v72, v73
    v_lshlrev_b32 v72, 16, v51
    v_and_b32 v73, s53, v51
    v_sub_f32 v72, v72, v4
    v_sub_f32 v73, v73, v4
    v_mul_f32 v72, v72, v5
    v_mul_f32 v73, v73, v5
    v_cvt_pk_bf16_f32 v51, v72, v73
    global_store_dwordx4 v3, v[48:51], s[54:55] offset:2048 sc1
    v_lshlrev_b32 v72, 16, v52
    v_and_b32 v73, s53, v52
    v_sub_f32 v72, v72, v4
    v_sub_f32 v73, v73, v4
    v_mul_f32 v72, v72, v5
    v_mul_f32 v73, v73, v5
    v_cvt_pk_bf16_f32 v52, v72, v73
    v_lshlrev_b32 v72, 16, v53
    v_and_b32 v73, s53, v53
    v_sub_f32 v72, v72, v4
    v_sub_f32 v73, v73, v4
    v_mul_f32 v72, v72, v5
    v_mul_f32 v73, v73, v5
    v_cvt_pk_bf16_f32 v53, v72, v73
    v_lshlrev_b32 v72, 16, v54
    v_and_b32 v73, s53, v54
    v_sub_f32 v72, v72, v4
    v_sub_f32 v73, v73, v4
    v_mul_f32 v72, v72, v5
    v_mul_f32 v73, v73, v5
    v_cvt_pk_bf16_f32 v54, v72, v73
    v_lshlrev_b32 v72, 16, v55
    v_and_b32 v73, s53, v55
    v_sub_f32 v72, v72, v4
    v_sub_f32 v73, v73, v4
    v_mul_f32 v72, v72, v5
    v_mul_f32 v73, v73, v5
    v_cvt_pk_bf16_f32 v55, v72, v73
    global_store_dwordx4 v3, v[52:55], s[54:55] offset:3072 sc1
    v_lshlrev_b32 v72, 16, v56
    v_and_b32 v73, s53, v56
    v_sub_f32 v72, v72, v4
    v_sub_f32 v73, v73, v4
    v_mul_f32 v72, v72, v5
    v_mul_f32 v73, v73, v5
    v_cvt_pk_bf16_f32 v56, v72, v73
    v_lshlrev_b32 v72, 16, v57
    v_and_b32 v73, s53, v57
    v_sub_f32 v72, v72, v4
    v_sub_f32 v73, v73, v4
    v_mul_f32 v72, v72, v5
    v_mul_f32 v73, v73, v5
    v_cvt_pk_bf16_f32 v57, v72, v73
    v_lshlrev_b32 v72, 16, v58
    v_and_b32 v73, s53, v58
    v_sub_f32 v72, v72, v4
    v_sub_f32 v73, v73, v4
    v_mul_f32 v72, v72, v5
    v_mul_f32 v73, v73, v5
    v_cvt_pk_bf16_f32 v58, v72, v73
    v_lshlrev_b32 v72, 16, v59
    v_and_b32 v73, s53, v59
    v_sub_f32 v72, v72, v4
    v_sub_f32 v73, v73, v4
    v_mul_f32 v72, v72, v5
    v_mul_f32 v73, v73, v5
    v_cvt_pk_bf16_f32 v59, v72, v73
    v_add_u32 v3, 4096, v3
    global_store_dwordx4 v3, v[56:59], s[54:55] offset:0 sc1
    v_lshlrev_b32 v72, 16, v60
    v_and_b32 v73, s53, v60
    v_sub_f32 v72, v72, v4
    v_sub_f32 v73, v73, v4
    v_mul_f32 v72, v72, v5
    v_mul_f32 v73, v73, v5
    v_cvt_pk_bf16_f32 v60, v72, v73
    v_lshlrev_b32 v72, 16, v61
    v_and_b32 v73, s53, v61
    v_sub_f32 v72, v72, v4
    v_sub_f32 v73, v73, v4
    v_mul_f32 v72, v72, v5
    v_mul_f32 v73, v73, v5
    v_cvt_pk_bf16_f32 v61, v72, v73
    v_lshlrev_b32 v72, 16, v62
    v_and_b32 v73, s53, v62
    v_sub_f32 v72, v72, v4
    v_sub_f32 v73, v73, v4
    v_mul_f32 v72, v72, v5
    v_mul_f32 v73, v73, v5
    v_cvt_pk_bf16_f32 v62, v72, v73
    v_lshlrev_b32 v72, 16, v63
    v_and_b32 v73, s53, v63
    v_sub_f32 v72, v72, v4
    v_sub_f32 v73, v73, v4
    v_mul_f32 v72, v72, v5
    v_mul_f32 v73, v73, v5
    v_cvt_pk_bf16_f32 v63, v72, v73
    global_store_dwordx4 v3, v[60:63], s[54:55] offset:1024 sc1
    v_lshlrev_b32 v72, 16, v64
    v_and_b32 v73, s53, v64
    v_sub_f32 v72, v72, v4
    v_sub_f32 v73, v73, v4
    v_mul_f32 v72, v72, v5
    v_mul_f32 v73, v73, v5
    v_cvt_pk_bf16_f32 v64, v72, v73
    v_lshlrev_b32 v72, 16, v65
    v_and_b32 v73, s53, v65
    v_sub_f32 v72, v72, v4
    v_sub_f32 v73, v73, v4
    v_mul_f32 v72, v72, v5
    v_mul_f32 v73, v73, v5
    v_cvt_pk_bf16_f32 v65, v72, v73
    v_lshlrev_b32 v72, 16, v66
    v_and_b32 v73, s53, v66
    v_sub_f32 v72, v72, v4
    v_sub_f32 v73, v73, v4
    v_mul_f32 v72, v72, v5
    v_mul_f32 v73, v73, v5
    v_cvt_pk_bf16_f32 v66, v72, v73
    v_lshlrev_b32 v72, 16, v67
    v_and_b32 v73, s53, v67
    v_sub_f32 v72, v72, v4
    v_sub_f32 v73, v73, v4
    v_mul_f32 v72, v72, v5
    v_mul_f32 v73, v73, v5
    v_cvt_pk_bf16_f32 v67, v72, v73
    global_store_dwordx4 v3, v[64:67], s[54:55] offset:2048 sc1
    v_lshlrev_b32 v72, 16, v68
    v_and_b32 v73, s53, v68
    v_sub_f32 v72, v72, v4
    v_sub_f32 v73, v73, v4
    v_mul_f32 v72, v72, v5
    v_mul_f32 v73, v73, v5
    v_cvt_pk_bf16_f32 v68, v72, v73
    v_lshlrev_b32 v72, 16, v69
    v_and_b32 v73, s53, v69
    v_sub_f32 v72, v72, v4
    v_sub_f32 v73, v73, v4
    v_mul_f32 v72, v72, v5
    v_mul_f32 v73, v73, v5
    v_cvt_pk_bf16_f32 v69, v72, v73
    v_lshlrev_b32 v72, 16, v70
    v_and_b32 v73, s53, v70
    v_sub_f32 v72, v72, v4
    v_sub_f32 v73, v73, v4
    v_mul_f32 v72, v72, v5
    v_mul_f32 v73, v73, v5
    v_cvt_pk_bf16_f32 v70, v72, v73
    v_lshlrev_b32 v72, 16, v71
    v_and_b32 v73, s53, v71
    v_sub_f32 v72, v72, v4
    v_sub_f32 v73, v73, v4
    v_mul_f32 v72, v72, v5
    v_mul_f32 v73, v73, v5
    v_cvt_pk_bf16_f32 v71, v72, v73
    global_store_dwordx4 v3, v[68:71], s[54:55] offset:3072 sc1
    s_waitcnt vmcnt(0)
L_x_noln:
    s_waitcnt vmcnt(0)
    s_barrier
    s_cmp_eq_u32 s19, 0
    s_cbranch_scc0 L_x_lnarr
    s_add_u32 s56, s84, 32
    v_mov_b32 v1, s56
    v_mov_b32 v2, 1
    s_mov_b64 exec, 1
    global_atomic_add v1, v2, s[16:17]
    s_mov_b64 exec, -1
L_x_lnarr:
    s_mov_b32 s24, s42
    s_mul_i32 s52, s42, 4194304
    s_add_u32 s52, s52, 0x4000000
    s_add_u32 s26, s14, s52
    s_addc_u32 s27, s15, 0
    s_cmp_eq_u32 s82, 0
    s_cbranch_scc0 L_x_initS
    v_mov_b32 v108, -1
    v_mov_b32 v109, -1
    v_mov_b32 v110, -1
    v_mov_b32 v111, -1
    s_lshl_b32 s52, s18, 15
    s_lshl_b32 s53, s19, 13
    s_add_u32 s52, s52, s53
    v_lshlrev_b32 v106, 4, v0
    v_add_u32 v106, s52, v106
    s_add_u32 s32, s26, 0x0
    s_addc_u32 s33, s27, 0
    global_store_dwordx4 v106, v[108:111], s[32:33] offset:0
    global_store_dwordx4 v106, v[108:111], s[32:33] offset:1024
    global_store_dwordx4 v106, v[108:111], s[32:33] offset:2048
    global_store_dwordx4 v106, v[108:111], s[32:33] offset:3072
    s_add_u32 s32, s32, 0x1000
    s_addc_u32 s33, s33, 0
    global_store_dwordx4 v106, v[108:111], s[32:33] offset:0
    global_store_dwordx4 v106, v[108:111], s[32:33] offset:1024
    global_store_dwordx4 v106, v[108:111], s[32:33] offset:2048
    global_store_dwordx4 v106, v[108:111], s[32:33] offset:3072
    s_add_u32 s32, s26, 0x100000
    s_addc_u32 s33, s27, 0
    global_store_dwordx4 v106, v[108:111], s[32:33] offset:0
    global_store_dwordx4 v106, v[108:111], s[32:33] offset:1024
    global_store_dwordx4 v106, v[108:111], s[32:33] offset:2048
    global_store_dwordx4 v106, v[108:111], s[32:33] offset:3072
    s_add_u32 s32, s32, 0x1000
    s_addc_u32 s33, s33, 0
    global_store_dwordx4 v106, v[108:111], s[32:33] offset:0
    global_store_dwordx4 v106, v[108:111], s[32:33] offset:1024
    global_store_dwordx4 v106, v[108:111], s[32:33] offset:2048
    global_store_dwordx4 v106, v[108:111], s[32:33] offset:3072
    s_branch L_x_initD
L_x_initS:
    v_mov_b32 v108, -1
    v_mov_b32 v109, -1
    v_mov_b32 v110, -1
    v_mov_b32 v111, -1
    s_lshl_b32 s52, s18, 15
    s_lshl_b32 s53, s19, 13
    s_add_u32 s52, s52, s53
    v_lshlrev_b32 v106, 4, v0
    v_add_u32 v106, s52, v106
    s_add_u32 s32, s26, 0x0
    s_addc_u32 s33, s27, 0
    global_store_dwordx4 v106, v[108:111], s[32:33] offset:0 sc1
    global_store_dwordx4 v106, v[108:111], s[32:33] offset:1024 sc1
    global_store_dwordx4 v106, v[108:111], s[32:33] offset:2048 sc1
    global_store_dwordx4 v106, v[108:111], s[32:33] offset:3072 sc1
    s_add_u32 s32, s32, 0x1000
    s_addc_u32 s33, s33, 0
    global_store_dwordx4 v106, v[108:111], s[32:33] offset:0 sc1
    global_store_dwordx4 v106, v[108:111], s[32:33] offset:1024 sc1
    global_store_dwordx4 v106, v[108:111], s[32:33] offset:2048 sc1
    global_store_dwordx4 v106, v[108:111], s[32:33] offset:3072 sc1
    s_add_u32 s32, s26, 0x100000
    s_addc_u32 s33, s27, 0
    global_store_dwordx4 v106, v[108:111], s[32:33] offset:0 sc1
    global_store_dwordx4 v106, v[108:111], s[32:33] offset:1024 sc1
    global_store_dwordx4 v106, v[108:111], s[32:33] offset:2048 sc1
    global_store_dwordx4 v106, v[108:111], s[32:33] offset:3072 sc1
    s_add_u32 s32, s32, 0x1000
    s_addc_u32 s33, s33, 0
    global_store_dwordx4 v106, v[108:111], s[32:33] offset:0 sc1
    global_store_dwordx4 v106, v[108:111], s[32:33] offset:1024 sc1
    global_store_dwordx4 v106, v[108:111], s[32:33] offset:2048 sc1
    global_store_dwordx4 v106, v[108:111], s[32:33] offset:3072 sc1
L_x_initD:
    s_lshl_b32 s41, s42, 2
    s_waitcnt vmcnt(0)
    s_barrier
    s_cmp_eq_u32 s19, 0
    s_cbranch_scc0 L_x_tarr
    s_add_u32 s56, s84, 68
    s_add_u32 s56, s56, s41
    v_mov_b32 v1, s56
    v_mov_b32 v2, 1
    s_mov_b64 exec, 1
    global_atomic_add v1, v2, s[16:17]
    s_mov_b64 exec, -1
L_x_tarr:
    v_and_b32 v104, 15, v0
    v_lshrrev_b32 v105, 4, v0
    v_lshlrev_b32 v1, 4, v0
    v_lshrrev_b32 v101, 2, v104
    v_lshlrev_b32 v101, 1, v101
    v_and_b32 v102, 1, v104
    v_add_u32 v101, v101, v102
    v_lshlrev_b32 v101, 4, v101
    v_lshl_add_u32 v2, v105, 7, v101
    s_and_b32 s52, s19, 1
    s_lshl_b32 s52, s52, 10
    v_lshlrev_b32 v101, 2, v0
    v_add_u32 v3, s52, v101
    s_lshl_b32 s52, s19, 18
    s_lshl_b32 s53, s18, 10
    s_add_u32 s52, s52, s53
    v_add_u32 v4, s52, v1
    s_lshl_b32 s52, s18, 15
    s_lshl_b32 s53, s19, 8
    s_add_u32 s52, s52, s53
    v_lshlrev_b32 v101, 10, v105
    v_lshl_add_u32 v101, v104, 4, v101
    v_add_u32 v5, s52, v101
    v_and_b32 v101, 31, v0
    v_lshlrev_b32 v101, 10, v101
    s_lshl_b32 s52, s18, 5
    s_lshl_b32 s53, s19, 3
    s_add_u32 s52, s52, s53
    v_add_u32 v6, s52, v101
    v_and_b32 v101, 1, v105
    v_lshlrev_b32 v101, 14, v101
    v_lshl_add_u32 v101, v104, 4, v101
    s_lshr_b32 s52, s18, 1
    s_lshl_b32 s52, s52, 10
    s_lshl_b32 s53, s19, 8
    s_add_u32 s52, s52, s53
    s_and_b32 s53, s18, 1
    s_lshl_b32 s53, s53, 3
    s_add_u32 s52, s52, s53
    v_add_u32 v7, s52, v101
    s_mul_i32 s52, s19, 12288
    s_add_u32 s52, s52, 114688
    v_add_u32 v9, s52, v1
    v_lshlrev_b32 v101, 2, v105
    v_mov_b32 v103, 0xf149f2ca
    v_add_u32 v102, 0, v101
    v_cmp_gt_u32 vcc, v102, v104
    s_nop 1
    v_cndmask_b32 v16, 0, v103, vcc
    v_add_u32 v102, 1, v101
    v_cmp_gt_u32 vcc, v102, v104
    s_nop 1
    v_cndmask_b32 v17, 0, v103, vcc
    v_add_u32 v102, 2, v101
    v_cmp_gt_u32 vcc, v102, v104
    s_nop 1
    v_cndmask_b32 v18, 0, v103, vcc
    v_add_u32 v102, 3, v101
    v_cmp_gt_u32 vcc, v102, v104
    s_nop 1
    v_cndmask_b32 v19, 0, v103, vcc
    s_cmp_lt_u32 s19, 2
    s_cbranch_scc1 L_x_mU0
    v_mov_b32 v20, v16
    v_mov_b32 v16, 0
    v_mov_b32 v21, v17
    v_mov_b32 v17, 0
    v_mov_b32 v22, v18
    v_mov_b32 v18, 0
    v_mov_b32 v23, v19
    v_mov_b32 v19, 0
    s_branch L_x_mdone
L_x_mU0:
    v_mov_b32 v20, v103
    v_mov_b32 v21, v103
    v_mov_b32 v22, v103
    v_mov_b32 v23, v103
L_x_mdone:
    v_and_b32 v102, 7, v104
    v_mov_b32 v28, 0
    v_mov_b32 v103, 0x3f80
    v_cmp_eq_u32 vcc, 0, v102
    s_nop 1
    v_cndmask_b32 v28, v28, v103, vcc
    v_mov_b32 v103, 0x3f800000
    v_cmp_eq_u32 vcc, 1, v102
    s_nop 1
    v_cndmask_b32 v28, v28, v103, vcc
    v_mov_b32 v24, 0x3f803f80
    v_mov_b32 v29, 0
    v_mov_b32 v103, 0x3f80
    v_cmp_eq_u32 vcc, 2, v102
    s_nop 1
    v_cndmask_b32 v29, v29, v103, vcc
    v_mov_b32 v103, 0x3f800000
    v_cmp_eq_u32 vcc, 3, v102
    s_nop 1
    v_cndmask_b32 v29, v29, v103, vcc
    v_mov_b32 v25, 0x3f803f80
    v_mov_b32 v30, 0
    v_mov_b32 v103, 0x3f80
    v_cmp_eq_u32 vcc, 4, v102
    s_nop 1
    v_cndmask_b32 v30, v30, v103, vcc
    v_mov_b32 v103, 0x3f800000
    v_cmp_eq_u32 vcc, 5, v102
    s_nop 1
    v_cndmask_b32 v30, v30, v103, vcc
    v_mov_b32 v26, 0x3f803f80
    v_mov_b32 v31, 0
    v_mov_b32 v103, 0x3f80
    v_cmp_eq_u32 vcc, 6, v102
    s_nop 1
    v_cndmask_b32 v31, v31, v103, vcc
    v_mov_b32 v103, 0x3f800000
    v_cmp_eq_u32 vcc, 7, v102
    s_nop 1
    v_cndmask_b32 v31, v31, v103, vcc
    v_mov_b32 v27, 0x3f803f80
    s_mov_b32 s40, -1
    s_mov_b32 s41, 0
    s_mov_b32 s30, 0x3e0293ee
    s_mov_b32 s31, 0x3e0293ee
    s_cmp_eq_u32 s19, 0
    s_cbranch_scc0 L_x_cload_ok
    s_add_u32 s56, s84, 40
    v_mov_b32 v10, s56
    s_mov_b32 s56, 0
L_x_cload:
    global_load_dword v11, v10, s[16:17] sc1
    s_add_u32 s56, s56, 1
    s_cmp_gt_u32 s56, 400000
    s_cbranch_scc1 L_fail
    s_waitcnt vmcnt(0)
    v_readfirstlane_b32 s57, v11
    s_nop 3
    s_cmp_ge_u32 s57, 32
    s_cbranch_scc1 L_x_cload_ok
    s_sleep 16
    s_branch L_x_cload
L_x_cload_ok:
    s_barrier
    v_mov_b32 v100, v0
    s_lshl_b32 s53, s18, 8
    v_lshrrev_b32 v101, 4, v100
    v_lshlrev_b32 v102, 1, v101
    v_and_b32 v103, 15, v100
    v_xor_b32 v102, v102, v103
    s_lshl_b32 s52, s19, 4
    v_add_u32 v101, s52, v101
    v_lshlrev_b32 v101, 13, v101
    v_add_u32 v101, s53, v101
    v_lshl_add_u32 v106, v102, 4, v101
    v_xor_b32 v102, 8, v102
    v_lshl_add_u32 v107, v102, 4, v101
    v_lshrrev_b32 v101, 4, v100
    v_bfe_u32 v102, v100, 2, 2
    v_lshl_add_u32 v103, v101, 3, v102
    v_lshlrev_b32 v103, 8, v103
    v_and_b32 v101, 1, v101
    v_lshlrev_b32 v101, 3, v101
    v_lshl_add_u32 v101, v102, 1, v101
    v_bfe_u32 v102, v100, 1, 1
    s_lshl_b32 s52, s19, 2
    v_or_b32 v102, s52, v102
    v_xor_b32 v101, v101, v102
    v_lshl_add_u32 v103, v101, 4, v103
    v_and_b32 v101, 1, v100
    v_lshl_add_u32 v108, v101, 3, v103
    v_xor_b32 v109, 32, v108
    v_add_u32 v110, 0x10000, v108
    v_add_u32 v111, 0x10000, v109
    v_lshrrev_b32 v101, 4, v100
    v_lshlrev_b32 v102, 1, v101
    v_or_b32 v102, 0, v102
    v_and_b32 v103, 15, v100
    v_xor_b32 v102, v102, v103
    v_lshrrev_b32 v103, 2, v102
    v_lshlrev_b32 v103, 8, v103
    v_and_b32 v102, 3, v102
    v_lshl_add_u32 v103, v102, 4, v103
    s_lshl_b32 s52, s19, 4
    v_add_u32 v101, s52, v101
    v_lshlrev_b32 v101, 10, v101
    s_lshl_b32 s52, s18, 17
    v_add3_u32 v112, v101, v103, s52
    v_lshrrev_b32 v101, 4, v100
    v_lshlrev_b32 v102, 1, v101
    v_or_b32 v102, 8, v102
    v_and_b32 v103, 15, v100
    v_xor_b32 v102, v102, v103
    v_lshrrev_b32 v103, 2, v102
    v_lshlrev_b32 v103, 8, v103
    v_and_b32 v102, 3, v102
    v_lshl_add_u32 v103, v102, 4, v103
    s_lshl_b32 s52, s19, 4
    v_add_u32 v101, s52, v101
    v_lshlrev_b32 v101, 10, v101
    s_lshl_b32 s52, s18, 17
    v_add3_u32 v113, v101, v103, s52
    v_lshrrev_b32 v101, 4, v100
    v_bfe_u32 v102, v100, 2, 2
    v_lshl_add_u32 v101, v101, 2, v102
    v_and_b32 v102, 7, v101
    v_lshlrev_b32 v102, 1, v102
    v_bfe_u32 v103, v100, 1, 1
    s_lshl_b32 s52, s19, 2
    v_or_b32 v103, s52, v103
    v_xor_b32 v102, v102, v103
    v_lshlrev_b32 v101, 8, v101
    v_lshl_add_u32 v101, v102, 4, v101
    v_and_b32 v103, 1, v100
    v_lshl_add_u32 v114, v103, 3, v101
    v_xor_b32 v115, 32, v114
    v_add_u32 v116, 0x10000, v114
    v_add_u32 v117, 0x10000, v115
    v_and_b32 v101, 7, v100
    v_min_u32 v101, 5, v101
    v_lshlrev_b32 v101, 3, v101
    s_mul_i32 s52, s18, 48
    v_add_u32 v101, s52, v101
    v_min_u32 v101, 1368, v101
    v_lshlrev_b32 v101, 1, v101
    v_lshrrev_b32 v102, 3, v100
    s_mov_b32 s52, 2752
    v_mul_lo_u32 v102, v102, s52
    v_add_u32 v118, v101, v102
    v_lshrrev_b32 v101, 4, v100
    v_bfe_u32 v102, v100, 2, 2
    v_lshl_add_u32 v101, v101, 2, v102
    v_lshlrev_b32 v101, 7, v101
    v_bfe_u32 v102, v100, 1, 1
    s_min_u32 s52, s19, 2
    s_lshl_b32 s52, s52, 1
    v_add_u32 v102, s52, v102
    v_lshl_add_u32 v101, v102, 4, v101
    v_and_b32 v102, 1, v100
    v_lshl_add_u32 v119, v102, 3, v101
    v_add_u32 v120, 0x10000, v119
    v_lshrrev_b32 v101, 4, v100
    v_bfe_u32 v102, v100, 2, 2
    v_lshl_add_u32 v101, v101, 2, v102
    v_lshlrev_b32 v101, 10, v101
    v_and_b32 v102, 3, v100
    v_lshl_add_u32 v101, v102, 3, v101
    s_lshl_b32 s52, s19, 8
    v_add_u32 v121, s52, v101
    v_add_u32 v122, 0x10000, v121
    v_lshlrev_b32 v123, 4, v100
    s_add_u32 s54, s6, 0x0
    s_addc_u32 s55, s7, 0
    s_lshl_b32 s52, s19, 12
    s_add_u32 m0, s52, 0
    s_nop 0
    global_load_lds_dwordx4 v106, s[54:55]
    s_add_u32 s54, s6, 0x8000
    s_addc_u32 s55, s7, 0
    s_lshl_b32 s52, s19, 12
    s_add_u32 m0, s52, 1024
    s_nop 0
    global_load_lds_dwordx4 v106, s[54:55]
    s_add_u32 s54, s6, 0x10000
    s_addc_u32 s55, s7, 0
    s_lshl_b32 s52, s19, 12
    s_add_u32 m0, s52, 2048
    s_nop 0
    global_load_lds_dwordx4 v107, s[54:55]
    s_add_u32 s54, s6, 0x18000
    s_addc_u32 s55, s7, 0
    s_lshl_b32 s52, s19, 12
    s_add_u32 m0, s52, 3072
    s_nop 0
    global_load_lds_dwordx4 v107, s[54:55]
    s_add_u32 s54, s6, 0x80000
    s_addc_u32 s55, s7, 0
    s_lshl_b32 s52, s19, 12
    s_add_u32 m0, s52, 16384
    s_nop 0
    global_load_lds_dwordx4 v106, s[54:55]
    s_add_u32 s54, s6, 0x88000
    s_addc_u32 s55, s7, 0
    s_lshl_b32 s52, s19, 12
    s_add_u32 m0, s52, 17408
    s_nop 0
    global_load_lds_dwordx4 v106, s[54:55]
    s_add_u32 s54, s6, 0x90000
    s_addc_u32 s55, s7, 0
    s_lshl_b32 s52, s19, 12
    s_add_u32 m0, s52, 18432
    s_nop 0
    global_load_lds_dwordx4 v107, s[54:55]
    s_add_u32 s54, s6, 0x98000
    s_addc_u32 s55, s7, 0
    s_lshl_b32 s52, s19, 12
    s_add_u32 m0, s52, 19456
    s_nop 0
    global_load_lds_dwordx4 v107, s[54:55]
    s_add_u32 s54, s6, 0x100000
    s_addc_u32 s55, s7, 0
    s_lshl_b32 s52, s19, 12
    s_add_u32 m0, s52, 32768
    s_nop 0
    global_load_lds_dwordx4 v106, s[54:55]
    s_add_u32 s54, s6, 0x108000
    s_addc_u32 s55, s7, 0
    s_lshl_b32 s52, s19, 12
    s_add_u32 m0, s52, 33792
    s_nop 0
    global_load_lds_dwordx4 v106, s[54:55]
    s_add_u32 s54, s6, 0x110000
    s_addc_u32 s55, s7, 0
    s_lshl_b32 s52, s19, 12
    s_add_u32 m0, s52, 34816
    s_nop 0
    global_load_lds_dwordx4 v107, s[54:55]
    s_add_u32 s54, s6, 0x118000
    s_addc_u32 s55, s7, 0
    s_lshl_b32 s52, s19, 12
    s_add_u32 m0, s52, 35840
    s_nop 0
    global_load_lds_dwordx4 v107, s[54:55]
    s_add_u32 s54, s6, 0x180000
    s_addc_u32 s55, s7, 0
    s_lshl_b32 s52, s19, 12
    s_add_u32 m0, s52, 49152
    s_nop 0
    global_load_lds_dwordx4 v106, s[54:55]
    s_add_u32 s54, s6, 0x188000
    s_addc_u32 s55, s7, 0
    s_lshl_b32 s52, s19, 12
    s_add_u32 m0, s52, 50176
    s_nop 0
    global_load_lds_dwordx4 v106, s[54:55]
    s_add_u32 s54, s6, 0x190000
    s_addc_u32 s55, s7, 0
    s_lshl_b32 s52, s19, 12
    s_add_u32 m0, s52, 51200
    s_nop 0
    global_load_lds_dwordx4 v107, s[54:55]
    s_add_u32 s54, s6, 0x198000
    s_addc_u32 s55, s7, 0
    s_lshl_b32 s52, s19, 12
    s_add_u32 m0, s52, 52224
    s_nop 0
    global_load_lds_dwordx4 v107, s[54:55]
    s_add_u32 s54, s6, 0x200000
    s_addc_u32 s55, s7, 0
    s_lshl_b32 s52, s19, 12
    s_add_u32 m0, s52, 65536
    s_nop 0
    global_load_lds_dwordx4 v106, s[54:55]
    s_add_u32 s54, s6, 0x208000
    s_addc_u32 s55, s7, 0
    s_lshl_b32 s52, s19, 12
    s_add_u32 m0, s52, 66560
    s_nop 0
    global_load_lds_dwordx4 v106, s[54:55]
    s_add_u32 s54, s6, 0x210000
    s_addc_u32 s55, s7, 0
    s_lshl_b32 s52, s19, 12
    s_add_u32 m0, s52, 67584
    s_nop 0
    global_load_lds_dwordx4 v107, s[54:55]
    s_add_u32 s54, s6, 0x218000
    s_addc_u32 s55, s7, 0
    s_lshl_b32 s52, s19, 12
    s_add_u32 m0, s52, 68608
    s_nop 0
    global_load_lds_dwordx4 v107, s[54:55]
    s_add_u32 s54, s6, 0x280000
    s_addc_u32 s55, s7, 0
    s_lshl_b32 s52, s19, 12
    s_add_u32 m0, s52, 81920
    s_nop 0
    global_load_lds_dwordx4 v106, s[54:55]
    s_add_u32 s54, s6, 0x288000
    s_addc_u32 s55, s7, 0
    s_lshl_b32 s52, s19, 12
    s_add_u32 m0, s52, 82944
    s_nop 0
    global_load_lds_dwordx4 v106, s[54:55]
    s_add_u32 s54, s6, 0x290000
    s_addc_u32 s55, s7, 0
    s_lshl_b32 s52, s19, 12
    s_add_u32 m0, s52, 83968
    s_nop 0
    global_load_lds_dwordx4 v107, s[54:55]
    s_add_u32 s54, s6, 0x298000
    s_addc_u32 s55, s7, 0
    s_lshl_b32 s52, s19, 12
    s_add_u32 m0, s52, 84992
    s_nop 0
    global_load_lds_dwordx4 v107, s[54:55]
    s_waitcnt vmcnt(20)
    s_barrier
    s_add_u32 s54, s6, 0x300000
    s_addc_u32 s55, s7, 0
    s_lshl_b32 s52, s19, 12
    s_add_u32 m0, s52, 98304
    s_nop 0
    global_load_lds_dwordx4 v106, s[54:55]
    s_add_u32 s54, s6, 0x308000
    s_addc_u32 s55, s7, 0
    s_lshl_b32 s52, s19, 12
    s_add_u32 m0, s52, 99328
    s_nop 0
    global_load_lds_dwordx4 v106, s[54:55]
    s_add_u32 s54, s6, 0x310000
    s_addc_u32 s55, s7, 0
    s_lshl_b32 s52, s19, 12
    s_add_u32 m0, s52, 100352
    s_nop 0
    global_load_lds_dwordx4 v107, s[54:55]
    s_add_u32 s54, s6, 0x318000
    s_addc_u32 s55, s7, 0
    s_lshl_b32 s52, s19, 12
    s_add_u32 m0, s52, 101376
    s_nop 0
    global_load_lds_dwordx4 v107, s[54:55]
    ds_read_b64_tr_b16 a[0:1], v108 offset:0
    ds_read_b64_tr_b16 a[2:3], v108 offset:1024
    ds_read_b64_tr_b16 a[4:5], v108 offset:8192
    ds_read_b64_tr_b16 a[6:7], v108 offset:9216
    ds_read_b64_tr_b16 a[64:65], v109 offset:0
    ds_read_b64_tr_b16 a[66:67], v109 offset:1024
    ds_read_b64_tr_b16 a[68:69], v109 offset:8192
    ds_read_b64_tr_b16 a[70:71], v109 offset:9216
    s_waitcnt lgkmcnt(0)
    s_waitcnt vmcnt(20)
    s_barrier
    s_add_u32 s54, s6, 0x380000
    s_addc_u32 s55, s7, 0
    s_lshl_b32 s52, s19, 12
    s_add_u32 m0, s52, 0
    s_nop 0
    global_load_lds_dwordx4 v106, s[54:55]
    s_add_u32 s54, s6, 0x388000
    s_addc_u32 s55, s7, 0
    s_lshl_b32 s52, s19, 12
    s_add_u32 m0, s52, 1024
    s_nop 0
    global_load_lds_dwordx4 v106, s[54:55]
    s_add_u32 s54, s6, 0x390000
    s_addc_u32 s55, s7, 0
    s_lshl_b32 s52, s19, 12
    s_add_u32 m0, s52, 2048
    s_nop 0
    global_load_lds_dwordx4 v107, s[54:55]
    s_add_u32 s54, s6, 0x398000
    s_addc_u32 s55, s7, 0
    s_lshl_b32 s52, s19, 12
    s_add_u32 m0, s52, 3072
    s_nop 0
    global_load_lds_dwordx4 v107, s[54:55]
    ds_read_b64_tr_b16 a[8:9], v108 offset:16384
    ds_read_b64_tr_b16 a[10:11], v108 offset:17408
    ds_read_b64_tr_b16 a[12:13], v108 offset:24576
    ds_read_b64_tr_b16 a[14:15], v108 offset:25600
    ds_read_b64_tr_b16 a[72:73], v109 offset:16384
    ds_read_b64_tr_b16 a[74:75], v109 offset:17408
    ds_read_b64_tr_b16 a[76:77], v109 offset:24576
    ds_read_b64_tr_b16 a[78:79], v109 offset:25600
    s_waitcnt lgkmcnt(0)
    s_waitcnt vmcnt(20)
    s_barrier
    s_add_u32 s54, s8, 0x0
    s_addc_u32 s55, s9, 0
    s_lshl_b32 s52, s19, 12
    s_add_u32 m0, s52, 16384
    s_nop 0
    global_load_lds_dwordx4 v112, s[54:55]
    s_add_u32 s54, s8, 0x1000
    s_addc_u32 s55, s9, 0
    s_lshl_b32 s52, s19, 12
    s_add_u32 m0, s52, 17408
    s_nop 0
    global_load_lds_dwordx4 v113, s[54:55]
    s_add_u32 s54, s8, 0x2000
    s_addc_u32 s55, s9, 0
    s_lshl_b32 s52, s19, 12
    s_add_u32 m0, s52, 18432
    s_nop 0
    global_load_lds_dwordx4 v112, s[54:55]
    s_add_u32 s54, s8, 0x3000
    s_addc_u32 s55, s9, 0
    s_lshl_b32 s52, s19, 12
    s_add_u32 m0, s52, 19456
    s_nop 0
    global_load_lds_dwordx4 v113, s[54:55]
    ds_read_b64_tr_b16 a[16:17], v108 offset:32768
    ds_read_b64_tr_b16 a[18:19], v108 offset:33792
    ds_read_b64_tr_b16 a[20:21], v108 offset:40960
    ds_read_b64_tr_b16 a[22:23], v108 offset:41984
    ds_read_b64_tr_b16 a[80:81], v109 offset:32768
    ds_read_b64_tr_b16 a[82:83], v109 offset:33792
    ds_read_b64_tr_b16 a[84:85], v109 offset:40960
    ds_read_b64_tr_b16 a[86:87], v109 offset:41984
    s_waitcnt lgkmcnt(0)
    s_waitcnt vmcnt(20)
    s_barrier
    s_add_u32 s54, s8, 0x40
    s_addc_u32 s55, s9, 0
    s_lshl_b32 s52, s19, 12
    s_add_u32 m0, s52, 32768
    s_nop 0
    global_load_lds_dwordx4 v112, s[54:55]
    s_add_u32 s54, s8, 0x1040
    s_addc_u32 s55, s9, 0
    s_lshl_b32 s52, s19, 12
    s_add_u32 m0, s52, 33792
    s_nop 0
    global_load_lds_dwordx4 v113, s[54:55]
    s_add_u32 s54, s8, 0x2040
    s_addc_u32 s55, s9, 0
    s_lshl_b32 s52, s19, 12
    s_add_u32 m0, s52, 34816
    s_nop 0
    global_load_lds_dwordx4 v112, s[54:55]
    s_add_u32 s54, s8, 0x3040
    s_addc_u32 s55, s9, 0
    s_lshl_b32 s52, s19, 12
    s_add_u32 m0, s52, 35840
    s_nop 0
    global_load_lds_dwordx4 v113, s[54:55]
    ds_read_b64_tr_b16 a[24:25], v108 offset:49152
    ds_read_b64_tr_b16 a[26:27], v108 offset:50176
    ds_read_b64_tr_b16 a[28:29], v108 offset:57344
    ds_read_b64_tr_b16 a[30:31], v108 offset:58368
    ds_read_b64_tr_b16 a[88:89], v109 offset:49152
    ds_read_b64_tr_b16 a[90:91], v109 offset:50176
    ds_read_b64_tr_b16 a[92:93], v109 offset:57344
    ds_read_b64_tr_b16 a[94:95], v109 offset:58368
    s_waitcnt lgkmcnt(0)
    s_waitcnt vmcnt(20)
    s_barrier
    s_add_u32 s54, s8, 0x80
    s_addc_u32 s55, s9, 0
    s_lshl_b32 s52, s19, 12
    s_add_u32 m0, s52, 49152
    s_nop 0
    global_load_lds_dwordx4 v112, s[54:55]
    s_add_u32 s54, s8, 0x1080
    s_addc_u32 s55, s9, 0
    s_lshl_b32 s52, s19, 12
    s_add_u32 m0, s52, 50176
    s_nop 0
    global_load_lds_dwordx4 v113, s[54:55]
    s_add_u32 s54, s8, 0x2080
    s_addc_u32 s55, s9, 0
    s_lshl_b32 s52, s19, 12
    s_add_u32 m0, s52, 51200
    s_nop 0
    global_load_lds_dwordx4 v112, s[54:55]
    s_add_u32 s54, s8, 0x3080
    s_addc_u32 s55, s9, 0
    s_lshl_b32 s52, s19, 12
    s_add_u32 m0, s52, 52224
    s_nop 0
    global_load_lds_dwordx4 v113, s[54:55]
    ds_read_b64_tr_b16 a[32:33], v110 offset:0
    ds_read_b64_tr_b16 a[34:35], v110 offset:1024
    ds_read_b64_tr_b16 a[36:37], v110 offset:8192
    ds_read_b64_tr_b16 a[38:39], v110 offset:9216
    ds_read_b64_tr_b16 a[96:97], v111 offset:0
    ds_read_b64_tr_b16 a[98:99], v111 offset:1024
    ds_read_b64_tr_b16 a[100:101], v111 offset:8192
    ds_read_b64_tr_b16 a[102:103], v111 offset:9216
    s_waitcnt lgkmcnt(0)
    s_waitcnt vmcnt(20)
    s_barrier
    s_add_u32 s54, s8, 0xc0
    s_addc_u32 s55, s9, 0
    s_lshl_b32 s52, s19, 12
    s_add_u32 m0, s52, 65536
    s_nop 0
    global_load_lds_dwordx4 v112, s[54:55]
    s_add_u32 s54, s8, 0x10c0
    s_addc_u32 s55, s9, 0
    s_lshl_b32 s52, s19, 12
    s_add_u32 m0, s52, 66560
    s_nop 0
    global_load_lds_dwordx4 v113, s[54:55]
    s_add_u32 s54, s8, 0x20c0
    s_addc_u32 s55, s9, 0
    s_lshl_b32 s52, s19, 12
    s_add_u32 m0, s52, 67584
    s_nop 0
    global_load_lds_dwordx4 v112, s[54:55]
    s_add_u32 s54, s8, 0x30c0
    s_addc_u32 s55, s9, 0
    s_lshl_b32 s52, s19, 12
    s_add_u32 m0, s52, 68608
    s_nop 0
    global_load_lds_dwordx4 v113, s[54:55]
    ds_read_b64_tr_b16 a[40:41], v110 offset:16384
    ds_read_b64_tr_b16 a[42:43], v110 offset:17408
    ds_read_b64_tr_b16 a[44:45], v110 offset:24576
    ds_read_b64_tr_b16 a[46:47], v110 offset:25600
    ds_read_b64_tr_b16 a[104:105], v111 offset:16384
    ds_read_b64_tr_b16 a[106:107], v111 offset:17408
    ds_read_b64_tr_b16 a[108:109], v111 offset:24576
    ds_read_b64_tr_b16 a[110:111], v111 offset:25600
    s_waitcnt lgkmcnt(0)
    s_waitcnt vmcnt(20)
    s_barrier
    s_add_u32 s54, s8, 0x10000
    s_addc_u32 s55, s9, 0
    s_lshl_b32 s52, s19, 12
    s_add_u32 m0, s52, 81920
    s_nop 0
    global_load_lds_dwordx4 v112, s[54:55]
    s_add_u32 s54, s8, 0x11000
    s_addc_u32 s55, s9, 0
    s_lshl_b32 s52, s19, 12
    s_add_u32 m0, s52, 82944
    s_nop 0
    global_load_lds_dwordx4 v113, s[54:55]
    s_add_u32 s54, s8, 0x12000
    s_addc_u32 s55, s9, 0
    s_lshl_b32 s52, s19, 12
    s_add_u32 m0, s52, 83968
    s_nop 0
    global_load_lds_dwordx4 v112, s[54:55]
    s_add_u32 s54, s8, 0x13000
    s_addc_u32 s55, s9, 0
    s_lshl_b32 s52, s19, 12
    s_add_u32 m0, s52, 84992
    s_nop 0
    global_load_lds_dwordx4 v113, s[54:55]
    ds_read_b64_tr_b16 a[48:49], v110 offset:32768
    ds_read_b64_tr_b16 a[50:51], v110 offset:33792
    ds_read_b64_tr_b16 a[52:53], v110 offset:40960
    ds_read_b64_tr_b16 a[54:55], v110 offset:41984
    ds_read_b64_tr_b16 a[112:113], v111 offset:32768
    ds_read_b64_tr_b16 a[114:115], v111 offset:33792
    ds_read_b64_tr_b16 a[116:117], v111 offset:40960
    ds_read_b64_tr_b16 a[118:119], v111 offset:41984
    s_waitcnt lgkmcnt(0)
    s_waitcnt vmcnt(20)
    s_barrier
    s_add_u32 s54, s8, 0x10040
    s_addc_u32 s55, s9, 0
    s_lshl_b32 s52, s19, 12
    s_add_u32 m0, s52, 98304
    s_nop 0
    global_load_lds_dwordx4 v112, s[54:55]
    s_add_u32 s54, s8, 0x11040
    s_addc_u32 s55, s9, 0
    s_lshl_b32 s52, s19, 12
    s_add_u32 m0, s52, 99328
    s_nop 0
    global_load_lds_dwordx4 v113, s[54:55]
    s_add_u32 s54, s8, 0x12040
    s_addc_u32 s55, s9, 0
    s_lshl_b32 s52, s19, 12
    s_add_u32 m0, s52, 100352
    s_nop 0
    global_load_lds_dwordx4 v112, s[54:55]
    s_add_u32 s54, s8, 0x13040
    s_addc_u32 s55, s9, 0
    s_lshl_b32 s52, s19, 12
    s_add_u32 m0, s52, 101376
    s_nop 0
    global_load_lds_dwordx4 v113, s[54:55]
    ds_read_b64_tr_b16 a[56:57], v108 offset:0
    ds_read_b64_tr_b16 a[58:59], v108 offset:1024
    ds_read_b64_tr_b16 a[60:61], v108 offset:8192
    ds_read_b64_tr_b16 a[62:63], v108 offset:9216
    ds_read_b64_tr_b16 a[120:121], v109 offset:0
    ds_read_b64_tr_b16 a[122:123], v109 offset:1024
    ds_read_b64_tr_b16 a[124:125], v109 offset:8192
    ds_read_b64_tr_b16 a[126:127], v109 offset:9216
    s_waitcnt lgkmcnt(0)
    s_waitcnt vmcnt(20)
    s_barrier
    s_add_u32 s54, s8, 0x10080
    s_addc_u32 s55, s9, 0
    s_lshl_b32 s52, s19, 12
    s_add_u32 m0, s52, 0
    s_nop 0
    global_load_lds_dwordx4 v112, s[54:55]
    s_add_u32 s54, s8, 0x11080
    s_addc_u32 s55, s9, 0
    s_lshl_b32 s52, s19, 12
    s_add_u32 m0, s52, 1024
    s_nop 0
    global_load_lds_dwordx4 v113, s[54:55]
    s_add_u32 s54, s8, 0x12080
    s_addc_u32 s55, s9, 0
    s_lshl_b32 s52, s19, 12
    s_add_u32 m0, s52, 2048
    s_nop 0
    global_load_lds_dwordx4 v112, s[54:55]
    s_add_u32 s54, s8, 0x13080
    s_addc_u32 s55, s9, 0
    s_lshl_b32 s52, s19, 12
    s_add_u32 m0, s52, 3072
    s_nop 0
    global_load_lds_dwordx4 v113, s[54:55]
    ds_read_b64_tr_b16 a[128:129], v114 offset:16384
    ds_read_b64_tr_b16 a[130:131], v114 offset:20480
    ds_read_b64_tr_b16 a[132:133], v114 offset:24576
    ds_read_b64_tr_b16 a[134:135], v114 offset:28672
    ds_read_b64_tr_b16 a[144:145], v115 offset:16384
    ds_read_b64_tr_b16 a[146:147], v115 offset:20480
    ds_read_b64_tr_b16 a[148:149], v115 offset:24576
    ds_read_b64_tr_b16 a[150:151], v115 offset:28672
    s_waitcnt lgkmcnt(0)
    s_waitcnt vmcnt(20)
    s_barrier
    s_add_u32 s54, s8, 0x100c0
    s_addc_u32 s55, s9, 0
    s_lshl_b32 s52, s19, 12
    s_add_u32 m0, s52, 16384
    s_nop 0
    global_load_lds_dwordx4 v112, s[54:55]
    s_add_u32 s54, s8, 0x110c0
    s_addc_u32 s55, s9, 0
    s_lshl_b32 s52, s19, 12
    s_add_u32 m0, s52, 17408
    s_nop 0
    global_load_lds_dwordx4 v113, s[54:55]
    s_add_u32 s54, s8, 0x120c0
    s_addc_u32 s55, s9, 0
    s_lshl_b32 s52, s19, 12
    s_add_u32 m0, s52, 18432
    s_nop 0
    global_load_lds_dwordx4 v112, s[54:55]
    s_add_u32 s54, s8, 0x130c0
    s_addc_u32 s55, s9, 0
    s_lshl_b32 s52, s19, 12
    s_add_u32 m0, s52, 19456
    s_nop 0
    global_load_lds_dwordx4 v113, s[54:55]
    ds_read_b64_tr_b16 a[160:161], v114 offset:32768
    ds_read_b64_tr_b16 a[162:163], v114 offset:36864
    ds_read_b64_tr_b16 a[164:165], v114 offset:40960
    ds_read_b64_tr_b16 a[166:167], v114 offset:45056
    ds_read_b64_tr_b16 a[176:177], v115 offset:32768
    ds_read_b64_tr_b16 a[178:179], v115 offset:36864
    ds_read_b64_tr_b16 a[180:181], v115 offset:40960
    ds_read_b64_tr_b16 a[182:183], v115 offset:45056
    s_waitcnt lgkmcnt(0)
    s_waitcnt vmcnt(20)
    s_barrier
    s_mul_i32 s52, s19, 88064
    s_add_u32 s52, s52, 0
    s_add_u32 s54, s10, s52
    s_addc_u32 s55, s11, 0
    s_lshl_b32 s52, s19, 12
    s_add_u32 m0, s52, 32768
    s_nop 0
    global_load_lds_dwordx4 v118, s[54:55]
    s_mul_i32 s52, s19, 88064
    s_add_u32 s52, s52, 22016
    s_add_u32 s54, s10, s52
    s_addc_u32 s55, s11, 0
    s_lshl_b32 s52, s19, 12
    s_add_u32 m0, s52, 33792
    s_nop 0
    global_load_lds_dwordx4 v118, s[54:55]
    s_mul_i32 s52, s19, 88064
    s_add_u32 s52, s52, 44032
    s_add_u32 s54, s10, s52
    s_addc_u32 s55, s11, 0
    s_lshl_b32 s52, s19, 12
    s_add_u32 m0, s52, 34816
    s_nop 0
    global_load_lds_dwordx4 v118, s[54:55]
    s_mul_i32 s52, s19, 88064
    s_add_u32 s52, s52, 66048
    s_add_u32 s54, s10, s52
    s_addc_u32 s55, s11, 0
    s_lshl_b32 s52, s19, 12
    s_add_u32 m0, s52, 35840
    s_nop 0
    global_load_lds_dwordx4 v118, s[54:55]
    ds_read_b64_tr_b16 a[192:193], v114 offset:49152
    ds_read_b64_tr_b16 a[194:195], v114 offset:53248
    ds_read_b64_tr_b16 a[196:197], v114 offset:57344
    ds_read_b64_tr_b16 a[198:199], v114 offset:61440
    ds_read_b64_tr_b16 a[208:209], v115 offset:49152
    ds_read_b64_tr_b16 a[210:211], v115 offset:53248
    ds_read_b64_tr_b16 a[212:213], v115 offset:57344
    ds_read_b64_tr_b16 a[214:215], v115 offset:61440
    s_waitcnt lgkmcnt(0)
    s_waitcnt vmcnt(20)
    s_barrier
    s_mul_i32 s52, s19, 88064
    s_add_u32 s52, s52, 352256
    s_add_u32 s54, s10, s52
    s_addc_u32 s55, s11, 0
    s_lshl_b32 s52, s19, 12
    s_add_u32 m0, s52, 49152
    s_nop 0
    global_load_lds_dwordx4 v118, s[54:55]
    s_mul_i32 s52, s19, 88064
    s_add_u32 s52, s52, 374272
    s_add_u32 s54, s10, s52
    s_addc_u32 s55, s11, 0
    s_lshl_b32 s52, s19, 12
    s_add_u32 m0, s52, 50176
    s_nop 0
    global_load_lds_dwordx4 v118, s[54:55]
    s_mul_i32 s52, s19, 88064
    s_add_u32 s52, s52, 396288
    s_add_u32 s54, s10, s52
    s_addc_u32 s55, s11, 0
    s_lshl_b32 s52, s19, 12
    s_add_u32 m0, s52, 51200
    s_nop 0
    global_load_lds_dwordx4 v118, s[54:55]
    s_mul_i32 s52, s19, 88064
    s_add_u32 s52, s52, 418304
    s_add_u32 s54, s10, s52
    s_addc_u32 s55, s11, 0
    s_lshl_b32 s52, s19, 12
    s_add_u32 m0, s52, 52224
    s_nop 0
    global_load_lds_dwordx4 v118, s[54:55]
    ds_read_b64_tr_b16 a[224:225], v116 offset:0
    ds_read_b64_tr_b16 a[226:227], v116 offset:4096
    ds_read_b64_tr_b16 a[228:229], v116 offset:8192
    ds_read_b64_tr_b16 a[230:231], v116 offset:12288
    ds_read_b64_tr_b16 a[240:241], v117 offset:0
    ds_read_b64_tr_b16 a[242:243], v117 offset:4096
    ds_read_b64_tr_b16 a[244:245], v117 offset:8192
    ds_read_b64_tr_b16 a[246:247], v117 offset:12288
    s_waitcnt lgkmcnt(0)
    s_waitcnt vmcnt(20)
    s_barrier
    s_mul_i32 s52, s19, 88064
    s_add_u32 s52, s52, 704512
    s_add_u32 s54, s10, s52
    s_addc_u32 s55, s11, 0
    s_lshl_b32 s52, s19, 12
    s_add_u32 m0, s52, 65536
    s_nop 0
    global_load_lds_dwordx4 v118, s[54:55]
    s_mul_i32 s52, s19, 88064
    s_add_u32 s52, s52, 726528
    s_add_u32 s54, s10, s52
    s_addc_u32 s55, s11, 0
    s_lshl_b32 s52, s19, 12
    s_add_u32 m0, s52, 66560
    s_nop 0
    global_load_lds_dwordx4 v118, s[54:55]
    s_mul_i32 s52, s19, 88064
    s_add_u32 s52, s52, 748544
    s_add_u32 s54, s10, s52
    s_addc_u32 s55, s11, 0
    s_lshl_b32 s52, s19, 12
    s_add_u32 m0, s52, 67584
    s_nop 0
    global_load_lds_dwordx4 v118, s[54:55]
    s_mul_i32 s52, s19, 88064
    s_add_u32 s52, s52, 770560
    s_add_u32 s54, s10, s52
    s_addc_u32 s55, s11, 0
    s_lshl_b32 s52, s19, 12
    s_add_u32 m0, s52, 68608
    s_nop 0
    global_load_lds_dwordx4 v118, s[54:55]
    ds_read_b64_tr_b16 a[136:137], v116 offset:16384
    ds_read_b64_tr_b16 a[138:139], v116 offset:20480
    ds_read_b64_tr_b16 a[140:141], v116 offset:24576
    ds_read_b64_tr_b16 a[142:143], v116 offset:28672
    ds_read_b64_tr_b16 a[152:153], v117 offset:16384
    ds_read_b64_tr_b16 a[154:155], v117 offset:20480
    ds_read_b64_tr_b16 a[156:157], v117 offset:24576
    ds_read_b64_tr_b16 a[158:159], v117 offset:28672
    s_waitcnt lgkmcnt(0)
    s_waitcnt vmcnt(20)
    s_barrier
    s_mul_i32 s52, s19, 88064
    s_add_u32 s52, s52, 1056768
    s_add_u32 s54, s10, s52
    s_addc_u32 s55, s11, 0
    s_lshl_b32 s52, s19, 12
    s_add_u32 m0, s52, 81920
    s_nop 0
    global_load_lds_dwordx4 v118, s[54:55]
    s_mul_i32 s52, s19, 88064
    s_add_u32 s52, s52, 1078784
    s_add_u32 s54, s10, s52
    s_addc_u32 s55, s11, 0
    s_lshl_b32 s52, s19, 12
    s_add_u32 m0, s52, 82944
    s_nop 0
    global_load_lds_dwordx4 v118, s[54:55]
    s_mul_i32 s52, s19, 88064
    s_add_u32 s52, s52, 1100800
    s_add_u32 s54, s10, s52
    s_addc_u32 s55, s11, 0
    s_lshl_b32 s52, s19, 12
    s_add_u32 m0, s52, 83968
    s_nop 0
    global_load_lds_dwordx4 v118, s[54:55]
    s_mul_i32 s52, s19, 88064
    s_add_u32 s52, s52, 1122816
    s_add_u32 s54, s10, s52
    s_addc_u32 s55, s11, 0
    s_lshl_b32 s52, s19, 12
    s_add_u32 m0, s52, 84992
    s_nop 0
    global_load_lds_dwordx4 v118, s[54:55]
    ds_read_b64_tr_b16 a[168:169], v116 offset:32768
    ds_read_b64_tr_b16 a[170:171], v116 offset:36864
    ds_read_b64_tr_b16 a[172:173], v116 offset:40960
    ds_read_b64_tr_b16 a[174:175], v116 offset:45056
    ds_read_b64_tr_b16 a[184:185], v117 offset:32768
    ds_read_b64_tr_b16 a[186:187], v117 offset:36864
    ds_read_b64_tr_b16 a[188:189], v117 offset:40960
    ds_read_b64_tr_b16 a[190:191], v117 offset:45056
    s_waitcnt lgkmcnt(0)
    s_waitcnt vmcnt(20)
    s_barrier
    s_mul_i32 s52, s19, 88064
    s_add_u32 s52, s52, 0
    s_add_u32 s54, s12, s52
    s_addc_u32 s55, s13, 0
    s_lshl_b32 s52, s19, 12
    s_add_u32 m0, s52, 98304
    s_nop 0
    global_load_lds_dwordx4 v118, s[54:55]
    s_mul_i32 s52, s19, 88064
    s_add_u32 s52, s52, 22016
    s_add_u32 s54, s12, s52
    s_addc_u32 s55, s13, 0
    s_lshl_b32 s52, s19, 12
    s_add_u32 m0, s52, 99328
    s_nop 0
    global_load_lds_dwordx4 v118, s[54:55]
    s_mul_i32 s52, s19, 88064
    s_add_u32 s52, s52, 44032
    s_add_u32 s54, s12, s52
    s_addc_u32 s55, s13, 0
    s_lshl_b32 s52, s19, 12
    s_add_u32 m0, s52, 100352
    s_nop 0
    global_load_lds_dwordx4 v118, s[54:55]
    s_mul_i32 s52, s19, 88064
    s_add_u32 s52, s52, 66048
    s_add_u32 s54, s12, s52
    s_addc_u32 s55, s13, 0
    s_lshl_b32 s52, s19, 12
    s_add_u32 m0, s52, 101376
    s_nop 0
    global_load_lds_dwordx4 v118, s[54:55]
    ds_read_b64_tr_b16 a[200:201], v114 offset:0
    ds_read_b64_tr_b16 a[202:203], v114 offset:4096
    ds_read_b64_tr_b16 a[204:205], v114 offset:8192
    ds_read_b64_tr_b16 a[206:207], v114 offset:12288
    ds_read_b64_tr_b16 a[216:217], v115 offset:0
    ds_read_b64_tr_b16 a[218:219], v115 offset:4096
    ds_read_b64_tr_b16 a[220:221], v115 offset:8192
    ds_read_b64_tr_b16 a[222:223], v115 offset:12288
    s_waitcnt lgkmcnt(0)
    s_waitcnt vmcnt(20)
    s_barrier
    s_mul_i32 s52, s19, 88064
    s_add_u32 s52, s52, 352256
    s_add_u32 s54, s12, s52
    s_addc_u32 s55, s13, 0
    s_lshl_b32 s52, s19, 12
    s_add_u32 m0, s52, 0
    s_nop 0
    global_load_lds_dwordx4 v118, s[54:55]
    s_mul_i32 s52, s19, 88064
    s_add_u32 s52, s52, 374272
    s_add_u32 s54, s12, s52
    s_addc_u32 s55, s13, 0
    s_lshl_b32 s52, s19, 12
    s_add_u32 m0, s52, 1024
    s_nop 0
    global_load_lds_dwordx4 v118, s[54:55]
    s_mul_i32 s52, s19, 88064
    s_add_u32 s52, s52, 396288
    s_add_u32 s54, s12, s52
    s_addc_u32 s55, s13, 0
    s_lshl_b32 s52, s19, 12
    s_add_u32 m0, s52, 2048
    s_nop 0
    global_load_lds_dwordx4 v118, s[54:55]
    s_mul_i32 s52, s19, 88064
    s_add_u32 s52, s52, 418304
    s_add_u32 s54, s12, s52
    s_addc_u32 s55, s13, 0
    s_lshl_b32 s52, s19, 12
    s_add_u32 m0, s52, 3072
    s_nop 0
    global_load_lds_dwordx4 v118, s[54:55]
    ds_read_b64_tr_b16 a[232:233], v114 offset:16384
    ds_read_b64_tr_b16 a[234:235], v114 offset:20480
    ds_read_b64_tr_b16 a[236:237], v114 offset:24576
    ds_read_b64_tr_b16 a[238:239], v114 offset:28672
    ds_read_b64_tr_b16 a[248:249], v115 offset:16384
    ds_read_b64_tr_b16 a[250:251], v115 offset:20480
    ds_read_b64_tr_b16 a[252:253], v115 offset:24576
    ds_read_b64_tr_b16 a[254:255], v115 offset:28672
    s_waitcnt lgkmcnt(0)
    s_waitcnt vmcnt(20)
    s_barrier
    s_mul_i32 s52, s19, 88064
    s_add_u32 s52, s52, 704512
    s_add_u32 s54, s12, s52
    s_addc_u32 s55, s13, 0
    s_lshl_b32 s52, s19, 12
    s_add_u32 m0, s52, 16384
    s_nop 0
    global_load_lds_dwordx4 v118, s[54:55]
    s_mul_i32 s52, s19, 88064
    s_add_u32 s52, s52, 726528
    s_add_u32 s54, s12, s52
    s_addc_u32 s55, s13, 0
    s_lshl_b32 s52, s19, 12
    s_add_u32 m0, s52, 17408
    s_nop 0
    global_load_lds_dwordx4 v118, s[54:55]
    s_mul_i32 s52, s19, 88064
    s_add_u32 s52, s52, 748544
    s_add_u32 s54, s12, s52
    s_addc_u32 s55, s13, 0
    s_lshl_b32 s52, s19, 12
    s_add_u32 m0, s52, 18432
    s_nop 0
    global_load_lds_dwordx4 v118, s[54:55]
    s_mul_i32 s52, s19, 88064
    s_add_u32 s52, s52, 770560
    s_add_u32 s54, s12, s52
    s_addc_u32 s55, s13, 0
    s_lshl_b32 s52, s19, 12
    s_add_u32 m0, s52, 19456
    s_nop 0
    global_load_lds_dwordx4 v118, s[54:55]
    ds_read_b64_tr_b16 v[128:129], v119 offset:32768
    ds_read_b64_tr_b16 v[130:131], v119 offset:34816
    ds_read_b64_tr_b16 v[132:133], v119 offset:36864
    ds_read_b64_tr_b16 v[134:135], v119 offset:38912
    ds_read_b64_tr_b16 v[136:137], v119 offset:40960
    ds_read_b64_tr_b16 v[138:139], v119 offset:43008
    ds_read_b64_tr_b16 v[140:141], v119 offset:45056
    ds_read_b64_tr_b16 v[142:143], v119 offset:47104
    s_waitcnt lgkmcnt(0)
    s_waitcnt vmcnt(20)
    s_barrier
    s_mul_i32 s52, s19, 88064
    s_add_u32 s52, s52, 1056768
    s_add_u32 s54, s12, s52
    s_addc_u32 s55, s13, 0
    s_lshl_b32 s52, s19, 12
    s_add_u32 m0, s52, 32768
    s_nop 0
    global_load_lds_dwordx4 v118, s[54:55]
    s_mul_i32 s52, s19, 88064
    s_add_u32 s52, s52, 1078784
    s_add_u32 s54, s12, s52
    s_addc_u32 s55, s13, 0
    s_lshl_b32 s52, s19, 12
    s_add_u32 m0, s52, 33792
    s_nop 0
    global_load_lds_dwordx4 v118, s[54:55]
    s_mul_i32 s52, s19, 88064
    s_add_u32 s52, s52, 1100800
    s_add_u32 s54, s12, s52
    s_addc_u32 s55, s13, 0
    s_lshl_b32 s52, s19, 12
    s_add_u32 m0, s52, 34816
    s_nop 0
    global_load_lds_dwordx4 v118, s[54:55]
    s_mul_i32 s52, s19, 88064
    s_add_u32 s52, s52, 1122816
    s_add_u32 s54, s12, s52
    s_addc_u32 s55, s13, 0
    s_lshl_b32 s52, s19, 12
    s_add_u32 m0, s52, 35840
    s_nop 0
    global_load_lds_dwordx4 v118, s[54:55]
    ds_read_b64_tr_b16 v[144:145], v119 offset:49152
    ds_read_b64_tr_b16 v[146:147], v119 offset:51200
    ds_read_b64_tr_b16 v[148:149], v119 offset:53248
    ds_read_b64_tr_b16 v[150:151], v119 offset:55296
    ds_read_b64_tr_b16 v[152:153], v119 offset:57344
    ds_read_b64_tr_b16 v[154:155], v119 offset:59392
    ds_read_b64_tr_b16 v[156:157], v119 offset:61440
    ds_read_b64_tr_b16 v[158:159], v119 offset:63488
    s_waitcnt lgkmcnt(0)
    s_waitcnt vmcnt(20)
    s_barrier
    s_mul_i32 s52, s18, 48
    s_lshl_b32 s53, s19, 2
    s_add_u32 s52, s52, s53
    s_add_u32 s52, s52, 0
    s_min_u32 s52, s52, 1375
    s_lshl_b32 s52, s52, 10
    s_add_u32 s54, s20, s52
    s_addc_u32 s55, s21, 0
    s_lshl_b32 s52, s19, 12
    s_add_u32 m0, s52, 49152
    s_nop 0
    global_load_lds_dwordx4 v123, s[54:55]
    s_mul_i32 s52, s18, 48
    s_lshl_b32 s53, s19, 2
    s_add_u32 s52, s52, s53
    s_add_u32 s52, s52, 1
    s_min_u32 s52, s52, 1375
    s_lshl_b32 s52, s52, 10
    s_add_u32 s54, s20, s52
    s_addc_u32 s55, s21, 0
    s_lshl_b32 s52, s19, 12
    s_add_u32 m0, s52, 50176
    s_nop 0
    global_load_lds_dwordx4 v123, s[54:55]
    s_mul_i32 s52, s18, 48
    s_lshl_b32 s53, s19, 2
    s_add_u32 s52, s52, s53
    s_add_u32 s52, s52, 2
    s_min_u32 s52, s52, 1375
    s_lshl_b32 s52, s52, 10
    s_add_u32 s54, s20, s52
    s_addc_u32 s55, s21, 0
    s_lshl_b32 s52, s19, 12
    s_add_u32 m0, s52, 51200
    s_nop 0
    global_load_lds_dwordx4 v123, s[54:55]
    s_mul_i32 s52, s18, 48
    s_lshl_b32 s53, s19, 2
    s_add_u32 s52, s52, s53
    s_add_u32 s52, s52, 3
    s_min_u32 s52, s52, 1375
    s_lshl_b32 s52, s52, 10
    s_add_u32 s54, s20, s52
    s_addc_u32 s55, s21, 0
    s_lshl_b32 s52, s19, 12
    s_add_u32 m0, s52, 52224
    s_nop 0
    global_load_lds_dwordx4 v123, s[54:55]
    ds_read_b64_tr_b16 v[160:161], v120 offset:0
    ds_read_b64_tr_b16 v[162:163], v120 offset:2048
    ds_read_b64_tr_b16 v[164:165], v120 offset:4096
    ds_read_b64_tr_b16 v[166:167], v120 offset:6144
    ds_read_b64_tr_b16 v[168:169], v120 offset:8192
    ds_read_b64_tr_b16 v[170:171], v120 offset:10240
    ds_read_b64_tr_b16 v[172:173], v120 offset:12288
    ds_read_b64_tr_b16 v[174:175], v120 offset:14336
    s_waitcnt lgkmcnt(0)
    s_waitcnt vmcnt(20)
    s_barrier
    s_mul_i32 s52, s18, 48
    s_lshl_b32 s53, s19, 2
    s_add_u32 s52, s52, s53
    s_add_u32 s52, s52, 16
    s_min_u32 s52, s52, 1375
    s_lshl_b32 s52, s52, 10
    s_add_u32 s54, s20, s52
    s_addc_u32 s55, s21, 0
    s_lshl_b32 s52, s19, 12
    s_add_u32 m0, s52, 65536
    s_nop 0
    global_load_lds_dwordx4 v123, s[54:55]
    s_mul_i32 s52, s18, 48
    s_lshl_b32 s53, s19, 2
    s_add_u32 s52, s52, s53
    s_add_u32 s52, s52, 17
    s_min_u32 s52, s52, 1375
    s_lshl_b32 s52, s52, 10
    s_add_u32 s54, s20, s52
    s_addc_u32 s55, s21, 0
    s_lshl_b32 s52, s19, 12
    s_add_u32 m0, s52, 66560
    s_nop 0
    global_load_lds_dwordx4 v123, s[54:55]
    s_mul_i32 s52, s18, 48
    s_lshl_b32 s53, s19, 2
    s_add_u32 s52, s52, s53
    s_add_u32 s52, s52, 18
    s_min_u32 s52, s52, 1375
    s_lshl_b32 s52, s52, 10
    s_add_u32 s54, s20, s52
    s_addc_u32 s55, s21, 0
    s_lshl_b32 s52, s19, 12
    s_add_u32 m0, s52, 67584
    s_nop 0
    global_load_lds_dwordx4 v123, s[54:55]
    s_mul_i32 s52, s18, 48
    s_lshl_b32 s53, s19, 2
    s_add_u32 s52, s52, s53
    s_add_u32 s52, s52, 19
    s_min_u32 s52, s52, 1375
    s_lshl_b32 s52, s52, 10
    s_add_u32 s54, s20, s52
    s_addc_u32 s55, s21, 0
    s_lshl_b32 s52, s19, 12
    s_add_u32 m0, s52, 68608
    s_nop 0
    global_load_lds_dwordx4 v123, s[54:55]
    ds_read_b64_tr_b16 v[176:177], v120 offset:16384
    ds_read_b64_tr_b16 v[178:179], v120 offset:18432
    ds_read_b64_tr_b16 v[180:181], v120 offset:20480
    ds_read_b64_tr_b16 v[182:183], v120 offset:22528
    ds_read_b64_tr_b16 v[184:185], v120 offset:24576
    ds_read_b64_tr_b16 v[186:187], v120 offset:26624
    ds_read_b64_tr_b16 v[188:189], v120 offset:28672
    ds_read_b64_tr_b16 v[190:191], v120 offset:30720
    s_waitcnt lgkmcnt(0)
    s_waitcnt vmcnt(20)
    s_barrier
    s_mul_i32 s52, s18, 48
    s_lshl_b32 s53, s19, 2
    s_add_u32 s52, s52, s53
    s_add_u32 s52, s52, 32
    s_min_u32 s52, s52, 1375
    s_lshl_b32 s52, s52, 10
    s_add_u32 s54, s20, s52
    s_addc_u32 s55, s21, 0
    s_lshl_b32 s52, s19, 12
    s_add_u32 m0, s52, 81920
    s_nop 0
    global_load_lds_dwordx4 v123, s[54:55]
    s_mul_i32 s52, s18, 48
    s_lshl_b32 s53, s19, 2
    s_add_u32 s52, s52, s53
    s_add_u32 s52, s52, 33
    s_min_u32 s52, s52, 1375
    s_lshl_b32 s52, s52, 10
    s_add_u32 s54, s20, s52
    s_addc_u32 s55, s21, 0
    s_lshl_b32 s52, s19, 12
    s_add_u32 m0, s52, 82944
    s_nop 0
    global_load_lds_dwordx4 v123, s[54:55]
    s_mul_i32 s52, s18, 48
    s_lshl_b32 s53, s19, 2
    s_add_u32 s52, s52, s53
    s_add_u32 s52, s52, 34
    s_min_u32 s52, s52, 1375
    s_lshl_b32 s52, s52, 10
    s_add_u32 s54, s20, s52
    s_addc_u32 s55, s21, 0
    s_lshl_b32 s52, s19, 12
    s_add_u32 m0, s52, 83968
    s_nop 0
    global_load_lds_dwordx4 v123, s[54:55]
    s_mul_i32 s52, s18, 48
    s_lshl_b32 s53, s19, 2
    s_add_u32 s52, s52, s53
    s_add_u32 s52, s52, 35
    s_min_u32 s52, s52, 1375
    s_lshl_b32 s52, s52, 10
    s_add_u32 s54, s20, s52
    s_addc_u32 s55, s21, 0
    s_lshl_b32 s52, s19, 12
    s_add_u32 m0, s52, 84992
    s_nop 0
    global_load_lds_dwordx4 v123, s[54:55]
    ds_read_b64_tr_b16 v[192:193], v120 offset:32768
    ds_read_b64_tr_b16 v[194:195], v120 offset:34816
    ds_read_b64_tr_b16 v[196:197], v120 offset:36864
    ds_read_b64_tr_b16 v[198:199], v120 offset:38912
    ds_read_b64_tr_b16 v[200:201], v120 offset:40960
    ds_read_b64_tr_b16 v[202:203], v120 offset:43008
    ds_read_b64_tr_b16 v[204:205], v120 offset:45056
    ds_read_b64_tr_b16 v[206:207], v120 offset:47104
    s_waitcnt lgkmcnt(0)
    s_waitcnt vmcnt(20)
    s_barrier
    ds_read_b64_tr_b16 v[208:209], v119 offset:0
    ds_read_b64_tr_b16 v[210:211], v119 offset:2048
    ds_read_b64_tr_b16 v[212:213], v119 offset:4096
    ds_read_b64_tr_b16 v[214:215], v119 offset:6144
    ds_read_b64_tr_b16 v[216:217], v119 offset:8192
    ds_read_b64_tr_b16 v[218:219], v119 offset:10240
    ds_read_b64_tr_b16 v[220:221], v119 offset:12288
    ds_read_b64_tr_b16 v[222:223], v119 offset:14336
    s_waitcnt lgkmcnt(0)
    s_waitcnt vmcnt(16)
    s_barrier
    ds_read_b64_tr_b16 v[224:225], v119 offset:16384
    ds_read_b64_tr_b16 v[226:227], v119 offset:18432
    ds_read_b64_tr_b16 v[228:229], v119 offset:20480
    ds_read_b64_tr_b16 v[230:231], v119 offset:22528
    ds_read_b64_tr_b16 v[232:233], v119 offset:24576
    ds_read_b64_tr_b16 v[234:235], v119 offset:26624
    ds_read_b64_tr_b16 v[236:237], v119 offset:28672
    ds_read_b64_tr_b16 v[238:239], v119 offset:30720
    s_waitcnt lgkmcnt(0)
    s_waitcnt vmcnt(12)
    s_barrier
    ds_read_b64_tr_b16 v[240:241], v119 offset:32768
    ds_read_b64_tr_b16 v[242:243], v119 offset:34816
    ds_read_b64_tr_b16 v[244:245], v119 offset:36864
    ds_read_b64_tr_b16 v[246:247], v119 offset:38912
    ds_read_b64_tr_b16 v[248:249], v119 offset:40960
    ds_read_b64_tr_b16 v[250:251], v119 offset:43008
    ds_read_b64_tr_b16 v[252:253], v119 offset:45056
    ds_read_b64_tr_b16 v[254:255], v119 offset:47104
    s_waitcnt lgkmcnt(0)
    s_waitcnt vmcnt(8)
    s_barrier
    ds_read_b64_tr_b16 v[48:49], v121 offset:49152
    ds_read_b64_tr_b16 v[50:51], v121 offset:49184
    ds_read_b64_tr_b16 v[52:53], v121 offset:49216
    ds_read_b64_tr_b16 v[54:55], v121 offset:49248
    ds_read_b64_tr_b16 v[56:57], v121 offset:49280
    ds_read_b64_tr_b16 v[58:59], v121 offset:49312
    ds_read_b64_tr_b16 v[60:61], v121 offset:49344
    ds_read_b64_tr_b16 v[62:63], v121 offset:49376
    s_waitcnt lgkmcnt(0)
    s_mul_i32 s52, s18, 3
    s_add_u32 s52, s52, 0
    s_cmp_lt_u32 s52, 86
    s_cbranch_scc1 L_x_wdok0
    v_mov_b64 v[48:49], 0
    v_mov_b64 v[50:51], 0
    v_mov_b64 v[52:53], 0
    v_mov_b64 v[54:55], 0
    v_mov_b64 v[56:57], 0
    v_mov_b64 v[58:59], 0
    v_mov_b64 v[60:61], 0
    v_mov_b64 v[62:63], 0
L_x_wdok0:
    v_lshrrev_b32 v124, 1, v9
    s_mul_i32 s52, s19, 12288
    s_add_u32 s52, s52, 114688
    v_lshlrev_b32 v124, 3, v100
    v_add_u32 v124, s52, v124
    ds_write_b64 v9, v[48:49] offset:0
    ds_write_b64 v9, v[50:51] offset:1024
    ds_write_b64 v9, v[52:53] offset:2048
    ds_write_b64 v9, v[54:55] offset:3072
    ds_write_b64 v9, v[56:57] offset:4096
    ds_write_b64 v9, v[58:59] offset:5120
    ds_write_b64 v9, v[60:61] offset:6144
    ds_write_b64 v9, v[62:63] offset:7168
    s_waitcnt lgkmcnt(0)
    s_waitcnt vmcnt(4)
    s_barrier
    ds_read_b64_tr_b16 v[48:49], v122 offset:0
    ds_read_b64_tr_b16 v[50:51], v122 offset:32
    ds_read_b64_tr_b16 v[52:53], v122 offset:64
    ds_read_b64_tr_b16 v[54:55], v122 offset:96
    ds_read_b64_tr_b16 v[56:57], v122 offset:128
    ds_read_b64_tr_b16 v[58:59], v122 offset:160
    ds_read_b64_tr_b16 v[60:61], v122 offset:192
    ds_read_b64_tr_b16 v[62:63], v122 offset:224
    s_waitcnt lgkmcnt(0)
    s_mul_i32 s52, s18, 3
    s_add_u32 s52, s52, 1
    s_cmp_lt_u32 s52, 86
    s_cbranch_scc1 L_x_wdok1
    v_mov_b64 v[48:49], 0
    v_mov_b64 v[50:51], 0
    v_mov_b64 v[52:53], 0
    v_mov_b64 v[54:55], 0
    v_mov_b64 v[56:57], 0
    v_mov_b64 v[58:59], 0
    v_mov_b64 v[60:61], 0
    v_mov_b64 v[62:63], 0
L_x_wdok1:
    v_lshrrev_b32 v124, 1, v9
    s_mul_i32 s52, s19, 12288
    s_add_u32 s52, s52, 114688
    v_lshlrev_b32 v124, 3, v100
    v_add_u32 v124, s52, v124
    ds_write_b64 v9, v[48:49] offset:8
    ds_write_b64 v9, v[50:51] offset:1032
    ds_write_b64 v9, v[52:53] offset:2056
    ds_write_b64 v9, v[54:55] offset:3080
    ds_write_b64 v9, v[56:57] offset:4104
    ds_write_b64 v9, v[58:59] offset:5128
    ds_write_b64 v9, v[60:61] offset:6152
    ds_write_b64 v9, v[62:63] offset:7176
    s_waitcnt lgkmcnt(0)
    s_waitcnt vmcnt(0)
    s_barrier
    ds_read_b64_tr_b16 v[48:49], v122 offset:16384
    ds_read_b64_tr_b16 v[50:51], v122 offset:16416
    ds_read_b64_tr_b16 v[52:53], v122 offset:16448
    ds_read_b64_tr_b16 v[54:55], v122 offset:16480
    ds_read_b64_tr_b16 v[56:57], v122 offset:16512
    ds_read_b64_tr_b16 v[58:59], v122 offset:16544
    ds_read_b64_tr_b16 v[60:61], v122 offset:16576
    ds_read_b64_tr_b16 v[62:63], v122 offset:16608
    s_waitcnt lgkmcnt(0)
    s_mul_i32 s52, s18, 3
    s_add_u32 s52, s52, 2
    s_cmp_lt_u32 s52, 86
    s_cbranch_scc1 L_x_wdok2
    v_mov_b64 v[48:49], 0
    v_mov_b64 v[50:51], 0
    v_mov_b64 v[52:53], 0
    v_mov_b64 v[54:55], 0
    v_mov_b64 v[56:57], 0
    v_mov_b64 v[58:59], 0
    v_mov_b64 v[60:61], 0
    v_mov_b64 v[62:63], 0
L_x_wdok2:
    v_lshrrev_b32 v124, 1, v9
    s_mul_i32 s52, s19, 12288
    s_add_u32 s52, s52, 114688
    v_lshlrev_b32 v124, 3, v100
    v_add_u32 v124, s52, v124
    ds_write_b64 v124, v[48:49] offset:8192
    ds_write_b64 v124, v[50:51] offset:8704
    ds_write_b64 v124, v[52:53] offset:9216
    ds_write_b64 v124, v[54:55] offset:9728
    ds_write_b64 v124, v[56:57] offset:10240
    ds_write_b64 v124, v[58:59] offset:10752
    ds_write_b64 v124, v[60:61] offset:11264
    ds_write_b64 v124, v[62:63] offset:11776
    s_waitcnt lgkmcnt(0)
    s_barrier
    v_mfma_f32_16x16x32_bf16 v[32:35], v[128:131], v[24:27], 0
    v_mfma_f32_16x16x32_bf16 v[32:35], v[132:135], v[24:27], v[32:35]
    v_mfma_f32_16x16x32_bf16 v[32:35], v[136:139], v[24:27], v[32:35]
    v_mfma_f32_16x16x32_bf16 v[32:35], v[140:143], v[24:27], v[32:35]
    v_mfma_f32_16x16x32_bf16 v[32:35], v[144:147], v[24:27], v[32:35]
    v_mfma_f32_16x16x32_bf16 v[32:35], v[148:151], v[24:27], v[32:35]
    v_mfma_f32_16x16x32_bf16 v[32:35], v[152:155], v[24:27], v[32:35]
    v_mfma_f32_16x16x32_bf16 v[32:35], v[156:159], v[24:27], v[32:35]
    v_mfma_f32_16x16x32_bf16 v[32:35], v[160:163], v[24:27], v[32:35]
    v_mfma_f32_16x16x32_bf16 v[32:35], v[164:167], v[24:27], v[32:35]
    v_mfma_f32_16x16x32_bf16 v[32:35], v[168:171], v[24:27], v[32:35]
    v_mfma_f32_16x16x32_bf16 v[32:35], v[172:175], v[24:27], v[32:35]
    v_mfma_f32_16x16x32_bf16 v[32:35], v[176:179], v[24:27], v[32:35]
    v_mfma_f32_16x16x32_bf16 v[32:35], v[180:183], v[24:27], v[32:35]
    v_mfma_f32_16x16x32_bf16 v[32:35], v[184:187], v[24:27], v[32:35]
    v_mfma_f32_16x16x32_bf16 v[32:35], v[188:191], v[24:27], v[32:35]
    v_mfma_f32_16x16x32_bf16 v[36:39], v[192:195], v[24:27], 0
    v_mfma_f32_16x16x32_bf16 v[36:39], v[196:199], v[24:27], v[36:39]
    v_mfma_f32_16x16x32_bf16 v[36:39], v[200:203], v[24:27], v[36:39]
    v_mfma_f32_16x16x32_bf16 v[36:39], v[204:207], v[24:27], v[36:39]
    v_mfma_f32_16x16x32_bf16 v[36:39], v[208:211], v[24:27], v[36:39]
    v_mfma_f32_16x16x32_bf16 v[36:39], v[212:215], v[24:27], v[36:39]
    v_mfma_f32_16x16x32_bf16 v[36:39], v[216:219], v[24:27], v[36:39]
    v_mfma_f32_16x16x32_bf16 v[36:39], v[220:223], v[24:27], v[36:39]
    v_mfma_f32_16x16x32_bf16 v[36:39], v[224:227], v[24:27], v[36:39]
    v_mfma_f32_16x16x32_bf16 v[36:39], v[228:231], v[24:27], v[36:39]
    v_mfma_f32_16x16x32_bf16 v[36:39], v[232:235], v[24:27], v[36:39]
    v_mfma_f32_16x16x32_bf16 v[36:39], v[236:239], v[24:27], v[36:39]
    v_mfma_f32_16x16x32_bf16 v[36:39], v[240:243], v[24:27], v[36:39]
    v_mfma_f32_16x16x32_bf16 v[36:39], v[244:247], v[24:27], v[36:39]
    v_mfma_f32_16x16x32_bf16 v[36:39], v[248:251], v[24:27], v[36:39]
    v_mfma_f32_16x16x32_bf16 v[36:39], v[252:255], v[24:27], v[36:39]
    s_nop 7
    s_cmp_eq_u32 s19, 0
    s_cbranch_scc0 L_x_lnw_ok
    s_add_u32 s56, s84, 32
    v_mov_b32 v10, s56
    s_mov_b32 s56, 0
L_x_lnw:
    global_load_dword v11, v10, s[16:17] sc1
    s_add_u32 s56, s56, 1
    s_cmp_gt_u32 s56, 400000
    s_cbranch_scc1 L_fail
    s_waitcnt vmcnt(0)
    v_readfirstlane_b32 s57, v11
    s_nop 3
    s_cmp_ge_u32 s57, 192
    s_cbranch_scc1 L_x_lnw_ok
    s_sleep 16
    s_branch L_x_lnw
L_x_lnw_ok:
    s_barrier
    s_lshl_b32 s41, s42, 2
    s_cmp_eq_u32 s19, 0
    s_cbranch_scc0 L_x_tw_ok
    s_add_u32 s56, s84, 68
    s_add_u32 s56, s56, s41
    v_mov_b32 v10, s56
    s_mov_b32 s56, 0
L_x_tw:
    global_load_dword v11, v10, s[16:17] sc1
    s_add_u32 s56, s56, 1
    s_cmp_gt_u32 s56, 400000
    s_cbranch_scc1 L_fail
    s_waitcnt vmcnt(0)
    v_readfirstlane_b32 s57, v11
    s_nop 3
    s_cmp_ge_u32 s57, 32
    s_cbranch_scc1 L_x_tw_ok
    s_sleep 16
    s_branch L_x_tw
L_x_tw_ok:
    s_barrier
    s_cmp_eq_u32 s82, 0
    s_cbranch_scc0 L_x_slow
    s_mov_b32 s25, 0
L_XF_loop:
    s_and_b32 s28, s25, 1
    s_lshl_b32 s55, s24, 5
    s_add_u32 s55, s55, s18
    s_mov_b32 s44, s55
    s_lshl_b32 s52, s44, 2
    s_add_u32 s45, s52, 0xa0000
    s_cmp_eq_u32 s19, 0
    s_cbranch_scc0 L_XF_kvf_ok
    v_mov_b32 v10, s45
    s_mov_b32 s29, 0
L_XF_kvf:
    global_load_dword v11, v10, s[14:15] sc1
    s_add_u32 s29, s29, 1
    s_cmp_gt_u32 s29, 400000
    s_cbranch_scc1 L_fail
    s_waitcnt vmcnt(0)
    v_readfirstlane_b32 s53, v11
    s_nop 3
    s_cmp_lg_u32 s53, 0
    s_cbranch_scc1 L_XF_kvf_ok
    s_sleep 8
    s_branch L_XF_kvf
L_XF_kvf_ok:
    s_barrier
    s_lshl_b32 s52, s24, 15
    s_add_u32 s52, s52, 0x3800000
    s_add_u32 s34, s14, s52
    s_addc_u32 s35, s15, 0
    s_lshl_b32 s52, s19, 13
    s_add_u32 s52, s52, 0
    s_add_u32 m0, s52, 0
    s_add_u32 s54, s34, s52
    s_addc_u32 s55, s35, 0
    global_load_lds_dwordx4 v1, s[54:55] offset:0 sc1
    global_load_lds_dwordx4 v1, s[54:55] offset:1024 sc1
    global_load_lds_dwordx4 v1, s[54:55] offset:2048 sc1
    global_load_lds_dwordx4 v1, s[54:55] offset:3072 sc1
    s_lshl_b32 s52, s19, 13
    s_add_u32 s52, s52, 4096
    s_add_u32 m0, s52, 0
    s_add_u32 s54, s34, s52
    s_addc_u32 s55, s35, 0
    global_load_lds_dwordx4 v1, s[54:55] offset:0 sc1
    global_load_lds_dwordx4 v1, s[54:55] offset:1024 sc1
    global_load_lds_dwordx4 v1, s[54:55] offset:2048 sc1
    global_load_lds_dwordx4 v1, s[54:55] offset:3072 sc1
    s_lshl_b32 s52, s44, 13
    s_lshl_b32 s53, s19, 11
    s_add_u32 s52, s52, s53
    s_add_u32 s52, s52, 0x1000000
    s_add_u32 s54, s14, s52
    s_addc_u32 s55, s15, 0
    s_add_u32 m0, s53, 65536
    s_nop 0
    global_load_lds_dwordx4 v1, s[54:55] sc1
    global_load_lds_dwordx4 v1, s[54:55] offset:1024 sc1
    s_lshl_b32 s52, s44, 13
    s_lshl_b32 s53, s19, 11
    s_add_u32 s52, s52, s53
    s_add_u32 s52, s52, 0x2000000
    s_add_u32 s54, s14, s52
    s_addc_u32 s55, s15, 0
    s_add_u32 m0, s53, 73728
    s_nop 0
    global_load_lds_dwordx4 v1, s[54:55] sc1
    global_load_lds_dwordx4 v1, s[54:55] offset:1024 sc1
    s_lshl_b32 s52, s24, 15
    s_add_u32 s34, s4, s52
    s_addc_u32 s35, s5, 0
    global_load_dwordx2 v[44:45], v6, s[34:35]
    s_waitcnt vmcnt(0)
    s_barrier
    ds_read_b128 v[48:51], v1 offset:0
    ds_read_b128 v[52:55], v1 offset:1024
    ds_read_b128 v[56:59], v1 offset:2048
    ds_read_b128 v[60:63], v1 offset:3072
    s_waitcnt lgkmcnt(3)
    v_mfma_f32_16x16x32_bf16 v[64:67], a[0:3], v[48:51], 0
    v_mfma_f32_16x16x32_bf16 v[72:75], a[64:67], v[48:51], 0
    ds_read_b128 v[48:51], v1 offset:4096
    s_waitcnt lgkmcnt(3)
    v_mfma_f32_16x16x32_bf16 v[64:67], a[4:7], v[52:55], v[64:67]
    v_mfma_f32_16x16x32_bf16 v[72:75], a[68:71], v[52:55], v[72:75]
    ds_read_b128 v[52:55], v1 offset:5120
    s_waitcnt lgkmcnt(3)
    v_mfma_f32_16x16x32_bf16 v[64:67], a[8:11], v[56:59], v[64:67]
    v_mfma_f32_16x16x32_bf16 v[72:75], a[72:75], v[56:59], v[72:75]
    ds_read_b128 v[56:59], v1 offset:6144
    s_waitcnt lgkmcnt(3)
    v_mfma_f32_16x16x32_bf16 v[64:67], a[12:15], v[60:63], v[64:67]
    v_mfma_f32_16x16x32_bf16 v[72:75], a[76:79], v[60:63], v[72:75]
    ds_read_b128 v[60:63], v1 offset:7168
    s_waitcnt lgkmcnt(3)
    v_mfma_f32_16x16x32_bf16 v[64:67], a[16:19], v[48:51], v[64:67]
    v_mfma_f32_16x16x32_bf16 v[72:75], a[80:83], v[48:51], v[72:75]
    ds_read_b128 v[48:51], v1 offset:8192
    s_waitcnt lgkmcnt(3)
    v_mfma_f32_16x16x32_bf16 v[64:67], a[20:23], v[52:55], v[64:67]
    v_mfma_f32_16x16x32_bf16 v[72:75], a[84:87], v[52:55], v[72:75]
    ds_read_b128 v[52:55], v1 offset:9216
    s_waitcnt lgkmcnt(3)
    v_mfma_f32_16x16x32_bf16 v[64:67], a[24:27], v[56:59], v[64:67]
    v_mfma_f32_16x16x32_bf16 v[72:75], a[88:91], v[56:59], v[72:75]
    ds_read_b128 v[56:59], v1 offset:10240
    s_waitcnt lgkmcnt(3)
    v_mfma_f32_16x16x32_bf16 v[64:67], a[28:31], v[60:63], v[64:67]
    v_mfma_f32_16x16x32_bf16 v[72:75], a[92:95], v[60:63], v[72:75]
    ds_read_b128 v[60:63], v1 offset:11264
    s_waitcnt lgkmcnt(3)
    v_mfma_f32_16x16x32_bf16 v[64:67], a[32:35], v[48:51], v[64:67]
    v_mfma_f32_16x16x32_bf16 v[72:75], a[96:99], v[48:51], v[72:75]
    ds_read_b128 v[48:51], v1 offset:12288
    s_waitcnt lgkmcnt(3)
    v_mfma_f32_16x16x32_bf16 v[64:67], a[36:39], v[52:55], v[64:67]
    v_mfma_f32_16x16x32_bf16 v[72:75], a[100:103], v[52:55], v[72:75]
    ds_read_b128 v[52:55], v1 offset:13312
    s_waitcnt lgkmcnt(3)
    v_mfma_f32_16x16x32_bf16 v[64:67], a[40:43], v[56:59], v[64:67]
    v_mfma_f32_16x16x32_bf16 v[72:75], a[104:107], v[56:59], v[72:75]
    ds_read_b128 v[56:59], v1 offset:14336
    s_waitcnt lgkmcnt(3)
    v_mfma_f32_16x16x32_bf16 v[64:67], a[44:47], v[60:63], v[64:67]
    v_mfma_f32_16x16x32_bf16 v[72:75], a[108:111], v[60:63], v[72:75]
    ds_read_b128 v[60:63], v1 offset:15360
    s_waitcnt lgkmcnt(3)
    v_mfma_f32_16x16x32_bf16 v[64:67], a[48:51], v[48:51], v[64:67]
    v_mfma_f32_16x16x32_bf16 v[72:75], a[112:115], v[48:51], v[72:75]
    ds_read_b128 v[48:51], v1 offset:16384
    s_waitcnt lgkmcnt(3)
    v_mfma_f32_16x16x32_bf16 v[64:67], a[52:55], v[52:55], v[64:67]
    v_mfma_f32_16x16x32_bf16 v[72:75], a[116:119], v[52:55], v[72:75]
    ds_read_b128 v[52:55], v1 offset:17408
    s_waitcnt lgkmcnt(3)
    v_mfma_f32_16x16x32_bf16 v[64:67], a[56:59], v[56:59], v[64:67]
    v_mfma_f32_16x16x32_bf16 v[72:75], a[120:123], v[56:59], v[72:75]
    ds_read_b128 v[56:59], v1 offset:18432
    s_waitcnt lgkmcnt(3)
    v_mfma_f32_16x16x32_bf16 v[64:67], a[60:63], v[60:63], v[64:67]
    v_mfma_f32_16x16x32_bf16 v[72:75], a[124:127], v[60:63], v[72:75]
    ds_read_b128 v[60:63], v1 offset:19456
    s_waitcnt lgkmcnt(3)
    v_mfma_f32_16x16x32_bf16 v[68:71], a[0:3], v[48:51], 0
    v_mfma_f32_16x16x32_bf16 v[76:79], a[64:67], v[48:51], 0
    ds_read_b128 v[48:51], v1 offset:20480
    s_waitcnt lgkmcnt(3)
    v_mfma_f32_16x16x32_bf16 v[68:71], a[4:7], v[52:55], v[68:71]
    v_mfma_f32_16x16x32_bf16 v[76:79], a[68:71], v[52:55], v[76:79]
    ds_read_b128 v[52:55], v1 offset:21504
    s_waitcnt lgkmcnt(3)
    v_mfma_f32_16x16x32_bf16 v[68:71], a[8:11], v[56:59], v[68:71]
    v_mfma_f32_16x16x32_bf16 v[76:79], a[72:75], v[56:59], v[76:79]
    ds_read_b128 v[56:59], v1 offset:22528
    s_waitcnt lgkmcnt(3)
    v_mfma_f32_16x16x32_bf16 v[68:71], a[12:15], v[60:63], v[68:71]
    v_mfma_f32_16x16x32_bf16 v[76:79], a[76:79], v[60:63], v[76:79]
    ds_read_b128 v[60:63], v1 offset:23552
    s_waitcnt lgkmcnt(3)
    v_mfma_f32_16x16x32_bf16 v[68:71], a[16:19], v[48:51], v[68:71]
    v_mfma_f32_16x16x32_bf16 v[76:79], a[80:83], v[48:51], v[76:79]
    ds_read_b128 v[48:51], v1 offset:24576
    s_waitcnt lgkmcnt(3)
    v_mfma_f32_16x16x32_bf16 v[68:71], a[20:23], v[52:55], v[68:71]
    v_mfma_f32_16x16x32_bf16 v[76:79], a[84:87], v[52:55], v[76:79]
    ds_read_b128 v[52:55], v1 offset:25600
    s_waitcnt lgkmcnt(3)
    v_mfma_f32_16x16x32_bf16 v[68:71], a[24:27], v[56:59], v[68:71]
    v_mfma_f32_16x16x32_bf16 v[76:79], a[88:91], v[56:59], v[76:79]
    ds_read_b128 v[56:59], v1 offset:26624
    s_waitcnt lgkmcnt(3)
    v_mfma_f32_16x16x32_bf16 v[68:71], a[28:31], v[60:63], v[68:71]
    v_mfma_f32_16x16x32_bf16 v[76:79], a[92:95], v[60:63], v[76:79]
    ds_read_b128 v[60:63], v1 offset:27648
    s_waitcnt lgkmcnt(3)
    v_mfma_f32_16x16x32_bf16 v[68:71], a[32:35], v[48:51], v[68:71]
    v_mfma_f32_16x16x32_bf16 v[76:79], a[96:99], v[48:51], v[76:79]
    ds_read_b128 v[48:51], v1 offset:28672
    s_waitcnt lgkmcnt(3)
    v_mfma_f32_16x16x32_bf16 v[68:71], a[36:39], v[52:55], v[68:71]
    v_mfma_f32_16x16x32_bf16 v[76:79], a[100:103], v[52:55], v[76:79]
    ds_read_b128 v[52:55], v1 offset:29696
    s_waitcnt lgkmcnt(3)
    v_mfma_f32_16x16x32_bf16 v[68:71], a[40:43], v[56:59], v[68:71]
    v_mfma_f32_16x16x32_bf16 v[76:79], a[104:107], v[56:59], v[76:79]
    ds_read_b128 v[56:59], v1 offset:30720
    s_waitcnt lgkmcnt(3)
    v_mfma_f32_16x16x32_bf16 v[68:71], a[44:47], v[60:63], v[68:71]
    v_mfma_f32_16x16x32_bf16 v[76:79], a[108:111], v[60:63], v[76:79]
    ds_read_b128 v[60:63], v1 offset:31744
    s_waitcnt lgkmcnt(3)
    v_mfma_f32_16x16x32_bf16 v[68:71], a[48:51], v[48:51], v[68:71]
    v_mfma_f32_16x16x32_bf16 v[76:79], a[112:115], v[48:51], v[76:79]
    s_waitcnt lgkmcnt(2)
    v_mfma_f32_16x16x32_bf16 v[68:71], a[52:55], v[52:55], v[68:71]
    v_mfma_f32_16x16x32_bf16 v[76:79], a[116:119], v[52:55], v[76:79]
    s_waitcnt lgkmcnt(1)
    v_mfma_f32_16x16x32_bf16 v[68:71], a[56:59], v[56:59], v[68:71]
    v_mfma_f32_16x16x32_bf16 v[76:79], a[120:123], v[56:59], v[76:79]
    s_waitcnt lgkmcnt(0)
    v_mfma_f32_16x16x32_bf16 v[68:71], a[60:63], v[60:63], v[68:71]
    v_mfma_f32_16x16x32_bf16 v[76:79], a[124:127], v[60:63], v[76:79]
    s_nop 7
    v_cvt_pk_bf16_f32 v80, v64, v72
    v_cvt_pk_bf16_f32 v81, v65, v73
    v_cvt_pk_bf16_f32 v82, v66, v74
    v_cvt_pk_bf16_f32 v83, v67, v75
    v_cvt_pk_bf16_f32 v84, v68, v76
    v_cvt_pk_bf16_f32 v85, v69, v77
    v_cvt_pk_bf16_f32 v86, v70, v78
    v_cvt_pk_bf16_f32 v87, v71, v79
    s_lshl_b32 s52, s19, 10
    v_add_u32 v10, s52, v1
    v_add_u32 v10, 81920, v10
    ds_write_b128 v10, v[80:83]
    ds_write_b128 v10, v[84:87] offset:4096
    s_lshl_b32 s52, s44, 2
    s_add_u32 s45, s52, 0xa2100
    s_cmp_eq_u32 s19, 0
    s_cbranch_scc0 L_XF_memf_ok
    v_mov_b32 v10, s45
    s_mov_b32 s29, 0
L_XF_memf:
    global_load_dword v11, v10, s[14:15] sc1
    s_add_u32 s29, s29, 1
    s_cmp_gt_u32 s29, 400000
    s_cbranch_scc1 L_fail
    s_waitcnt vmcnt(0)
    v_readfirstlane_b32 s53, v11
    s_nop 3
    s_cmp_lg_u32 s53, 0
    s_cbranch_scc1 L_XF_memf_ok
    s_sleep 8
    s_branch L_XF_memf
L_XF_memf_ok:
    s_barrier
    s_lshl_b32 s52, s44, 11
    s_add_u32 s53, s52, 0x3000000
    s_add_u32 s34, s14, s53
    s_addc_u32 s35, s15, 0
    global_load_dwordx4 v[64:67], v2, s[34:35] offset:0 sc1
    global_load_dwordx4 v[68:71], v2, s[34:35] offset:512 sc1
    global_load_dwordx4 v[72:75], v2, s[34:35] offset:1024 sc1
    global_load_dwordx4 v[76:79], v2, s[34:35] offset:1536 sc1
    s_add_u32 s53, s52, 0x3400000
    s_add_u32 s36, s14, s53
    s_addc_u32 s37, s15, 0
    global_load_dword v124, v3, s[36:37] offset:0 sc1
    global_load_dword v125, v3, s[36:37] offset:256 sc1
    global_load_dword v126, v3, s[36:37] offset:512 sc1
    global_load_dword v127, v3, s[36:37] offset:768 sc1
    s_waitcnt lgkmcnt(0)
    s_barrier
    s_lshr_b32 s52, s19, 1
    s_lshl_b32 s52, s52, 12
    v_add_u32 v10, s52, v1
    v_add_u32 v10, 81920, v10
    ds_read_b128 v[48:51], v10 offset:0
    ds_read_b128 v[52:55], v10 offset:1024
    ds_read_b128 v[56:59], v10 offset:2048
    ds_read_b128 v[60:63], v10 offset:3072
    v_add_u32 v11, 65536, v1
    ds_read_b128 v[80:83], v11 offset:0
    ds_read_b128 v[96:99], v11 offset:4096
    ds_read_b128 v[84:87], v11 offset:1024
    ds_read_b128 v[100:103], v11 offset:5120
    ds_read_b128 v[88:91], v11 offset:2048
    ds_read_b128 v[104:107], v11 offset:6144
    ds_read_b128 v[92:95], v11 offset:3072
    ds_read_b128 v[108:111], v11 offset:7168
    s_waitcnt vmcnt(0) lgkmcnt(0)
    v_mfma_f32_16x16x32_bf16 v[112:115], v[64:67], v[48:51], 0
    v_mfma_f32_16x16x32_bf16 v[116:119], v[80:83], v[48:51], v[16:19]
    v_mfma_f32_16x16x32_bf16 v[120:123], v[96:99], v[48:51], v[20:23]
    v_mfma_f32_16x16x32_bf16 v[112:115], v[68:71], v[52:55], v[112:115]
    v_mfma_f32_16x16x32_bf16 v[116:119], v[84:87], v[52:55], v[116:119]
    v_mfma_f32_16x16x32_bf16 v[120:123], v[100:103], v[52:55], v[120:123]
    v_mfma_f32_16x16x32_bf16 v[112:115], v[72:75], v[56:59], v[112:115]
    v_mfma_f32_16x16x32_bf16 v[116:119], v[88:91], v[56:59], v[116:119]
    v_mfma_f32_16x16x32_bf16 v[120:123], v[104:107], v[56:59], v[120:123]
    v_mfma_f32_16x16x32_bf16 v[112:115], v[76:79], v[60:63], v[112:115]
    v_mfma_f32_16x16x32_bf16 v[116:119], v[92:95], v[60:63], v[116:119]
    v_mfma_f32_16x16x32_bf16 v[120:123], v[108:111], v[60:63], v[120:123]
    s_and_b32 s52, s19, 1
    s_lshl_b32 s52, s52, 12
    v_add_u32 v10, s52, v1
    v_add_u32 v10, 73728, v10
    ds_read_b128 v[64:67], v10 offset:0
    ds_read_b128 v[68:71], v10 offset:1024
    ds_read_b128 v[72:75], v10 offset:2048
    ds_read_b128 v[76:79], v10 offset:3072
    s_nop 4
    v_max3_f32 v12, v116, v117, v118
    v_max3_f32 v12, v12, v119, v120
    v_max3_f32 v12, v12, v121, v122
    v_max3_f32 v12, v12, v123, v112
    v_max_f32 v12, v12, v113
    v_mov_b32 v13, v12
    s_nop 1
    v_permlane32_swap_b32 v12, v13
    v_max_f32 v12, v12, v13
    v_mov_b32 v13, v12
    s_nop 1
    v_permlane16_swap_b32 v12, v13
    v_max_f32 v12, v12, v13
    v_mul_f32 v12, s30, v12
    v_fma_f32 v116, v116, s30, -v12
    v_fma_f32 v117, v117, s30, -v12
    v_fma_f32 v118, v118, s30, -v12
    v_fma_f32 v119, v119, s30, -v12
    v_fma_f32 v120, v120, s30, -v12
    v_fma_f32 v121, v121, s30, -v12
    v_fma_f32 v122, v122, s30, -v12
    v_fma_f32 v123, v123, s30, -v12
    v_fma_f32 v112, v112, s30, -v12
    v_fma_f32 v113, v113, s30, -v12
    v_exp_f32 v116, v116
    v_exp_f32 v117, v117
    v_exp_f32 v118, v118
    v_exp_f32 v119, v119
    v_exp_f32 v120, v120
    v_exp_f32 v121, v121
    v_exp_f32 v122, v122
    v_exp_f32 v123, v123
    v_exp_f32 v112, v112
    v_exp_f32 v113, v113
    v_mov_b32 v53, 0
    v_cvt_pk_bf16_f32 v48, v116, v117
    v_cvt_pk_bf16_f32 v49, v118, v119
    v_cvt_pk_bf16_f32 v50, v120, v121
    v_cvt_pk_bf16_f32 v51, v122, v123
    v_cvt_pk_bf16_f32 v52, v112, v113
    v_mov_b32 v112, v124
    v_mov_b32 v113, 0
    v_mov_b32 v114, v125
    v_mov_b32 v115, 0
    v_mov_b32 v116, v126
    v_mov_b32 v117, 0
    v_mov_b32 v118, v127
    v_mov_b32 v119, 0
    s_waitcnt lgkmcnt(0)
    v_mfma_f32_16x16x32_bf16 v[96:99], v[24:27], v[48:51], 0
    v_mfma_f32_16x16x32_bf16 v[80:83], v[64:67], v[48:51], 0
    v_mfma_f32_16x16x32_bf16 v[84:87], v[68:71], v[48:51], 0
    v_mfma_f32_16x16x32_bf16 v[88:91], v[72:75], v[48:51], 0
    v_mfma_f32_16x16x32_bf16 v[92:95], v[76:79], v[48:51], 0
    s_nop 1
    v_mfma_f32_16x16x16_bf16 v[96:99], v[24:25], v[52:53], v[96:99]
    v_mfma_f32_16x16x16_bf16 v[80:83], v[112:113], v[52:53], v[80:83]
    v_mfma_f32_16x16x16_bf16 v[84:87], v[114:115], v[52:53], v[84:87]
    v_mfma_f32_16x16x16_bf16 v[88:91], v[116:117], v[52:53], v[88:91]
    v_mfma_f32_16x16x16_bf16 v[92:95], v[118:119], v[52:53], v[92:95]
    v_rcp_f32 v12, v96
    s_nop 5
    v_mul_f32 v80, v80, v12
    v_mul_f32 v81, v81, v12
    v_mul_f32 v82, v82, v12
    v_mul_f32 v83, v83, v12
    v_mul_f32 v84, v84, v12
    v_mul_f32 v85, v85, v12
    v_mul_f32 v86, v86, v12
    v_mul_f32 v87, v87, v12
    v_mul_f32 v88, v88, v12
    v_mul_f32 v89, v89, v12
    v_mul_f32 v90, v90, v12
    v_mul_f32 v91, v91, v12
    v_mul_f32 v92, v92, v12
    v_mul_f32 v93, v93, v12
    v_mul_f32 v94, v94, v12
    v_mul_f32 v95, v95, v12
    v_cvt_pk_bf16_f32 v100, v80, v81
    v_cvt_pk_bf16_f32 v101, v82, v83
    v_cvt_pk_bf16_f32 v102, v84, v85
    v_cvt_pk_bf16_f32 v103, v86, v87
    v_cvt_pk_bf16_f32 v104, v88, v89
    v_cvt_pk_bf16_f32 v105, v90, v91
    v_cvt_pk_bf16_f32 v106, v92, v93
    v_cvt_pk_bf16_f32 v107, v94, v95
    s_lshl_b32 s52, s19, 11
    v_add_u32 v10, s52, v1
    v_add_u32 v10, 90112, v10
    ds_write_b128 v10, v[100:103]
    ds_write_b128 v10, v[104:107] offset:1024
    s_waitcnt lgkmcnt(0)
    s_barrier
    v_add_u32 v10, 90112, v1
    ds_read_b128 v[48:51], v10 offset:0
    ds_read_b128 v[52:55], v10 offset:1024
    ds_read_b128 v[56:59], v10 offset:2048
    ds_read_b128 v[60:63], v10 offset:3072
    ds_read_b128 v[64:67], v10 offset:4096
    ds_read_b128 v[68:71], v10 offset:5120
    ds_read_b128 v[72:75], v10 offset:6144
    ds_read_b128 v[76:79], v10 offset:7168
    s_waitcnt lgkmcnt(0)
    s_add_u32 s32, s26, 0x0
    s_addc_u32 s33, s27, 0
    v_mfma_f32_16x16x32_bf16 v[80:83], a[128:131], v[48:51], 0
    v_mfma_f32_16x16x32_bf16 v[84:87], a[128:131], v[64:67], 0
    v_mfma_f32_16x16x32_bf16 v[80:83], a[132:135], v[52:55], v[80:83]
    v_mfma_f32_16x16x32_bf16 v[84:87], a[132:135], v[68:71], v[84:87]
    v_mfma_f32_16x16x32_bf16 v[80:83], a[136:139], v[56:59], v[80:83]
    v_mfma_f32_16x16x32_bf16 v[84:87], a[136:139], v[72:75], v[84:87]
    v_mfma_f32_16x16x32_bf16 v[80:83], a[140:143], v[60:63], v[80:83]
    v_mfma_f32_16x16x32_bf16 v[84:87], a[140:143], v[76:79], v[84:87]
    v_mfma_f32_16x16x32_bf16 v[88:91], a[144:147], v[48:51], 0
    v_mfma_f32_16x16x32_bf16 v[92:95], a[144:147], v[64:67], 0
    v_mfma_f32_16x16x32_bf16 v[88:91], a[148:151], v[52:55], v[88:91]
    v_mfma_f32_16x16x32_bf16 v[92:95], a[148:151], v[68:71], v[92:95]
    v_mfma_f32_16x16x32_bf16 v[88:91], a[152:155], v[56:59], v[88:91]
    v_mfma_f32_16x16x32_bf16 v[92:95], a[152:155], v[72:75], v[92:95]
    v_mfma_f32_16x16x32_bf16 v[88:91], a[156:159], v[60:63], v[88:91]
    v_mfma_f32_16x16x32_bf16 v[92:95], a[156:159], v[76:79], v[92:95]
    v_cvt_pk_bf16_f32 v96, v80, v81
    v_cvt_pk_bf16_f32 v97, v82, v83
    v_cvt_pk_bf16_f32 v98, v84, v85
    v_cvt_pk_bf16_f32 v99, v86, v87
    v_and_or_b32 v96, v96, -2, s28
    global_store_dwordx4 v4, v[96:99], s[32:33]
    s_add_u32 s32, s32, 0x8000
    s_addc_u32 s33, s33, 0
    v_mfma_f32_16x16x32_bf16 v[80:83], a[160:163], v[48:51], 0
    v_mfma_f32_16x16x32_bf16 v[84:87], a[160:163], v[64:67], 0
    v_mfma_f32_16x16x32_bf16 v[80:83], a[164:167], v[52:55], v[80:83]
    v_mfma_f32_16x16x32_bf16 v[84:87], a[164:167], v[68:71], v[84:87]
    v_mfma_f32_16x16x32_bf16 v[80:83], a[168:171], v[56:59], v[80:83]
    v_mfma_f32_16x16x32_bf16 v[84:87], a[168:171], v[72:75], v[84:87]
    v_mfma_f32_16x16x32_bf16 v[80:83], a[172:175], v[60:63], v[80:83]
    v_mfma_f32_16x16x32_bf16 v[84:87], a[172:175], v[76:79], v[84:87]
    v_cvt_pk_bf16_f32 v100, v88, v89
    v_cvt_pk_bf16_f32 v101, v90, v91
    v_cvt_pk_bf16_f32 v102, v92, v93
    v_cvt_pk_bf16_f32 v103, v94, v95
    v_and_or_b32 v100, v100, -2, s28
    global_store_dwordx4 v4, v[100:103], s[32:33]
    s_add_u32 s32, s32, 0x8000
    s_addc_u32 s33, s33, 0
    v_mfma_f32_16x16x32_bf16 v[88:91], a[176:179], v[48:51], 0
    v_mfma_f32_16x16x32_bf16 v[92:95], a[176:179], v[64:67], 0
    v_mfma_f32_16x16x32_bf16 v[88:91], a[180:183], v[52:55], v[88:91]
    v_mfma_f32_16x16x32_bf16 v[92:95], a[180:183], v[68:71], v[92:95]
    v_mfma_f32_16x16x32_bf16 v[88:91], a[184:187], v[56:59], v[88:91]
    v_mfma_f32_16x16x32_bf16 v[92:95], a[184:187], v[72:75], v[92:95]
    v_mfma_f32_16x16x32_bf16 v[88:91], a[188:191], v[60:63], v[88:91]
    v_mfma_f32_16x16x32_bf16 v[92:95], a[188:191], v[76:79], v[92:95]
    v_cvt_pk_bf16_f32 v96, v80, v81
    v_cvt_pk_bf16_f32 v97, v82, v83
    v_cvt_pk_bf16_f32 v98, v84, v85
    v_cvt_pk_bf16_f32 v99, v86, v87
    v_and_or_b32 v96, v96, -2, s28
    global_store_dwordx4 v4, v[96:99], s[32:33]
    s_add_u32 s32, s32, 0x8000
    s_addc_u32 s33, s33, 0
    v_mfma_f32_16x16x32_bf16 v[80:83], a[192:195], v[48:51], 0
    v_mfma_f32_16x16x32_bf16 v[84:87], a[192:195], v[64:67], 0
    v_mfma_f32_16x16x32_bf16 v[80:83], a[196:199], v[52:55], v[80:83]
    v_mfma_f32_16x16x32_bf16 v[84:87], a[196:199], v[68:71], v[84:87]
    v_mfma_f32_16x16x32_bf16 v[80:83], a[200:203], v[56:59], v[80:83]
    v_mfma_f32_16x16x32_bf16 v[84:87], a[200:203], v[72:75], v[84:87]
    v_mfma_f32_16x16x32_bf16 v[80:83], a[204:207], v[60:63], v[80:83]
    v_mfma_f32_16x16x32_bf16 v[84:87], a[204:207], v[76:79], v[84:87]
    v_cvt_pk_bf16_f32 v100, v88, v89
    v_cvt_pk_bf16_f32 v101, v90, v91
    v_cvt_pk_bf16_f32 v102, v92, v93
    v_cvt_pk_bf16_f32 v103, v94, v95
    v_and_or_b32 v100, v100, -2, s28
    global_store_dwordx4 v4, v[100:103], s[32:33]
    s_add_u32 s32, s32, 0x8000
    s_addc_u32 s33, s33, 0
    v_mfma_f32_16x16x32_bf16 v[88:91], a[208:211], v[48:51], 0
    v_mfma_f32_16x16x32_bf16 v[92:95], a[208:211], v[64:67], 0
    v_mfma_f32_16x16x32_bf16 v[88:91], a[212:215], v[52:55], v[88:91]
    v_mfma_f32_16x16x32_bf16 v[92:95], a[212:215], v[68:71], v[92:95]
    v_mfma_f32_16x16x32_bf16 v[88:91], a[216:219], v[56:59], v[88:91]
    v_mfma_f32_16x16x32_bf16 v[92:95], a[216:219], v[72:75], v[92:95]
    v_mfma_f32_16x16x32_bf16 v[88:91], a[220:223], v[60:63], v[88:91]
    v_mfma_f32_16x16x32_bf16 v[92:95], a[220:223], v[76:79], v[92:95]
    v_cvt_pk_bf16_f32 v96, v80, v81
    v_cvt_pk_bf16_f32 v97, v82, v83
    v_cvt_pk_bf16_f32 v98, v84, v85
    v_cvt_pk_bf16_f32 v99, v86, v87
    v_and_or_b32 v96, v96, -2, s28
    global_store_dwordx4 v4, v[96:99], s[32:33]
    s_add_u32 s32, s32, 0x8000
    s_addc_u32 s33, s33, 0
    v_mfma_f32_16x16x32_bf16 v[80:83], a[224:227], v[48:51], 0
    v_mfma_f32_16x16x32_bf16 v[84:87], a[224:227], v[64:67], 0
    v_mfma_f32_16x16x32_bf16 v[80:83], a[228:231], v[52:55], v[80:83]
    v_mfma_f32_16x16x32_bf16 v[84:87], a[228:231], v[68:71], v[84:87]
    v_mfma_f32_16x16x32_bf16 v[80:83], a[232:235], v[56:59], v[80:83]
    v_mfma_f32_16x16x32_bf16 v[84:87], a[232:235], v[72:75], v[84:87]
    v_mfma_f32_16x16x32_bf16 v[80:83], a[236:239], v[60:63], v[80:83]
    v_mfma_f32_16x16x32_bf16 v[84:87], a[236:239], v[76:79], v[84:87]
    v_cvt_pk_bf16_f32 v100, v88, v89
    v_cvt_pk_bf16_f32 v101, v90, v91
    v_cvt_pk_bf16_f32 v102, v92, v93
    v_cvt_pk_bf16_f32 v103, v94, v95
    v_and_or_b32 v100, v100, -2, s28
    global_store_dwordx4 v4, v[100:103], s[32:33]
    s_add_u32 s32, s32, 0x8000
    s_addc_u32 s33, s33, 0
    v_mfma_f32_16x16x32_bf16 v[88:91], a[240:243], v[48:51], 0
    v_mfma_f32_16x16x32_bf16 v[92:95], a[240:243], v[64:67], 0
    v_mfma_f32_16x16x32_bf16 v[88:91], a[244:247], v[52:55], v[88:91]
    v_mfma_f32_16x16x32_bf16 v[92:95], a[244:247], v[68:71], v[92:95]
    v_mfma_f32_16x16x32_bf16 v[88:91], a[248:251], v[56:59], v[88:91]
    v_mfma_f32_16x16x32_bf16 v[92:95], a[248:251], v[72:75], v[92:95]
    v_mfma_f32_16x16x32_bf16 v[88:91], a[252:255], v[60:63], v[88:91]
    v_mfma_f32_16x16x32_bf16 v[92:95], a[252:255], v[76:79], v[92:95]
    v_cvt_pk_bf16_f32 v96, v80, v81
    v_cvt_pk_bf16_f32 v97, v82, v83
    v_cvt_pk_bf16_f32 v98, v84, v85
    v_cvt_pk_bf16_f32 v99, v86, v87
    v_and_or_b32 v96, v96, -2, s28
    global_store_dwordx4 v4, v[96:99], s[32:33]
    s_add_u32 s32, s32, 0x8000
    s_addc_u32 s33, s33, 0
    s_nop 7
    v_cvt_pk_bf16_f32 v100, v88, v89
    v_cvt_pk_bf16_f32 v101, v90, v91
    v_cvt_pk_bf16_f32 v102, v92, v93
    v_cvt_pk_bf16_f32 v103, v94, v95
    v_and_or_b32 v100, v100, -2, s28
    global_store_dwordx4 v4, v[100:103], s[32:33]
    s_add_u32 s32, s32, 0x8000
    s_addc_u32 s33, s33, 0
    s_add_u32 s32, s26, 0x0
    s_addc_u32 s33, s27, 0
    s_mov_b32 s29, 0
L_XF_r0:
    v_mov_b32 v10, v5
    global_load_dwordx4 v[48:51], v10, s[32:33] sc1
    v_add_u32 v10, 4096, v10
    global_load_dwordx4 v[52:55], v10, s[32:33] sc1
    v_add_u32 v10, 4096, v10
    global_load_dwordx4 v[56:59], v10, s[32:33] sc1
    v_add_u32 v10, 4096, v10
    global_load_dwordx4 v[60:63], v10, s[32:33] sc1
    v_add_u32 v10, 4096, v10
    global_load_dwordx4 v[64:67], v10, s[32:33] sc1
    v_add_u32 v10, 4096, v10
    global_load_dwordx4 v[68:71], v10, s[32:33] sc1
    v_add_u32 v10, 4096, v10
    global_load_dwordx4 v[72:75], v10, s[32:33] sc1
    v_add_u32 v10, 4096, v10
    global_load_dwordx4 v[76:79], v10, s[32:33] sc1
    s_add_u32 s29, s29, 1
    s_cmp_gt_u32 s29, 400000
    s_cbranch_scc1 L_fail
    s_waitcnt vmcnt(0)
    v_bitop3_b32 v11, v48, v52, s28 bitop3:0x7e
    v_bitop3_b32 v12, v56, v60, s28 bitop3:0x7e
    v_or_b32 v11, v11, v12
    v_bitop3_b32 v12, v64, v68, s28 bitop3:0x7e
    v_or_b32 v11, v11, v12
    v_bitop3_b32 v12, v72, v76, s28 bitop3:0x7e
    v_or_b32 v11, v11, v12
    v_and_b32 v11, 1, v11
    v_cmp_ne_u32 vcc, 0, v11
    s_cbranch_vccnz L_XF_r0
    v_mfma_f32_16x16x32_bf16 v[80:83], v[28:31], v[48:51], 0
    v_mfma_f32_16x16x32_bf16 v[80:83], v[28:31], v[52:55], v[80:83]
    v_mfma_f32_16x16x32_bf16 v[80:83], v[28:31], v[56:59], v[80:83]
    v_mfma_f32_16x16x32_bf16 v[80:83], v[28:31], v[60:63], v[80:83]
    v_mfma_f32_16x16x32_bf16 v[80:83], v[28:31], v[64:67], v[80:83]
    v_mfma_f32_16x16x32_bf16 v[80:83], v[28:31], v[68:71], v[80:83]
    v_mfma_f32_16x16x32_bf16 v[80:83], v[28:31], v[72:75], v[80:83]
    v_mfma_f32_16x16x32_bf16 v[80:83], v[28:31], v[76:79], v[80:83]
    s_nop 7
    v_cvt_pk_bf16_f32 v10, v80, v81
    v_cvt_pk_bf16_f32 v11, v82, v83
    v_lshlrev_b32 v80, 16, v10
    v_and_b32 v81, 0xffff0000, v10
    v_lshlrev_b32 v82, 16, v11
    v_and_b32 v83, 0xffff0000, v11
    v_lshlrev_b32 v10, 16, v44
    v_add_f32 v40, v80, v10
    v_and_b32 v10, 0xffff0000, v44
    v_add_f32 v41, v81, v10
    v_lshlrev_b32 v10, 16, v45
    v_add_f32 v42, v82, v10
    v_and_b32 v10, 0xffff0000, v45
    v_add_f32 v43, v83, v10
    v_cvt_pk_bf16_f32 v10, v40, v41
    v_cvt_pk_bf16_f32 v11, v42, v43
    v_lshlrev_b32 v40, 16, v10
    v_and_b32 v41, 0xffff0000, v10
    v_lshlrev_b32 v42, 16, v11
    v_and_b32 v43, 0xffff0000, v11
    s_add_u32 s32, s26, 0x200000
    s_addc_u32 s33, s27, 0
    s_mov_b64 exec, s[40:41]
    global_store_dwordx2 v7, v[10:11], s[32:33]
    s_mov_b64 exec, -1
    s_waitcnt vmcnt(0)
    s_barrier
    s_lshl_b32 s52, s42, 8
    s_add_u32 s46, s52, 0xa4800
    s_cmp_eq_u32 s19, 0
    s_cbranch_scc0 L_XF_nofl
    s_lshl_b32 s52, s18, 2
    s_add_u32 s52, s52, s46
    s_add_u32 s53, s25, 1
    v_mov_b32 v10, s52
    v_mov_b32 v11, s53
    s_mov_b64 exec, 1
    global_store_dword v10, v11, s[14:15]
    s_mov_b64 exec, -1
L_XF_nofl:
    v_and_b32 v10, 31, v0
    v_lshlrev_b32 v10, 2, v10
    v_add_u32 v10, s46, v10
    s_add_u32 s47, s25, 1
    s_mov_b32 s29, 0
L_XF_hw:
    global_load_dword v11, v10, s[14:15] sc1
    s_add_u32 s29, s29, 1
    s_cmp_gt_u32 s29, 400000
    s_cbranch_scc1 L_fail
    s_waitcnt vmcnt(0)
    v_cmp_gt_u32 vcc, s47, v11
    s_cbranch_vccnz L_XF_hw
    s_add_u32 s34, s26, 0x200000
    s_addc_u32 s35, s27, 0
    s_lshl_b32 s52, s19, 13
    s_add_u32 s52, s52, 0
    s_add_u32 m0, s52, 0
    s_add_u32 s54, s34, s52
    s_addc_u32 s55, s35, 0
    global_load_lds_dwordx4 v1, s[54:55] offset:0 sc1
    global_load_lds_dwordx4 v1, s[54:55] offset:1024 sc1
    global_load_lds_dwordx4 v1, s[54:55] offset:2048 sc1
    global_load_lds_dwordx4 v1, s[54:55] offset:3072 sc1
    s_lshl_b32 s52, s19, 13
    s_add_u32 s52, s52, 4096
    s_add_u32 m0, s52, 0
    s_add_u32 s54, s34, s52
    s_addc_u32 s55, s35, 0
    global_load_lds_dwordx4 v1, s[54:55] offset:0 sc1
    global_load_lds_dwordx4 v1, s[54:55] offset:1024 sc1
    global_load_lds_dwordx4 v1, s[54:55] offset:2048 sc1
    global_load_lds_dwordx4 v1, s[54:55] offset:3072 sc1
    s_waitcnt vmcnt(0)
    s_barrier
    s_cmp_eq_u32 s19, 3
    s_cbranch_scc1 L_XF_stats
    ds_read_b128 v[48:51], v1 offset:0
    ds_read_b128 v[52:55], v1 offset:1024
    ds_read_b128 v[56:59], v1 offset:2048
    ds_read_b128 v[60:63], v1 offset:3072
    s_waitcnt lgkmcnt(3)
    v_mfma_f32_16x16x32_bf16 v[64:67], v[128:131], v[48:51], 0
    v_mfma_f32_16x16x32_bf16 v[72:75], v[192:195], v[48:51], 0
    ds_read_b128 v[48:51], v1 offset:4096
    s_waitcnt lgkmcnt(3)
    v_mfma_f32_16x16x32_bf16 v[64:67], v[132:135], v[52:55], v[64:67]
    v_mfma_f32_16x16x32_bf16 v[72:75], v[196:199], v[52:55], v[72:75]
    ds_read_b128 v[52:55], v1 offset:5120
    s_waitcnt lgkmcnt(3)
    v_mfma_f32_16x16x32_bf16 v[64:67], v[136:139], v[56:59], v[64:67]
    v_mfma_f32_16x16x32_bf16 v[72:75], v[200:203], v[56:59], v[72:75]
    ds_read_b128 v[56:59], v1 offset:6144
    s_waitcnt lgkmcnt(3)
    v_mfma_f32_16x16x32_bf16 v[64:67], v[140:143], v[60:63], v[64:67]
    v_mfma_f32_16x16x32_bf16 v[72:75], v[204:207], v[60:63], v[72:75]
    ds_read_b128 v[60:63], v1 offset:7168
    s_waitcnt lgkmcnt(3)
    v_mfma_f32_16x16x32_bf16 v[64:67], v[144:147], v[48:51], v[64:67]
    v_mfma_f32_16x16x32_bf16 v[72:75], v[208:211], v[48:51], v[72:75]
    ds_read_b128 v[48:51], v1 offset:8192
    s_waitcnt lgkmcnt(3)
    v_mfma_f32_16x16x32_bf16 v[64:67], v[148:151], v[52:55], v[64:67]
    v_mfma_f32_16x16x32_bf16 v[72:75], v[212:215], v[52:55], v[72:75]
    ds_read_b128 v[52:55], v1 offset:9216
    s_waitcnt lgkmcnt(3)
    v_mfma_f32_16x16x32_bf16 v[64:67], v[152:155], v[56:59], v[64:67]
    v_mfma_f32_16x16x32_bf16 v[72:75], v[216:219], v[56:59], v[72:75]
    ds_read_b128 v[56:59], v1 offset:10240
    s_waitcnt lgkmcnt(3)
    v_mfma_f32_16x16x32_bf16 v[64:67], v[156:159], v[60:63], v[64:67]
    v_mfma_f32_16x16x32_bf16 v[72:75], v[220:223], v[60:63], v[72:75]
    ds_read_b128 v[60:63], v1 offset:11264
    s_waitcnt lgkmcnt(3)
    v_mfma_f32_16x16x32_bf16 v[64:67], v[160:163], v[48:51], v[64:67]
    v_mfma_f32_16x16x32_bf16 v[72:75], v[224:227], v[48:51], v[72:75]
    ds_read_b128 v[48:51], v1 offset:12288
    s_waitcnt lgkmcnt(3)
    v_mfma_f32_16x16x32_bf16 v[64:67], v[164:167], v[52:55], v[64:67]
    v_mfma_f32_16x16x32_bf16 v[72:75], v[228:231], v[52:55], v[72:75]
    ds_read_b128 v[52:55], v1 offset:13312
    s_waitcnt lgkmcnt(3)
    v_mfma_f32_16x16x32_bf16 v[64:67], v[168:171], v[56:59], v[64:67]
    v_mfma_f32_16x16x32_bf16 v[72:75], v[232:235], v[56:59], v[72:75]
    ds_read_b128 v[56:59], v1 offset:14336
    s_waitcnt lgkmcnt(3)
    v_mfma_f32_16x16x32_bf16 v[64:67], v[172:175], v[60:63], v[64:67]
    v_mfma_f32_16x16x32_bf16 v[72:75], v[236:239], v[60:63], v[72:75]
    ds_read_b128 v[60:63], v1 offset:15360
    s_waitcnt lgkmcnt(3)
    v_mfma_f32_16x16x32_bf16 v[64:67], v[176:179], v[48:51], v[64:67]
    v_mfma_f32_16x16x32_bf16 v[72:75], v[240:243], v[48:51], v[72:75]
    ds_read_b128 v[48:51], v1 offset:16384
    s_waitcnt lgkmcnt(3)
    v_mfma_f32_16x16x32_bf16 v[64:67], v[180:183], v[52:55], v[64:67]
    v_mfma_f32_16x16x32_bf16 v[72:75], v[244:247], v[52:55], v[72:75]
    ds_read_b128 v[52:55], v1 offset:17408
    s_waitcnt lgkmcnt(3)
    v_mfma_f32_16x16x32_bf16 v[64:67], v[184:187], v[56:59], v[64:67]
    v_mfma_f32_16x16x32_bf16 v[72:75], v[248:251], v[56:59], v[72:75]
    ds_read_b128 v[56:59], v1 offset:18432
    s_waitcnt lgkmcnt(3)
    v_mfma_f32_16x16x32_bf16 v[64:67], v[188:191], v[60:63], v[64:67]
    v_mfma_f32_16x16x32_bf16 v[72:75], v[252:255], v[60:63], v[72:75]
    ds_read_b128 v[60:63], v1 offset:19456
    s_waitcnt lgkmcnt(3)
    v_mfma_f32_16x16x32_bf16 v[68:71], v[128:131], v[48:51], 0
    v_mfma_f32_16x16x32_bf16 v[76:79], v[192:195], v[48:51], 0
    ds_read_b128 v[48:51], v1 offset:20480
    s_waitcnt lgkmcnt(3)
    v_mfma_f32_16x16x32_bf16 v[68:71], v[132:135], v[52:55], v[68:71]
    v_mfma_f32_16x16x32_bf16 v[76:79], v[196:199], v[52:55], v[76:79]
    ds_read_b128 v[52:55], v1 offset:21504
    s_waitcnt lgkmcnt(3)
    v_mfma_f32_16x16x32_bf16 v[68:71], v[136:139], v[56:59], v[68:71]
    v_mfma_f32_16x16x32_bf16 v[76:79], v[200:203], v[56:59], v[76:79]
    ds_read_b128 v[56:59], v1 offset:22528
    s_waitcnt lgkmcnt(3)
    v_mfma_f32_16x16x32_bf16 v[68:71], v[140:143], v[60:63], v[68:71]
    v_mfma_f32_16x16x32_bf16 v[76:79], v[204:207], v[60:63], v[76:79]
    ds_read_b128 v[60:63], v1 offset:23552
    s_waitcnt lgkmcnt(3)
    v_mfma_f32_16x16x32_bf16 v[68:71], v[144:147], v[48:51], v[68:71]
    v_mfma_f32_16x16x32_bf16 v[76:79], v[208:211], v[48:51], v[76:79]
    ds_read_b128 v[48:51], v1 offset:24576
    s_waitcnt lgkmcnt(3)
    v_mfma_f32_16x16x32_bf16 v[68:71], v[148:151], v[52:55], v[68:71]
    v_mfma_f32_16x16x32_bf16 v[76:79], v[212:215], v[52:55], v[76:79]
    ds_read_b128 v[52:55], v1 offset:25600
    s_waitcnt lgkmcnt(3)
    v_mfma_f32_16x16x32_bf16 v[68:71], v[152:155], v[56:59], v[68:71]
    v_mfma_f32_16x16x32_bf16 v[76:79], v[216:219], v[56:59], v[76:79]
    ds_read_b128 v[56:59], v1 offset:26624
    s_waitcnt lgkmcnt(3)
    v_mfma_f32_16x16x32_bf16 v[68:71], v[156:159], v[60:63], v[68:71]
    v_mfma_f32_16x16x32_bf16 v[76:79], v[220:223], v[60:63], v[76:79]
    ds_read_b128 v[60:63], v1 offset:27648
    s_waitcnt lgkmcnt(3)
    v_mfma_f32_16x16x32_bf16 v[68:71], v[160:163], v[48:51], v[68:71]
    v_mfma_f32_16x16x32_bf16 v[76:79], v[224:227], v[48:51], v[76:79]
    ds_read_b128 v[48:51], v1 offset:28672
    s_waitcnt lgkmcnt(3)
    v_mfma_f32_16x16x32_bf16 v[68:71], v[164:167], v[52:55], v[68:71]
    v_mfma_f32_16x16x32_bf16 v[76:79], v[228:231], v[52:55], v[76:79]
    ds_read_b128 v[52:55], v1 offset:29696
    s_waitcnt lgkmcnt(3)
    v_mfma_f32_16x16x32_bf16 v[68:71], v[168:171], v[56:59], v[68:71]
    v_mfma_f32_16x16x32_bf16 v[76:79], v[232:235], v[56:59], v[76:79]
    ds_read_b128 v[56:59], v1 offset:30720
    s_waitcnt lgkmcnt(3)
    v_mfma_f32_16x16x32_bf16 v[68:71], v[172:175], v[60:63], v[68:71]
    v_mfma_f32_16x16x32_bf16 v[76:79], v[236:239], v[60:63], v[76:79]
    ds_read_b128 v[60:63], v1 offset:31744
    s_waitcnt lgkmcnt(3)
    v_mfma_f32_16x16x32_bf16 v[68:71], v[176:179], v[48:51], v[68:71]
    v_mfma_f32_16x16x32_bf16 v[76:79], v[240:243], v[48:51], v[76:79]
    s_waitcnt lgkmcnt(2)
    v_mfma_f32_16x16x32_bf16 v[68:71], v[180:183], v[52:55], v[68:71]
    v_mfma_f32_16x16x32_bf16 v[76:79], v[244:247], v[52:55], v[76:79]
    s_waitcnt lgkmcnt(1)
    v_mfma_f32_16x16x32_bf16 v[68:71], v[184:187], v[56:59], v[68:71]
    v_mfma_f32_16x16x32_bf16 v[76:79], v[248:251], v[56:59], v[76:79]
    s_waitcnt lgkmcnt(0)
    v_mfma_f32_16x16x32_bf16 v[68:71], v[188:191], v[60:63], v[68:71]
    v_mfma_f32_16x16x32_bf16 v[76:79], v[252:255], v[60:63], v[76:79]
    s_branch L_XF_s7j
L_XF_stats:
    ds_read_b128 v[48:51], v1 offset:0
    ds_read_b128 v[52:55], v1 offset:1024
    ds_read_b128 v[56:59], v1 offset:2048
    ds_read_b128 v[60:63], v1 offset:3072
    s_waitcnt lgkmcnt(3)
    v_mfma_f32_16x16x32_bf16 v[64:67], v[24:27], v[48:51], 0
    v_mfma_f32_16x16x32_bf16 v[72:75], v[48:51], v[48:51], 0
    ds_read_b128 v[48:51], v1 offset:4096
    s_waitcnt lgkmcnt(3)
    v_mfma_f32_16x16x32_bf16 v[64:67], v[24:27], v[52:55], v[64:67]
    v_mfma_f32_16x16x32_bf16 v[72:75], v[52:55], v[52:55], v[72:75]
    ds_read_b128 v[52:55], v1 offset:5120
    s_waitcnt lgkmcnt(3)
    v_mfma_f32_16x16x32_bf16 v[64:67], v[24:27], v[56:59], v[64:67]
    v_mfma_f32_16x16x32_bf16 v[72:75], v[56:59], v[56:59], v[72:75]
    ds_read_b128 v[56:59], v1 offset:6144
    s_waitcnt lgkmcnt(3)
    v_mfma_f32_16x16x32_bf16 v[64:67], v[24:27], v[60:63], v[64:67]
    v_mfma_f32_16x16x32_bf16 v[72:75], v[60:63], v[60:63], v[72:75]
    ds_read_b128 v[60:63], v1 offset:7168
    s_waitcnt lgkmcnt(3)
    v_mfma_f32_16x16x32_bf16 v[64:67], v[24:27], v[48:51], v[64:67]
    v_mfma_f32_16x16x32_bf16 v[72:75], v[48:51], v[48:51], v[72:75]
    ds_read_b128 v[48:51], v1 offset:8192
    s_waitcnt lgkmcnt(3)
    v_mfma_f32_16x16x32_bf16 v[64:67], v[24:27], v[52:55], v[64:67]
    v_mfma_f32_16x16x32_bf16 v[72:75], v[52:55], v[52:55], v[72:75]
    ds_read_b128 v[52:55], v1 offset:9216
    s_waitcnt lgkmcnt(3)
    v_mfma_f32_16x16x32_bf16 v[64:67], v[24:27], v[56:59], v[64:67]
    v_mfma_f32_16x16x32_bf16 v[72:75], v[56:59], v[56:59], v[72:75]
    ds_read_b128 v[56:59], v1 offset:10240
    s_waitcnt lgkmcnt(3)
    v_mfma_f32_16x16x32_bf16 v[64:67], v[24:27], v[60:63], v[64:67]
    v_mfma_f32_16x16x32_bf16 v[72:75], v[60:63], v[60:63], v[72:75]
    ds_read_b128 v[60:63], v1 offset:11264
    s_waitcnt lgkmcnt(3)
    v_mfma_f32_16x16x32_bf16 v[64:67], v[24:27], v[48:51], v[64:67]
    v_mfma_f32_16x16x32_bf16 v[72:75], v[48:51], v[48:51], v[72:75]
    ds_read_b128 v[48:51], v1 offset:12288
    s_waitcnt lgkmcnt(3)
    v_mfma_f32_16x16x32_bf16 v[64:67], v[24:27], v[52:55], v[64:67]
    v_mfma_f32_16x16x32_bf16 v[72:75], v[52:55], v[52:55], v[72:75]
    ds_read_b128 v[52:55], v1 offset:13312
    s_waitcnt lgkmcnt(3)
    v_mfma_f32_16x16x32_bf16 v[64:67], v[24:27], v[56:59], v[64:67]
    v_mfma_f32_16x16x32_bf16 v[72:75], v[56:59], v[56:59], v[72:75]
    ds_read_b128 v[56:59], v1 offset:14336
    s_waitcnt lgkmcnt(3)
    v_mfma_f32_16x16x32_bf16 v[64:67], v[24:27], v[60:63], v[64:67]
    v_mfma_f32_16x16x32_bf16 v[72:75], v[60:63], v[60:63], v[72:75]
    ds_read_b128 v[60:63], v1 offset:15360
    s_waitcnt lgkmcnt(3)
    v_mfma_f32_16x16x32_bf16 v[64:67], v[24:27], v[48:51], v[64:67]
    v_mfma_f32_16x16x32_bf16 v[72:75], v[48:51], v[48:51], v[72:75]
    ds_read_b128 v[48:51], v1 offset:16384
    s_waitcnt lgkmcnt(3)
    v_mfma_f32_16x16x32_bf16 v[64:67], v[24:27], v[52:55], v[64:67]
    v_mfma_f32_16x16x32_bf16 v[72:75], v[52:55], v[52:55], v[72:75]
    ds_read_b128 v[52:55], v1 offset:17408
    s_waitcnt lgkmcnt(3)
    v_mfma_f32_16x16x32_bf16 v[64:67], v[24:27], v[56:59], v[64:67]
    v_mfma_f32_16x16x32_bf16 v[72:75], v[56:59], v[56:59], v[72:75]
    ds_read_b128 v[56:59], v1 offset:18432
    s_waitcnt lgkmcnt(3)
    v_mfma_f32_16x16x32_bf16 v[64:67], v[24:27], v[60:63], v[64:67]
    v_mfma_f32_16x16x32_bf16 v[72:75], v[60:63], v[60:63], v[72:75]
    ds_read_b128 v[60:63], v1 offset:19456
    s_waitcnt lgkmcnt(3)
    v_mfma_f32_16x16x32_bf16 v[68:71], v[24:27], v[48:51], 0
    v_mfma_f32_16x16x32_bf16 v[76:79], v[48:51], v[48:51], 0
    ds_read_b128 v[48:51], v1 offset:20480
    s_waitcnt lgkmcnt(3)
    v_mfma_f32_16x16x32_bf16 v[68:71], v[24:27], v[52:55], v[68:71]
    v_mfma_f32_16x16x32_bf16 v[76:79], v[52:55], v[52:55], v[76:79]
    ds_read_b128 v[52:55], v1 offset:21504
    s_waitcnt lgkmcnt(3)
    v_mfma_f32_16x16x32_bf16 v[68:71], v[24:27], v[56:59], v[68:71]
    v_mfma_f32_16x16x32_bf16 v[76:79], v[56:59], v[56:59], v[76:79]
    ds_read_b128 v[56:59], v1 offset:22528
    s_waitcnt lgkmcnt(3)
    v_mfma_f32_16x16x32_bf16 v[68:71], v[24:27], v[60:63], v[68:71]
    v_mfma_f32_16x16x32_bf16 v[76:79], v[60:63], v[60:63], v[76:79]
    ds_read_b128 v[60:63], v1 offset:23552
    s_waitcnt lgkmcnt(3)
    v_mfma_f32_16x16x32_bf16 v[68:71], v[24:27], v[48:51], v[68:71]
    v_mfma_f32_16x16x32_bf16 v[76:79], v[48:51], v[48:51], v[76:79]
    ds_read_b128 v[48:51], v1 offset:24576
    s_waitcnt lgkmcnt(3)
    v_mfma_f32_16x16x32_bf16 v[68:71], v[24:27], v[52:55], v[68:71]
    v_mfma_f32_16x16x32_bf16 v[76:79], v[52:55], v[52:55], v[76:79]
    ds_read_b128 v[52:55], v1 offset:25600
    s_waitcnt lgkmcnt(3)
    v_mfma_f32_16x16x32_bf16 v[68:71], v[24:27], v[56:59], v[68:71]
    v_mfma_f32_16x16x32_bf16 v[76:79], v[56:59], v[56:59], v[76:79]
    ds_read_b128 v[56:59], v1 offset:26624
    s_waitcnt lgkmcnt(3)
    v_mfma_f32_16x16x32_bf16 v[68:71], v[24:27], v[60:63], v[68:71]
    v_mfma_f32_16x16x32_bf16 v[76:79], v[60:63], v[60:63], v[76:79]
    ds_read_b128 v[60:63], v1 offset:27648
    s_waitcnt lgkmcnt(3)
    v_mfma_f32_16x16x32_bf16 v[68:71], v[24:27], v[48:51], v[68:71]
    v_mfma_f32_16x16x32_bf16 v[76:79], v[48:51], v[48:51], v[76:79]
    ds_read_b128 v[48:51], v1 offset:28672
    s_waitcnt lgkmcnt(3)
    v_mfma_f32_16x16x32_bf16 v[68:71], v[24:27], v[52:55], v[68:71]
    v_mfma_f32_16x16x32_bf16 v[76:79], v[52:55], v[52:55], v[76:79]
    ds_read_b128 v[52:55], v1 offset:29696
    s_waitcnt lgkmcnt(3)
    v_mfma_f32_16x16x32_bf16 v[68:71], v[24:27], v[56:59], v[68:71]
    v_mfma_f32_16x16x32_bf16 v[76:79], v[56:59], v[56:59], v[76:79]
    ds_read_b128 v[56:59], v1 offset:30720
    s_waitcnt lgkmcnt(3)
    v_mfma_f32_16x16x32_bf16 v[68:71], v[24:27], v[60:63], v[68:71]
    v_mfma_f32_16x16x32_bf16 v[76:79], v[60:63], v[60:63], v[76:79]
    ds_read_b128 v[60:63], v1 offset:31744
    s_waitcnt lgkmcnt(3)
    v_mfma_f32_16x16x32_bf16 v[68:71], v[24:27], v[48:51], v[68:71]
    v_mfma_f32_16x16x32_bf16 v[76:79], v[48:51], v[48:51], v[76:79]
    s_waitcnt lgkmcnt(2)
    v_mfma_f32_16x16x32_bf16 v[68:71], v[24:27], v[52:55], v[68:71]
    v_mfma_f32_16x16x32_bf16 v[76:79], v[52:55], v[52:55], v[76:79]
    s_waitcnt lgkmcnt(1)
    v_mfma_f32_16x16x32_bf16 v[68:71], v[24:27], v[56:59], v[68:71]
    v_mfma_f32_16x16x32_bf16 v[76:79], v[56:59], v[56:59], v[76:79]
    s_waitcnt lgkmcnt(0)
    v_mfma_f32_16x16x32_bf16 v[68:71], v[24:27], v[60:63], v[68:71]
    v_mfma_f32_16x16x32_bf16 v[76:79], v[60:63], v[60:63], v[76:79]
    s_nop 7
    v_and_b32 v10, 3, v0
    v_bfe_u32 v11, v0, 2, 2
    v_lshrrev_b32 v12, 4, v0
    v_cmp_eq_u32 vcc, 1, v10
    s_nop 1
    v_cndmask_b32 v72, v72, v73, vcc
    v_cmp_eq_u32 vcc, 2, v10
    s_nop 1
    v_cndmask_b32 v72, v72, v74, vcc
    v_cmp_eq_u32 vcc, 3, v10
    s_nop 1
    v_cndmask_b32 v72, v72, v75, vcc
    v_cmp_eq_u32 vcc, v11, v12
    s_nop 1
    v_cndmask_b32 v72, 0, v72, vcc
    v_mov_b32 v73, v72
    s_nop 1
    v_permlane32_swap_b32 v72, v73
    v_add_f32 v72, v72, v73
    v_mov_b32 v73, v72
    s_nop 1
    v_permlane16_swap_b32 v72, v73
    v_add_f32 v72, v72, v73
    v_mul_f32 v64, 0x3b000000, v64
    v_mul_f32 v72, 0x3b000000, v72
    v_fma_f32 v72, -v64, v64, v72
    v_max_f32 v72, 0, v72
    v_add_f32 v72, 0x3727c5ac, v72
    v_rsq_f32 v65, v72
    v_cmp_eq_u32 vcc, 1, v10
    s_nop 1
    v_cndmask_b32 v76, v76, v77, vcc
    v_cmp_eq_u32 vcc, 2, v10
    s_nop 1
    v_cndmask_b32 v76, v76, v78, vcc
    v_cmp_eq_u32 vcc, 3, v10
    s_nop 1
    v_cndmask_b32 v76, v76, v79, vcc
    v_cmp_eq_u32 vcc, v11, v12
    s_nop 1
    v_cndmask_b32 v76, 0, v76, vcc
    v_mov_b32 v77, v76
    s_nop 1
    v_permlane32_swap_b32 v76, v77
    v_add_f32 v76, v76, v77
    v_mov_b32 v77, v76
    s_nop 1
    v_permlane16_swap_b32 v76, v77
    v_add_f32 v76, v76, v77
    v_mul_f32 v68, 0x3b000000, v68
    v_mul_f32 v76, 0x3b000000, v76
    v_fma_f32 v76, -v68, v68, v76
    v_max_f32 v76, 0, v76
    v_add_f32 v76, 0x3727c5ac, v76
    v_rsq_f32 v69, v76
    v_and_b32 v10, 15, v0
    v_lshlrev_b32 v10, 3, v10
    v_add_u32 v10, 101376, v10
    s_mov_b64 exec, 0xffff
    ds_write_b64 v10, v[64:65] offset:0
    ds_write_b64 v10, v[68:69] offset:128
    s_mov_b64 exec, -1
    s_waitcnt lgkmcnt(0)
L_XF_s7j:
    s_barrier
    s_cmp_eq_u32 s19, 3
    s_cbranch_scc1 L_XF_hfdone
    v_and_b32 v10, 15, v0
    v_lshlrev_b32 v10, 3, v10
    v_add_u32 v10, 101376, v10
    ds_read_b64 v[48:49], v10 offset:0
    ds_read_b64 v[50:51], v10 offset:128
    s_waitcnt lgkmcnt(0)
    v_fma_f32 v64, -v48, v32, v64
    v_fma_f32 v72, -v48, v36, v72
    v_mul_f32 v64, v64, v49
    v_mul_f32 v72, v72, v49
    v_mul_f32 v64, v64, v72
    v_fma_f32 v65, -v48, v33, v65
    v_fma_f32 v73, -v48, v37, v73
    v_mul_f32 v65, v65, v49
    v_mul_f32 v73, v73, v49
    v_mul_f32 v65, v65, v73
    v_fma_f32 v66, -v48, v34, v66
    v_fma_f32 v74, -v48, v38, v74
    v_mul_f32 v66, v66, v49
    v_mul_f32 v74, v74, v49
    v_mul_f32 v66, v66, v74
    v_fma_f32 v67, -v48, v35, v67
    v_fma_f32 v75, -v48, v39, v75
    v_mul_f32 v67, v67, v49
    v_mul_f32 v75, v75, v49
    v_mul_f32 v67, v67, v75
    v_cvt_pk_bf16_f32 v56, v64, v65
    v_cvt_pk_bf16_f32 v57, v66, v67
    v_fma_f32 v68, -v50, v32, v68
    v_fma_f32 v76, -v50, v36, v76
    v_mul_f32 v68, v68, v51
    v_mul_f32 v76, v76, v51
    v_mul_f32 v68, v68, v76
    v_fma_f32 v69, -v50, v33, v69
    v_fma_f32 v77, -v50, v37, v77
    v_mul_f32 v69, v69, v51
    v_mul_f32 v77, v77, v51
    v_mul_f32 v69, v69, v77
    v_fma_f32 v70, -v50, v34, v70
    v_fma_f32 v78, -v50, v38, v78
    v_mul_f32 v70, v70, v51
    v_mul_f32 v78, v78, v51
    v_mul_f32 v70, v70, v78
    v_fma_f32 v71, -v50, v35, v71
    v_fma_f32 v79, -v50, v39, v79
    v_mul_f32 v71, v71, v51
    v_mul_f32 v79, v79, v51
    v_mul_f32 v71, v71, v79
    v_cvt_pk_bf16_f32 v58, v68, v69
    v_cvt_pk_bf16_f32 v59, v70, v71
    s_mul_i32 s52, s18, 3
    s_add_u32 s52, s52, s19
    s_cmp_lt_u32 s52, 86
    s_cbranch_scc1 L_XF_hfok
    v_mov_b64 v[56:57], 0
    v_mov_b64 v[58:59], 0
L_XF_hfok:
    s_cmp_eq_u32 s19, 2
    s_cbranch_scc1 L_XF_hf2
    s_lshl_b32 s52, s19, 3
    s_add_u32 s52, s52, 98304
    v_add_u32 v10, s52, v1
    ds_write_b64 v10, v[56:57] offset:0
    ds_write_b64 v10, v[58:59] offset:1024
    s_branch L_XF_hfw
L_XF_hf2:
    v_lshlrev_b32 v10, 3, v0
    v_add_u32 v10, 100352, v10
    ds_write_b64 v10, v[56:57] offset:0
    ds_write_b64 v10, v[58:59] offset:512
L_XF_hfw:
    s_waitcnt lgkmcnt(0)
L_XF_hfdone:
    s_barrier
    v_add_u32 v10, 98304, v1
    ds_read_b128 v[48:51], v10 offset:0
    ds_read_b128 v[52:55], v10 offset:1024
    v_lshlrev_b32 v11, 3, v0
    v_add_u32 v11, 100352, v11
    ds_read_b64 v[56:57], v11 offset:0
    ds_read_b64 v[58:59], v11 offset:512
    s_mul_i32 s52, s19, 12288
    s_add_u32 s52, s52, 122880
    v_lshlrev_b32 v12, 3, v0
    v_add_u32 v12, s52, v12
    s_add_u32 s32, s26, 0x100000
    s_addc_u32 s33, s27, 0
    ds_read_b128 v[60:63], v9 offset:0
    ds_read_b64 v[64:65], v12 offset:0
    s_waitcnt lgkmcnt(0)
    s_nop 0
    v_mfma_f32_16x16x32_bf16 v[80:83], v[60:63], v[48:51], 0
    v_mfma_f32_16x16x32_bf16 v[84:87], v[60:63], v[52:55], 0
    s_nop 4
    v_mfma_f32_16x16x16_bf16 v[80:83], v[64:65], v[56:57], v[80:83]
    v_mfma_f32_16x16x16_bf16 v[84:87], v[64:65], v[58:59], v[84:87]
    ds_read_b128 v[68:71], v9 offset:1024
    ds_read_b64 v[72:73], v12 offset:512
    s_waitcnt lgkmcnt(0)
    s_nop 0
    v_mfma_f32_16x16x32_bf16 v[88:91], v[68:71], v[48:51], 0
    v_mfma_f32_16x16x32_bf16 v[92:95], v[68:71], v[52:55], 0
    s_nop 4
    v_mfma_f32_16x16x16_bf16 v[88:91], v[72:73], v[56:57], v[88:91]
    v_mfma_f32_16x16x16_bf16 v[92:95], v[72:73], v[58:59], v[92:95]
    v_cvt_pk_bf16_f32 v96, v80, v81
    v_cvt_pk_bf16_f32 v97, v82, v83
    v_cvt_pk_bf16_f32 v98, v84, v85
    v_cvt_pk_bf16_f32 v99, v86, v87
    v_and_or_b32 v96, v96, -2, s28
    global_store_dwordx4 v4, v[96:99], s[32:33]
    s_add_u32 s32, s32, 0x8000
    s_addc_u32 s33, s33, 0
    ds_read_b128 v[60:63], v9 offset:2048
    ds_read_b64 v[64:65], v12 offset:1024
    s_waitcnt lgkmcnt(0)
    s_nop 0
    v_mfma_f32_16x16x32_bf16 v[80:83], v[60:63], v[48:51], 0
    v_mfma_f32_16x16x32_bf16 v[84:87], v[60:63], v[52:55], 0
    s_nop 4
    v_mfma_f32_16x16x16_bf16 v[80:83], v[64:65], v[56:57], v[80:83]
    v_mfma_f32_16x16x16_bf16 v[84:87], v[64:65], v[58:59], v[84:87]
    v_cvt_pk_bf16_f32 v100, v88, v89
    v_cvt_pk_bf16_f32 v101, v90, v91
    v_cvt_pk_bf16_f32 v102, v92, v93
    v_cvt_pk_bf16_f32 v103, v94, v95
    v_and_or_b32 v100, v100, -2, s28
    global_store_dwordx4 v4, v[100:103], s[32:33]
    s_add_u32 s32, s32, 0x8000
    s_addc_u32 s33, s33, 0
    ds_read_b128 v[68:71], v9 offset:3072
    ds_read_b64 v[72:73], v12 offset:1536
    s_waitcnt lgkmcnt(0)
    s_nop 0
    v_mfma_f32_16x16x32_bf16 v[88:91], v[68:71], v[48:51], 0
    v_mfma_f32_16x16x32_bf16 v[92:95], v[68:71], v[52:55], 0
    s_nop 4
    v_mfma_f32_16x16x16_bf16 v[88:91], v[72:73], v[56:57], v[88:91]
    v_mfma_f32_16x16x16_bf16 v[92:95], v[72:73], v[58:59], v[92:95]
    v_cvt_pk_bf16_f32 v96, v80, v81
    v_cvt_pk_bf16_f32 v97, v82, v83
    v_cvt_pk_bf16_f32 v98, v84, v85
    v_cvt_pk_bf16_f32 v99, v86, v87
    v_and_or_b32 v96, v96, -2, s28
    global_store_dwordx4 v4, v[96:99], s[32:33]
    s_add_u32 s32, s32, 0x8000
    s_addc_u32 s33, s33, 0
    ds_read_b128 v[60:63], v9 offset:4096
    ds_read_b64 v[64:65], v12 offset:2048
    s_waitcnt lgkmcnt(0)
    s_nop 0
    v_mfma_f32_16x16x32_bf16 v[80:83], v[60:63], v[48:51], 0
    v_mfma_f32_16x16x32_bf16 v[84:87], v[60:63], v[52:55], 0
    s_nop 4
    v_mfma_f32_16x16x16_bf16 v[80:83], v[64:65], v[56:57], v[80:83]
    v_mfma_f32_16x16x16_bf16 v[84:87], v[64:65], v[58:59], v[84:87]
    v_cvt_pk_bf16_f32 v100, v88, v89
    v_cvt_pk_bf16_f32 v101, v90, v91
    v_cvt_pk_bf16_f32 v102, v92, v93
    v_cvt_pk_bf16_f32 v103, v94, v95
    v_and_or_b32 v100, v100, -2, s28
    global_store_dwordx4 v4, v[100:103], s[32:33]
    s_add_u32 s32, s32, 0x8000
    s_addc_u32 s33, s33, 0
    ds_read_b128 v[68:71], v9 offset:5120
    ds_read_b64 v[72:73], v12 offset:2560
    s_waitcnt lgkmcnt(0)
    s_nop 0
    v_mfma_f32_16x16x32_bf16 v[88:91], v[68:71], v[48:51], 0
    v_mfma_f32_16x16x32_bf16 v[92:95], v[68:71], v[52:55], 0
    s_nop 4
    v_mfma_f32_16x16x16_bf16 v[88:91], v[72:73], v[56:57], v[88:91]
    v_mfma_f32_16x16x16_bf16 v[92:95], v[72:73], v[58:59], v[92:95]
    v_cvt_pk_bf16_f32 v96, v80, v81
    v_cvt_pk_bf16_f32 v97, v82, v83
    v_cvt_pk_bf16_f32 v98, v84, v85
    v_cvt_pk_bf16_f32 v99, v86, v87
    v_and_or_b32 v96, v96, -2, s28
    global_store_dwordx4 v4, v[96:99], s[32:33]
    s_add_u32 s32, s32, 0x8000
    s_addc_u32 s33, s33, 0
    ds_read_b128 v[60:63], v9 offset:6144
    ds_read_b64 v[64:65], v12 offset:3072
    s_waitcnt lgkmcnt(0)
    s_nop 0
    v_mfma_f32_16x16x32_bf16 v[80:83], v[60:63], v[48:51], 0
    v_mfma_f32_16x16x32_bf16 v[84:87], v[60:63], v[52:55], 0
    s_nop 4
    v_mfma_f32_16x16x16_bf16 v[80:83], v[64:65], v[56:57], v[80:83]
    v_mfma_f32_16x16x16_bf16 v[84:87], v[64:65], v[58:59], v[84:87]
    v_cvt_pk_bf16_f32 v100, v88, v89
    v_cvt_pk_bf16_f32 v101, v90, v91
    v_cvt_pk_bf16_f32 v102, v92, v93
    v_cvt_pk_bf16_f32 v103, v94, v95
    v_and_or_b32 v100, v100, -2, s28
    global_store_dwordx4 v4, v[100:103], s[32:33]
    s_add_u32 s32, s32, 0x8000
    s_addc_u32 s33, s33, 0
    ds_read_b128 v[68:71], v9 offset:7168
    ds_read_b64 v[72:73], v12 offset:3584
    s_waitcnt lgkmcnt(0)
    s_nop 0
    v_mfma_f32_16x16x32_bf16 v[88:91], v[68:71], v[48:51], 0
    v_mfma_f32_16x16x32_bf16 v[92:95], v[68:71], v[52:55], 0
    s_nop 4
    v_mfma_f32_16x16x16_bf16 v[88:91], v[72:73], v[56:57], v[88:91]
    v_mfma_f32_16x16x16_bf16 v[92:95], v[72:73], v[58:59], v[92:95]
    v_cvt_pk_bf16_f32 v96, v80, v81
    v_cvt_pk_bf16_f32 v97, v82, v83
    v_cvt_pk_bf16_f32 v98, v84, v85
    v_cvt_pk_bf16_f32 v99, v86, v87
    v_and_or_b32 v96, v96, -2, s28
    global_store_dwordx4 v4, v[96:99], s[32:33]
    s_add_u32 s32, s32, 0x8000
    s_addc_u32 s33, s33, 0
    s_nop 7
    v_cvt_pk_bf16_f32 v100, v88, v89
    v_cvt_pk_bf16_f32 v101, v90, v91
    v_cvt_pk_bf16_f32 v102, v92, v93
    v_cvt_pk_bf16_f32 v103, v94, v95
    v_and_or_b32 v100, v100, -2, s28
    global_store_dwordx4 v4, v[100:103], s[32:33]
    s_add_u32 s32, s32, 0x8000
    s_addc_u32 s33, s33, 0
    s_add_u32 s32, s26, 0x100000
    s_addc_u32 s33, s27, 0
    s_mov_b32 s29, 0
L_XF_r1:
    v_mov_b32 v10, v5
    global_load_dwordx4 v[48:51], v10, s[32:33] sc1
    v_add_u32 v10, 4096, v10
    global_load_dwordx4 v[52:55], v10, s[32:33] sc1
    v_add_u32 v10, 4096, v10
    global_load_dwordx4 v[56:59], v10, s[32:33] sc1
    v_add_u32 v10, 4096, v10
    global_load_dwordx4 v[60:63], v10, s[32:33] sc1
    v_add_u32 v10, 4096, v10
    global_load_dwordx4 v[64:67], v10, s[32:33] sc1
    v_add_u32 v10, 4096, v10
    global_load_dwordx4 v[68:71], v10, s[32:33] sc1
    v_add_u32 v10, 4096, v10
    global_load_dwordx4 v[72:75], v10, s[32:33] sc1
    v_add_u32 v10, 4096, v10
    global_load_dwordx4 v[76:79], v10, s[32:33] sc1
    s_add_u32 s29, s29, 1
    s_cmp_gt_u32 s29, 400000
    s_cbranch_scc1 L_fail
    s_waitcnt vmcnt(0)
    v_bitop3_b32 v11, v48, v52, s28 bitop3:0x7e
    v_bitop3_b32 v12, v56, v60, s28 bitop3:0x7e
    v_or_b32 v11, v11, v12
    v_bitop3_b32 v12, v64, v68, s28 bitop3:0x7e
    v_or_b32 v11, v11, v12
    v_bitop3_b32 v12, v72, v76, s28 bitop3:0x7e
    v_or_b32 v11, v11, v12
    v_and_b32 v11, 1, v11
    v_cmp_ne_u32 vcc, 0, v11
    s_cbranch_vccnz L_XF_r1
    v_mfma_f32_16x16x32_bf16 v[80:83], v[28:31], v[48:51], 0
    v_mfma_f32_16x16x32_bf16 v[80:83], v[28:31], v[52:55], v[80:83]
    v_mfma_f32_16x16x32_bf16 v[80:83], v[28:31], v[56:59], v[80:83]
    v_mfma_f32_16x16x32_bf16 v[80:83], v[28:31], v[60:63], v[80:83]
    v_mfma_f32_16x16x32_bf16 v[80:83], v[28:31], v[64:67], v[80:83]
    v_mfma_f32_16x16x32_bf16 v[80:83], v[28:31], v[68:71], v[80:83]
    v_mfma_f32_16x16x32_bf16 v[80:83], v[28:31], v[72:75], v[80:83]
    v_mfma_f32_16x16x32_bf16 v[80:83], v[28:31], v[76:79], v[80:83]
    s_nop 7
    v_cvt_pk_bf16_f32 v10, v80, v81
    v_cvt_pk_bf16_f32 v11, v82, v83
    v_lshlrev_b32 v80, 16, v10
    v_and_b32 v81, 0xffff0000, v10
    v_lshlrev_b32 v82, 16, v11
    v_and_b32 v83, 0xffff0000, v11
    v_add_f32 v80, v80, v40
    v_add_f32 v81, v81, v41
    v_add_f32 v82, v82, v42
    v_add_f32 v83, v83, v43
    v_cvt_pk_bf16_f32 v10, v80, v81
    v_cvt_pk_bf16_f32 v11, v82, v83
    s_lshl_b32 s52, s24, 15
    s_add_u32 s34, s22, s52
    s_addc_u32 s35, s23, 0
    s_mov_b64 exec, s[40:41]
    global_store_dwordx2 v6, v[10:11], s[34:35]
    s_mov_b64 exec, -1
    s_add_u32 s25, s25, 1
    s_add_u32 s24, s24, 6
    s_cmp_lt_u32 s24, 64
    s_cbranch_scc1 L_XF_loop
    s_waitcnt vmcnt(0)
    s_branch L_x_end
L_x_slow:
    s_mov_b32 s25, 0
L_XS_loop:
    s_and_b32 s28, s25, 1
    s_lshl_b32 s55, s24, 5
    s_add_u32 s55, s55, s18
    s_mov_b32 s44, s55
    s_lshl_b32 s52, s44, 2
    s_add_u32 s45, s52, 0xa0000
    s_cmp_eq_u32 s19, 0
    s_cbranch_scc0 L_XS_kvf_ok
    v_mov_b32 v10, s45
    s_mov_b32 s29, 0
L_XS_kvf:
    global_load_dword v11, v10, s[14:15] sc1
    s_add_u32 s29, s29, 1
    s_cmp_gt_u32 s29, 400000
    s_cbranch_scc1 L_fail
    s_waitcnt vmcnt(0)
    v_readfirstlane_b32 s53, v11
    s_nop 3
    s_cmp_lg_u32 s53, 0
    s_cbranch_scc1 L_XS_kvf_ok
    s_sleep 8
    s_branch L_XS_kvf
L_XS_kvf_ok:
    s_barrier
    s_lshl_b32 s52, s24, 15
    s_add_u32 s52, s52, 0x3800000
    s_add_u32 s34, s14, s52
    s_addc_u32 s35, s15, 0
    s_lshl_b32 s52, s19, 13
    s_add_u32 s52, s52, 0
    s_add_u32 m0, s52, 0
    s_add_u32 s54, s34, s52
    s_addc_u32 s55, s35, 0
    global_load_lds_dwordx4 v1, s[54:55] offset:0 sc1
    global_load_lds_dwordx4 v1, s[54:55] offset:1024 sc1
    global_load_lds_dwordx4 v1, s[54:55] offset:2048 sc1
    global_load_lds_dwordx4 v1, s[54:55] offset:3072 sc1
    s_lshl_b32 s52, s19, 13
    s_add_u32 s52, s52, 4096
    s_add_u32 m0, s52, 0
    s_add_u32 s54, s34, s52
    s_addc_u32 s55, s35, 0
    global_load_lds_dwordx4 v1, s[54:55] offset:0 sc1
    global_load_lds_dwordx4 v1, s[54:55] offset:1024 sc1
    global_load_lds_dwordx4 v1, s[54:55] offset:2048 sc1
    global_load_lds_dwordx4 v1, s[54:55] offset:3072 sc1
    s_lshl_b32 s52, s44, 13
    s_lshl_b32 s53, s19, 11
    s_add_u32 s52, s52, s53
    s_add_u32 s52, s52, 0x1000000
    s_add_u32 s54, s14, s52
    s_addc_u32 s55, s15, 0
    s_add_u32 m0, s53, 65536
    s_nop 0
    global_load_lds_dwordx4 v1, s[54:55] sc1
    global_load_lds_dwordx4 v1, s[54:55] offset:1024 sc1
    s_lshl_b32 s52, s44, 13
    s_lshl_b32 s53, s19, 11
    s_add_u32 s52, s52, s53
    s_add_u32 s52, s52, 0x2000000
    s_add_u32 s54, s14, s52
    s_addc_u32 s55, s15, 0
    s_add_u32 m0, s53, 73728
    s_nop 0
    global_load_lds_dwordx4 v1, s[54:55] sc1
    global_load_lds_dwordx4 v1, s[54:55] offset:1024 sc1
    s_lshl_b32 s52, s24, 15
    s_add_u32 s34, s4, s52
    s_addc_u32 s35, s5, 0
    global_load_dwordx2 v[44:45], v6, s[34:35]
    s_waitcnt vmcnt(0)
    s_barrier
    ds_read_b128 v[48:51], v1 offset:0
    ds_read_b128 v[52:55], v1 offset:1024
    ds_read_b128 v[56:59], v1 offset:2048
    ds_read_b128 v[60:63], v1 offset:3072
    s_waitcnt lgkmcnt(3)
    v_mfma_f32_16x16x32_bf16 v[64:67], a[0:3], v[48:51], 0
    v_mfma_f32_16x16x32_bf16 v[72:75], a[64:67], v[48:51], 0
    ds_read_b128 v[48:51], v1 offset:4096
    s_waitcnt lgkmcnt(3)
    v_mfma_f32_16x16x32_bf16 v[64:67], a[4:7], v[52:55], v[64:67]
    v_mfma_f32_16x16x32_bf16 v[72:75], a[68:71], v[52:55], v[72:75]
    ds_read_b128 v[52:55], v1 offset:5120
    s_waitcnt lgkmcnt(3)
    v_mfma_f32_16x16x32_bf16 v[64:67], a[8:11], v[56:59], v[64:67]
    v_mfma_f32_16x16x32_bf16 v[72:75], a[72:75], v[56:59], v[72:75]
    ds_read_b128 v[56:59], v1 offset:6144
    s_waitcnt lgkmcnt(3)
    v_mfma_f32_16x16x32_bf16 v[64:67], a[12:15], v[60:63], v[64:67]
    v_mfma_f32_16x16x32_bf16 v[72:75], a[76:79], v[60:63], v[72:75]
    ds_read_b128 v[60:63], v1 offset:7168
    s_waitcnt lgkmcnt(3)
    v_mfma_f32_16x16x32_bf16 v[64:67], a[16:19], v[48:51], v[64:67]
    v_mfma_f32_16x16x32_bf16 v[72:75], a[80:83], v[48:51], v[72:75]
    ds_read_b128 v[48:51], v1 offset:8192
    s_waitcnt lgkmcnt(3)
    v_mfma_f32_16x16x32_bf16 v[64:67], a[20:23], v[52:55], v[64:67]
    v_mfma_f32_16x16x32_bf16 v[72:75], a[84:87], v[52:55], v[72:75]
    ds_read_b128 v[52:55], v1 offset:9216
    s_waitcnt lgkmcnt(3)
    v_mfma_f32_16x16x32_bf16 v[64:67], a[24:27], v[56:59], v[64:67]
    v_mfma_f32_16x16x32_bf16 v[72:75], a[88:91], v[56:59], v[72:75]
    ds_read_b128 v[56:59], v1 offset:10240
    s_waitcnt lgkmcnt(3)
    v_mfma_f32_16x16x32_bf16 v[64:67], a[28:31], v[60:63], v[64:67]
    v_mfma_f32_16x16x32_bf16 v[72:75], a[92:95], v[60:63], v[72:75]
    ds_read_b128 v[60:63], v1 offset:11264
    s_waitcnt lgkmcnt(3)
    v_mfma_f32_16x16x32_bf16 v[64:67], a[32:35], v[48:51], v[64:67]
    v_mfma_f32_16x16x32_bf16 v[72:75], a[96:99], v[48:51], v[72:75]
    ds_read_b128 v[48:51], v1 offset:12288
    s_waitcnt lgkmcnt(3)
    v_mfma_f32_16x16x32_bf16 v[64:67], a[36:39], v[52:55], v[64:67]
    v_mfma_f32_16x16x32_bf16 v[72:75], a[100:103], v[52:55], v[72:75]
    ds_read_b128 v[52:55], v1 offset:13312
    s_waitcnt lgkmcnt(3)
    v_mfma_f32_16x16x32_bf16 v[64:67], a[40:43], v[56:59], v[64:67]
    v_mfma_f32_16x16x32_bf16 v[72:75], a[104:107], v[56:59], v[72:75]
    ds_read_b128 v[56:59], v1 offset:14336
    s_waitcnt lgkmcnt(3)
    v_mfma_f32_16x16x32_bf16 v[64:67], a[44:47], v[60:63], v[64:67]
    v_mfma_f32_16x16x32_bf16 v[72:75], a[108:111], v[60:63], v[72:75]
    ds_read_b128 v[60:63], v1 offset:15360
    s_waitcnt lgkmcnt(3)
    v_mfma_f32_16x16x32_bf16 v[64:67], a[48:51], v[48:51], v[64:67]
    v_mfma_f32_16x16x32_bf16 v[72:75], a[112:115], v[48:51], v[72:75]
    ds_read_b128 v[48:51], v1 offset:16384
    s_waitcnt lgkmcnt(3)
    v_mfma_f32_16x16x32_bf16 v[64:67], a[52:55], v[52:55], v[64:67]
    v_mfma_f32_16x16x32_bf16 v[72:75], a[116:119], v[52:55], v[72:75]
    ds_read_b128 v[52:55], v1 offset:17408
    s_waitcnt lgkmcnt(3)
    v_mfma_f32_16x16x32_bf16 v[64:67], a[56:59], v[56:59], v[64:67]
    v_mfma_f32_16x16x32_bf16 v[72:75], a[120:123], v[56:59], v[72:75]
    ds_read_b128 v[56:59], v1 offset:18432
    s_waitcnt lgkmcnt(3)
    v_mfma_f32_16x16x32_bf16 v[64:67], a[60:63], v[60:63], v[64:67]
    v_mfma_f32_16x16x32_bf16 v[72:75], a[124:127], v[60:63], v[72:75]
    ds_read_b128 v[60:63], v1 offset:19456
    s_waitcnt lgkmcnt(3)
    v_mfma_f32_16x16x32_bf16 v[68:71], a[0:3], v[48:51], 0
    v_mfma_f32_16x16x32_bf16 v[76:79], a[64:67], v[48:51], 0
    ds_read_b128 v[48:51], v1 offset:20480
    s_waitcnt lgkmcnt(3)
    v_mfma_f32_16x16x32_bf16 v[68:71], a[4:7], v[52:55], v[68:71]
    v_mfma_f32_16x16x32_bf16 v[76:79], a[68:71], v[52:55], v[76:79]
    ds_read_b128 v[52:55], v1 offset:21504
    s_waitcnt lgkmcnt(3)
    v_mfma_f32_16x16x32_bf16 v[68:71], a[8:11], v[56:59], v[68:71]
    v_mfma_f32_16x16x32_bf16 v[76:79], a[72:75], v[56:59], v[76:79]
    ds_read_b128 v[56:59], v1 offset:22528
    s_waitcnt lgkmcnt(3)
    v_mfma_f32_16x16x32_bf16 v[68:71], a[12:15], v[60:63], v[68:71]
    v_mfma_f32_16x16x32_bf16 v[76:79], a[76:79], v[60:63], v[76:79]
    ds_read_b128 v[60:63], v1 offset:23552
    s_waitcnt lgkmcnt(3)
    v_mfma_f32_16x16x32_bf16 v[68:71], a[16:19], v[48:51], v[68:71]
    v_mfma_f32_16x16x32_bf16 v[76:79], a[80:83], v[48:51], v[76:79]
    ds_read_b128 v[48:51], v1 offset:24576
    s_waitcnt lgkmcnt(3)
    v_mfma_f32_16x16x32_bf16 v[68:71], a[20:23], v[52:55], v[68:71]
    v_mfma_f32_16x16x32_bf16 v[76:79], a[84:87], v[52:55], v[76:79]
    ds_read_b128 v[52:55], v1 offset:25600
    s_waitcnt lgkmcnt(3)
    v_mfma_f32_16x16x32_bf16 v[68:71], a[24:27], v[56:59], v[68:71]
    v_mfma_f32_16x16x32_bf16 v[76:79], a[88:91], v[56:59], v[76:79]
    ds_read_b128 v[56:59], v1 offset:26624
    s_waitcnt lgkmcnt(3)
    v_mfma_f32_16x16x32_bf16 v[68:71], a[28:31], v[60:63], v[68:71]
    v_mfma_f32_16x16x32_bf16 v[76:79], a[92:95], v[60:63], v[76:79]
    ds_read_b128 v[60:63], v1 offset:27648
    s_waitcnt lgkmcnt(3)
    v_mfma_f32_16x16x32_bf16 v[68:71], a[32:35], v[48:51], v[68:71]
    v_mfma_f32_16x16x32_bf16 v[76:79], a[96:99], v[48:51], v[76:79]
    ds_read_b128 v[48:51], v1 offset:28672
    s_waitcnt lgkmcnt(3)
    v_mfma_f32_16x16x32_bf16 v[68:71], a[36:39], v[52:55], v[68:71]
    v_mfma_f32_16x16x32_bf16 v[76:79], a[100:103], v[52:55], v[76:79]
    ds_read_b128 v[52:55], v1 offset:29696
    s_waitcnt lgkmcnt(3)
    v_mfma_f32_16x16x32_bf16 v[68:71], a[40:43], v[56:59], v[68:71]
    v_mfma_f32_16x16x32_bf16 v[76:79], a[104:107], v[56:59], v[76:79]
    ds_read_b128 v[56:59], v1 offset:30720
    s_waitcnt lgkmcnt(3)
    v_mfma_f32_16x16x32_bf16 v[68:71], a[44:47], v[60:63], v[68:71]
    v_mfma_f32_16x16x32_bf16 v[76:79], a[108:111], v[60:63], v[76:79]
    ds_read_b128 v[60:63], v1 offset:31744
    s_waitcnt lgkmcnt(3)
    v_mfma_f32_16x16x32_bf16 v[68:71], a[48:51], v[48:51], v[68:71]
    v_mfma_f32_16x16x32_bf16 v[76:79], a[112:115], v[48:51], v[76:79]
    s_waitcnt lgkmcnt(2)
    v_mfma_f32_16x16x32_bf16 v[68:71], a[52:55], v[52:55], v[68:71]
    v_mfma_f32_16x16x32_bf16 v[76:79], a[116:119], v[52:55], v[76:79]
    s_waitcnt lgkmcnt(1)
    v_mfma_f32_16x16x32_bf16 v[68:71], a[56:59], v[56:59], v[68:71]
    v_mfma_f32_16x16x32_bf16 v[76:79], a[120:123], v[56:59], v[76:79]
    s_waitcnt lgkmcnt(0)
    v_mfma_f32_16x16x32_bf16 v[68:71], a[60:63], v[60:63], v[68:71]
    v_mfma_f32_16x16x32_bf16 v[76:79], a[124:127], v[60:63], v[76:79]
    s_nop 7
    v_cvt_pk_bf16_f32 v80, v64, v72
    v_cvt_pk_bf16_f32 v81, v65, v73
    v_cvt_pk_bf16_f32 v82, v66, v74
    v_cvt_pk_bf16_f32 v83, v67, v75
    v_cvt_pk_bf16_f32 v84, v68, v76
    v_cvt_pk_bf16_f32 v85, v69, v77
    v_cvt_pk_bf16_f32 v86, v70, v78
    v_cvt_pk_bf16_f32 v87, v71, v79
    s_lshl_b32 s52, s19, 10
    v_add_u32 v10, s52, v1
    v_add_u32 v10, 81920, v10
    ds_write_b128 v10, v[80:83]
    ds_write_b128 v10, v[84:87] offset:4096
    s_lshl_b32 s52, s44, 2
    s_add_u32 s45, s52, 0xa2100
    s_cmp_eq_u32 s19, 0
    s_cbranch_scc0 L_XS_memf_ok
    v_mov_b32 v10, s45
    s_mov_b32 s29, 0
L_XS_memf:
    global_load_dword v11, v10, s[14:15] sc1
    s_add_u32 s29, s29, 1
    s_cmp_gt_u32 s29, 400000
    s_cbranch_scc1 L_fail
    s_waitcnt vmcnt(0)
    v_readfirstlane_b32 s53, v11
    s_nop 3
    s_cmp_lg_u32 s53, 0
    s_cbranch_scc1 L_XS_memf_ok
    s_sleep 8
    s_branch L_XS_memf
L_XS_memf_ok:
    s_barrier
    s_lshl_b32 s52, s44, 11
    s_add_u32 s53, s52, 0x3000000
    s_add_u32 s34, s14, s53
    s_addc_u32 s35, s15, 0
    global_load_dwordx4 v[64:67], v2, s[34:35] offset:0 sc1
    global_load_dwordx4 v[68:71], v2, s[34:35] offset:512 sc1
    global_load_dwordx4 v[72:75], v2, s[34:35] offset:1024 sc1
    global_load_dwordx4 v[76:79], v2, s[34:35] offset:1536 sc1
    s_add_u32 s53, s52, 0x3400000
    s_add_u32 s36, s14, s53
    s_addc_u32 s37, s15, 0
    global_load_dword v124, v3, s[36:37] offset:0 sc1
    global_load_dword v125, v3, s[36:37] offset:256 sc1
    global_load_dword v126, v3, s[36:37] offset:512 sc1
    global_load_dword v127, v3, s[36:37] offset:768 sc1
    s_waitcnt lgkmcnt(0)
    s_barrier
    s_lshr_b32 s52, s19, 1
    s_lshl_b32 s52, s52, 12
    v_add_u32 v10, s52, v1
    v_add_u32 v10, 81920, v10
    ds_read_b128 v[48:51], v10 offset:0
    ds_read_b128 v[52:55], v10 offset:1024
    ds_read_b128 v[56:59], v10 offset:2048
    ds_read_b128 v[60:63], v10 offset:3072
    v_add_u32 v11, 65536, v1
    ds_read_b128 v[80:83], v11 offset:0
    ds_read_b128 v[96:99], v11 offset:4096
    ds_read_b128 v[84:87], v11 offset:1024
    ds_read_b128 v[100:103], v11 offset:5120
    ds_read_b128 v[88:91], v11 offset:2048
    ds_read_b128 v[104:107], v11 offset:6144
    ds_read_b128 v[92:95], v11 offset:3072
    ds_read_b128 v[108:111], v11 offset:7168
    s_waitcnt vmcnt(0) lgkmcnt(0)
    v_mfma_f32_16x16x32_bf16 v[112:115], v[64:67], v[48:51], 0
    v_mfma_f32_16x16x32_bf16 v[116:119], v[80:83], v[48:51], v[16:19]
    v_mfma_f32_16x16x32_bf16 v[120:123], v[96:99], v[48:51], v[20:23]
    v_mfma_f32_16x16x32_bf16 v[112:115], v[68:71], v[52:55], v[112:115]
    v_mfma_f32_16x16x32_bf16 v[116:119], v[84:87], v[52:55], v[116:119]
    v_mfma_f32_16x16x32_bf16 v[120:123], v[100:103], v[52:55], v[120:123]
    v_mfma_f32_16x16x32_bf16 v[112:115], v[72:75], v[56:59], v[112:115]
    v_mfma_f32_16x16x32_bf16 v[116:119], v[88:91], v[56:59], v[116:119]
    v_mfma_f32_16x16x32_bf16 v[120:123], v[104:107], v[56:59], v[120:123]
    v_mfma_f32_16x16x32_bf16 v[112:115], v[76:79], v[60:63], v[112:115]
    v_mfma_f32_16x16x32_bf16 v[116:119], v[92:95], v[60:63], v[116:119]
    v_mfma_f32_16x16x32_bf16 v[120:123], v[108:111], v[60:63], v[120:123]
    s_and_b32 s52, s19, 1
    s_lshl_b32 s52, s52, 12
    v_add_u32 v10, s52, v1
    v_add_u32 v10, 73728, v10
    ds_read_b128 v[64:67], v10 offset:0
    ds_read_b128 v[68:71], v10 offset:1024
    ds_read_b128 v[72:75], v10 offset:2048
    ds_read_b128 v[76:79], v10 offset:3072
    s_nop 4
    v_max3_f32 v12, v116, v117, v118
    v_max3_f32 v12, v12, v119, v120
    v_max3_f32 v12, v12, v121, v122
    v_max3_f32 v12, v12, v123, v112
    v_max_f32 v12, v12, v113
    v_mov_b32 v13, v12
    s_nop 1
    v_permlane32_swap_b32 v12, v13
    v_max_f32 v12, v12, v13
    v_mov_b32 v13, v12
    s_nop 1
    v_permlane16_swap_b32 v12, v13
    v_max_f32 v12, v12, v13
    v_mul_f32 v12, s30, v12
    v_fma_f32 v116, v116, s30, -v12
    v_fma_f32 v117, v117, s30, -v12
    v_fma_f32 v118, v118, s30, -v12
    v_fma_f32 v119, v119, s30, -v12
    v_fma_f32 v120, v120, s30, -v12
    v_fma_f32 v121, v121, s30, -v12
    v_fma_f32 v122, v122, s30, -v12
    v_fma_f32 v123, v123, s30, -v12
    v_fma_f32 v112, v112, s30, -v12
    v_fma_f32 v113, v113, s30, -v12
    v_exp_f32 v116, v116
    v_exp_f32 v117, v117
    v_exp_f32 v118, v118
    v_exp_f32 v119, v119
    v_exp_f32 v120, v120
    v_exp_f32 v121, v121
    v_exp_f32 v122, v122
    v_exp_f32 v123, v123
    v_exp_f32 v112, v112
    v_exp_f32 v113, v113
    v_mov_b32 v53, 0
    v_cvt_pk_bf16_f32 v48, v116, v117
    v_cvt_pk_bf16_f32 v49, v118, v119
    v_cvt_pk_bf16_f32 v50, v120, v121
    v_cvt_pk_bf16_f32 v51, v122, v123
    v_cvt_pk_bf16_f32 v52, v112, v113
    v_mov_b32 v112, v124
    v_mov_b32 v113, 0
    v_mov_b32 v114, v125
    v_mov_b32 v115, 0
    v_mov_b32 v116, v126
    v_mov_b32 v117, 0
    v_mov_b32 v118, v127
    v_mov_b32 v119, 0
    s_waitcnt lgkmcnt(0)
    v_mfma_f32_16x16x32_bf16 v[96:99], v[24:27], v[48:51], 0
    v_mfma_f32_16x16x32_bf16 v[80:83], v[64:67], v[48:51], 0
    v_mfma_f32_16x16x32_bf16 v[84:87], v[68:71], v[48:51], 0
    v_mfma_f32_16x16x32_bf16 v[88:91], v[72:75], v[48:51], 0
    v_mfma_f32_16x16x32_bf16 v[92:95], v[76:79], v[48:51], 0
    s_nop 1
    v_mfma_f32_16x16x16_bf16 v[96:99], v[24:25], v[52:53], v[96:99]
    v_mfma_f32_16x16x16_bf16 v[80:83], v[112:113], v[52:53], v[80:83]
    v_mfma_f32_16x16x16_bf16 v[84:87], v[114:115], v[52:53], v[84:87]
    v_mfma_f32_16x16x16_bf16 v[88:91], v[116:117], v[52:53], v[88:91]
    v_mfma_f32_16x16x16_bf16 v[92:95], v[118:119], v[52:53], v[92:95]
    v_rcp_f32 v12, v96
    s_nop 5
    v_mul_f32 v80, v80, v12
    v_mul_f32 v81, v81, v12
    v_mul_f32 v82, v82, v12
    v_mul_f32 v83, v83, v12
    v_mul_f32 v84, v84, v12
    v_mul_f32 v85, v85, v12
    v_mul_f32 v86, v86, v12
    v_mul_f32 v87, v87, v12
    v_mul_f32 v88, v88, v12
    v_mul_f32 v89, v89, v12
    v_mul_f32 v90, v90, v12
    v_mul_f32 v91, v91, v12
    v_mul_f32 v92, v92, v12
    v_mul_f32 v93, v93, v12
    v_mul_f32 v94, v94, v12
    v_mul_f32 v95, v95, v12
    v_cvt_pk_bf16_f32 v100, v80, v81
    v_cvt_pk_bf16_f32 v101, v82, v83
    v_cvt_pk_bf16_f32 v102, v84, v85
    v_cvt_pk_bf16_f32 v103, v86, v87
    v_cvt_pk_bf16_f32 v104, v88, v89
    v_cvt_pk_bf16_f32 v105, v90, v91
    v_cvt_pk_bf16_f32 v106, v92, v93
    v_cvt_pk_bf16_f32 v107, v94, v95
    s_lshl_b32 s52, s19, 11
    v_add_u32 v10, s52, v1
    v_add_u32 v10, 90112, v10
    ds_write_b128 v10, v[100:103]
    ds_write_b128 v10, v[104:107] offset:1024
    s_waitcnt lgkmcnt(0)
    s_barrier
    v_add_u32 v10, 90112, v1
    ds_read_b128 v[48:51], v10 offset:0
    ds_read_b128 v[52:55], v10 offset:1024
    ds_read_b128 v[56:59], v10 offset:2048
    ds_read_b128 v[60:63], v10 offset:3072
    ds_read_b128 v[64:67], v10 offset:4096
    ds_read_b128 v[68:71], v10 offset:5120
    ds_read_b128 v[72:75], v10 offset:6144
    ds_read_b128 v[76:79], v10 offset:7168
    s_waitcnt lgkmcnt(0)
    s_add_u32 s32, s26, 0x0
    s_addc_u32 s33, s27, 0
    v_mfma_f32_16x16x32_bf16 v[80:83], a[128:131], v[48:51], 0
    v_mfma_f32_16x16x32_bf16 v[84:87], a[128:131], v[64:67], 0
    v_mfma_f32_16x16x32_bf16 v[80:83], a[132:135], v[52:55], v[80:83]
    v_mfma_f32_16x16x32_bf16 v[84:87], a[132:135], v[68:71], v[84:87]
    v_mfma_f32_16x16x32_bf16 v[80:83], a[136:139], v[56:59], v[80:83]
    v_mfma_f32_16x16x32_bf16 v[84:87], a[136:139], v[72:75], v[84:87]
    v_mfma_f32_16x16x32_bf16 v[80:83], a[140:143], v[60:63], v[80:83]
    v_mfma_f32_16x16x32_bf16 v[84:87], a[140:143], v[76:79], v[84:87]
    v_mfma_f32_16x16x32_bf16 v[88:91], a[144:147], v[48:51], 0
    v_mfma_f32_16x16x32_bf16 v[92:95], a[144:147], v[64:67], 0
    v_mfma_f32_16x16x32_bf16 v[88:91], a[148:151], v[52:55], v[88:91]
    v_mfma_f32_16x16x32_bf16 v[92:95], a[148:151], v[68:71], v[92:95]
    v_mfma_f32_16x16x32_bf16 v[88:91], a[152:155], v[56:59], v[88:91]
    v_mfma_f32_16x16x32_bf16 v[92:95], a[152:155], v[72:75], v[92:95]
    v_mfma_f32_16x16x32_bf16 v[88:91], a[156:159], v[60:63], v[88:91]
    v_mfma_f32_16x16x32_bf16 v[92:95], a[156:159], v[76:79], v[92:95]
    v_cvt_pk_bf16_f32 v96, v80, v81
    v_cvt_pk_bf16_f32 v97, v82, v83
    v_cvt_pk_bf16_f32 v98, v84, v85
    v_cvt_pk_bf16_f32 v99, v86, v87
    v_and_or_b32 v96, v96, -2, s28
    global_store_dwordx4 v4, v[96:99], s[32:33] sc1
    s_add_u32 s32, s32, 0x8000
    s_addc_u32 s33, s33, 0
    v_mfma_f32_16x16x32_bf16 v[80:83], a[160:163], v[48:51], 0
    v_mfma_f32_16x16x32_bf16 v[84:87], a[160:163], v[64:67], 0
    v_mfma_f32_16x16x32_bf16 v[80:83], a[164:167], v[52:55], v[80:83]
    v_mfma_f32_16x16x32_bf16 v[84:87], a[164:167], v[68:71], v[84:87]
    v_mfma_f32_16x16x32_bf16 v[80:83], a[168:171], v[56:59], v[80:83]
    v_mfma_f32_16x16x32_bf16 v[84:87], a[168:171], v[72:75], v[84:87]
    v_mfma_f32_16x16x32_bf16 v[80:83], a[172:175], v[60:63], v[80:83]
    v_mfma_f32_16x16x32_bf16 v[84:87], a[172:175], v[76:79], v[84:87]
    v_cvt_pk_bf16_f32 v100, v88, v89
    v_cvt_pk_bf16_f32 v101, v90, v91
    v_cvt_pk_bf16_f32 v102, v92, v93
    v_cvt_pk_bf16_f32 v103, v94, v95
    v_and_or_b32 v100, v100, -2, s28
    global_store_dwordx4 v4, v[100:103], s[32:33] sc1
    s_add_u32 s32, s32, 0x8000
    s_addc_u32 s33, s33, 0
    v_mfma_f32_16x16x32_bf16 v[88:91], a[176:179], v[48:51], 0
    v_mfma_f32_16x16x32_bf16 v[92:95], a[176:179], v[64:67], 0
    v_mfma_f32_16x16x32_bf16 v[88:91], a[180:183], v[52:55], v[88:91]
    v_mfma_f32_16x16x32_bf16 v[92:95], a[180:183], v[68:71], v[92:95]
    v_mfma_f32_16x16x32_bf16 v[88:91], a[184:187], v[56:59], v[88:91]
    v_mfma_f32_16x16x32_bf16 v[92:95], a[184:187], v[72:75], v[92:95]
    v_mfma_f32_16x16x32_bf16 v[88:91], a[188:191], v[60:63], v[88:91]
    v_mfma_f32_16x16x32_bf16 v[92:95], a[188:191], v[76:79], v[92:95]
    v_cvt_pk_bf16_f32 v96, v80, v81
    v_cvt_pk_bf16_f32 v97, v82, v83
    v_cvt_pk_bf16_f32 v98, v84, v85
    v_cvt_pk_bf16_f32 v99, v86, v87
    v_and_or_b32 v96, v96, -2, s28
    global_store_dwordx4 v4, v[96:99], s[32:33] sc1
    s_add_u32 s32, s32, 0x8000
    s_addc_u32 s33, s33, 0
    v_mfma_f32_16x16x32_bf16 v[80:83], a[192:195], v[48:51], 0
    v_mfma_f32_16x16x32_bf16 v[84:87], a[192:195], v[64:67], 0
    v_mfma_f32_16x16x32_bf16 v[80:83], a[196:199], v[52:55], v[80:83]
    v_mfma_f32_16x16x32_bf16 v[84:87], a[196:199], v[68:71], v[84:87]
    v_mfma_f32_16x16x32_bf16 v[80:83], a[200:203], v[56:59], v[80:83]
    v_mfma_f32_16x16x32_bf16 v[84:87], a[200:203], v[72:75], v[84:87]
    v_mfma_f32_16x16x32_bf16 v[80:83], a[204:207], v[60:63], v[80:83]
    v_mfma_f32_16x16x32_bf16 v[84:87], a[204:207], v[76:79], v[84:87]
    v_cvt_pk_bf16_f32 v100, v88, v89
    v_cvt_pk_bf16_f32 v101, v90, v91
    v_cvt_pk_bf16_f32 v102, v92, v93
    v_cvt_pk_bf16_f32 v103, v94, v95
    v_and_or_b32 v100, v100, -2, s28
    global_store_dwordx4 v4, v[100:103], s[32:33] sc1
    s_add_u32 s32, s32, 0x8000
    s_addc_u32 s33, s33, 0
    v_mfma_f32_16x16x32_bf16 v[88:91], a[208:211], v[48:51], 0
    v_mfma_f32_16x16x32_bf16 v[92:95], a[208:211], v[64:67], 0
    v_mfma_f32_16x16x32_bf16 v[88:91], a[212:215], v[52:55], v[88:91]
    v_mfma_f32_16x16x32_bf16 v[92:95], a[212:215], v[68:71], v[92:95]
    v_mfma_f32_16x16x32_bf16 v[88:91], a[216:219], v[56:59], v[88:91]
    v_mfma_f32_16x16x32_bf16 v[92:95], a[216:219], v[72:75], v[92:95]
    v_mfma_f32_16x16x32_bf16 v[88:91], a[220:223], v[60:63], v[88:91]
    v_mfma_f32_16x16x32_bf16 v[92:95], a[220:223], v[76:79], v[92:95]
    v_cvt_pk_bf16_f32 v96, v80, v81
    v_cvt_pk_bf16_f32 v97, v82, v83
    v_cvt_pk_bf16_f32 v98, v84, v85
    v_cvt_pk_bf16_f32 v99, v86, v87
    v_and_or_b32 v96, v96, -2, s28
    global_store_dwordx4 v4, v[96:99], s[32:33] sc1
    s_add_u32 s32, s32, 0x8000
    s_addc_u32 s33, s33, 0
    v_mfma_f32_16x16x32_bf16 v[80:83], a[224:227], v[48:51], 0
    v_mfma_f32_16x16x32_bf16 v[84:87], a[224:227], v[64:67], 0
    v_mfma_f32_16x16x32_bf16 v[80:83], a[228:231], v[52:55], v[80:83]
    v_mfma_f32_16x16x32_bf16 v[84:87], a[228:231], v[68:71], v[84:87]
    v_mfma_f32_16x16x32_bf16 v[80:83], a[232:235], v[56:59], v[80:83]
    v_mfma_f32_16x16x32_bf16 v[84:87], a[232:235], v[72:75], v[84:87]
    v_mfma_f32_16x16x32_bf16 v[80:83], a[236:239], v[60:63], v[80:83]
    v_mfma_f32_16x16x32_bf16 v[84:87], a[236:239], v[76:79], v[84:87]
    v_cvt_pk_bf16_f32 v100, v88, v89
    v_cvt_pk_bf16_f32 v101, v90, v91
    v_cvt_pk_bf16_f32 v102, v92, v93
    v_cvt_pk_bf16_f32 v103, v94, v95
    v_and_or_b32 v100, v100, -2, s28
    global_store_dwordx4 v4, v[100:103], s[32:33] sc1
    s_add_u32 s32, s32, 0x8000
    s_addc_u32 s33, s33, 0
    v_mfma_f32_16x16x32_bf16 v[88:91], a[240:243], v[48:51], 0
    v_mfma_f32_16x16x32_bf16 v[92:95], a[240:243], v[64:67], 0
    v_mfma_f32_16x16x32_bf16 v[88:91], a[244:247], v[52:55], v[88:91]
    v_mfma_f32_16x16x32_bf16 v[92:95], a[244:247], v[68:71], v[92:95]
    v_mfma_f32_16x16x32_bf16 v[88:91], a[248:251], v[56:59], v[88:91]
    v_mfma_f32_16x16x32_bf16 v[92:95], a[248:251], v[72:75], v[92:95]
    v_mfma_f32_16x16x32_bf16 v[88:91], a[252:255], v[60:63], v[88:91]
    v_mfma_f32_16x16x32_bf16 v[92:95], a[252:255], v[76:79], v[92:95]
    v_cvt_pk_bf16_f32 v96, v80, v81
    v_cvt_pk_bf16_f32 v97, v82, v83
    v_cvt_pk_bf16_f32 v98, v84, v85
    v_cvt_pk_bf16_f32 v99, v86, v87
    v_and_or_b32 v96, v96, -2, s28
    global_store_dwordx4 v4, v[96:99], s[32:33] sc1
    s_add_u32 s32, s32, 0x8000
    s_addc_u32 s33, s33, 0
    s_nop 7
    v_cvt_pk_bf16_f32 v100, v88, v89
    v_cvt_pk_bf16_f32 v101, v90, v91
    v_cvt_pk_bf16_f32 v102, v92, v93
    v_cvt_pk_bf16_f32 v103, v94, v95
    v_and_or_b32 v100, v100, -2, s28
    global_store_dwordx4 v4, v[100:103], s[32:33] sc1
    s_add_u32 s32, s32, 0x8000
    s_addc_u32 s33, s33, 0
    s_add_u32 s32, s26, 0x0
    s_addc_u32 s33, s27, 0
    s_mov_b32 s29, 0
L_XS_r0:
    v_mov_b32 v10, v5
    global_load_dwordx4 v[48:51], v10, s[32:33] sc1
    v_add_u32 v10, 4096, v10
    global_load_dwordx4 v[52:55], v10, s[32:33] sc1
    v_add_u32 v10, 4096, v10
    global_load_dwordx4 v[56:59], v10, s[32:33] sc1
    v_add_u32 v10, 4096, v10
    global_load_dwordx4 v[60:63], v10, s[32:33] sc1
    v_add_u32 v10, 4096, v10
    global_load_dwordx4 v[64:67], v10, s[32:33] sc1
    v_add_u32 v10, 4096, v10
    global_load_dwordx4 v[68:71], v10, s[32:33] sc1
    v_add_u32 v10, 4096, v10
    global_load_dwordx4 v[72:75], v10, s[32:33] sc1
    v_add_u32 v10, 4096, v10
    global_load_dwordx4 v[76:79], v10, s[32:33] sc1
    s_add_u32 s29, s29, 1
    s_cmp_gt_u32 s29, 400000
    s_cbranch_scc1 L_fail
    s_waitcnt vmcnt(0)
    v_bitop3_b32 v11, v48, v52, s28 bitop3:0x7e
    v_bitop3_b32 v12, v56, v60, s28 bitop3:0x7e
    v_or_b32 v11, v11, v12
    v_bitop3_b32 v12, v64, v68, s28 bitop3:0x7e
    v_or_b32 v11, v11, v12
    v_bitop3_b32 v12, v72, v76, s28 bitop3:0x7e
    v_or_b32 v11, v11, v12
    v_and_b32 v11, 1, v11
    v_cmp_ne_u32 vcc, 0, v11
    s_cbranch_vccnz L_XS_r0
    v_mfma_f32_16x16x32_bf16 v[80:83], v[28:31], v[48:51], 0
    v_mfma_f32_16x16x32_bf16 v[80:83], v[28:31], v[52:55], v[80:83]
    v_mfma_f32_16x16x32_bf16 v[80:83], v[28:31], v[56:59], v[80:83]
    v_mfma_f32_16x16x32_bf16 v[80:83], v[28:31], v[60:63], v[80:83]
    v_mfma_f32_16x16x32_bf16 v[80:83], v[28:31], v[64:67], v[80:83]
    v_mfma_f32_16x16x32_bf16 v[80:83], v[28:31], v[68:71], v[80:83]
    v_mfma_f32_16x16x32_bf16 v[80:83], v[28:31], v[72:75], v[80:83]
    v_mfma_f32_16x16x32_bf16 v[80:83], v[28:31], v[76:79], v[80:83]
    s_nop 7
    v_cvt_pk_bf16_f32 v10, v80, v81
    v_cvt_pk_bf16_f32 v11, v82, v83
    v_lshlrev_b32 v80, 16, v10
    v_and_b32 v81, 0xffff0000, v10
    v_lshlrev_b32 v82, 16, v11
    v_and_b32 v83, 0xffff0000, v11
    v_lshlrev_b32 v10, 16, v44
    v_add_f32 v40, v80, v10
    v_and_b32 v10, 0xffff0000, v44
    v_add_f32 v41, v81, v10
    v_lshlrev_b32 v10, 16, v45
    v_add_f32 v42, v82, v10
    v_and_b32 v10, 0xffff0000, v45
    v_add_f32 v43, v83, v10
    v_cvt_pk_bf16_f32 v10, v40, v41
    v_cvt_pk_bf16_f32 v11, v42, v43
    v_lshlrev_b32 v40, 16, v10
    v_and_b32 v41, 0xffff0000, v10
    v_lshlrev_b32 v42, 16, v11
    v_and_b32 v43, 0xffff0000, v11
    s_add_u32 s32, s26, 0x200000
    s_addc_u32 s33, s27, 0
    s_mov_b64 exec, s[40:41]
    global_store_dwordx2 v7, v[10:11], s[32:33] sc1
    s_mov_b64 exec, -1
    s_waitcnt vmcnt(0)
    s_barrier
    s_lshl_b32 s52, s42, 8
    s_add_u32 s46, s52, 0xa4800
    s_cmp_eq_u32 s19, 0
    s_cbranch_scc0 L_XS_nofl
    s_lshl_b32 s52, s18, 2
    s_add_u32 s52, s52, s46
    s_add_u32 s53, s25, 1
    v_mov_b32 v10, s52
    v_mov_b32 v11, s53
    s_mov_b64 exec, 1
    global_store_dword v10, v11, s[14:15] sc1
    s_mov_b64 exec, -1
L_XS_nofl:
    v_and_b32 v10, 31, v0
    v_lshlrev_b32 v10, 2, v10
    v_add_u32 v10, s46, v10
    s_add_u32 s47, s25, 1
    s_mov_b32 s29, 0
L_XS_hw:
    global_load_dword v11, v10, s[14:15] sc1
    s_add_u32 s29, s29, 1
    s_cmp_gt_u32 s29, 400000
    s_cbranch_scc1 L_fail
    s_waitcnt vmcnt(0)
    v_cmp_gt_u32 vcc, s47, v11
    s_cbranch_vccnz L_XS_hw
    s_add_u32 s34, s26, 0x200000
    s_addc_u32 s35, s27, 0
    s_lshl_b32 s52, s19, 13
    s_add_u32 s52, s52, 0
    s_add_u32 m0, s52, 0
    s_add_u32 s54, s34, s52
    s_addc_u32 s55, s35, 0
    global_load_lds_dwordx4 v1, s[54:55] offset:0 sc1
    global_load_lds_dwordx4 v1, s[54:55] offset:1024 sc1
    global_load_lds_dwordx4 v1, s[54:55] offset:2048 sc1
    global_load_lds_dwordx4 v1, s[54:55] offset:3072 sc1
    s_lshl_b32 s52, s19, 13
    s_add_u32 s52, s52, 4096
    s_add_u32 m0, s52, 0
    s_add_u32 s54, s34, s52
    s_addc_u32 s55, s35, 0
    global_load_lds_dwordx4 v1, s[54:55] offset:0 sc1
    global_load_lds_dwordx4 v1, s[54:55] offset:1024 sc1
    global_load_lds_dwordx4 v1, s[54:55] offset:2048 sc1
    global_load_lds_dwordx4 v1, s[54:55] offset:3072 sc1
    s_waitcnt vmcnt(0)
    s_barrier
    s_cmp_eq_u32 s19, 3
    s_cbranch_scc1 L_XS_stats
    ds_read_b128 v[48:51], v1 offset:0
    ds_read_b128 v[52:55], v1 offset:1024
    ds_read_b128 v[56:59], v1 offset:2048
    ds_read_b128 v[60:63], v1 offset:3072
    s_waitcnt lgkmcnt(3)
    v_mfma_f32_16x16x32_bf16 v[64:67], v[128:131], v[48:51], 0
    v_mfma_f32_16x16x32_bf16 v[72:75], v[192:195], v[48:51], 0
    ds_read_b128 v[48:51], v1 offset:4096
    s_waitcnt lgkmcnt(3)
    v_mfma_f32_16x16x32_bf16 v[64:67], v[132:135], v[52:55], v[64:67]
    v_mfma_f32_16x16x32_bf16 v[72:75], v[196:199], v[52:55], v[72:75]
    ds_read_b128 v[52:55], v1 offset:5120
    s_waitcnt lgkmcnt(3)
    v_mfma_f32_16x16x32_bf16 v[64:67], v[136:139], v[56:59], v[64:67]
    v_mfma_f32_16x16x32_bf16 v[72:75], v[200:203], v[56:59], v[72:75]
    ds_read_b128 v[56:59], v1 offset:6144
    s_waitcnt lgkmcnt(3)
    v_mfma_f32_16x16x32_bf16 v[64:67], v[140:143], v[60:63], v[64:67]
    v_mfma_f32_16x16x32_bf16 v[72:75], v[204:207], v[60:63], v[72:75]
    ds_read_b128 v[60:63], v1 offset:7168
    s_waitcnt lgkmcnt(3)
    v_mfma_f32_16x16x32_bf16 v[64:67], v[144:147], v[48:51], v[64:67]
    v_mfma_f32_16x16x32_bf16 v[72:75], v[208:211], v[48:51], v[72:75]
    ds_read_b128 v[48:51], v1 offset:8192
    s_waitcnt lgkmcnt(3)
    v_mfma_f32_16x16x32_bf16 v[64:67], v[148:151], v[52:55], v[64:67]
    v_mfma_f32_16x16x32_bf16 v[72:75], v[212:215], v[52:55], v[72:75]
    ds_read_b128 v[52:55], v1 offset:9216
    s_waitcnt lgkmcnt(3)
    v_mfma_f32_16x16x32_bf16 v[64:67], v[152:155], v[56:59], v[64:67]
    v_mfma_f32_16x16x32_bf16 v[72:75], v[216:219], v[56:59], v[72:75]
    ds_read_b128 v[56:59], v1 offset:10240
    s_waitcnt lgkmcnt(3)
    v_mfma_f32_16x16x32_bf16 v[64:67], v[156:159], v[60:63], v[64:67]
    v_mfma_f32_16x16x32_bf16 v[72:75], v[220:223], v[60:63], v[72:75]
    ds_read_b128 v[60:63], v1 offset:11264
    s_waitcnt lgkmcnt(3)
    v_mfma_f32_16x16x32_bf16 v[64:67], v[160:163], v[48:51], v[64:67]
    v_mfma_f32_16x16x32_bf16 v[72:75], v[224:227], v[48:51], v[72:75]
    ds_read_b128 v[48:51], v1 offset:12288
    s_waitcnt lgkmcnt(3)
    v_mfma_f32_16x16x32_bf16 v[64:67], v[164:167], v[52:55], v[64:67]
    v_mfma_f32_16x16x32_bf16 v[72:75], v[228:231], v[52:55], v[72:75]
    ds_read_b128 v[52:55], v1 offset:13312
    s_waitcnt lgkmcnt(3)
    v_mfma_f32_16x16x32_bf16 v[64:67], v[168:171], v[56:59], v[64:67]
    v_mfma_f32_16x16x32_bf16 v[72:75], v[232:235], v[56:59], v[72:75]
    ds_read_b128 v[56:59], v1 offset:14336
    s_waitcnt lgkmcnt(3)
    v_mfma_f32_16x16x32_bf16 v[64:67], v[172:175], v[60:63], v[64:67]
    v_mfma_f32_16x16x32_bf16 v[72:75], v[236:239], v[60:63], v[72:75]
    ds_read_b128 v[60:63], v1 offset:15360
    s_waitcnt lgkmcnt(3)
    v_mfma_f32_16x16x32_bf16 v[64:67], v[176:179], v[48:51], v[64:67]
    v_mfma_f32_16x16x32_bf16 v[72:75], v[240:243], v[48:51], v[72:75]
    ds_read_b128 v[48:51], v1 offset:16384
    s_waitcnt lgkmcnt(3)
    v_mfma_f32_16x16x32_bf16 v[64:67], v[180:183], v[52:55], v[64:67]
    v_mfma_f32_16x16x32_bf16 v[72:75], v[244:247], v[52:55], v[72:75]
    ds_read_b128 v[52:55], v1 offset:17408
    s_waitcnt lgkmcnt(3)
    v_mfma_f32_16x16x32_bf16 v[64:67], v[184:187], v[56:59], v[64:67]
    v_mfma_f32_16x16x32_bf16 v[72:75], v[248:251], v[56:59], v[72:75]
    ds_read_b128 v[56:59], v1 offset:18432
    s_waitcnt lgkmcnt(3)
    v_mfma_f32_16x16x32_bf16 v[64:67], v[188:191], v[60:63], v[64:67]
    v_mfma_f32_16x16x32_bf16 v[72:75], v[252:255], v[60:63], v[72:75]
    ds_read_b128 v[60:63], v1 offset:19456
    s_waitcnt lgkmcnt(3)
    v_mfma_f32_16x16x32_bf16 v[68:71], v[128:131], v[48:51], 0
    v_mfma_f32_16x16x32_bf16 v[76:79], v[192:195], v[48:51], 0
    ds_read_b128 v[48:51], v1 offset:20480
    s_waitcnt lgkmcnt(3)
    v_mfma_f32_16x16x32_bf16 v[68:71], v[132:135], v[52:55], v[68:71]
    v_mfma_f32_16x16x32_bf16 v[76:79], v[196:199], v[52:55], v[76:79]
    ds_read_b128 v[52:55], v1 offset:21504
    s_waitcnt lgkmcnt(3)
    v_mfma_f32_16x16x32_bf16 v[68:71], v[136:139], v[56:59], v[68:71]
    v_mfma_f32_16x16x32_bf16 v[76:79], v[200:203], v[56:59], v[76:79]
    ds_read_b128 v[56:59], v1 offset:22528
    s_waitcnt lgkmcnt(3)
    v_mfma_f32_16x16x32_bf16 v[68:71], v[140:143], v[60:63], v[68:71]
    v_mfma_f32_16x16x32_bf16 v[76:79], v[204:207], v[60:63], v[76:79]
    ds_read_b128 v[60:63], v1 offset:23552
    s_waitcnt lgkmcnt(3)
    v_mfma_f32_16x16x32_bf16 v[68:71], v[144:147], v[48:51], v[68:71]
    v_mfma_f32_16x16x32_bf16 v[76:79], v[208:211], v[48:51], v[76:79]
    ds_read_b128 v[48:51], v1 offset:24576
    s_waitcnt lgkmcnt(3)
    v_mfma_f32_16x16x32_bf16 v[68:71], v[148:151], v[52:55], v[68:71]
    v_mfma_f32_16x16x32_bf16 v[76:79], v[212:215], v[52:55], v[76:79]
    ds_read_b128 v[52:55], v1 offset:25600
    s_waitcnt lgkmcnt(3)
    v_mfma_f32_16x16x32_bf16 v[68:71], v[152:155], v[56:59], v[68:71]
    v_mfma_f32_16x16x32_bf16 v[76:79], v[216:219], v[56:59], v[76:79]
    ds_read_b128 v[56:59], v1 offset:26624
    s_waitcnt lgkmcnt(3)
    v_mfma_f32_16x16x32_bf16 v[68:71], v[156:159], v[60:63], v[68:71]
    v_mfma_f32_16x16x32_bf16 v[76:79], v[220:223], v[60:63], v[76:79]
    ds_read_b128 v[60:63], v1 offset:27648
    s_waitcnt lgkmcnt(3)
    v_mfma_f32_16x16x32_bf16 v[68:71], v[160:163], v[48:51], v[68:71]
    v_mfma_f32_16x16x32_bf16 v[76:79], v[224:227], v[48:51], v[76:79]
    ds_read_b128 v[48:51], v1 offset:28672
    s_waitcnt lgkmcnt(3)
    v_mfma_f32_16x16x32_bf16 v[68:71], v[164:167], v[52:55], v[68:71]
    v_mfma_f32_16x16x32_bf16 v[76:79], v[228:231], v[52:55], v[76:79]
    ds_read_b128 v[52:55], v1 offset:29696
    s_waitcnt lgkmcnt(3)
    v_mfma_f32_16x16x32_bf16 v[68:71], v[168:171], v[56:59], v[68:71]
    v_mfma_f32_16x16x32_bf16 v[76:79], v[232:235], v[56:59], v[76:79]
    ds_read_b128 v[56:59], v1 offset:30720
    s_waitcnt lgkmcnt(3)
    v_mfma_f32_16x16x32_bf16 v[68:71], v[172:175], v[60:63], v[68:71]
    v_mfma_f32_16x16x32_bf16 v[76:79], v[236:239], v[60:63], v[76:79]
    ds_read_b128 v[60:63], v1 offset:31744
    s_waitcnt lgkmcnt(3)
    v_mfma_f32_16x16x32_bf16 v[68:71], v[176:179], v[48:51], v[68:71]
    v_mfma_f32_16x16x32_bf16 v[76:79], v[240:243], v[48:51], v[76:79]
    s_waitcnt lgkmcnt(2)
    v_mfma_f32_16x16x32_bf16 v[68:71], v[180:183], v[52:55], v[68:71]
    v_mfma_f32_16x16x32_bf16 v[76:79], v[244:247], v[52:55], v[76:79]
    s_waitcnt lgkmcnt(1)
    v_mfma_f32_16x16x32_bf16 v[68:71], v[184:187], v[56:59], v[68:71]
    v_mfma_f32_16x16x32_bf16 v[76:79], v[248:251], v[56:59], v[76:79]
    s_waitcnt lgkmcnt(0)
    v_mfma_f32_16x16x32_bf16 v[68:71], v[188:191], v[60:63], v[68:71]
    v_mfma_f32_16x16x32_bf16 v[76:79], v[252:255], v[60:63], v[76:79]
    s_branch L_XS_s7j
L_XS_stats:
    ds_read_b128 v[48:51], v1 offset:0
    ds_read_b128 v[52:55], v1 offset:1024
    ds_read_b128 v[56:59], v1 offset:2048
    ds_read_b128 v[60:63], v1 offset:3072
    s_waitcnt lgkmcnt(3)
    v_mfma_f32_16x16x32_bf16 v[64:67], v[24:27], v[48:51], 0
    v_mfma_f32_16x16x32_bf16 v[72:75], v[48:51], v[48:51], 0
    ds_read_b128 v[48:51], v1 offset:4096
    s_waitcnt lgkmcnt(3)
    v_mfma_f32_16x16x32_bf16 v[64:67], v[24:27], v[52:55], v[64:67]
    v_mfma_f32_16x16x32_bf16 v[72:75], v[52:55], v[52:55], v[72:75]
    ds_read_b128 v[52:55], v1 offset:5120
    s_waitcnt lgkmcnt(3)
    v_mfma_f32_16x16x32_bf16 v[64:67], v[24:27], v[56:59], v[64:67]
    v_mfma_f32_16x16x32_bf16 v[72:75], v[56:59], v[56:59], v[72:75]
    ds_read_b128 v[56:59], v1 offset:6144
    s_waitcnt lgkmcnt(3)
    v_mfma_f32_16x16x32_bf16 v[64:67], v[24:27], v[60:63], v[64:67]
    v_mfma_f32_16x16x32_bf16 v[72:75], v[60:63], v[60:63], v[72:75]
    ds_read_b128 v[60:63], v1 offset:7168
    s_waitcnt lgkmcnt(3)
    v_mfma_f32_16x16x32_bf16 v[64:67], v[24:27], v[48:51], v[64:67]
    v_mfma_f32_16x16x32_bf16 v[72:75], v[48:51], v[48:51], v[72:75]
    ds_read_b128 v[48:51], v1 offset:8192
    s_waitcnt lgkmcnt(3)
    v_mfma_f32_16x16x32_bf16 v[64:67], v[24:27], v[52:55], v[64:67]
    v_mfma_f32_16x16x32_bf16 v[72:75], v[52:55], v[52:55], v[72:75]
    ds_read_b128 v[52:55], v1 offset:9216
    s_waitcnt lgkmcnt(3)
    v_mfma_f32_16x16x32_bf16 v[64:67], v[24:27], v[56:59], v[64:67]
    v_mfma_f32_16x16x32_bf16 v[72:75], v[56:59], v[56:59], v[72:75]
    ds_read_b128 v[56:59], v1 offset:10240
    s_waitcnt lgkmcnt(3)
    v_mfma_f32_16x16x32_bf16 v[64:67], v[24:27], v[60:63], v[64:67]
    v_mfma_f32_16x16x32_bf16 v[72:75], v[60:63], v[60:63], v[72:75]
    ds_read_b128 v[60:63], v1 offset:11264
    s_waitcnt lgkmcnt(3)
    v_mfma_f32_16x16x32_bf16 v[64:67], v[24:27], v[48:51], v[64:67]
    v_mfma_f32_16x16x32_bf16 v[72:75], v[48:51], v[48:51], v[72:75]
    ds_read_b128 v[48:51], v1 offset:12288
    s_waitcnt lgkmcnt(3)
    v_mfma_f32_16x16x32_bf16 v[64:67], v[24:27], v[52:55], v[64:67]
    v_mfma_f32_16x16x32_bf16 v[72:75], v[52:55], v[52:55], v[72:75]
    ds_read_b128 v[52:55], v1 offset:13312
    s_waitcnt lgkmcnt(3)
    v_mfma_f32_16x16x32_bf16 v[64:67], v[24:27], v[56:59], v[64:67]
    v_mfma_f32_16x16x32_bf16 v[72:75], v[56:59], v[56:59], v[72:75]
    ds_read_b128 v[56:59], v1 offset:14336
    s_waitcnt lgkmcnt(3)
    v_mfma_f32_16x16x32_bf16 v[64:67], v[24:27], v[60:63], v[64:67]
    v_mfma_f32_16x16x32_bf16 v[72:75], v[60:63], v[60:63], v[72:75]
    ds_read_b128 v[60:63], v1 offset:15360
    s_waitcnt lgkmcnt(3)
    v_mfma_f32_16x16x32_bf16 v[64:67], v[24:27], v[48:51], v[64:67]
    v_mfma_f32_16x16x32_bf16 v[72:75], v[48:51], v[48:51], v[72:75]
    ds_read_b128 v[48:51], v1 offset:16384
    s_waitcnt lgkmcnt(3)
    v_mfma_f32_16x16x32_bf16 v[64:67], v[24:27], v[52:55], v[64:67]
    v_mfma_f32_16x16x32_bf16 v[72:75], v[52:55], v[52:55], v[72:75]
    ds_read_b128 v[52:55], v1 offset:17408
    s_waitcnt lgkmcnt(3)
    v_mfma_f32_16x16x32_bf16 v[64:67], v[24:27], v[56:59], v[64:67]
    v_mfma_f32_16x16x32_bf16 v[72:75], v[56:59], v[56:59], v[72:75]
    ds_read_b128 v[56:59], v1 offset:18432
    s_waitcnt lgkmcnt(3)
    v_mfma_f32_16x16x32_bf16 v[64:67], v[24:27], v[60:63], v[64:67]
    v_mfma_f32_16x16x32_bf16 v[72:75], v[60:63], v[60:63], v[72:75]
    ds_read_b128 v[60:63], v1 offset:19456
    s_waitcnt lgkmcnt(3)
    v_mfma_f32_16x16x32_bf16 v[68:71], v[24:27], v[48:51], 0
    v_mfma_f32_16x16x32_bf16 v[76:79], v[48:51], v[48:51], 0
    ds_read_b128 v[48:51], v1 offset:20480
    s_waitcnt lgkmcnt(3)
    v_mfma_f32_16x16x32_bf16 v[68:71], v[24:27], v[52:55], v[68:71]
    v_mfma_f32_16x16x32_bf16 v[76:79], v[52:55], v[52:55], v[76:79]
    ds_read_b128 v[52:55], v1 offset:21504
    s_waitcnt lgkmcnt(3)
    v_mfma_f32_16x16x32_bf16 v[68:71], v[24:27], v[56:59], v[68:71]
    v_mfma_f32_16x16x32_bf16 v[76:79], v[56:59], v[56:59], v[76:79]
    ds_read_b128 v[56:59], v1 offset:22528
    s_waitcnt lgkmcnt(3)
    v_mfma_f32_16x16x32_bf16 v[68:71], v[24:27], v[60:63], v[68:71]
    v_mfma_f32_16x16x32_bf16 v[76:79], v[60:63], v[60:63], v[76:79]
    ds_read_b128 v[60:63], v1 offset:23552
    s_waitcnt lgkmcnt(3)
    v_mfma_f32_16x16x32_bf16 v[68:71], v[24:27], v[48:51], v[68:71]
    v_mfma_f32_16x16x32_bf16 v[76:79], v[48:51], v[48:51], v[76:79]
    ds_read_b128 v[48:51], v1 offset:24576
    s_waitcnt lgkmcnt(3)
    v_mfma_f32_16x16x32_bf16 v[68:71], v[24:27], v[52:55], v[68:71]
    v_mfma_f32_16x16x32_bf16 v[76:79], v[52:55], v[52:55], v[76:79]
    ds_read_b128 v[52:55], v1 offset:25600
    s_waitcnt lgkmcnt(3)
    v_mfma_f32_16x16x32_bf16 v[68:71], v[24:27], v[56:59], v[68:71]
    v_mfma_f32_16x16x32_bf16 v[76:79], v[56:59], v[56:59], v[76:79]
    ds_read_b128 v[56:59], v1 offset:26624
    s_waitcnt lgkmcnt(3)
    v_mfma_f32_16x16x32_bf16 v[68:71], v[24:27], v[60:63], v[68:71]
    v_mfma_f32_16x16x32_bf16 v[76:79], v[60:63], v[60:63], v[76:79]
    ds_read_b128 v[60:63], v1 offset:27648
    s_waitcnt lgkmcnt(3)
    v_mfma_f32_16x16x32_bf16 v[68:71], v[24:27], v[48:51], v[68:71]
    v_mfma_f32_16x16x32_bf16 v[76:79], v[48:51], v[48:51], v[76:79]
    ds_read_b128 v[48:51], v1 offset:28672
    s_waitcnt lgkmcnt(3)
    v_mfma_f32_16x16x32_bf16 v[68:71], v[24:27], v[52:55], v[68:71]
    v_mfma_f32_16x16x32_bf16 v[76:79], v[52:55], v[52:55], v[76:79]
    ds_read_b128 v[52:55], v1 offset:29696
    s_waitcnt lgkmcnt(3)
    v_mfma_f32_16x16x32_bf16 v[68:71], v[24:27], v[56:59], v[68:71]
    v_mfma_f32_16x16x32_bf16 v[76:79], v[56:59], v[56:59], v[76:79]
    ds_read_b128 v[56:59], v1 offset:30720
    s_waitcnt lgkmcnt(3)
    v_mfma_f32_16x16x32_bf16 v[68:71], v[24:27], v[60:63], v[68:71]
    v_mfma_f32_16x16x32_bf16 v[76:79], v[60:63], v[60:63], v[76:79]
    ds_read_b128 v[60:63], v1 offset:31744
    s_waitcnt lgkmcnt(3)
    v_mfma_f32_16x16x32_bf16 v[68:71], v[24:27], v[48:51], v[68:71]
    v_mfma_f32_16x16x32_bf16 v[76:79], v[48:51], v[48:51], v[76:79]
    s_waitcnt lgkmcnt(2)
    v_mfma_f32_16x16x32_bf16 v[68:71], v[24:27], v[52:55], v[68:71]
    v_mfma_f32_16x16x32_bf16 v[76:79], v[52:55], v[52:55], v[76:79]
    s_waitcnt lgkmcnt(1)
    v_mfma_f32_16x16x32_bf16 v[68:71], v[24:27], v[56:59], v[68:71]
    v_mfma_f32_16x16x32_bf16 v[76:79], v[56:59], v[56:59], v[76:79]
    s_waitcnt lgkmcnt(0)
    v_mfma_f32_16x16x32_bf16 v[68:71], v[24:27], v[60:63], v[68:71]
    v_mfma_f32_16x16x32_bf16 v[76:79], v[60:63], v[60:63], v[76:79]
    s_nop 7
    v_and_b32 v10, 3, v0
    v_bfe_u32 v11, v0, 2, 2
    v_lshrrev_b32 v12, 4, v0
    v_cmp_eq_u32 vcc, 1, v10
    s_nop 1
    v_cndmask_b32 v72, v72, v73, vcc
    v_cmp_eq_u32 vcc, 2, v10
    s_nop 1
    v_cndmask_b32 v72, v72, v74, vcc
    v_cmp_eq_u32 vcc, 3, v10
    s_nop 1
    v_cndmask_b32 v72, v72, v75, vcc
    v_cmp_eq_u32 vcc, v11, v12
    s_nop 1
    v_cndmask_b32 v72, 0, v72, vcc
    v_mov_b32 v73, v72
    s_nop 1
    v_permlane32_swap_b32 v72, v73
    v_add_f32 v72, v72, v73
    v_mov_b32 v73, v72
    s_nop 1
    v_permlane16_swap_b32 v72, v73
    v_add_f32 v72, v72, v73
    v_mul_f32 v64, 0x3b000000, v64
    v_mul_f32 v72, 0x3b000000, v72
    v_fma_f32 v72, -v64, v64, v72
    v_max_f32 v72, 0, v72
    v_add_f32 v72, 0x3727c5ac, v72
    v_rsq_f32 v65, v72
    v_cmp_eq_u32 vcc, 1, v10
    s_nop 1
    v_cndmask_b32 v76, v76, v77, vcc
    v_cmp_eq_u32 vcc, 2, v10
    s_nop 1
    v_cndmask_b32 v76, v76, v78, vcc
    v_cmp_eq_u32 vcc, 3, v10
    s_nop 1
    v_cndmask_b32 v76, v76, v79, vcc
    v_cmp_eq_u32 vcc, v11, v12
    s_nop 1
    v_cndmask_b32 v76, 0, v76, vcc
    v_mov_b32 v77, v76
    s_nop 1
    v_permlane32_swap_b32 v76, v77
    v_add_f32 v76, v76, v77
    v_mov_b32 v77, v76
    s_nop 1
    v_permlane16_swap_b32 v76, v77
    v_add_f32 v76, v76, v77
    v_mul_f32 v68, 0x3b000000, v68
    v_mul_f32 v76, 0x3b000000, v76
    v_fma_f32 v76, -v68, v68, v76
    v_max_f32 v76, 0, v76
    v_add_f32 v76, 0x3727c5ac, v76
    v_rsq_f32 v69, v76
    v_and_b32 v10, 15, v0
    v_lshlrev_b32 v10, 3, v10
    v_add_u32 v10, 101376, v10
    s_mov_b64 exec, 0xffff
    ds_write_b64 v10, v[64:65] offset:0
    ds_write_b64 v10, v[68:69] offset:128
    s_mov_b64 exec, -1
    s_waitcnt lgkmcnt(0)
L_XS_s7j:
    s_barrier
    s_cmp_eq_u32 s19, 3
    s_cbranch_scc1 L_XS_hfdone
    v_and_b32 v10, 15, v0
    v_lshlrev_b32 v10, 3, v10
    v_add_u32 v10, 101376, v10
    ds_read_b64 v[48:49], v10 offset:0
    ds_read_b64 v[50:51], v10 offset:128
    s_waitcnt lgkmcnt(0)
    v_fma_f32 v64, -v48, v32, v64
    v_fma_f32 v72, -v48, v36, v72
    v_mul_f32 v64, v64, v49
    v_mul_f32 v72, v72, v49
    v_mul_f32 v64, v64, v72
    v_fma_f32 v65, -v48, v33, v65
    v_fma_f32 v73, -v48, v37, v73
    v_mul_f32 v65, v65, v49
    v_mul_f32 v73, v73, v49
    v_mul_f32 v65, v65, v73
    v_fma_f32 v66, -v48, v34, v66
    v_fma_f32 v74, -v48, v38, v74
    v_mul_f32 v66, v66, v49
    v_mul_f32 v74, v74, v49
    v_mul_f32 v66, v66, v74
    v_fma_f32 v67, -v48, v35, v67
    v_fma_f32 v75, -v48, v39, v75
    v_mul_f32 v67, v67, v49
    v_mul_f32 v75, v75, v49
    v_mul_f32 v67, v67, v75
    v_cvt_pk_bf16_f32 v56, v64, v65
    v_cvt_pk_bf16_f32 v57, v66, v67
    v_fma_f32 v68, -v50, v32, v68
    v_fma_f32 v76, -v50, v36, v76
    v_mul_f32 v68, v68, v51
    v_mul_f32 v76, v76, v51
    v_mul_f32 v68, v68, v76
    v_fma_f32 v69, -v50, v33, v69
    v_fma_f32 v77, -v50, v37, v77
    v_mul_f32 v69, v69, v51
    v_mul_f32 v77, v77, v51
    v_mul_f32 v69, v69, v77
    v_fma_f32 v70, -v50, v34, v70
    v_fma_f32 v78, -v50, v38, v78
    v_mul_f32 v70, v70, v51
    v_mul_f32 v78, v78, v51
    v_mul_f32 v70, v70, v78
    v_fma_f32 v71, -v50, v35, v71
    v_fma_f32 v79, -v50, v39, v79
    v_mul_f32 v71, v71, v51
    v_mul_f32 v79, v79, v51
    v_mul_f32 v71, v71, v79
    v_cvt_pk_bf16_f32 v58, v68, v69
    v_cvt_pk_bf16_f32 v59, v70, v71
    s_mul_i32 s52, s18, 3
    s_add_u32 s52, s52, s19
    s_cmp_lt_u32 s52, 86
    s_cbranch_scc1 L_XS_hfok
    v_mov_b64 v[56:57], 0
    v_mov_b64 v[58:59], 0
L_XS_hfok:
    s_cmp_eq_u32 s19, 2
    s_cbranch_scc1 L_XS_hf2
    s_lshl_b32 s52, s19, 3
    s_add_u32 s52, s52, 98304
    v_add_u32 v10, s52, v1
    ds_write_b64 v10, v[56:57] offset:0
    ds_write_b64 v10, v[58:59] offset:1024
    s_branch L_XS_hfw
L_XS_hf2:
    v_lshlrev_b32 v10, 3, v0
    v_add_u32 v10, 100352, v10
    ds_write_b64 v10, v[56:57] offset:0
    ds_write_b64 v10, v[58:59] offset:512
L_XS_hfw:
    s_waitcnt lgkmcnt(0)
L_XS_hfdone:
    s_barrier
    v_add_u32 v10, 98304, v1
    ds_read_b128 v[48:51], v10 offset:0
    ds_read_b128 v[52:55], v10 offset:1024
    v_lshlrev_b32 v11, 3, v0
    v_add_u32 v11, 100352, v11
    ds_read_b64 v[56:57], v11 offset:0
    ds_read_b64 v[58:59], v11 offset:512
    s_mul_i32 s52, s19, 12288
    s_add_u32 s52, s52, 122880
    v_lshlrev_b32 v12, 3, v0
    v_add_u32 v12, s52, v12
    s_add_u32 s32, s26, 0x100000
    s_addc_u32 s33, s27, 0
    ds_read_b128 v[60:63], v9 offset:0
    ds_read_b64 v[64:65], v12 offset:0
    s_waitcnt lgkmcnt(0)
    s_nop 0
    v_mfma_f32_16x16x32_bf16 v[80:83], v[60:63], v[48:51], 0
    v_mfma_f32_16x16x32_bf16 v[84:87], v[60:63], v[52:55], 0
    s_nop 4
    v_mfma_f32_16x16x16_bf16 v[80:83], v[64:65], v[56:57], v[80:83]
    v_mfma_f32_16x16x16_bf16 v[84:87], v[64:65], v[58:59], v[84:87]
    ds_read_b128 v[68:71], v9 offset:1024
    ds_read_b64 v[72:73], v12 offset:512
    s_waitcnt lgkmcnt(0)
    s_nop 0
    v_mfma_f32_16x16x32_bf16 v[88:91], v[68:71], v[48:51], 0
    v_mfma_f32_16x16x32_bf16 v[92:95], v[68:71], v[52:55], 0
    s_nop 4
    v_mfma_f32_16x16x16_bf16 v[88:91], v[72:73], v[56:57], v[88:91]
    v_mfma_f32_16x16x16_bf16 v[92:95], v[72:73], v[58:59], v[92:95]
    v_cvt_pk_bf16_f32 v96, v80, v81
    v_cvt_pk_bf16_f32 v97, v82, v83
    v_cvt_pk_bf16_f32 v98, v84, v85
    v_cvt_pk_bf16_f32 v99, v86, v87
    v_and_or_b32 v96, v96, -2, s28
    global_store_dwordx4 v4, v[96:99], s[32:33] sc1
    s_add_u32 s32, s32, 0x8000
    s_addc_u32 s33, s33, 0
    ds_read_b128 v[60:63], v9 offset:2048
    ds_read_b64 v[64:65], v12 offset:1024
    s_waitcnt lgkmcnt(0)
    s_nop 0
    v_mfma_f32_16x16x32_bf16 v[80:83], v[60:63], v[48:51], 0
    v_mfma_f32_16x16x32_bf16 v[84:87], v[60:63], v[52:55], 0
    s_nop 4
    v_mfma_f32_16x16x16_bf16 v[80:83], v[64:65], v[56:57], v[80:83]
    v_mfma_f32_16x16x16_bf16 v[84:87], v[64:65], v[58:59], v[84:87]
    v_cvt_pk_bf16_f32 v100, v88, v89
    v_cvt_pk_bf16_f32 v101, v90, v91
    v_cvt_pk_bf16_f32 v102, v92, v93
    v_cvt_pk_bf16_f32 v103, v94, v95
    v_and_or_b32 v100, v100, -2, s28
    global_store_dwordx4 v4, v[100:103], s[32:33] sc1
    s_add_u32 s32, s32, 0x8000
    s_addc_u32 s33, s33, 0
    ds_read_b128 v[68:71], v9 offset:3072
    ds_read_b64 v[72:73], v12 offset:1536
    s_waitcnt lgkmcnt(0)
    s_nop 0
    v_mfma_f32_16x16x32_bf16 v[88:91], v[68:71], v[48:51], 0
    v_mfma_f32_16x16x32_bf16 v[92:95], v[68:71], v[52:55], 0
    s_nop 4
    v_mfma_f32_16x16x16_bf16 v[88:91], v[72:73], v[56:57], v[88:91]
    v_mfma_f32_16x16x16_bf16 v[92:95], v[72:73], v[58:59], v[92:95]
    v_cvt_pk_bf16_f32 v96, v80, v81
    v_cvt_pk_bf16_f32 v97, v82, v83
    v_cvt_pk_bf16_f32 v98, v84, v85
    v_cvt_pk_bf16_f32 v99, v86, v87
    v_and_or_b32 v96, v96, -2, s28
    global_store_dwordx4 v4, v[96:99], s[32:33] sc1
    s_add_u32 s32, s32, 0x8000
    s_addc_u32 s33, s33, 0
    ds_read_b128 v[60:63], v9 offset:4096
    ds_read_b64 v[64:65], v12 offset:2048
    s_waitcnt lgkmcnt(0)
    s_nop 0
    v_mfma_f32_16x16x32_bf16 v[80:83], v[60:63], v[48:51], 0
    v_mfma_f32_16x16x32_bf16 v[84:87], v[60:63], v[52:55], 0
    s_nop 4
    v_mfma_f32_16x16x16_bf16 v[80:83], v[64:65], v[56:57], v[80:83]
    v_mfma_f32_16x16x16_bf16 v[84:87], v[64:65], v[58:59], v[84:87]
    v_cvt_pk_bf16_f32 v100, v88, v89
    v_cvt_pk_bf16_f32 v101, v90, v91
    v_cvt_pk_bf16_f32 v102, v92, v93
    v_cvt_pk_bf16_f32 v103, v94, v95
    v_and_or_b32 v100, v100, -2, s28
    global_store_dwordx4 v4, v[100:103], s[32:33] sc1
    s_add_u32 s32, s32, 0x8000
    s_addc_u32 s33, s33, 0
    ds_read_b128 v[68:71], v9 offset:5120
    ds_read_b64 v[72:73], v12 offset:2560
    s_waitcnt lgkmcnt(0)
    s_nop 0
    v_mfma_f32_16x16x32_bf16 v[88:91], v[68:71], v[48:51], 0
    v_mfma_f32_16x16x32_bf16 v[92:95], v[68:71], v[52:55], 0
    s_nop 4
    v_mfma_f32_16x16x16_bf16 v[88:91], v[72:73], v[56:57], v[88:91]
    v_mfma_f32_16x16x16_bf16 v[92:95], v[72:73], v[58:59], v[92:95]
    v_cvt_pk_bf16_f32 v96, v80, v81
    v_cvt_pk_bf16_f32 v97, v82, v83
    v_cvt_pk_bf16_f32 v98, v84, v85
    v_cvt_pk_bf16_f32 v99, v86, v87
    v_and_or_b32 v96, v96, -2, s28
    global_store_dwordx4 v4, v[96:99], s[32:33] sc1
    s_add_u32 s32, s32, 0x8000
    s_addc_u32 s33, s33, 0
    ds_read_b128 v[60:63], v9 offset:6144
    ds_read_b64 v[64:65], v12 offset:3072
    s_waitcnt lgkmcnt(0)
    s_nop 0
    v_mfma_f32_16x16x32_bf16 v[80:83], v[60:63], v[48:51], 0
    v_mfma_f32_16x16x32_bf16 v[84:87], v[60:63], v[52:55], 0
    s_nop 4
    v_mfma_f32_16x16x16_bf16 v[80:83], v[64:65], v[56:57], v[80:83]
    v_mfma_f32_16x16x16_bf16 v[84:87], v[64:65], v[58:59], v[84:87]
    v_cvt_pk_bf16_f32 v100, v88, v89
    v_cvt_pk_bf16_f32 v101, v90, v91
    v_cvt_pk_bf16_f32 v102, v92, v93
    v_cvt_pk_bf16_f32 v103, v94, v95
    v_and_or_b32 v100, v100, -2, s28
    global_store_dwordx4 v4, v[100:103], s[32:33] sc1
    s_add_u32 s32, s32, 0x8000
    s_addc_u32 s33, s33, 0
    ds_read_b128 v[68:71], v9 offset:7168
    ds_read_b64 v[72:73], v12 offset:3584
    s_waitcnt lgkmcnt(0)
    s_nop 0
    v_mfma_f32_16x16x32_bf16 v[88:91], v[68:71], v[48:51], 0
    v_mfma_f32_16x16x32_bf16 v[92:95], v[68:71], v[52:55], 0
    s_nop 4
    v_mfma_f32_16x16x16_bf16 v[88:91], v[72:73], v[56:57], v[88:91]
    v_mfma_f32_16x16x16_bf16 v[92:95], v[72:73], v[58:59], v[92:95]
    v_cvt_pk_bf16_f32 v96, v80, v81
    v_cvt_pk_bf16_f32 v97, v82, v83
    v_cvt_pk_bf16_f32 v98, v84, v85
    v_cvt_pk_bf16_f32 v99, v86, v87
    v_and_or_b32 v96, v96, -2, s28
    global_store_dwordx4 v4, v[96:99], s[32:33] sc1
    s_add_u32 s32, s32, 0x8000
    s_addc_u32 s33, s33, 0
    s_nop 7
    v_cvt_pk_bf16_f32 v100, v88, v89
    v_cvt_pk_bf16_f32 v101, v90, v91
    v_cvt_pk_bf16_f32 v102, v92, v93
    v_cvt_pk_bf16_f32 v103, v94, v95
    v_and_or_b32 v100, v100, -2, s28
    global_store_dwordx4 v4, v[100:103], s[32:33] sc1
    s_add_u32 s32, s32, 0x8000
    s_addc_u32 s33, s33, 0
    s_add_u32 s32, s26, 0x100000
    s_addc_u32 s33, s27, 0
    s_mov_b32 s29, 0
L_XS_r1:
    v_mov_b32 v10, v5
    global_load_dwordx4 v[48:51], v10, s[32:33] sc1
    v_add_u32 v10, 4096, v10
    global_load_dwordx4 v[52:55], v10, s[32:33] sc1
    v_add_u32 v10, 4096, v10
    global_load_dwordx4 v[56:59], v10, s[32:33] sc1
    v_add_u32 v10, 4096, v10
    global_load_dwordx4 v[60:63], v10, s[32:33] sc1
    v_add_u32 v10, 4096, v10
    global_load_dwordx4 v[64:67], v10, s[32:33] sc1
    v_add_u32 v10, 4096, v10
    global_load_dwordx4 v[68:71], v10, s[32:33] sc1
    v_add_u32 v10, 4096, v10
    global_load_dwordx4 v[72:75], v10, s[32:33] sc1
    v_add_u32 v10, 4096, v10
    global_load_dwordx4 v[76:79], v10, s[32:33] sc1
    s_add_u32 s29, s29, 1
    s_cmp_gt_u32 s29, 400000
    s_cbranch_scc1 L_fail
    s_waitcnt vmcnt(0)
    v_bitop3_b32 v11, v48, v52, s28 bitop3:0x7e
    v_bitop3_b32 v12, v56, v60, s28 bitop3:0x7e
    v_or_b32 v11, v11, v12
    v_bitop3_b32 v12, v64, v68, s28 bitop3:0x7e
    v_or_b32 v11, v11, v12
    v_bitop3_b32 v12, v72, v76, s28 bitop3:0x7e
    v_or_b32 v11, v11, v12
    v_and_b32 v11, 1, v11
    v_cmp_ne_u32 vcc, 0, v11
    s_cbranch_vccnz L_XS_r1
    v_mfma_f32_16x16x32_bf16 v[80:83], v[28:31], v[48:51], 0
    v_mfma_f32_16x16x32_bf16 v[80:83], v[28:31], v[52:55], v[80:83]
    v_mfma_f32_16x16x32_bf16 v[80:83], v[28:31], v[56:59], v[80:83]
    v_mfma_f32_16x16x32_bf16 v[80:83], v[28:31], v[60:63], v[80:83]
    v_mfma_f32_16x16x32_bf16 v[80:83], v[28:31], v[64:67], v[80:83]
    v_mfma_f32_16x16x32_bf16 v[80:83], v[28:31], v[68:71], v[80:83]
    v_mfma_f32_16x16x32_bf16 v[80:83], v[28:31], v[72:75], v[80:83]
    v_mfma_f32_16x16x32_bf16 v[80:83], v[28:31], v[76:79], v[80:83]
    s_nop 7
    v_cvt_pk_bf16_f32 v10, v80, v81
    v_cvt_pk_bf16_f32 v11, v82, v83
    v_lshlrev_b32 v80, 16, v10
    v_and_b32 v81, 0xffff0000, v10
    v_lshlrev_b32 v82, 16, v11
    v_and_b32 v83, 0xffff0000, v11
    v_add_f32 v80, v80, v40
    v_add_f32 v81, v81, v41
    v_add_f32 v82, v82, v42
    v_add_f32 v83, v83, v43
    v_cvt_pk_bf16_f32 v10, v80, v81
    v_cvt_pk_bf16_f32 v11, v82, v83
    s_lshl_b32 s52, s24, 15
    s_add_u32 s34, s22, s52
    s_addc_u32 s35, s23, 0
    s_mov_b64 exec, s[40:41]
    global_store_dwordx2 v6, v[10:11], s[34:35]
    s_mov_b64 exec, -1
    s_add_u32 s25, s25, 1
    s_add_u32 s24, s24, 6
    s_cmp_lt_u32 s24, 64
    s_cbranch_scc1 L_XS_loop
    s_waitcnt vmcnt(0)
L_x_end:
    s_endpgm
L_fail:
    v_mov_b32 v1, 244
    v_mov_b32 v2, 0xdead
    global_store_dword v1, v2, s[16:17]
    s_endpgm
.section .rodata,"a"
.p2align 6
.amdhsa_kernel sequential_preLN__memory_aug_recurrent_mem_tr__glu_gated_bilinear__prompt_kernel
  .amdhsa_next_free_vgpr 512
  .amdhsa_next_free_sgpr 102
  .amdhsa_accum_offset 256
  .amdhsa_group_segment_fixed_size 0
  .amdhsa_kernarg_size 112
  .amdhsa_user_sgpr_count 2
  .amdhsa_user_sgpr_kernarg_segment_ptr 1
  .amdhsa_system_sgpr_workgroup_id_x 1
.end_amdhsa_kernel
```
